```python
import torch

def _softmax(x, axis=-1):
    return torch.softmax(x, dim=axis)

def _gelu(x):
    return torch.nn.functional.gelu(x, approximate='tanh')

def _silu(x):
    return torch.nn.functional.silu(x)

def _sigmoid(x):
    return torch.sigmoid(x)

def _layernorm(x, axis=-1, eps=1e-05):
    m = x.mean(dim=axis, keepdim=True)
    v = x.var(dim=axis, keepdim=True, unbiased=False)
    return (x - m) / torch.sqrt(v + eps)

def _scatter_add(tgt, idx, src, axis=0):
    return tgt.clone().index_add_(axis, idx, src)

def _segment_sum(src, seg, n):
    out = torch.zeros((n,) + src.shape[1:], dtype=src.dtype)
    return out.index_add_(0, seg, src)

def _pad(x, pw):
    flat = tuple((v for pair in reversed(pw) for v in pair))
    return torch.nn.functional.pad(x, flat)
kernel_name = 'adaLN_cond__memory_aug_recurrent_mem_tr__glu_gated_swiglu__prompt'

def setup_inputs():

    _w = lambda a: (lambda t: t.to(torch.bfloat16) if t.is_floating_point() else t)(torch.as_tensor(a))

    def _A_setup():
        B, S, Dm = (1, 2048, 640)
        H, Dh = (32, 192)
        M, seg = (8, 32)
        seg = min(seg, S)
        S = S // seg * seg
        return {'x': _w((lambda *s: torch.randn(*s, dtype=torch.bfloat16) * 0.05)(B, S, Dm)), 'mem0': _w((lambda *s: torch.randn(*s, dtype=torch.bfloat16) * 0.8)(B, M, Dm)), 'Wq': _w((lambda *s: torch.randn(*s, dtype=torch.bfloat16) * 0.8)(Dm, H, Dh) * Dm ** (-0.5)), 'Wk': _w((lambda *s: torch.randn(*s, dtype=torch.bfloat16) * 0.8)(Dm, H, Dh) * Dm ** (-0.5)), 'Wv': _w((lambda *s: torch.randn(*s, dtype=torch.bfloat16) * 0.8)(Dm, H, Dh) * Dm ** (-0.5)), 'Wo': _w((lambda *s: torch.randn(*s, dtype=torch.bfloat16) * 0.8)(H, Dh, Dm) * (H * Dh) ** (-0.5)), 'seg_len': seg}
    _A_in = _A_setup()

    def _B_setup():
        B, S, D, F = (1, 2048, 640, 1536)
        return {'x': _w((lambda *s: torch.randn(*s, dtype=torch.bfloat16) * 0.05)(B, S, D)), 'w1': _w((lambda *s: torch.randn(*s, dtype=torch.bfloat16) * 0.4)(D, F) * (2.0 / D) ** 0.5), 'w3': _w((lambda *s: torch.randn(*s, dtype=torch.bfloat16) * 0.4)(D, F) * (2.0 / D) ** 0.5), 'w2': _w((lambda *s: torch.randn(*s, dtype=torch.bfloat16) * 0.4)(F, D) * (2.0 / F) ** 0.5)}
    _B_in = _B_setup()
    return {'A_x': _A_in['x'], 'A_mem0': _A_in['mem0'], 'A_Wq': _A_in['Wq'], 'A_Wk': _A_in['Wk'], 'A_Wv': _A_in['Wv'], 'A_Wo': _A_in['Wo'], 'A_seg_len': _A_in['seg_len'], 'B_x': _B_in['x'], 'B_w1': _B_in['w1'], 'B_w3': _B_in['w3'], 'B_w2': _B_in['w2'], 'c': _w((lambda *s: torch.randn(*s, dtype=torch.bfloat16) * 0.1)(1, 640) * 8.0), 'w_mod': _w((lambda *s: torch.randn(*s, dtype=torch.bfloat16) * 0.1)(640, 6 * 640) * 640 ** (-0.5) * 8.0)}

def reference(A_x, A_mem0, A_Wq, A_Wk, A_Wv, A_Wo, A_seg_len, B_x, B_w1, B_w3, B_w2, c, w_mod):

    def _A_ref(x, mem0, Wq, Wk, Wv, Wo, seg_len):
        B, S, Dm = x.shape
        H, Dh = (Wq.shape[1], Wq.shape[2])
        M = mem0.shape[1]
        scale = Dh ** (-0.5)
        n_seg = S // seg_len
        L = M + seg_len
        idx = torch.arange(L)
        mask = (idx[:, None] < M) | (idx[:, None] >= idx[None, :])
        mem = mem0
        outs = []
        for s in range(n_seg):
            xs = x[:, s * seg_len:(s + 1) * seg_len, :].clone()
            h = torch.concatenate([mem, xs], axis=1)
            q = torch.einsum('btd,dhe->bhte', h, Wq)
            k = torch.einsum('btd,dhe->bhte', h, Wk)
            v = torch.einsum('btd,dhe->bhte', h, Wv)
            scores = torch.einsum('bhqe,bhke->bhqk', q, k) * scale
            scores = torch.where(mask[None, None], scores, -1000000000.0)
            p = _softmax(scores, axis=-1)
            o = torch.einsum('bhqk,bhke->bhqe', p, v)
            o = torch.einsum('bhte,hed->btd', o, Wo)
            mem = o[:, :M, :].clone()
            outs.append(o[:, M:, :])
        return torch.concatenate(outs, axis=1)

    def _B_ref(x, w1, w3, w2):
        gate = torch.einsum('bsd,df->bsf', x, w1)
        up = torch.einsum('bsd,df->bsf', x, w3)
        h = _silu(gate) * up
        out = torch.einsum('bsf,fd->bsd', h, w2)
        return out
    x = A_x
    mod = (_silu(c) @ w_mod).reshape(c.shape[0], 6, 1, -1)
    sa, ca, ga, sb, cb, gb = (mod[:, 0].clone(), mod[:, 1].clone(), mod[:, 2].clone(), mod[:, 3].clone(), mod[:, 4].clone(), mod[:, 5].clone())
    h = _layernorm(x, axis=-1) * (1 + ca) + sa
    x = x + ga * _A_ref(h, A_mem0, A_Wq, A_Wk, A_Wv, A_Wo, A_seg_len)
    h = _layernorm(x, axis=-1) * (1 + cb) + sb
    x = x + gb * _B_ref(h, B_w1, B_w3, B_w2)
    return x
```

```asm
; @launch kernel=mod_kernel grid=(286,1,1) block=(256,1,1) lds=12288
; @launch kernel=mega_kernel grid=(256,1,1) block=(256,1,1) lds=98304
.amdgcn_target "amdgcn-amd-amdhsa--gfx950"
.text
.globl mod_kernel
.p2align 8
.type mod_kernel,@function
mod_kernel:
    s_cmp_ge_u32 s2, 30
    s_cbranch_scc1 mod_kernel_fill2
    s_load_dwordx2 s[8:9], s[0:1], 88
    s_waitcnt lgkmcnt(0)
    s_and_b32 s9, s9, 0xffff
    s_mov_b32 s10, 1280
    s_mov_b32 s11, 0x00020000
    s_load_dwordx2 s[12:13], s[0:1], 96
    s_waitcnt lgkmcnt(0)
    s_and_b32 s13, s13, 0xffff
    s_mov_b32 s14, 4915200
    s_mov_b32 s15, 0x00020000
    s_load_dwordx2 s[16:17], s[0:1], 120
    s_waitcnt lgkmcnt(0)
    s_and_b32 s17, s17, 0xffff
    s_mov_b32 s18, 15360
    s_mov_b32 s19, 0x00020000
    v_add_u32 v1, 0, v0
    v_lshlrev_b32 v2, 1, v1
    buffer_load_ushort v3, v2, s[8:11], 0 offen
    s_waitcnt vmcnt(0)
    v_lshlrev_b32 v3, 16, v3
    v_mul_f32 v4, 0xbfb8aa3b, v3
    v_exp_f32 v4, v4
    s_nop 0
    v_add_f32 v4, 1.0, v4
    v_rcp_f32 v4, v4
    s_nop 0
    v_mul_f32 v4, v4, v3
    v_cvt_pk_bf16_f32 v4, v4, v4
    v_and_b32 v4, 0xffff0000, v4
    v_lshlrev_b32 v2, 2, v1
    ds_write_b32 v2, v4
    v_add_u32 v1, 256, v0
    v_lshlrev_b32 v2, 1, v1
    buffer_load_ushort v3, v2, s[8:11], 0 offen
    s_waitcnt vmcnt(0)
    v_lshlrev_b32 v3, 16, v3
    v_mul_f32 v4, 0xbfb8aa3b, v3
    v_exp_f32 v4, v4
    s_nop 0
    v_add_f32 v4, 1.0, v4
    v_rcp_f32 v4, v4
    s_nop 0
    v_mul_f32 v4, v4, v3
    v_cvt_pk_bf16_f32 v4, v4, v4
    v_and_b32 v4, 0xffff0000, v4
    v_lshlrev_b32 v2, 2, v1
    ds_write_b32 v2, v4
    v_add_u32 v1, 512, v0
    v_lshlrev_b32 v2, 1, v1
    buffer_load_ushort v3, v2, s[8:11], 0 offen
    s_waitcnt vmcnt(0)
    v_lshlrev_b32 v3, 16, v3
    v_mul_f32 v4, 0xbfb8aa3b, v3
    v_exp_f32 v4, v4
    s_nop 0
    v_add_f32 v4, 1.0, v4
    v_rcp_f32 v4, v4
    s_nop 0
    v_mul_f32 v4, v4, v3
    v_cvt_pk_bf16_f32 v4, v4, v4
    v_and_b32 v4, 0xffff0000, v4
    v_lshlrev_b32 v2, 2, v1
    ds_write_b32 v2, v4
    s_waitcnt lgkmcnt(0)
    s_barrier
    v_and_b32 v1, 63, v0
    v_lshrrev_b32 v2, 6, v0
    v_and_b32 v3, 15, v1
    v_lshrrev_b32 v4, 4, v1
    v_mul_u32_u24 v5, 160, v2
    v_add_u32 v5, v5, v4
    v_lshlrev_b32 v6, 2, v5
    s_movk_i32 s20, 7680
    v_mul_lo_u32 v5, v5, s20
    v_lshlrev_b32 v3, 4, v3
    v_add_u32 v5, v5, v3
    s_lshl_b32 s21, s2, 8
    v_add_u32 v5, s21, v5
    s_mov_b32 s20, 0
    buffer_load_dwordx4 v[32:35], v5, s[12:15], s20 offen
    s_mov_b32 s20, 30720
    buffer_load_dwordx4 v[36:39], v5, s[12:15], s20 offen
    s_mov_b32 s20, 61440
    buffer_load_dwordx4 v[40:43], v5, s[12:15], s20 offen
    s_mov_b32 s20, 92160
    buffer_load_dwordx4 v[44:47], v5, s[12:15], s20 offen
    s_mov_b32 s20, 122880
    buffer_load_dwordx4 v[48:51], v5, s[12:15], s20 offen
    s_mov_b32 s20, 153600
    buffer_load_dwordx4 v[52:55], v5, s[12:15], s20 offen
    s_mov_b32 s20, 184320
    buffer_load_dwordx4 v[56:59], v5, s[12:15], s20 offen
    s_mov_b32 s20, 215040
    buffer_load_dwordx4 v[60:63], v5, s[12:15], s20 offen
    s_mov_b32 s20, 245760
    buffer_load_dwordx4 v[64:67], v5, s[12:15], s20 offen
    s_mov_b32 s20, 276480
    buffer_load_dwordx4 v[68:71], v5, s[12:15], s20 offen
    s_mov_b32 s20, 307200
    buffer_load_dwordx4 v[72:75], v5, s[12:15], s20 offen
    s_mov_b32 s20, 337920
    buffer_load_dwordx4 v[76:79], v5, s[12:15], s20 offen
    s_mov_b32 s20, 368640
    buffer_load_dwordx4 v[80:83], v5, s[12:15], s20 offen
    s_mov_b32 s20, 399360
    buffer_load_dwordx4 v[84:87], v5, s[12:15], s20 offen
    s_mov_b32 s20, 430080
    buffer_load_dwordx4 v[88:91], v5, s[12:15], s20 offen
    s_mov_b32 s20, 460800
    buffer_load_dwordx4 v[92:95], v5, s[12:15], s20 offen
    s_mov_b32 s20, 491520
    buffer_load_dwordx4 v[96:99], v5, s[12:15], s20 offen
    s_mov_b32 s20, 522240
    buffer_load_dwordx4 v[100:103], v5, s[12:15], s20 offen
    s_mov_b32 s20, 552960
    buffer_load_dwordx4 v[104:107], v5, s[12:15], s20 offen
    s_mov_b32 s20, 583680
    buffer_load_dwordx4 v[108:111], v5, s[12:15], s20 offen
    s_mov_b32 s20, 614400
    buffer_load_dwordx4 v[112:115], v5, s[12:15], s20 offen
    s_mov_b32 s20, 645120
    buffer_load_dwordx4 v[116:119], v5, s[12:15], s20 offen
    s_mov_b32 s20, 675840
    buffer_load_dwordx4 v[120:123], v5, s[12:15], s20 offen
    s_mov_b32 s20, 706560
    buffer_load_dwordx4 v[124:127], v5, s[12:15], s20 offen
    s_mov_b32 s20, 737280
    buffer_load_dwordx4 v[128:131], v5, s[12:15], s20 offen
    s_mov_b32 s20, 768000
    buffer_load_dwordx4 v[132:135], v5, s[12:15], s20 offen
    s_mov_b32 s20, 798720
    buffer_load_dwordx4 v[136:139], v5, s[12:15], s20 offen
    s_mov_b32 s20, 829440
    buffer_load_dwordx4 v[140:143], v5, s[12:15], s20 offen
    s_mov_b32 s20, 860160
    buffer_load_dwordx4 v[144:147], v5, s[12:15], s20 offen
    s_mov_b32 s20, 890880
    buffer_load_dwordx4 v[148:151], v5, s[12:15], s20 offen
    s_mov_b32 s20, 921600
    buffer_load_dwordx4 v[152:155], v5, s[12:15], s20 offen
    s_mov_b32 s20, 952320
    buffer_load_dwordx4 v[156:159], v5, s[12:15], s20 offen
    s_mov_b32 s20, 983040
    buffer_load_dwordx4 v[160:163], v5, s[12:15], s20 offen
    s_mov_b32 s20, 1013760
    buffer_load_dwordx4 v[164:167], v5, s[12:15], s20 offen
    s_mov_b32 s20, 1044480
    buffer_load_dwordx4 v[168:171], v5, s[12:15], s20 offen
    s_mov_b32 s20, 1075200
    buffer_load_dwordx4 v[172:175], v5, s[12:15], s20 offen
    s_mov_b32 s20, 1105920
    buffer_load_dwordx4 v[176:179], v5, s[12:15], s20 offen
    s_mov_b32 s20, 1136640
    buffer_load_dwordx4 v[180:183], v5, s[12:15], s20 offen
    s_mov_b32 s20, 1167360
    buffer_load_dwordx4 v[184:187], v5, s[12:15], s20 offen
    s_mov_b32 s20, 1198080
    buffer_load_dwordx4 v[188:191], v5, s[12:15], s20 offen
    ds_read_b32 v192, v6 offset:0
    ds_read_b32 v193, v6 offset:16
    ds_read_b32 v194, v6 offset:32
    ds_read_b32 v195, v6 offset:48
    ds_read_b32 v196, v6 offset:64
    ds_read_b32 v197, v6 offset:80
    ds_read_b32 v198, v6 offset:96
    ds_read_b32 v199, v6 offset:112
    ds_read_b32 v200, v6 offset:128
    ds_read_b32 v201, v6 offset:144
    ds_read_b32 v202, v6 offset:160
    ds_read_b32 v203, v6 offset:176
    ds_read_b32 v204, v6 offset:192
    ds_read_b32 v205, v6 offset:208
    ds_read_b32 v206, v6 offset:224
    ds_read_b32 v207, v6 offset:240
    ds_read_b32 v208, v6 offset:256
    ds_read_b32 v209, v6 offset:272
    ds_read_b32 v210, v6 offset:288
    ds_read_b32 v211, v6 offset:304
    ds_read_b32 v212, v6 offset:320
    ds_read_b32 v213, v6 offset:336
    ds_read_b32 v214, v6 offset:352
    ds_read_b32 v215, v6 offset:368
    ds_read_b32 v216, v6 offset:384
    ds_read_b32 v217, v6 offset:400
    ds_read_b32 v218, v6 offset:416
    ds_read_b32 v219, v6 offset:432
    ds_read_b32 v220, v6 offset:448
    ds_read_b32 v221, v6 offset:464
    ds_read_b32 v222, v6 offset:480
    ds_read_b32 v223, v6 offset:496
    ds_read_b32 v224, v6 offset:512
    ds_read_b32 v225, v6 offset:528
    ds_read_b32 v226, v6 offset:544
    ds_read_b32 v227, v6 offset:560
    ds_read_b32 v228, v6 offset:576
    ds_read_b32 v229, v6 offset:592
    ds_read_b32 v230, v6 offset:608
    ds_read_b32 v231, v6 offset:624
    v_mov_b32 v8, 0
    v_mov_b32 v9, 0
    v_mov_b32 v10, 0
    v_mov_b32 v11, 0
    v_mov_b32 v12, 0
    v_mov_b32 v13, 0
    v_mov_b32 v14, 0
    v_mov_b32 v15, 0
    s_waitcnt lgkmcnt(0)
    s_waitcnt vmcnt(39)
    v_lshlrev_b32 v16, 16, v32
    v_and_b32 v17, 0xffff0000, v32
    v_fmac_f32 v8, v192, v16
    v_fmac_f32 v9, v192, v17
    v_lshlrev_b32 v16, 16, v33
    v_and_b32 v17, 0xffff0000, v33
    v_fmac_f32 v10, v192, v16
    v_fmac_f32 v11, v192, v17
    v_lshlrev_b32 v16, 16, v34
    v_and_b32 v17, 0xffff0000, v34
    v_fmac_f32 v12, v192, v16
    v_fmac_f32 v13, v192, v17
    v_lshlrev_b32 v16, 16, v35
    v_and_b32 v17, 0xffff0000, v35
    v_fmac_f32 v14, v192, v16
    v_fmac_f32 v15, v192, v17
    s_waitcnt vmcnt(38)
    v_lshlrev_b32 v16, 16, v36
    v_and_b32 v17, 0xffff0000, v36
    v_fmac_f32 v8, v193, v16
    v_fmac_f32 v9, v193, v17
    v_lshlrev_b32 v16, 16, v37
    v_and_b32 v17, 0xffff0000, v37
    v_fmac_f32 v10, v193, v16
    v_fmac_f32 v11, v193, v17
    v_lshlrev_b32 v16, 16, v38
    v_and_b32 v17, 0xffff0000, v38
    v_fmac_f32 v12, v193, v16
    v_fmac_f32 v13, v193, v17
    v_lshlrev_b32 v16, 16, v39
    v_and_b32 v17, 0xffff0000, v39
    v_fmac_f32 v14, v193, v16
    v_fmac_f32 v15, v193, v17
    s_waitcnt vmcnt(37)
    v_lshlrev_b32 v16, 16, v40
    v_and_b32 v17, 0xffff0000, v40
    v_fmac_f32 v8, v194, v16
    v_fmac_f32 v9, v194, v17
    v_lshlrev_b32 v16, 16, v41
    v_and_b32 v17, 0xffff0000, v41
    v_fmac_f32 v10, v194, v16
    v_fmac_f32 v11, v194, v17
    v_lshlrev_b32 v16, 16, v42
    v_and_b32 v17, 0xffff0000, v42
    v_fmac_f32 v12, v194, v16
    v_fmac_f32 v13, v194, v17
    v_lshlrev_b32 v16, 16, v43
    v_and_b32 v17, 0xffff0000, v43
    v_fmac_f32 v14, v194, v16
    v_fmac_f32 v15, v194, v17
    s_waitcnt vmcnt(36)
    v_lshlrev_b32 v16, 16, v44
    v_and_b32 v17, 0xffff0000, v44
    v_fmac_f32 v8, v195, v16
    v_fmac_f32 v9, v195, v17
    v_lshlrev_b32 v16, 16, v45
    v_and_b32 v17, 0xffff0000, v45
    v_fmac_f32 v10, v195, v16
    v_fmac_f32 v11, v195, v17
    v_lshlrev_b32 v16, 16, v46
    v_and_b32 v17, 0xffff0000, v46
    v_fmac_f32 v12, v195, v16
    v_fmac_f32 v13, v195, v17
    v_lshlrev_b32 v16, 16, v47
    v_and_b32 v17, 0xffff0000, v47
    v_fmac_f32 v14, v195, v16
    v_fmac_f32 v15, v195, v17
    s_waitcnt vmcnt(35)
    v_lshlrev_b32 v16, 16, v48
    v_and_b32 v17, 0xffff0000, v48
    v_fmac_f32 v8, v196, v16
    v_fmac_f32 v9, v196, v17
    v_lshlrev_b32 v16, 16, v49
    v_and_b32 v17, 0xffff0000, v49
    v_fmac_f32 v10, v196, v16
    v_fmac_f32 v11, v196, v17
    v_lshlrev_b32 v16, 16, v50
    v_and_b32 v17, 0xffff0000, v50
    v_fmac_f32 v12, v196, v16
    v_fmac_f32 v13, v196, v17
    v_lshlrev_b32 v16, 16, v51
    v_and_b32 v17, 0xffff0000, v51
    v_fmac_f32 v14, v196, v16
    v_fmac_f32 v15, v196, v17
    s_waitcnt vmcnt(34)
    v_lshlrev_b32 v16, 16, v52
    v_and_b32 v17, 0xffff0000, v52
    v_fmac_f32 v8, v197, v16
    v_fmac_f32 v9, v197, v17
    v_lshlrev_b32 v16, 16, v53
    v_and_b32 v17, 0xffff0000, v53
    v_fmac_f32 v10, v197, v16
    v_fmac_f32 v11, v197, v17
    v_lshlrev_b32 v16, 16, v54
    v_and_b32 v17, 0xffff0000, v54
    v_fmac_f32 v12, v197, v16
    v_fmac_f32 v13, v197, v17
    v_lshlrev_b32 v16, 16, v55
    v_and_b32 v17, 0xffff0000, v55
    v_fmac_f32 v14, v197, v16
    v_fmac_f32 v15, v197, v17
    s_waitcnt vmcnt(33)
    v_lshlrev_b32 v16, 16, v56
    v_and_b32 v17, 0xffff0000, v56
    v_fmac_f32 v8, v198, v16
    v_fmac_f32 v9, v198, v17
    v_lshlrev_b32 v16, 16, v57
    v_and_b32 v17, 0xffff0000, v57
    v_fmac_f32 v10, v198, v16
    v_fmac_f32 v11, v198, v17
    v_lshlrev_b32 v16, 16, v58
    v_and_b32 v17, 0xffff0000, v58
    v_fmac_f32 v12, v198, v16
    v_fmac_f32 v13, v198, v17
    v_lshlrev_b32 v16, 16, v59
    v_and_b32 v17, 0xffff0000, v59
    v_fmac_f32 v14, v198, v16
    v_fmac_f32 v15, v198, v17
    s_waitcnt vmcnt(32)
    v_lshlrev_b32 v16, 16, v60
    v_and_b32 v17, 0xffff0000, v60
    v_fmac_f32 v8, v199, v16
    v_fmac_f32 v9, v199, v17
    v_lshlrev_b32 v16, 16, v61
    v_and_b32 v17, 0xffff0000, v61
    v_fmac_f32 v10, v199, v16
    v_fmac_f32 v11, v199, v17
    v_lshlrev_b32 v16, 16, v62
    v_and_b32 v17, 0xffff0000, v62
    v_fmac_f32 v12, v199, v16
    v_fmac_f32 v13, v199, v17
    v_lshlrev_b32 v16, 16, v63
    v_and_b32 v17, 0xffff0000, v63
    v_fmac_f32 v14, v199, v16
    v_fmac_f32 v15, v199, v17
    s_waitcnt vmcnt(31)
    v_lshlrev_b32 v16, 16, v64
    v_and_b32 v17, 0xffff0000, v64
    v_fmac_f32 v8, v200, v16
    v_fmac_f32 v9, v200, v17
    v_lshlrev_b32 v16, 16, v65
    v_and_b32 v17, 0xffff0000, v65
    v_fmac_f32 v10, v200, v16
    v_fmac_f32 v11, v200, v17
    v_lshlrev_b32 v16, 16, v66
    v_and_b32 v17, 0xffff0000, v66
    v_fmac_f32 v12, v200, v16
    v_fmac_f32 v13, v200, v17
    v_lshlrev_b32 v16, 16, v67
    v_and_b32 v17, 0xffff0000, v67
    v_fmac_f32 v14, v200, v16
    v_fmac_f32 v15, v200, v17
    s_waitcnt vmcnt(30)
    v_lshlrev_b32 v16, 16, v68
    v_and_b32 v17, 0xffff0000, v68
    v_fmac_f32 v8, v201, v16
    v_fmac_f32 v9, v201, v17
    v_lshlrev_b32 v16, 16, v69
    v_and_b32 v17, 0xffff0000, v69
    v_fmac_f32 v10, v201, v16
    v_fmac_f32 v11, v201, v17
    v_lshlrev_b32 v16, 16, v70
    v_and_b32 v17, 0xffff0000, v70
    v_fmac_f32 v12, v201, v16
    v_fmac_f32 v13, v201, v17
    v_lshlrev_b32 v16, 16, v71
    v_and_b32 v17, 0xffff0000, v71
    v_fmac_f32 v14, v201, v16
    v_fmac_f32 v15, v201, v17
    s_waitcnt vmcnt(29)
    v_lshlrev_b32 v16, 16, v72
    v_and_b32 v17, 0xffff0000, v72
    v_fmac_f32 v8, v202, v16
    v_fmac_f32 v9, v202, v17
    v_lshlrev_b32 v16, 16, v73
    v_and_b32 v17, 0xffff0000, v73
    v_fmac_f32 v10, v202, v16
    v_fmac_f32 v11, v202, v17
    v_lshlrev_b32 v16, 16, v74
    v_and_b32 v17, 0xffff0000, v74
    v_fmac_f32 v12, v202, v16
    v_fmac_f32 v13, v202, v17
    v_lshlrev_b32 v16, 16, v75
    v_and_b32 v17, 0xffff0000, v75
    v_fmac_f32 v14, v202, v16
    v_fmac_f32 v15, v202, v17
    s_waitcnt vmcnt(28)
    v_lshlrev_b32 v16, 16, v76
    v_and_b32 v17, 0xffff0000, v76
    v_fmac_f32 v8, v203, v16
    v_fmac_f32 v9, v203, v17
    v_lshlrev_b32 v16, 16, v77
    v_and_b32 v17, 0xffff0000, v77
    v_fmac_f32 v10, v203, v16
    v_fmac_f32 v11, v203, v17
    v_lshlrev_b32 v16, 16, v78
    v_and_b32 v17, 0xffff0000, v78
    v_fmac_f32 v12, v203, v16
    v_fmac_f32 v13, v203, v17
    v_lshlrev_b32 v16, 16, v79
    v_and_b32 v17, 0xffff0000, v79
    v_fmac_f32 v14, v203, v16
    v_fmac_f32 v15, v203, v17
    s_waitcnt vmcnt(27)
    v_lshlrev_b32 v16, 16, v80
    v_and_b32 v17, 0xffff0000, v80
    v_fmac_f32 v8, v204, v16
    v_fmac_f32 v9, v204, v17
    v_lshlrev_b32 v16, 16, v81
    v_and_b32 v17, 0xffff0000, v81
    v_fmac_f32 v10, v204, v16
    v_fmac_f32 v11, v204, v17
    v_lshlrev_b32 v16, 16, v82
    v_and_b32 v17, 0xffff0000, v82
    v_fmac_f32 v12, v204, v16
    v_fmac_f32 v13, v204, v17
    v_lshlrev_b32 v16, 16, v83
    v_and_b32 v17, 0xffff0000, v83
    v_fmac_f32 v14, v204, v16
    v_fmac_f32 v15, v204, v17
    s_waitcnt vmcnt(26)
    v_lshlrev_b32 v16, 16, v84
    v_and_b32 v17, 0xffff0000, v84
    v_fmac_f32 v8, v205, v16
    v_fmac_f32 v9, v205, v17
    v_lshlrev_b32 v16, 16, v85
    v_and_b32 v17, 0xffff0000, v85
    v_fmac_f32 v10, v205, v16
    v_fmac_f32 v11, v205, v17
    v_lshlrev_b32 v16, 16, v86
    v_and_b32 v17, 0xffff0000, v86
    v_fmac_f32 v12, v205, v16
    v_fmac_f32 v13, v205, v17
    v_lshlrev_b32 v16, 16, v87
    v_and_b32 v17, 0xffff0000, v87
    v_fmac_f32 v14, v205, v16
    v_fmac_f32 v15, v205, v17
    s_waitcnt vmcnt(25)
    v_lshlrev_b32 v16, 16, v88
    v_and_b32 v17, 0xffff0000, v88
    v_fmac_f32 v8, v206, v16
    v_fmac_f32 v9, v206, v17
    v_lshlrev_b32 v16, 16, v89
    v_and_b32 v17, 0xffff0000, v89
    v_fmac_f32 v10, v206, v16
    v_fmac_f32 v11, v206, v17
    v_lshlrev_b32 v16, 16, v90
    v_and_b32 v17, 0xffff0000, v90
    v_fmac_f32 v12, v206, v16
    v_fmac_f32 v13, v206, v17
    v_lshlrev_b32 v16, 16, v91
    v_and_b32 v17, 0xffff0000, v91
    v_fmac_f32 v14, v206, v16
    v_fmac_f32 v15, v206, v17
    s_waitcnt vmcnt(24)
    v_lshlrev_b32 v16, 16, v92
    v_and_b32 v17, 0xffff0000, v92
    v_fmac_f32 v8, v207, v16
    v_fmac_f32 v9, v207, v17
    v_lshlrev_b32 v16, 16, v93
    v_and_b32 v17, 0xffff0000, v93
    v_fmac_f32 v10, v207, v16
    v_fmac_f32 v11, v207, v17
    v_lshlrev_b32 v16, 16, v94
    v_and_b32 v17, 0xffff0000, v94
    v_fmac_f32 v12, v207, v16
    v_fmac_f32 v13, v207, v17
    v_lshlrev_b32 v16, 16, v95
    v_and_b32 v17, 0xffff0000, v95
    v_fmac_f32 v14, v207, v16
    v_fmac_f32 v15, v207, v17
    s_waitcnt vmcnt(23)
    v_lshlrev_b32 v16, 16, v96
    v_and_b32 v17, 0xffff0000, v96
    v_fmac_f32 v8, v208, v16
    v_fmac_f32 v9, v208, v17
    v_lshlrev_b32 v16, 16, v97
    v_and_b32 v17, 0xffff0000, v97
    v_fmac_f32 v10, v208, v16
    v_fmac_f32 v11, v208, v17
    v_lshlrev_b32 v16, 16, v98
    v_and_b32 v17, 0xffff0000, v98
    v_fmac_f32 v12, v208, v16
    v_fmac_f32 v13, v208, v17
    v_lshlrev_b32 v16, 16, v99
    v_and_b32 v17, 0xffff0000, v99
    v_fmac_f32 v14, v208, v16
    v_fmac_f32 v15, v208, v17
    s_waitcnt vmcnt(22)
    v_lshlrev_b32 v16, 16, v100
    v_and_b32 v17, 0xffff0000, v100
    v_fmac_f32 v8, v209, v16
    v_fmac_f32 v9, v209, v17
    v_lshlrev_b32 v16, 16, v101
    v_and_b32 v17, 0xffff0000, v101
    v_fmac_f32 v10, v209, v16
    v_fmac_f32 v11, v209, v17
    v_lshlrev_b32 v16, 16, v102
    v_and_b32 v17, 0xffff0000, v102
    v_fmac_f32 v12, v209, v16
    v_fmac_f32 v13, v209, v17
    v_lshlrev_b32 v16, 16, v103
    v_and_b32 v17, 0xffff0000, v103
    v_fmac_f32 v14, v209, v16
    v_fmac_f32 v15, v209, v17
    s_waitcnt vmcnt(21)
    v_lshlrev_b32 v16, 16, v104
    v_and_b32 v17, 0xffff0000, v104
    v_fmac_f32 v8, v210, v16
    v_fmac_f32 v9, v210, v17
    v_lshlrev_b32 v16, 16, v105
    v_and_b32 v17, 0xffff0000, v105
    v_fmac_f32 v10, v210, v16
    v_fmac_f32 v11, v210, v17
    v_lshlrev_b32 v16, 16, v106
    v_and_b32 v17, 0xffff0000, v106
    v_fmac_f32 v12, v210, v16
    v_fmac_f32 v13, v210, v17
    v_lshlrev_b32 v16, 16, v107
    v_and_b32 v17, 0xffff0000, v107
    v_fmac_f32 v14, v210, v16
    v_fmac_f32 v15, v210, v17
    s_waitcnt vmcnt(20)
    v_lshlrev_b32 v16, 16, v108
    v_and_b32 v17, 0xffff0000, v108
    v_fmac_f32 v8, v211, v16
    v_fmac_f32 v9, v211, v17
    v_lshlrev_b32 v16, 16, v109
    v_and_b32 v17, 0xffff0000, v109
    v_fmac_f32 v10, v211, v16
    v_fmac_f32 v11, v211, v17
    v_lshlrev_b32 v16, 16, v110
    v_and_b32 v17, 0xffff0000, v110
    v_fmac_f32 v12, v211, v16
    v_fmac_f32 v13, v211, v17
    v_lshlrev_b32 v16, 16, v111
    v_and_b32 v17, 0xffff0000, v111
    v_fmac_f32 v14, v211, v16
    v_fmac_f32 v15, v211, v17
    s_waitcnt vmcnt(19)
    v_lshlrev_b32 v16, 16, v112
    v_and_b32 v17, 0xffff0000, v112
    v_fmac_f32 v8, v212, v16
    v_fmac_f32 v9, v212, v17
    v_lshlrev_b32 v16, 16, v113
    v_and_b32 v17, 0xffff0000, v113
    v_fmac_f32 v10, v212, v16
    v_fmac_f32 v11, v212, v17
    v_lshlrev_b32 v16, 16, v114
    v_and_b32 v17, 0xffff0000, v114
    v_fmac_f32 v12, v212, v16
    v_fmac_f32 v13, v212, v17
    v_lshlrev_b32 v16, 16, v115
    v_and_b32 v17, 0xffff0000, v115
    v_fmac_f32 v14, v212, v16
    v_fmac_f32 v15, v212, v17
    s_waitcnt vmcnt(18)
    v_lshlrev_b32 v16, 16, v116
    v_and_b32 v17, 0xffff0000, v116
    v_fmac_f32 v8, v213, v16
    v_fmac_f32 v9, v213, v17
    v_lshlrev_b32 v16, 16, v117
    v_and_b32 v17, 0xffff0000, v117
    v_fmac_f32 v10, v213, v16
    v_fmac_f32 v11, v213, v17
    v_lshlrev_b32 v16, 16, v118
    v_and_b32 v17, 0xffff0000, v118
    v_fmac_f32 v12, v213, v16
    v_fmac_f32 v13, v213, v17
    v_lshlrev_b32 v16, 16, v119
    v_and_b32 v17, 0xffff0000, v119
    v_fmac_f32 v14, v213, v16
    v_fmac_f32 v15, v213, v17
    s_waitcnt vmcnt(17)
    v_lshlrev_b32 v16, 16, v120
    v_and_b32 v17, 0xffff0000, v120
    v_fmac_f32 v8, v214, v16
    v_fmac_f32 v9, v214, v17
    v_lshlrev_b32 v16, 16, v121
    v_and_b32 v17, 0xffff0000, v121
    v_fmac_f32 v10, v214, v16
    v_fmac_f32 v11, v214, v17
    v_lshlrev_b32 v16, 16, v122
    v_and_b32 v17, 0xffff0000, v122
    v_fmac_f32 v12, v214, v16
    v_fmac_f32 v13, v214, v17
    v_lshlrev_b32 v16, 16, v123
    v_and_b32 v17, 0xffff0000, v123
    v_fmac_f32 v14, v214, v16
    v_fmac_f32 v15, v214, v17
    s_waitcnt vmcnt(16)
    v_lshlrev_b32 v16, 16, v124
    v_and_b32 v17, 0xffff0000, v124
    v_fmac_f32 v8, v215, v16
    v_fmac_f32 v9, v215, v17
    v_lshlrev_b32 v16, 16, v125
    v_and_b32 v17, 0xffff0000, v125
    v_fmac_f32 v10, v215, v16
    v_fmac_f32 v11, v215, v17
    v_lshlrev_b32 v16, 16, v126
    v_and_b32 v17, 0xffff0000, v126
    v_fmac_f32 v12, v215, v16
    v_fmac_f32 v13, v215, v17
    v_lshlrev_b32 v16, 16, v127
    v_and_b32 v17, 0xffff0000, v127
    v_fmac_f32 v14, v215, v16
    v_fmac_f32 v15, v215, v17
    s_waitcnt vmcnt(15)
    v_lshlrev_b32 v16, 16, v128
    v_and_b32 v17, 0xffff0000, v128
    v_fmac_f32 v8, v216, v16
    v_fmac_f32 v9, v216, v17
    v_lshlrev_b32 v16, 16, v129
    v_and_b32 v17, 0xffff0000, v129
    v_fmac_f32 v10, v216, v16
    v_fmac_f32 v11, v216, v17
    v_lshlrev_b32 v16, 16, v130
    v_and_b32 v17, 0xffff0000, v130
    v_fmac_f32 v12, v216, v16
    v_fmac_f32 v13, v216, v17
    v_lshlrev_b32 v16, 16, v131
    v_and_b32 v17, 0xffff0000, v131
    v_fmac_f32 v14, v216, v16
    v_fmac_f32 v15, v216, v17
    s_waitcnt vmcnt(14)
    v_lshlrev_b32 v16, 16, v132
    v_and_b32 v17, 0xffff0000, v132
    v_fmac_f32 v8, v217, v16
    v_fmac_f32 v9, v217, v17
    v_lshlrev_b32 v16, 16, v133
    v_and_b32 v17, 0xffff0000, v133
    v_fmac_f32 v10, v217, v16
    v_fmac_f32 v11, v217, v17
    v_lshlrev_b32 v16, 16, v134
    v_and_b32 v17, 0xffff0000, v134
    v_fmac_f32 v12, v217, v16
    v_fmac_f32 v13, v217, v17
    v_lshlrev_b32 v16, 16, v135
    v_and_b32 v17, 0xffff0000, v135
    v_fmac_f32 v14, v217, v16
    v_fmac_f32 v15, v217, v17
    s_waitcnt vmcnt(13)
    v_lshlrev_b32 v16, 16, v136
    v_and_b32 v17, 0xffff0000, v136
    v_fmac_f32 v8, v218, v16
    v_fmac_f32 v9, v218, v17
    v_lshlrev_b32 v16, 16, v137
    v_and_b32 v17, 0xffff0000, v137
    v_fmac_f32 v10, v218, v16
    v_fmac_f32 v11, v218, v17
    v_lshlrev_b32 v16, 16, v138
    v_and_b32 v17, 0xffff0000, v138
    v_fmac_f32 v12, v218, v16
    v_fmac_f32 v13, v218, v17
    v_lshlrev_b32 v16, 16, v139
    v_and_b32 v17, 0xffff0000, v139
    v_fmac_f32 v14, v218, v16
    v_fmac_f32 v15, v218, v17
    s_waitcnt vmcnt(12)
    v_lshlrev_b32 v16, 16, v140
    v_and_b32 v17, 0xffff0000, v140
    v_fmac_f32 v8, v219, v16
    v_fmac_f32 v9, v219, v17
    v_lshlrev_b32 v16, 16, v141
    v_and_b32 v17, 0xffff0000, v141
    v_fmac_f32 v10, v219, v16
    v_fmac_f32 v11, v219, v17
    v_lshlrev_b32 v16, 16, v142
    v_and_b32 v17, 0xffff0000, v142
    v_fmac_f32 v12, v219, v16
    v_fmac_f32 v13, v219, v17
    v_lshlrev_b32 v16, 16, v143
    v_and_b32 v17, 0xffff0000, v143
    v_fmac_f32 v14, v219, v16
    v_fmac_f32 v15, v219, v17
    s_waitcnt vmcnt(11)
    v_lshlrev_b32 v16, 16, v144
    v_and_b32 v17, 0xffff0000, v144
    v_fmac_f32 v8, v220, v16
    v_fmac_f32 v9, v220, v17
    v_lshlrev_b32 v16, 16, v145
    v_and_b32 v17, 0xffff0000, v145
    v_fmac_f32 v10, v220, v16
    v_fmac_f32 v11, v220, v17
    v_lshlrev_b32 v16, 16, v146
    v_and_b32 v17, 0xffff0000, v146
    v_fmac_f32 v12, v220, v16
    v_fmac_f32 v13, v220, v17
    v_lshlrev_b32 v16, 16, v147
    v_and_b32 v17, 0xffff0000, v147
    v_fmac_f32 v14, v220, v16
    v_fmac_f32 v15, v220, v17
    s_waitcnt vmcnt(10)
    v_lshlrev_b32 v16, 16, v148
    v_and_b32 v17, 0xffff0000, v148
    v_fmac_f32 v8, v221, v16
    v_fmac_f32 v9, v221, v17
    v_lshlrev_b32 v16, 16, v149
    v_and_b32 v17, 0xffff0000, v149
    v_fmac_f32 v10, v221, v16
    v_fmac_f32 v11, v221, v17
    v_lshlrev_b32 v16, 16, v150
    v_and_b32 v17, 0xffff0000, v150
    v_fmac_f32 v12, v221, v16
    v_fmac_f32 v13, v221, v17
    v_lshlrev_b32 v16, 16, v151
    v_and_b32 v17, 0xffff0000, v151
    v_fmac_f32 v14, v221, v16
    v_fmac_f32 v15, v221, v17
    s_waitcnt vmcnt(9)
    v_lshlrev_b32 v16, 16, v152
    v_and_b32 v17, 0xffff0000, v152
    v_fmac_f32 v8, v222, v16
    v_fmac_f32 v9, v222, v17
    v_lshlrev_b32 v16, 16, v153
    v_and_b32 v17, 0xffff0000, v153
    v_fmac_f32 v10, v222, v16
    v_fmac_f32 v11, v222, v17
    v_lshlrev_b32 v16, 16, v154
    v_and_b32 v17, 0xffff0000, v154
    v_fmac_f32 v12, v222, v16
    v_fmac_f32 v13, v222, v17
    v_lshlrev_b32 v16, 16, v155
    v_and_b32 v17, 0xffff0000, v155
    v_fmac_f32 v14, v222, v16
    v_fmac_f32 v15, v222, v17
    s_waitcnt vmcnt(8)
    v_lshlrev_b32 v16, 16, v156
    v_and_b32 v17, 0xffff0000, v156
    v_fmac_f32 v8, v223, v16
    v_fmac_f32 v9, v223, v17
    v_lshlrev_b32 v16, 16, v157
    v_and_b32 v17, 0xffff0000, v157
    v_fmac_f32 v10, v223, v16
    v_fmac_f32 v11, v223, v17
    v_lshlrev_b32 v16, 16, v158
    v_and_b32 v17, 0xffff0000, v158
    v_fmac_f32 v12, v223, v16
    v_fmac_f32 v13, v223, v17
    v_lshlrev_b32 v16, 16, v159
    v_and_b32 v17, 0xffff0000, v159
    v_fmac_f32 v14, v223, v16
    v_fmac_f32 v15, v223, v17
    s_waitcnt vmcnt(7)
    v_lshlrev_b32 v16, 16, v160
    v_and_b32 v17, 0xffff0000, v160
    v_fmac_f32 v8, v224, v16
    v_fmac_f32 v9, v224, v17
    v_lshlrev_b32 v16, 16, v161
    v_and_b32 v17, 0xffff0000, v161
    v_fmac_f32 v10, v224, v16
    v_fmac_f32 v11, v224, v17
    v_lshlrev_b32 v16, 16, v162
    v_and_b32 v17, 0xffff0000, v162
    v_fmac_f32 v12, v224, v16
    v_fmac_f32 v13, v224, v17
    v_lshlrev_b32 v16, 16, v163
    v_and_b32 v17, 0xffff0000, v163
    v_fmac_f32 v14, v224, v16
    v_fmac_f32 v15, v224, v17
    s_waitcnt vmcnt(6)
    v_lshlrev_b32 v16, 16, v164
    v_and_b32 v17, 0xffff0000, v164
    v_fmac_f32 v8, v225, v16
    v_fmac_f32 v9, v225, v17
    v_lshlrev_b32 v16, 16, v165
    v_and_b32 v17, 0xffff0000, v165
    v_fmac_f32 v10, v225, v16
    v_fmac_f32 v11, v225, v17
    v_lshlrev_b32 v16, 16, v166
    v_and_b32 v17, 0xffff0000, v166
    v_fmac_f32 v12, v225, v16
    v_fmac_f32 v13, v225, v17
    v_lshlrev_b32 v16, 16, v167
    v_and_b32 v17, 0xffff0000, v167
    v_fmac_f32 v14, v225, v16
    v_fmac_f32 v15, v225, v17
    s_waitcnt vmcnt(5)
    v_lshlrev_b32 v16, 16, v168
    v_and_b32 v17, 0xffff0000, v168
    v_fmac_f32 v8, v226, v16
    v_fmac_f32 v9, v226, v17
    v_lshlrev_b32 v16, 16, v169
    v_and_b32 v17, 0xffff0000, v169
    v_fmac_f32 v10, v226, v16
    v_fmac_f32 v11, v226, v17
    v_lshlrev_b32 v16, 16, v170
    v_and_b32 v17, 0xffff0000, v170
    v_fmac_f32 v12, v226, v16
    v_fmac_f32 v13, v226, v17
    v_lshlrev_b32 v16, 16, v171
    v_and_b32 v17, 0xffff0000, v171
    v_fmac_f32 v14, v226, v16
    v_fmac_f32 v15, v226, v17
    s_waitcnt vmcnt(4)
    v_lshlrev_b32 v16, 16, v172
    v_and_b32 v17, 0xffff0000, v172
    v_fmac_f32 v8, v227, v16
    v_fmac_f32 v9, v227, v17
    v_lshlrev_b32 v16, 16, v173
    v_and_b32 v17, 0xffff0000, v173
    v_fmac_f32 v10, v227, v16
    v_fmac_f32 v11, v227, v17
    v_lshlrev_b32 v16, 16, v174
    v_and_b32 v17, 0xffff0000, v174
    v_fmac_f32 v12, v227, v16
    v_fmac_f32 v13, v227, v17
    v_lshlrev_b32 v16, 16, v175
    v_and_b32 v17, 0xffff0000, v175
    v_fmac_f32 v14, v227, v16
    v_fmac_f32 v15, v227, v17
    s_waitcnt vmcnt(3)
    v_lshlrev_b32 v16, 16, v176
    v_and_b32 v17, 0xffff0000, v176
    v_fmac_f32 v8, v228, v16
    v_fmac_f32 v9, v228, v17
    v_lshlrev_b32 v16, 16, v177
    v_and_b32 v17, 0xffff0000, v177
    v_fmac_f32 v10, v228, v16
    v_fmac_f32 v11, v228, v17
    v_lshlrev_b32 v16, 16, v178
    v_and_b32 v17, 0xffff0000, v178
    v_fmac_f32 v12, v228, v16
    v_fmac_f32 v13, v228, v17
    v_lshlrev_b32 v16, 16, v179
    v_and_b32 v17, 0xffff0000, v179
    v_fmac_f32 v14, v228, v16
    v_fmac_f32 v15, v228, v17
    s_waitcnt vmcnt(2)
    v_lshlrev_b32 v16, 16, v180
    v_and_b32 v17, 0xffff0000, v180
    v_fmac_f32 v8, v229, v16
    v_fmac_f32 v9, v229, v17
    v_lshlrev_b32 v16, 16, v181
    v_and_b32 v17, 0xffff0000, v181
    v_fmac_f32 v10, v229, v16
    v_fmac_f32 v11, v229, v17
    v_lshlrev_b32 v16, 16, v182
    v_and_b32 v17, 0xffff0000, v182
    v_fmac_f32 v12, v229, v16
    v_fmac_f32 v13, v229, v17
    v_lshlrev_b32 v16, 16, v183
    v_and_b32 v17, 0xffff0000, v183
    v_fmac_f32 v14, v229, v16
    v_fmac_f32 v15, v229, v17
    s_waitcnt vmcnt(1)
    v_lshlrev_b32 v16, 16, v184
    v_and_b32 v17, 0xffff0000, v184
    v_fmac_f32 v8, v230, v16
    v_fmac_f32 v9, v230, v17
    v_lshlrev_b32 v16, 16, v185
    v_and_b32 v17, 0xffff0000, v185
    v_fmac_f32 v10, v230, v16
    v_fmac_f32 v11, v230, v17
    v_lshlrev_b32 v16, 16, v186
    v_and_b32 v17, 0xffff0000, v186
    v_fmac_f32 v12, v230, v16
    v_fmac_f32 v13, v230, v17
    v_lshlrev_b32 v16, 16, v187
    v_and_b32 v17, 0xffff0000, v187
    v_fmac_f32 v14, v230, v16
    v_fmac_f32 v15, v230, v17
    s_waitcnt vmcnt(0)
    v_lshlrev_b32 v16, 16, v188
    v_and_b32 v17, 0xffff0000, v188
    v_fmac_f32 v8, v231, v16
    v_fmac_f32 v9, v231, v17
    v_lshlrev_b32 v16, 16, v189
    v_and_b32 v17, 0xffff0000, v189
    v_fmac_f32 v10, v231, v16
    v_fmac_f32 v11, v231, v17
    v_lshlrev_b32 v16, 16, v190
    v_and_b32 v17, 0xffff0000, v190
    v_fmac_f32 v12, v231, v16
    v_fmac_f32 v13, v231, v17
    v_lshlrev_b32 v16, 16, v191
    v_and_b32 v17, 0xffff0000, v191
    v_fmac_f32 v14, v231, v16
    v_fmac_f32 v15, v231, v17
    v_lshlrev_b32 v1, 5, v0
    ds_write_b128 v1, v[8:11] offset:4096
    ds_write_b128 v1, v[12:15] offset:4112
    s_waitcnt lgkmcnt(0)
    s_barrier
    v_readfirstlane_b32 s22, v0
    s_nop 3
    s_cmp_ge_u32 s22, 128
    s_cbranch_scc1 mod_kernel_done1
    v_lshrrev_b32 v1, 3, v0
    v_and_b32 v2, 7, v0
    v_lshlrev_b32 v1, 5, v1
    v_lshlrev_b32 v2, 2, v2
    v_add_u32 v1, v1, v2
    ds_read_b32 v32, v1 offset:4096
    ds_read_b32 v33, v1 offset:4608
    ds_read_b32 v34, v1 offset:5120
    ds_read_b32 v35, v1 offset:5632
    ds_read_b32 v36, v1 offset:6144
    ds_read_b32 v37, v1 offset:6656
    ds_read_b32 v38, v1 offset:7168
    ds_read_b32 v39, v1 offset:7680
    ds_read_b32 v40, v1 offset:8192
    ds_read_b32 v41, v1 offset:8704
    ds_read_b32 v42, v1 offset:9216
    ds_read_b32 v43, v1 offset:9728
    ds_read_b32 v44, v1 offset:10240
    ds_read_b32 v45, v1 offset:10752
    ds_read_b32 v46, v1 offset:11264
    ds_read_b32 v47, v1 offset:11776
    s_waitcnt lgkmcnt(0)
    v_add_f32 v32, v32, v33
    v_add_f32 v32, v32, v34
    v_add_f32 v32, v32, v35
    v_add_f32 v32, v32, v36
    v_add_f32 v32, v32, v37
    v_add_f32 v32, v32, v38
    v_add_f32 v32, v32, v39
    v_add_f32 v32, v32, v40
    v_add_f32 v32, v32, v41
    v_add_f32 v32, v32, v42
    v_add_f32 v32, v32, v43
    v_add_f32 v32, v32, v44
    v_add_f32 v32, v32, v45
    v_add_f32 v32, v32, v46
    v_add_f32 v32, v32, v47
    v_cvt_pk_bf16_f32 v32, v32, v32
    v_and_b32 v32, 0xffff0000, v32
    s_mul_i32 s23, s2, 52429
    s_lshr_b32 s23, s23, 18
    s_cmp_eq_u32 s23, 1
    s_cbranch_scc1 mod_kernel_add4
    s_cmp_eq_u32 s23, 4
    s_cbranch_scc0 mod_kernel_noadd3
mod_kernel_add4:
    v_add_f32 v32, 1.0, v32
    v_cvt_pk_bf16_f32 v32, v32, v32
    v_and_b32 v32, 0xffff0000, v32
mod_kernel_noadd3:
    s_lshl_b32 s21, s2, 9
    v_lshlrev_b32 v1, 2, v0
    v_add_u32 v1, s21, v1
    buffer_store_dword v32, v1, s[16:19], 0 offen
    s_branch mod_kernel_done1
mod_kernel_fill2:
    s_sub_u32 s3, s2, 30
    s_cmp_ge_u32 s3, 256
    s_cbranch_scc1 mod_kernel_done1
    s_load_dwordx2 s[20:21], s[0:1], 120
    s_waitcnt lgkmcnt(0)
    s_add_u32 s20, s20, 16384
    s_addc_u32 s21, s21, 0
    s_and_b32 s21, s21, 0xffff
    s_mov_b32 s22, 16384
    s_mov_b32 s23, 0x00020000
    s_lshl_b32 s24, s3, 10
    v_lshlrev_b32 v1, 2, v0
    v_add_u32 v1, s24, v1
    v_mov_b32 v4, 0
    v_mov_b32 v5, 0
    v_mov_b32 v6, 0
    v_mov_b32 v7, 0
    buffer_store_dword v4, v1, s[20:23], 0 offen
    s_load_dwordx2 s[20:21], s[0:1], 120
    s_waitcnt lgkmcnt(0)
    s_add_u32 s20, s20, 1458176
    s_addc_u32 s21, s21, 0
    s_and_b32 s21, s21, 0xffff
    s_mov_b32 s22, 5242880
    s_mov_b32 s23, 0x00020000
    s_lshl_b32 s24, s3, 12
    v_lshlrev_b32 v1, 4, v0
    v_add_u32 v1, s24, v1
    s_mov_b32 s25, 0
    buffer_store_dwordx4 v[4:7], v1, s[20:23], s25 offen
    s_mov_b32 s25, 1048576
    buffer_store_dwordx4 v[4:7], v1, s[20:23], s25 offen
    s_mov_b32 s25, 2097152
    buffer_store_dwordx4 v[4:7], v1, s[20:23], s25 offen
    s_mov_b32 s25, 3145728
    buffer_store_dwordx4 v[4:7], v1, s[20:23], s25 offen
    s_mov_b32 s25, 4194304
    buffer_store_dwordx4 v[4:7], v1, s[20:23], s25 offen
    s_load_dwordx2 s[20:21], s[0:1], 120
    s_waitcnt lgkmcnt(0)
    s_add_u32 s20, s20, 84819968
    s_addc_u32 s21, s21, 0
    s_and_b32 s21, s21, 0xffff
    s_mov_b32 s22, 15237120
    s_mov_b32 s23, 0x00020000
    v_mov_b32 v4, -1
    v_mov_b32 v5, -1
    v_mov_b32 v6, -1
    v_mov_b32 v7, -1
    s_mov_b32 s25, 0
    buffer_store_dwordx4 v[4:7], v1, s[20:23], s25 offen
    s_mov_b32 s25, 1048576
    buffer_store_dwordx4 v[4:7], v1, s[20:23], s25 offen
    s_mov_b32 s25, 2097152
    buffer_store_dwordx4 v[4:7], v1, s[20:23], s25 offen
    s_mov_b32 s25, 3145728
    buffer_store_dwordx4 v[4:7], v1, s[20:23], s25 offen
    s_mov_b32 s25, 4194304
    buffer_store_dwordx4 v[4:7], v1, s[20:23], s25 offen
    s_mov_b32 s25, 5242880
    buffer_store_dwordx4 v[4:7], v1, s[20:23], s25 offen
    s_mov_b32 s25, 6291456
    buffer_store_dwordx4 v[4:7], v1, s[20:23], s25 offen
    s_mov_b32 s25, 7340032
    buffer_store_dwordx4 v[4:7], v1, s[20:23], s25 offen
    s_mov_b32 s25, 8388608
    buffer_store_dwordx4 v[4:7], v1, s[20:23], s25 offen
    s_mov_b32 s25, 9437184
    buffer_store_dwordx4 v[4:7], v1, s[20:23], s25 offen
    s_mov_b32 s25, 10485760
    buffer_store_dwordx4 v[4:7], v1, s[20:23], s25 offen
    s_mov_b32 s25, 11534336
    buffer_store_dwordx4 v[4:7], v1, s[20:23], s25 offen
    s_mov_b32 s25, 12582912
    buffer_store_dwordx4 v[4:7], v1, s[20:23], s25 offen
    s_mov_b32 s25, 13631488
    buffer_store_dwordx4 v[4:7], v1, s[20:23], s25 offen
    s_mov_b32 s25, 14680064
    buffer_store_dwordx4 v[4:7], v1, s[20:23], s25 offen
mod_kernel_done1:
    s_endpgm

.text
.globl mega_kernel
.p2align 8
.type mega_kernel,@function
mega_kernel:
    s_cmp_ge_u32 s2, 256
    s_cbranch_scc1 mega_kernel_done1
    s_lshr_b32 s90, s2, 4
    s_lshl_b32 s90, s90, 3
    s_and_b32 s91, s2, 7
    s_or_b32 s90, s90, s91
    s_and_b32 s91, s2, 8
    s_cmp_lg_u32 s91, 0
    s_cbranch_scc1 mega_kernel_worker2
    s_mov_b32 s19, s90
    s_and_b32 s22, s19, 7
    s_lshr_b32 s23, s19, 3
    s_lshr_b32 s20, s23, 2
    s_lshl_b32 s24, s22, 2
    s_add_u32 s20, s20, s24
    s_and_b32 s21, s23, 3
    s_load_dwordx2 s[4:5], s[0:1], 120
    s_waitcnt lgkmcnt(0)
    s_and_b32 s5, s5, 0xffff
    s_mov_b32 s6, 268435456
    s_mov_b32 s7, 0x00020000
    s_load_dwordx2 s[8:9], s[0:1], 112
    s_waitcnt lgkmcnt(0)
    s_and_b32 s9, s9, 0xffff
    s_mov_b32 s10, 256
    s_mov_b32 s11, 0x00020000
    s_load_dwordx2 s[26:27], s[0:1], 16
    s_load_dwordx2 s[28:29], s[0:1], 24
    s_load_dwordx2 s[30:31], s[0:1], 32
    s_load_dwordx2 s[32:33], s[0:1], 40
    s_load_dwordx2 s[12:13], s[0:1], 8
    s_waitcnt lgkmcnt(0)
    s_and_b32 s13, s13, 0xffff
    s_mov_b32 s14, 10240
    s_mov_b32 s15, 0x00020000
    v_and_b32 v1, 63, v0
    v_lshrrev_b32 v2, 6, v0
    v_and_b32 v3, 15, v1
    v_lshrrev_b32 v4, 4, v1
    s_nop 0
    v_readfirstlane_b32 s25, v2
    s_nop 3
    s_mul_i32 s34, s20, 192
    s_mul_i32 s35, s21, 48
    s_add_u32 s34, s34, s35
    v_mul_u32_u24 v5, 160, v2
    v_lshlrev_b32 v6, 3, v4
    v_add_u32 v5, v5, v6
    s_movk_i32 s35, 12288
    v_mul_lo_u32 v5, v5, s35
    v_add_u32 v6, s34, v3
    v_lshlrev_b32 v6, 1, v6
    v_add_u32 v5, v5, v6
    v_add_u32 v6, 0, v5
    global_load_ushort v40, v6, s[26:27]
    v_add_u32 v6, 12288, v6
    global_load_ushort v41, v6, s[26:27]
    v_add_u32 v6, 12288, v6
    global_load_ushort v42, v6, s[26:27]
    v_add_u32 v6, 12288, v6
    global_load_ushort v43, v6, s[26:27]
    v_add_u32 v6, 12288, v6
    global_load_ushort v44, v6, s[26:27]
    v_add_u32 v6, 12288, v6
    global_load_ushort v45, v6, s[26:27]
    v_add_u32 v6, 12288, v6
    global_load_ushort v46, v6, s[26:27]
    v_add_u32 v6, 12288, v6
    global_load_ushort v47, v6, s[26:27]
    v_add_u32 v6, 307200, v6
    global_load_ushort v48, v6, s[26:27]
    v_add_u32 v6, 12288, v6
    global_load_ushort v49, v6, s[26:27]
    v_add_u32 v6, 12288, v6
    global_load_ushort v50, v6, s[26:27]
    v_add_u32 v6, 12288, v6
    global_load_ushort v51, v6, s[26:27]
    v_add_u32 v6, 12288, v6
    global_load_ushort v52, v6, s[26:27]
    v_add_u32 v6, 12288, v6
    global_load_ushort v53, v6, s[26:27]
    v_add_u32 v6, 12288, v6
    global_load_ushort v54, v6, s[26:27]
    v_add_u32 v6, 12288, v6
    global_load_ushort v55, v6, s[26:27]
    v_add_u32 v6, 307200, v6
    global_load_ushort v56, v6, s[26:27]
    v_add_u32 v6, 12288, v6
    global_load_ushort v57, v6, s[26:27]
    v_add_u32 v6, 12288, v6
    global_load_ushort v58, v6, s[26:27]
    v_add_u32 v6, 12288, v6
    global_load_ushort v59, v6, s[26:27]
    v_add_u32 v6, 12288, v6
    global_load_ushort v60, v6, s[26:27]
    v_add_u32 v6, 12288, v6
    global_load_ushort v61, v6, s[26:27]
    v_add_u32 v6, 12288, v6
    global_load_ushort v62, v6, s[26:27]
    v_add_u32 v6, 12288, v6
    global_load_ushort v63, v6, s[26:27]
    v_add_u32 v6, 307200, v6
    global_load_ushort v64, v6, s[26:27]
    v_add_u32 v6, 12288, v6
    global_load_ushort v65, v6, s[26:27]
    v_add_u32 v6, 12288, v6
    global_load_ushort v66, v6, s[26:27]
    v_add_u32 v6, 12288, v6
    global_load_ushort v67, v6, s[26:27]
    v_add_u32 v6, 12288, v6
    global_load_ushort v68, v6, s[26:27]
    v_add_u32 v6, 12288, v6
    global_load_ushort v69, v6, s[26:27]
    v_add_u32 v6, 12288, v6
    global_load_ushort v70, v6, s[26:27]
    v_add_u32 v6, 12288, v6
    global_load_ushort v71, v6, s[26:27]
    v_add_u32 v6, 307200, v6
    global_load_ushort v72, v6, s[26:27]
    v_add_u32 v6, 12288, v6
    global_load_ushort v73, v6, s[26:27]
    v_add_u32 v6, 12288, v6
    global_load_ushort v74, v6, s[26:27]
    v_add_u32 v6, 12288, v6
    global_load_ushort v75, v6, s[26:27]
    v_add_u32 v6, 12288, v6
    global_load_ushort v76, v6, s[26:27]
    v_add_u32 v6, 12288, v6
    global_load_ushort v77, v6, s[26:27]
    v_add_u32 v6, 12288, v6
    global_load_ushort v78, v6, s[26:27]
    v_add_u32 v6, 12288, v6
    global_load_ushort v79, v6, s[26:27]
    v_add_u32 v6, 32, v5
    global_load_ushort v80, v6, s[26:27]
    v_add_u32 v6, 12288, v6
    global_load_ushort v81, v6, s[26:27]
    v_add_u32 v6, 12288, v6
    global_load_ushort v82, v6, s[26:27]
    v_add_u32 v6, 12288, v6
    global_load_ushort v83, v6, s[26:27]
    v_add_u32 v6, 12288, v6
    global_load_ushort v84, v6, s[26:27]
    v_add_u32 v6, 12288, v6
    global_load_ushort v85, v6, s[26:27]
    v_add_u32 v6, 12288, v6
    global_load_ushort v86, v6, s[26:27]
    v_add_u32 v6, 12288, v6
    global_load_ushort v87, v6, s[26:27]
    v_add_u32 v6, 307200, v6
    global_load_ushort v88, v6, s[26:27]
    v_add_u32 v6, 12288, v6
    global_load_ushort v89, v6, s[26:27]
    v_add_u32 v6, 12288, v6
    global_load_ushort v90, v6, s[26:27]
    v_add_u32 v6, 12288, v6
    global_load_ushort v91, v6, s[26:27]
    v_add_u32 v6, 12288, v6
    global_load_ushort v92, v6, s[26:27]
    v_add_u32 v6, 12288, v6
    global_load_ushort v93, v6, s[26:27]
    v_add_u32 v6, 12288, v6
    global_load_ushort v94, v6, s[26:27]
    v_add_u32 v6, 12288, v6
    global_load_ushort v95, v6, s[26:27]
    v_add_u32 v6, 307200, v6
    global_load_ushort v96, v6, s[26:27]
    v_add_u32 v6, 12288, v6
    global_load_ushort v97, v6, s[26:27]
    v_add_u32 v6, 12288, v6
    global_load_ushort v98, v6, s[26:27]
    v_add_u32 v6, 12288, v6
    global_load_ushort v99, v6, s[26:27]
    v_add_u32 v6, 12288, v6
    global_load_ushort v100, v6, s[26:27]
    v_add_u32 v6, 12288, v6
    global_load_ushort v101, v6, s[26:27]
    v_add_u32 v6, 12288, v6
    global_load_ushort v102, v6, s[26:27]
    v_add_u32 v6, 12288, v6
    global_load_ushort v103, v6, s[26:27]
    v_add_u32 v6, 307200, v6
    global_load_ushort v104, v6, s[26:27]
    v_add_u32 v6, 12288, v6
    global_load_ushort v105, v6, s[26:27]
    v_add_u32 v6, 12288, v6
    global_load_ushort v106, v6, s[26:27]
    v_add_u32 v6, 12288, v6
    global_load_ushort v107, v6, s[26:27]
    v_add_u32 v6, 12288, v6
    global_load_ushort v108, v6, s[26:27]
    v_add_u32 v6, 12288, v6
    global_load_ushort v109, v6, s[26:27]
    v_add_u32 v6, 12288, v6
    global_load_ushort v110, v6, s[26:27]
    v_add_u32 v6, 12288, v6
    global_load_ushort v111, v6, s[26:27]
    v_add_u32 v6, 307200, v6
    global_load_ushort v112, v6, s[26:27]
    v_add_u32 v6, 12288, v6
    global_load_ushort v113, v6, s[26:27]
    v_add_u32 v6, 12288, v6
    global_load_ushort v114, v6, s[26:27]
    v_add_u32 v6, 12288, v6
    global_load_ushort v115, v6, s[26:27]
    v_add_u32 v6, 12288, v6
    global_load_ushort v116, v6, s[26:27]
    v_add_u32 v6, 12288, v6
    global_load_ushort v117, v6, s[26:27]
    v_add_u32 v6, 12288, v6
    global_load_ushort v118, v6, s[26:27]
    v_add_u32 v6, 12288, v6
    global_load_ushort v119, v6, s[26:27]
    v_add_u32 v6, 64, v5
    global_load_ushort v120, v6, s[26:27]
    v_add_u32 v6, 12288, v6
    global_load_ushort v121, v6, s[26:27]
    v_add_u32 v6, 12288, v6
    global_load_ushort v122, v6, s[26:27]
    v_add_u32 v6, 12288, v6
    global_load_ushort v123, v6, s[26:27]
    v_add_u32 v6, 12288, v6
    global_load_ushort v124, v6, s[26:27]
    v_add_u32 v6, 12288, v6
    global_load_ushort v125, v6, s[26:27]
    v_add_u32 v6, 12288, v6
    global_load_ushort v126, v6, s[26:27]
    v_add_u32 v6, 12288, v6
    global_load_ushort v127, v6, s[26:27]
    v_add_u32 v6, 307200, v6
    global_load_ushort v128, v6, s[26:27]
    v_add_u32 v6, 12288, v6
    global_load_ushort v129, v6, s[26:27]
    v_add_u32 v6, 12288, v6
    global_load_ushort v130, v6, s[26:27]
    v_add_u32 v6, 12288, v6
    global_load_ushort v131, v6, s[26:27]
    v_add_u32 v6, 12288, v6
    global_load_ushort v132, v6, s[26:27]
    v_add_u32 v6, 12288, v6
    global_load_ushort v133, v6, s[26:27]
    v_add_u32 v6, 12288, v6
    global_load_ushort v134, v6, s[26:27]
    v_add_u32 v6, 12288, v6
    global_load_ushort v135, v6, s[26:27]
    v_add_u32 v6, 307200, v6
    global_load_ushort v136, v6, s[26:27]
    v_add_u32 v6, 12288, v6
    global_load_ushort v137, v6, s[26:27]
    v_add_u32 v6, 12288, v6
    global_load_ushort v138, v6, s[26:27]
    v_add_u32 v6, 12288, v6
    global_load_ushort v139, v6, s[26:27]
    v_add_u32 v6, 12288, v6
    global_load_ushort v140, v6, s[26:27]
    v_add_u32 v6, 12288, v6
    global_load_ushort v141, v6, s[26:27]
    v_add_u32 v6, 12288, v6
    global_load_ushort v142, v6, s[26:27]
    v_add_u32 v6, 12288, v6
    global_load_ushort v143, v6, s[26:27]
    v_add_u32 v6, 307200, v6
    global_load_ushort v144, v6, s[26:27]
    v_add_u32 v6, 12288, v6
    global_load_ushort v145, v6, s[26:27]
    v_add_u32 v6, 12288, v6
    global_load_ushort v146, v6, s[26:27]
    v_add_u32 v6, 12288, v6
    global_load_ushort v147, v6, s[26:27]
    v_add_u32 v6, 12288, v6
    global_load_ushort v148, v6, s[26:27]
    v_add_u32 v6, 12288, v6
    global_load_ushort v149, v6, s[26:27]
    v_add_u32 v6, 12288, v6
    global_load_ushort v150, v6, s[26:27]
    v_add_u32 v6, 12288, v6
    global_load_ushort v151, v6, s[26:27]
    v_add_u32 v6, 307200, v6
    global_load_ushort v152, v6, s[26:27]
    v_add_u32 v6, 12288, v6
    global_load_ushort v153, v6, s[26:27]
    v_add_u32 v6, 12288, v6
    global_load_ushort v154, v6, s[26:27]
    v_add_u32 v6, 12288, v6
    global_load_ushort v155, v6, s[26:27]
    v_add_u32 v6, 12288, v6
    global_load_ushort v156, v6, s[26:27]
    v_add_u32 v6, 12288, v6
    global_load_ushort v157, v6, s[26:27]
    v_add_u32 v6, 12288, v6
    global_load_ushort v158, v6, s[26:27]
    v_add_u32 v6, 12288, v6
    global_load_ushort v159, v6, s[26:27]
    v_add_u32 v6, 0, v5
    global_load_ushort v160, v6, s[28:29]
    v_add_u32 v6, 12288, v6
    global_load_ushort v161, v6, s[28:29]
    v_add_u32 v6, 12288, v6
    global_load_ushort v162, v6, s[28:29]
    v_add_u32 v6, 12288, v6
    global_load_ushort v163, v6, s[28:29]
    v_add_u32 v6, 12288, v6
    global_load_ushort v164, v6, s[28:29]
    v_add_u32 v6, 12288, v6
    global_load_ushort v165, v6, s[28:29]
    v_add_u32 v6, 12288, v6
    global_load_ushort v166, v6, s[28:29]
    v_add_u32 v6, 12288, v6
    global_load_ushort v167, v6, s[28:29]
    v_add_u32 v6, 307200, v6
    global_load_ushort v168, v6, s[28:29]
    v_add_u32 v6, 12288, v6
    global_load_ushort v169, v6, s[28:29]
    v_add_u32 v6, 12288, v6
    global_load_ushort v170, v6, s[28:29]
    v_add_u32 v6, 12288, v6
    global_load_ushort v171, v6, s[28:29]
    v_add_u32 v6, 12288, v6
    global_load_ushort v172, v6, s[28:29]
    v_add_u32 v6, 12288, v6
    global_load_ushort v173, v6, s[28:29]
    v_add_u32 v6, 12288, v6
    global_load_ushort v174, v6, s[28:29]
    v_add_u32 v6, 12288, v6
    global_load_ushort v175, v6, s[28:29]
    v_add_u32 v6, 307200, v6
    global_load_ushort v176, v6, s[28:29]
    v_add_u32 v6, 12288, v6
    global_load_ushort v177, v6, s[28:29]
    v_add_u32 v6, 12288, v6
    global_load_ushort v178, v6, s[28:29]
    v_add_u32 v6, 12288, v6
    global_load_ushort v179, v6, s[28:29]
    v_add_u32 v6, 12288, v6
    global_load_ushort v180, v6, s[28:29]
    v_add_u32 v6, 12288, v6
    global_load_ushort v181, v6, s[28:29]
    v_add_u32 v6, 12288, v6
    global_load_ushort v182, v6, s[28:29]
    v_add_u32 v6, 12288, v6
    global_load_ushort v183, v6, s[28:29]
    v_add_u32 v6, 307200, v6
    global_load_ushort v184, v6, s[28:29]
    v_add_u32 v6, 12288, v6
    global_load_ushort v185, v6, s[28:29]
    v_add_u32 v6, 12288, v6
    global_load_ushort v186, v6, s[28:29]
    v_add_u32 v6, 12288, v6
    global_load_ushort v187, v6, s[28:29]
    v_add_u32 v6, 12288, v6
    global_load_ushort v188, v6, s[28:29]
    v_add_u32 v6, 12288, v6
    global_load_ushort v189, v6, s[28:29]
    v_add_u32 v6, 12288, v6
    global_load_ushort v190, v6, s[28:29]
    v_add_u32 v6, 12288, v6
    global_load_ushort v191, v6, s[28:29]
    v_add_u32 v6, 307200, v6
    global_load_ushort v192, v6, s[28:29]
    v_add_u32 v6, 12288, v6
    global_load_ushort v193, v6, s[28:29]
    v_add_u32 v6, 12288, v6
    global_load_ushort v194, v6, s[28:29]
    v_add_u32 v6, 12288, v6
    global_load_ushort v195, v6, s[28:29]
    v_add_u32 v6, 12288, v6
    global_load_ushort v196, v6, s[28:29]
    v_add_u32 v6, 12288, v6
    global_load_ushort v197, v6, s[28:29]
    v_add_u32 v6, 12288, v6
    global_load_ushort v198, v6, s[28:29]
    v_add_u32 v6, 12288, v6
    global_load_ushort v199, v6, s[28:29]
    v_add_u32 v6, 32, v5
    global_load_ushort v200, v6, s[28:29]
    v_add_u32 v6, 12288, v6
    global_load_ushort v201, v6, s[28:29]
    v_add_u32 v6, 12288, v6
    global_load_ushort v202, v6, s[28:29]
    v_add_u32 v6, 12288, v6
    global_load_ushort v203, v6, s[28:29]
    v_add_u32 v6, 12288, v6
    global_load_ushort v204, v6, s[28:29]
    v_add_u32 v6, 12288, v6
    global_load_ushort v205, v6, s[28:29]
    v_add_u32 v6, 12288, v6
    global_load_ushort v206, v6, s[28:29]
    v_add_u32 v6, 12288, v6
    global_load_ushort v207, v6, s[28:29]
    v_add_u32 v6, 307200, v6
    global_load_ushort v208, v6, s[28:29]
    v_add_u32 v6, 12288, v6
    global_load_ushort v209, v6, s[28:29]
    v_add_u32 v6, 12288, v6
    global_load_ushort v210, v6, s[28:29]
    v_add_u32 v6, 12288, v6
    global_load_ushort v211, v6, s[28:29]
    v_add_u32 v6, 12288, v6
    global_load_ushort v212, v6, s[28:29]
    v_add_u32 v6, 12288, v6
    global_load_ushort v213, v6, s[28:29]
    v_add_u32 v6, 12288, v6
    global_load_ushort v214, v6, s[28:29]
    v_add_u32 v6, 12288, v6
    global_load_ushort v215, v6, s[28:29]
    v_add_u32 v6, 307200, v6
    global_load_ushort v216, v6, s[28:29]
    v_add_u32 v6, 12288, v6
    global_load_ushort v217, v6, s[28:29]
    v_add_u32 v6, 12288, v6
    global_load_ushort v218, v6, s[28:29]
    v_add_u32 v6, 12288, v6
    global_load_ushort v219, v6, s[28:29]
    v_add_u32 v6, 12288, v6
    global_load_ushort v220, v6, s[28:29]
    v_add_u32 v6, 12288, v6
    global_load_ushort v221, v6, s[28:29]
    v_add_u32 v6, 12288, v6
    global_load_ushort v222, v6, s[28:29]
    v_add_u32 v6, 12288, v6
    global_load_ushort v223, v6, s[28:29]
    v_add_u32 v6, 307200, v6
    global_load_ushort v224, v6, s[28:29]
    v_add_u32 v6, 12288, v6
    global_load_ushort v225, v6, s[28:29]
    v_add_u32 v6, 12288, v6
    global_load_ushort v226, v6, s[28:29]
    v_add_u32 v6, 12288, v6
    global_load_ushort v227, v6, s[28:29]
    v_add_u32 v6, 12288, v6
    global_load_ushort v228, v6, s[28:29]
    v_add_u32 v6, 12288, v6
    global_load_ushort v229, v6, s[28:29]
    v_add_u32 v6, 12288, v6
    global_load_ushort v230, v6, s[28:29]
    v_add_u32 v6, 12288, v6
    global_load_ushort v231, v6, s[28:29]
    v_add_u32 v6, 307200, v6
    global_load_ushort v232, v6, s[28:29]
    v_add_u32 v6, 12288, v6
    global_load_ushort v233, v6, s[28:29]
    v_add_u32 v6, 12288, v6
    global_load_ushort v234, v6, s[28:29]
    v_add_u32 v6, 12288, v6
    global_load_ushort v235, v6, s[28:29]
    v_add_u32 v6, 12288, v6
    global_load_ushort v236, v6, s[28:29]
    v_add_u32 v6, 12288, v6
    global_load_ushort v237, v6, s[28:29]
    v_add_u32 v6, 12288, v6
    global_load_ushort v238, v6, s[28:29]
    v_add_u32 v6, 12288, v6
    global_load_ushort v239, v6, s[28:29]
    s_waitcnt vmcnt(63)
    v_lshl_or_b32 v40, v41, 16, v40
    v_accvgpr_write_b32 a0, v40
    v_lshl_or_b32 v42, v43, 16, v42
    v_accvgpr_write_b32 a1, v42
    v_lshl_or_b32 v44, v45, 16, v44
    v_accvgpr_write_b32 a2, v44
    v_lshl_or_b32 v46, v47, 16, v46
    v_accvgpr_write_b32 a3, v46
    v_lshl_or_b32 v48, v49, 16, v48
    v_accvgpr_write_b32 a36, v48
    v_lshl_or_b32 v50, v51, 16, v50
    v_accvgpr_write_b32 a37, v50
    v_lshl_or_b32 v52, v53, 16, v52
    v_accvgpr_write_b32 a38, v52
    v_lshl_or_b32 v54, v55, 16, v54
    v_accvgpr_write_b32 a39, v54
    v_lshl_or_b32 v56, v57, 16, v56
    v_accvgpr_write_b32 a72, v56
    v_lshl_or_b32 v58, v59, 16, v58
    v_accvgpr_write_b32 a73, v58
    v_lshl_or_b32 v60, v61, 16, v60
    v_accvgpr_write_b32 a74, v60
    v_lshl_or_b32 v62, v63, 16, v62
    v_accvgpr_write_b32 a75, v62
    v_lshl_or_b32 v64, v65, 16, v64
    v_accvgpr_write_b32 a108, v64
    v_lshl_or_b32 v66, v67, 16, v66
    v_accvgpr_write_b32 a109, v66
    v_lshl_or_b32 v68, v69, 16, v68
    v_accvgpr_write_b32 a110, v68
    v_lshl_or_b32 v70, v71, 16, v70
    v_accvgpr_write_b32 a111, v70
    v_lshl_or_b32 v72, v73, 16, v72
    v_accvgpr_write_b32 a144, v72
    v_lshl_or_b32 v74, v75, 16, v74
    v_accvgpr_write_b32 a145, v74
    v_lshl_or_b32 v76, v77, 16, v76
    v_accvgpr_write_b32 a146, v76
    v_lshl_or_b32 v78, v79, 16, v78
    v_accvgpr_write_b32 a147, v78
    s_waitcnt vmcnt(63)
    v_lshl_or_b32 v80, v81, 16, v80
    v_accvgpr_write_b32 a4, v80
    v_lshl_or_b32 v82, v83, 16, v82
    v_accvgpr_write_b32 a5, v82
    v_lshl_or_b32 v84, v85, 16, v84
    v_accvgpr_write_b32 a6, v84
    v_lshl_or_b32 v86, v87, 16, v86
    v_accvgpr_write_b32 a7, v86
    v_lshl_or_b32 v88, v89, 16, v88
    v_accvgpr_write_b32 a40, v88
    v_lshl_or_b32 v90, v91, 16, v90
    v_accvgpr_write_b32 a41, v90
    v_lshl_or_b32 v92, v93, 16, v92
    v_accvgpr_write_b32 a42, v92
    v_lshl_or_b32 v94, v95, 16, v94
    v_accvgpr_write_b32 a43, v94
    v_lshl_or_b32 v96, v97, 16, v96
    v_accvgpr_write_b32 a76, v96
    v_lshl_or_b32 v98, v99, 16, v98
    v_accvgpr_write_b32 a77, v98
    v_lshl_or_b32 v100, v101, 16, v100
    v_accvgpr_write_b32 a78, v100
    v_lshl_or_b32 v102, v103, 16, v102
    v_accvgpr_write_b32 a79, v102
    v_lshl_or_b32 v104, v105, 16, v104
    v_accvgpr_write_b32 a112, v104
    v_lshl_or_b32 v106, v107, 16, v106
    v_accvgpr_write_b32 a113, v106
    v_lshl_or_b32 v108, v109, 16, v108
    v_accvgpr_write_b32 a114, v108
    v_lshl_or_b32 v110, v111, 16, v110
    v_accvgpr_write_b32 a115, v110
    v_lshl_or_b32 v112, v113, 16, v112
    v_accvgpr_write_b32 a148, v112
    v_lshl_or_b32 v114, v115, 16, v114
    v_accvgpr_write_b32 a149, v114
    v_lshl_or_b32 v116, v117, 16, v116
    v_accvgpr_write_b32 a150, v116
    v_lshl_or_b32 v118, v119, 16, v118
    v_accvgpr_write_b32 a151, v118
    s_waitcnt vmcnt(63)
    v_lshl_or_b32 v120, v121, 16, v120
    v_accvgpr_write_b32 a8, v120
    v_lshl_or_b32 v122, v123, 16, v122
    v_accvgpr_write_b32 a9, v122
    v_lshl_or_b32 v124, v125, 16, v124
    v_accvgpr_write_b32 a10, v124
    v_lshl_or_b32 v126, v127, 16, v126
    v_accvgpr_write_b32 a11, v126
    v_lshl_or_b32 v128, v129, 16, v128
    v_accvgpr_write_b32 a44, v128
    v_lshl_or_b32 v130, v131, 16, v130
    v_accvgpr_write_b32 a45, v130
    v_lshl_or_b32 v132, v133, 16, v132
    v_accvgpr_write_b32 a46, v132
    v_lshl_or_b32 v134, v135, 16, v134
    v_accvgpr_write_b32 a47, v134
    v_lshl_or_b32 v136, v137, 16, v136
    v_accvgpr_write_b32 a80, v136
    v_lshl_or_b32 v138, v139, 16, v138
    v_accvgpr_write_b32 a81, v138
    v_lshl_or_b32 v140, v141, 16, v140
    v_accvgpr_write_b32 a82, v140
    v_lshl_or_b32 v142, v143, 16, v142
    v_accvgpr_write_b32 a83, v142
    v_lshl_or_b32 v144, v145, 16, v144
    v_accvgpr_write_b32 a116, v144
    v_lshl_or_b32 v146, v147, 16, v146
    v_accvgpr_write_b32 a117, v146
    v_lshl_or_b32 v148, v149, 16, v148
    v_accvgpr_write_b32 a118, v148
    v_lshl_or_b32 v150, v151, 16, v150
    v_accvgpr_write_b32 a119, v150
    v_lshl_or_b32 v152, v153, 16, v152
    v_accvgpr_write_b32 a152, v152
    v_lshl_or_b32 v154, v155, 16, v154
    v_accvgpr_write_b32 a153, v154
    v_lshl_or_b32 v156, v157, 16, v156
    v_accvgpr_write_b32 a154, v156
    v_lshl_or_b32 v158, v159, 16, v158
    v_accvgpr_write_b32 a155, v158
    s_waitcnt vmcnt(40)
    v_lshl_or_b32 v160, v161, 16, v160
    v_accvgpr_write_b32 a12, v160
    v_lshl_or_b32 v162, v163, 16, v162
    v_accvgpr_write_b32 a13, v162
    v_lshl_or_b32 v164, v165, 16, v164
    v_accvgpr_write_b32 a14, v164
    v_lshl_or_b32 v166, v167, 16, v166
    v_accvgpr_write_b32 a15, v166
    v_lshl_or_b32 v168, v169, 16, v168
    v_accvgpr_write_b32 a48, v168
    v_lshl_or_b32 v170, v171, 16, v170
    v_accvgpr_write_b32 a49, v170
    v_lshl_or_b32 v172, v173, 16, v172
    v_accvgpr_write_b32 a50, v172
    v_lshl_or_b32 v174, v175, 16, v174
    v_accvgpr_write_b32 a51, v174
    v_lshl_or_b32 v176, v177, 16, v176
    v_accvgpr_write_b32 a84, v176
    v_lshl_or_b32 v178, v179, 16, v178
    v_accvgpr_write_b32 a85, v178
    v_lshl_or_b32 v180, v181, 16, v180
    v_accvgpr_write_b32 a86, v180
    v_lshl_or_b32 v182, v183, 16, v182
    v_accvgpr_write_b32 a87, v182
    v_lshl_or_b32 v184, v185, 16, v184
    v_accvgpr_write_b32 a120, v184
    v_lshl_or_b32 v186, v187, 16, v186
    v_accvgpr_write_b32 a121, v186
    v_lshl_or_b32 v188, v189, 16, v188
    v_accvgpr_write_b32 a122, v188
    v_lshl_or_b32 v190, v191, 16, v190
    v_accvgpr_write_b32 a123, v190
    v_lshl_or_b32 v192, v193, 16, v192
    v_accvgpr_write_b32 a156, v192
    v_lshl_or_b32 v194, v195, 16, v194
    v_accvgpr_write_b32 a157, v194
    v_lshl_or_b32 v196, v197, 16, v196
    v_accvgpr_write_b32 a158, v196
    v_lshl_or_b32 v198, v199, 16, v198
    v_accvgpr_write_b32 a159, v198
    s_waitcnt vmcnt(0)
    v_lshl_or_b32 v200, v201, 16, v200
    v_accvgpr_write_b32 a16, v200
    v_lshl_or_b32 v202, v203, 16, v202
    v_accvgpr_write_b32 a17, v202
    v_lshl_or_b32 v204, v205, 16, v204
    v_accvgpr_write_b32 a18, v204
    v_lshl_or_b32 v206, v207, 16, v206
    v_accvgpr_write_b32 a19, v206
    v_lshl_or_b32 v208, v209, 16, v208
    v_accvgpr_write_b32 a52, v208
    v_lshl_or_b32 v210, v211, 16, v210
    v_accvgpr_write_b32 a53, v210
    v_lshl_or_b32 v212, v213, 16, v212
    v_accvgpr_write_b32 a54, v212
    v_lshl_or_b32 v214, v215, 16, v214
    v_accvgpr_write_b32 a55, v214
    v_lshl_or_b32 v216, v217, 16, v216
    v_accvgpr_write_b32 a88, v216
    v_lshl_or_b32 v218, v219, 16, v218
    v_accvgpr_write_b32 a89, v218
    v_lshl_or_b32 v220, v221, 16, v220
    v_accvgpr_write_b32 a90, v220
    v_lshl_or_b32 v222, v223, 16, v222
    v_accvgpr_write_b32 a91, v222
    v_lshl_or_b32 v224, v225, 16, v224
    v_accvgpr_write_b32 a124, v224
    v_lshl_or_b32 v226, v227, 16, v226
    v_accvgpr_write_b32 a125, v226
    v_lshl_or_b32 v228, v229, 16, v228
    v_accvgpr_write_b32 a126, v228
    v_lshl_or_b32 v230, v231, 16, v230
    v_accvgpr_write_b32 a127, v230
    v_lshl_or_b32 v232, v233, 16, v232
    v_accvgpr_write_b32 a160, v232
    v_lshl_or_b32 v234, v235, 16, v234
    v_accvgpr_write_b32 a161, v234
    v_lshl_or_b32 v236, v237, 16, v236
    v_accvgpr_write_b32 a162, v236
    v_lshl_or_b32 v238, v239, 16, v238
    v_accvgpr_write_b32 a163, v238
    v_add_u32 v6, 64, v5
    global_load_ushort v40, v6, s[28:29]
    v_add_u32 v6, 12288, v6
    global_load_ushort v41, v6, s[28:29]
    v_add_u32 v6, 12288, v6
    global_load_ushort v42, v6, s[28:29]
    v_add_u32 v6, 12288, v6
    global_load_ushort v43, v6, s[28:29]
    v_add_u32 v6, 12288, v6
    global_load_ushort v44, v6, s[28:29]
    v_add_u32 v6, 12288, v6
    global_load_ushort v45, v6, s[28:29]
    v_add_u32 v6, 12288, v6
    global_load_ushort v46, v6, s[28:29]
    v_add_u32 v6, 12288, v6
    global_load_ushort v47, v6, s[28:29]
    v_add_u32 v6, 307200, v6
    global_load_ushort v48, v6, s[28:29]
    v_add_u32 v6, 12288, v6
    global_load_ushort v49, v6, s[28:29]
    v_add_u32 v6, 12288, v6
    global_load_ushort v50, v6, s[28:29]
    v_add_u32 v6, 12288, v6
    global_load_ushort v51, v6, s[28:29]
    v_add_u32 v6, 12288, v6
    global_load_ushort v52, v6, s[28:29]
    v_add_u32 v6, 12288, v6
    global_load_ushort v53, v6, s[28:29]
    v_add_u32 v6, 12288, v6
    global_load_ushort v54, v6, s[28:29]
    v_add_u32 v6, 12288, v6
    global_load_ushort v55, v6, s[28:29]
    v_add_u32 v6, 307200, v6
    global_load_ushort v56, v6, s[28:29]
    v_add_u32 v6, 12288, v6
    global_load_ushort v57, v6, s[28:29]
    v_add_u32 v6, 12288, v6
    global_load_ushort v58, v6, s[28:29]
    v_add_u32 v6, 12288, v6
    global_load_ushort v59, v6, s[28:29]
    v_add_u32 v6, 12288, v6
    global_load_ushort v60, v6, s[28:29]
    v_add_u32 v6, 12288, v6
    global_load_ushort v61, v6, s[28:29]
    v_add_u32 v6, 12288, v6
    global_load_ushort v62, v6, s[28:29]
    v_add_u32 v6, 12288, v6
    global_load_ushort v63, v6, s[28:29]
    v_add_u32 v6, 307200, v6
    global_load_ushort v64, v6, s[28:29]
    v_add_u32 v6, 12288, v6
    global_load_ushort v65, v6, s[28:29]
    v_add_u32 v6, 12288, v6
    global_load_ushort v66, v6, s[28:29]
    v_add_u32 v6, 12288, v6
    global_load_ushort v67, v6, s[28:29]
    v_add_u32 v6, 12288, v6
    global_load_ushort v68, v6, s[28:29]
    v_add_u32 v6, 12288, v6
    global_load_ushort v69, v6, s[28:29]
    v_add_u32 v6, 12288, v6
    global_load_ushort v70, v6, s[28:29]
    v_add_u32 v6, 12288, v6
    global_load_ushort v71, v6, s[28:29]
    v_add_u32 v6, 307200, v6
    global_load_ushort v72, v6, s[28:29]
    v_add_u32 v6, 12288, v6
    global_load_ushort v73, v6, s[28:29]
    v_add_u32 v6, 12288, v6
    global_load_ushort v74, v6, s[28:29]
    v_add_u32 v6, 12288, v6
    global_load_ushort v75, v6, s[28:29]
    v_add_u32 v6, 12288, v6
    global_load_ushort v76, v6, s[28:29]
    v_add_u32 v6, 12288, v6
    global_load_ushort v77, v6, s[28:29]
    v_add_u32 v6, 12288, v6
    global_load_ushort v78, v6, s[28:29]
    v_add_u32 v6, 12288, v6
    global_load_ushort v79, v6, s[28:29]
    v_add_u32 v6, 0, v5
    global_load_ushort v80, v6, s[30:31]
    v_add_u32 v6, 12288, v6
    global_load_ushort v81, v6, s[30:31]
    v_add_u32 v6, 12288, v6
    global_load_ushort v82, v6, s[30:31]
    v_add_u32 v6, 12288, v6
    global_load_ushort v83, v6, s[30:31]
    v_add_u32 v6, 12288, v6
    global_load_ushort v84, v6, s[30:31]
    v_add_u32 v6, 12288, v6
    global_load_ushort v85, v6, s[30:31]
    v_add_u32 v6, 12288, v6
    global_load_ushort v86, v6, s[30:31]
    v_add_u32 v6, 12288, v6
    global_load_ushort v87, v6, s[30:31]
    v_add_u32 v6, 307200, v6
    global_load_ushort v88, v6, s[30:31]
    v_add_u32 v6, 12288, v6
    global_load_ushort v89, v6, s[30:31]
    v_add_u32 v6, 12288, v6
    global_load_ushort v90, v6, s[30:31]
    v_add_u32 v6, 12288, v6
    global_load_ushort v91, v6, s[30:31]
    v_add_u32 v6, 12288, v6
    global_load_ushort v92, v6, s[30:31]
    v_add_u32 v6, 12288, v6
    global_load_ushort v93, v6, s[30:31]
    v_add_u32 v6, 12288, v6
    global_load_ushort v94, v6, s[30:31]
    v_add_u32 v6, 12288, v6
    global_load_ushort v95, v6, s[30:31]
    v_add_u32 v6, 307200, v6
    global_load_ushort v96, v6, s[30:31]
    v_add_u32 v6, 12288, v6
    global_load_ushort v97, v6, s[30:31]
    v_add_u32 v6, 12288, v6
    global_load_ushort v98, v6, s[30:31]
    v_add_u32 v6, 12288, v6
    global_load_ushort v99, v6, s[30:31]
    v_add_u32 v6, 12288, v6
    global_load_ushort v100, v6, s[30:31]
    v_add_u32 v6, 12288, v6
    global_load_ushort v101, v6, s[30:31]
    v_add_u32 v6, 12288, v6
    global_load_ushort v102, v6, s[30:31]
    v_add_u32 v6, 12288, v6
    global_load_ushort v103, v6, s[30:31]
    v_add_u32 v6, 307200, v6
    global_load_ushort v104, v6, s[30:31]
    v_add_u32 v6, 12288, v6
    global_load_ushort v105, v6, s[30:31]
    v_add_u32 v6, 12288, v6
    global_load_ushort v106, v6, s[30:31]
    v_add_u32 v6, 12288, v6
    global_load_ushort v107, v6, s[30:31]
    v_add_u32 v6, 12288, v6
    global_load_ushort v108, v6, s[30:31]
    v_add_u32 v6, 12288, v6
    global_load_ushort v109, v6, s[30:31]
    v_add_u32 v6, 12288, v6
    global_load_ushort v110, v6, s[30:31]
    v_add_u32 v6, 12288, v6
    global_load_ushort v111, v6, s[30:31]
    v_add_u32 v6, 307200, v6
    global_load_ushort v112, v6, s[30:31]
    v_add_u32 v6, 12288, v6
    global_load_ushort v113, v6, s[30:31]
    v_add_u32 v6, 12288, v6
    global_load_ushort v114, v6, s[30:31]
    v_add_u32 v6, 12288, v6
    global_load_ushort v115, v6, s[30:31]
    v_add_u32 v6, 12288, v6
    global_load_ushort v116, v6, s[30:31]
    v_add_u32 v6, 12288, v6
    global_load_ushort v117, v6, s[30:31]
    v_add_u32 v6, 12288, v6
    global_load_ushort v118, v6, s[30:31]
    v_add_u32 v6, 12288, v6
    global_load_ushort v119, v6, s[30:31]
    v_add_u32 v6, 32, v5
    global_load_ushort v120, v6, s[30:31]
    v_add_u32 v6, 12288, v6
    global_load_ushort v121, v6, s[30:31]
    v_add_u32 v6, 12288, v6
    global_load_ushort v122, v6, s[30:31]
    v_add_u32 v6, 12288, v6
    global_load_ushort v123, v6, s[30:31]
    v_add_u32 v6, 12288, v6
    global_load_ushort v124, v6, s[30:31]
    v_add_u32 v6, 12288, v6
    global_load_ushort v125, v6, s[30:31]
    v_add_u32 v6, 12288, v6
    global_load_ushort v126, v6, s[30:31]
    v_add_u32 v6, 12288, v6
    global_load_ushort v127, v6, s[30:31]
    v_add_u32 v6, 307200, v6
    global_load_ushort v128, v6, s[30:31]
    v_add_u32 v6, 12288, v6
    global_load_ushort v129, v6, s[30:31]
    v_add_u32 v6, 12288, v6
    global_load_ushort v130, v6, s[30:31]
    v_add_u32 v6, 12288, v6
    global_load_ushort v131, v6, s[30:31]
    v_add_u32 v6, 12288, v6
    global_load_ushort v132, v6, s[30:31]
    v_add_u32 v6, 12288, v6
    global_load_ushort v133, v6, s[30:31]
    v_add_u32 v6, 12288, v6
    global_load_ushort v134, v6, s[30:31]
    v_add_u32 v6, 12288, v6
    global_load_ushort v135, v6, s[30:31]
    v_add_u32 v6, 307200, v6
    global_load_ushort v136, v6, s[30:31]
    v_add_u32 v6, 12288, v6
    global_load_ushort v137, v6, s[30:31]
    v_add_u32 v6, 12288, v6
    global_load_ushort v138, v6, s[30:31]
    v_add_u32 v6, 12288, v6
    global_load_ushort v139, v6, s[30:31]
    v_add_u32 v6, 12288, v6
    global_load_ushort v140, v6, s[30:31]
    v_add_u32 v6, 12288, v6
    global_load_ushort v141, v6, s[30:31]
    v_add_u32 v6, 12288, v6
    global_load_ushort v142, v6, s[30:31]
    v_add_u32 v6, 12288, v6
    global_load_ushort v143, v6, s[30:31]
    v_add_u32 v6, 307200, v6
    global_load_ushort v144, v6, s[30:31]
    v_add_u32 v6, 12288, v6
    global_load_ushort v145, v6, s[30:31]
    v_add_u32 v6, 12288, v6
    global_load_ushort v146, v6, s[30:31]
    v_add_u32 v6, 12288, v6
    global_load_ushort v147, v6, s[30:31]
    v_add_u32 v6, 12288, v6
    global_load_ushort v148, v6, s[30:31]
    v_add_u32 v6, 12288, v6
    global_load_ushort v149, v6, s[30:31]
    v_add_u32 v6, 12288, v6
    global_load_ushort v150, v6, s[30:31]
    v_add_u32 v6, 12288, v6
    global_load_ushort v151, v6, s[30:31]
    v_add_u32 v6, 307200, v6
    global_load_ushort v152, v6, s[30:31]
    v_add_u32 v6, 12288, v6
    global_load_ushort v153, v6, s[30:31]
    v_add_u32 v6, 12288, v6
    global_load_ushort v154, v6, s[30:31]
    v_add_u32 v6, 12288, v6
    global_load_ushort v155, v6, s[30:31]
    v_add_u32 v6, 12288, v6
    global_load_ushort v156, v6, s[30:31]
    v_add_u32 v6, 12288, v6
    global_load_ushort v157, v6, s[30:31]
    v_add_u32 v6, 12288, v6
    global_load_ushort v158, v6, s[30:31]
    v_add_u32 v6, 12288, v6
    global_load_ushort v159, v6, s[30:31]
    v_add_u32 v6, 64, v5
    global_load_ushort v160, v6, s[30:31]
    v_add_u32 v6, 12288, v6
    global_load_ushort v161, v6, s[30:31]
    v_add_u32 v6, 12288, v6
    global_load_ushort v162, v6, s[30:31]
    v_add_u32 v6, 12288, v6
    global_load_ushort v163, v6, s[30:31]
    v_add_u32 v6, 12288, v6
    global_load_ushort v164, v6, s[30:31]
    v_add_u32 v6, 12288, v6
    global_load_ushort v165, v6, s[30:31]
    v_add_u32 v6, 12288, v6
    global_load_ushort v166, v6, s[30:31]
    v_add_u32 v6, 12288, v6
    global_load_ushort v167, v6, s[30:31]
    v_add_u32 v6, 307200, v6
    global_load_ushort v168, v6, s[30:31]
    v_add_u32 v6, 12288, v6
    global_load_ushort v169, v6, s[30:31]
    v_add_u32 v6, 12288, v6
    global_load_ushort v170, v6, s[30:31]
    v_add_u32 v6, 12288, v6
    global_load_ushort v171, v6, s[30:31]
    v_add_u32 v6, 12288, v6
    global_load_ushort v172, v6, s[30:31]
    v_add_u32 v6, 12288, v6
    global_load_ushort v173, v6, s[30:31]
    v_add_u32 v6, 12288, v6
    global_load_ushort v174, v6, s[30:31]
    v_add_u32 v6, 12288, v6
    global_load_ushort v175, v6, s[30:31]
    v_add_u32 v6, 307200, v6
    global_load_ushort v176, v6, s[30:31]
    v_add_u32 v6, 12288, v6
    global_load_ushort v177, v6, s[30:31]
    v_add_u32 v6, 12288, v6
    global_load_ushort v178, v6, s[30:31]
    v_add_u32 v6, 12288, v6
    global_load_ushort v179, v6, s[30:31]
    v_add_u32 v6, 12288, v6
    global_load_ushort v180, v6, s[30:31]
    v_add_u32 v6, 12288, v6
    global_load_ushort v181, v6, s[30:31]
    v_add_u32 v6, 12288, v6
    global_load_ushort v182, v6, s[30:31]
    v_add_u32 v6, 12288, v6
    global_load_ushort v183, v6, s[30:31]
    v_add_u32 v6, 307200, v6
    global_load_ushort v184, v6, s[30:31]
    v_add_u32 v6, 12288, v6
    global_load_ushort v185, v6, s[30:31]
    v_add_u32 v6, 12288, v6
    global_load_ushort v186, v6, s[30:31]
    v_add_u32 v6, 12288, v6
    global_load_ushort v187, v6, s[30:31]
    v_add_u32 v6, 12288, v6
    global_load_ushort v188, v6, s[30:31]
    v_add_u32 v6, 12288, v6
    global_load_ushort v189, v6, s[30:31]
    v_add_u32 v6, 12288, v6
    global_load_ushort v190, v6, s[30:31]
    v_add_u32 v6, 12288, v6
    global_load_ushort v191, v6, s[30:31]
    v_add_u32 v6, 307200, v6
    global_load_ushort v192, v6, s[30:31]
    v_add_u32 v6, 12288, v6
    global_load_ushort v193, v6, s[30:31]
    v_add_u32 v6, 12288, v6
    global_load_ushort v194, v6, s[30:31]
    v_add_u32 v6, 12288, v6
    global_load_ushort v195, v6, s[30:31]
    v_add_u32 v6, 12288, v6
    global_load_ushort v196, v6, s[30:31]
    v_add_u32 v6, 12288, v6
    global_load_ushort v197, v6, s[30:31]
    v_add_u32 v6, 12288, v6
    global_load_ushort v198, v6, s[30:31]
    v_add_u32 v6, 12288, v6
    global_load_ushort v199, v6, s[30:31]
    s_waitcnt vmcnt(63)
    v_lshl_or_b32 v40, v41, 16, v40
    v_accvgpr_write_b32 a20, v40
    v_lshl_or_b32 v42, v43, 16, v42
    v_accvgpr_write_b32 a21, v42
    v_lshl_or_b32 v44, v45, 16, v44
    v_accvgpr_write_b32 a22, v44
    v_lshl_or_b32 v46, v47, 16, v46
    v_accvgpr_write_b32 a23, v46
    v_lshl_or_b32 v48, v49, 16, v48
    v_accvgpr_write_b32 a56, v48
    v_lshl_or_b32 v50, v51, 16, v50
    v_accvgpr_write_b32 a57, v50
    v_lshl_or_b32 v52, v53, 16, v52
    v_accvgpr_write_b32 a58, v52
    v_lshl_or_b32 v54, v55, 16, v54
    v_accvgpr_write_b32 a59, v54
    v_lshl_or_b32 v56, v57, 16, v56
    v_accvgpr_write_b32 a92, v56
    v_lshl_or_b32 v58, v59, 16, v58
    v_accvgpr_write_b32 a93, v58
    v_lshl_or_b32 v60, v61, 16, v60
    v_accvgpr_write_b32 a94, v60
    v_lshl_or_b32 v62, v63, 16, v62
    v_accvgpr_write_b32 a95, v62
    v_lshl_or_b32 v64, v65, 16, v64
    v_accvgpr_write_b32 a128, v64
    v_lshl_or_b32 v66, v67, 16, v66
    v_accvgpr_write_b32 a129, v66
    v_lshl_or_b32 v68, v69, 16, v68
    v_accvgpr_write_b32 a130, v68
    v_lshl_or_b32 v70, v71, 16, v70
    v_accvgpr_write_b32 a131, v70
    v_lshl_or_b32 v72, v73, 16, v72
    v_accvgpr_write_b32 a164, v72
    v_lshl_or_b32 v74, v75, 16, v74
    v_accvgpr_write_b32 a165, v74
    v_lshl_or_b32 v76, v77, 16, v76
    v_accvgpr_write_b32 a166, v76
    v_lshl_or_b32 v78, v79, 16, v78
    v_accvgpr_write_b32 a167, v78
    s_waitcnt vmcnt(63)
    v_lshl_or_b32 v80, v81, 16, v80
    v_accvgpr_write_b32 a24, v80
    v_lshl_or_b32 v82, v83, 16, v82
    v_accvgpr_write_b32 a25, v82
    v_lshl_or_b32 v84, v85, 16, v84
    v_accvgpr_write_b32 a26, v84
    v_lshl_or_b32 v86, v87, 16, v86
    v_accvgpr_write_b32 a27, v86
    v_lshl_or_b32 v88, v89, 16, v88
    v_accvgpr_write_b32 a60, v88
    v_lshl_or_b32 v90, v91, 16, v90
    v_accvgpr_write_b32 a61, v90
    v_lshl_or_b32 v92, v93, 16, v92
    v_accvgpr_write_b32 a62, v92
    v_lshl_or_b32 v94, v95, 16, v94
    v_accvgpr_write_b32 a63, v94
    v_lshl_or_b32 v96, v97, 16, v96
    v_accvgpr_write_b32 a96, v96
    v_lshl_or_b32 v98, v99, 16, v98
    v_accvgpr_write_b32 a97, v98
    v_lshl_or_b32 v100, v101, 16, v100
    v_accvgpr_write_b32 a98, v100
    v_lshl_or_b32 v102, v103, 16, v102
    v_accvgpr_write_b32 a99, v102
    v_lshl_or_b32 v104, v105, 16, v104
    v_accvgpr_write_b32 a132, v104
    v_lshl_or_b32 v106, v107, 16, v106
    v_accvgpr_write_b32 a133, v106
    v_lshl_or_b32 v108, v109, 16, v108
    v_accvgpr_write_b32 a134, v108
    v_lshl_or_b32 v110, v111, 16, v110
    v_accvgpr_write_b32 a135, v110
    v_lshl_or_b32 v112, v113, 16, v112
    v_accvgpr_write_b32 a168, v112
    v_lshl_or_b32 v114, v115, 16, v114
    v_accvgpr_write_b32 a169, v114
    v_lshl_or_b32 v116, v117, 16, v116
    v_accvgpr_write_b32 a170, v116
    v_lshl_or_b32 v118, v119, 16, v118
    v_accvgpr_write_b32 a171, v118
    s_waitcnt vmcnt(40)
    v_lshl_or_b32 v120, v121, 16, v120
    v_accvgpr_write_b32 a28, v120
    v_lshl_or_b32 v122, v123, 16, v122
    v_accvgpr_write_b32 a29, v122
    v_lshl_or_b32 v124, v125, 16, v124
    v_accvgpr_write_b32 a30, v124
    v_lshl_or_b32 v126, v127, 16, v126
    v_accvgpr_write_b32 a31, v126
    v_lshl_or_b32 v128, v129, 16, v128
    v_accvgpr_write_b32 a64, v128
    v_lshl_or_b32 v130, v131, 16, v130
    v_accvgpr_write_b32 a65, v130
    v_lshl_or_b32 v132, v133, 16, v132
    v_accvgpr_write_b32 a66, v132
    v_lshl_or_b32 v134, v135, 16, v134
    v_accvgpr_write_b32 a67, v134
    v_lshl_or_b32 v136, v137, 16, v136
    v_accvgpr_write_b32 a100, v136
    v_lshl_or_b32 v138, v139, 16, v138
    v_accvgpr_write_b32 a101, v138
    v_lshl_or_b32 v140, v141, 16, v140
    v_accvgpr_write_b32 a102, v140
    v_lshl_or_b32 v142, v143, 16, v142
    v_accvgpr_write_b32 a103, v142
    v_lshl_or_b32 v144, v145, 16, v144
    v_accvgpr_write_b32 a136, v144
    v_lshl_or_b32 v146, v147, 16, v146
    v_accvgpr_write_b32 a137, v146
    v_lshl_or_b32 v148, v149, 16, v148
    v_accvgpr_write_b32 a138, v148
    v_lshl_or_b32 v150, v151, 16, v150
    v_accvgpr_write_b32 a139, v150
    v_lshl_or_b32 v152, v153, 16, v152
    v_accvgpr_write_b32 a172, v152
    v_lshl_or_b32 v154, v155, 16, v154
    v_accvgpr_write_b32 a173, v154
    v_lshl_or_b32 v156, v157, 16, v156
    v_accvgpr_write_b32 a174, v156
    v_lshl_or_b32 v158, v159, 16, v158
    v_accvgpr_write_b32 a175, v158
    s_waitcnt vmcnt(0)
    v_lshl_or_b32 v160, v161, 16, v160
    v_accvgpr_write_b32 a32, v160
    v_lshl_or_b32 v162, v163, 16, v162
    v_accvgpr_write_b32 a33, v162
    v_lshl_or_b32 v164, v165, 16, v164
    v_accvgpr_write_b32 a34, v164
    v_lshl_or_b32 v166, v167, 16, v166
    v_accvgpr_write_b32 a35, v166
    v_lshl_or_b32 v168, v169, 16, v168
    v_accvgpr_write_b32 a68, v168
    v_lshl_or_b32 v170, v171, 16, v170
    v_accvgpr_write_b32 a69, v170
    v_lshl_or_b32 v172, v173, 16, v172
    v_accvgpr_write_b32 a70, v172
    v_lshl_or_b32 v174, v175, 16, v174
    v_accvgpr_write_b32 a71, v174
    v_lshl_or_b32 v176, v177, 16, v176
    v_accvgpr_write_b32 a104, v176
    v_lshl_or_b32 v178, v179, 16, v178
    v_accvgpr_write_b32 a105, v178
    v_lshl_or_b32 v180, v181, 16, v180
    v_accvgpr_write_b32 a106, v180
    v_lshl_or_b32 v182, v183, 16, v182
    v_accvgpr_write_b32 a107, v182
    v_lshl_or_b32 v184, v185, 16, v184
    v_accvgpr_write_b32 a140, v184
    v_lshl_or_b32 v186, v187, 16, v186
    v_accvgpr_write_b32 a141, v186
    v_lshl_or_b32 v188, v189, 16, v188
    v_accvgpr_write_b32 a142, v188
    v_lshl_or_b32 v190, v191, 16, v190
    v_accvgpr_write_b32 a143, v190
    v_lshl_or_b32 v192, v193, 16, v192
    v_accvgpr_write_b32 a176, v192
    v_lshl_or_b32 v194, v195, 16, v194
    v_accvgpr_write_b32 a177, v194
    v_lshl_or_b32 v196, v197, 16, v196
    v_accvgpr_write_b32 a178, v196
    v_lshl_or_b32 v198, v199, 16, v198
    v_accvgpr_write_b32 a179, v198
    s_mul_i32 s34, s20, 192*640
    s_mul_i32 s35, s21, 160
    s_add_u32 s34, s34, s35
    s_add_u32 s35, s25, 0
    s_min_u32 s35, s35, 9
    s_lshl_b32 s35, s35, 4
    s_add_u32 s34, s34, s35
    v_mul_u32_u24 v6, 640*8, v4
    v_add_u32 v6, v6, v3
    v_add_u32 v6, s34, v6
    v_lshlrev_b32 v6, 1, v6
    global_load_ushort v40, v6, s[32:33]
    v_add_u32 v6, 1280, v6
    global_load_ushort v41, v6, s[32:33]
    v_add_u32 v6, 1280, v6
    global_load_ushort v42, v6, s[32:33]
    v_add_u32 v6, 1280, v6
    global_load_ushort v43, v6, s[32:33]
    v_add_u32 v6, 1280, v6
    global_load_ushort v44, v6, s[32:33]
    v_add_u32 v6, 1280, v6
    global_load_ushort v45, v6, s[32:33]
    v_add_u32 v6, 1280, v6
    global_load_ushort v46, v6, s[32:33]
    v_add_u32 v6, 1280, v6
    global_load_ushort v47, v6, s[32:33]
    v_add_u32 v6, 32000, v6
    global_load_ushort v48, v6, s[32:33]
    v_add_u32 v6, 1280, v6
    global_load_ushort v49, v6, s[32:33]
    v_add_u32 v6, 1280, v6
    global_load_ushort v50, v6, s[32:33]
    v_add_u32 v6, 1280, v6
    global_load_ushort v51, v6, s[32:33]
    v_add_u32 v6, 1280, v6
    global_load_ushort v52, v6, s[32:33]
    v_add_u32 v6, 1280, v6
    global_load_ushort v53, v6, s[32:33]
    v_add_u32 v6, 1280, v6
    global_load_ushort v54, v6, s[32:33]
    v_add_u32 v6, 1280, v6
    global_load_ushort v55, v6, s[32:33]
    v_add_u32 v6, 32000, v6
    global_load_ushort v56, v6, s[32:33]
    v_add_u32 v6, 1280, v6
    global_load_ushort v57, v6, s[32:33]
    v_add_u32 v6, 1280, v6
    global_load_ushort v58, v6, s[32:33]
    v_add_u32 v6, 1280, v6
    global_load_ushort v59, v6, s[32:33]
    v_add_u32 v6, 1280, v6
    global_load_ushort v60, v6, s[32:33]
    v_add_u32 v6, 1280, v6
    global_load_ushort v61, v6, s[32:33]
    v_add_u32 v6, 1280, v6
    global_load_ushort v62, v6, s[32:33]
    v_add_u32 v6, 1280, v6
    global_load_ushort v63, v6, s[32:33]
    v_add_u32 v6, 32000, v6
    global_load_ushort v64, v6, s[32:33]
    v_add_u32 v6, 1280, v6
    global_load_ushort v65, v6, s[32:33]
    v_add_u32 v6, 1280, v6
    global_load_ushort v66, v6, s[32:33]
    v_add_u32 v6, 1280, v6
    global_load_ushort v67, v6, s[32:33]
    v_add_u32 v6, 1280, v6
    global_load_ushort v68, v6, s[32:33]
    v_add_u32 v6, 1280, v6
    global_load_ushort v69, v6, s[32:33]
    v_add_u32 v6, 1280, v6
    global_load_ushort v70, v6, s[32:33]
    v_add_u32 v6, 1280, v6
    global_load_ushort v71, v6, s[32:33]
    v_add_u32 v6, 32000, v6
    global_load_ushort v72, v6, s[32:33]
    v_add_u32 v6, 1280, v6
    global_load_ushort v73, v6, s[32:33]
    v_add_u32 v6, 1280, v6
    global_load_ushort v74, v6, s[32:33]
    v_add_u32 v6, 1280, v6
    global_load_ushort v75, v6, s[32:33]
    v_add_u32 v6, 1280, v6
    global_load_ushort v76, v6, s[32:33]
    v_add_u32 v6, 1280, v6
    global_load_ushort v77, v6, s[32:33]
    v_add_u32 v6, 1280, v6
    global_load_ushort v78, v6, s[32:33]
    v_add_u32 v6, 1280, v6
    global_load_ushort v79, v6, s[32:33]
    v_add_u32 v6, 32000, v6
    global_load_ushort v80, v6, s[32:33]
    v_add_u32 v6, 1280, v6
    global_load_ushort v81, v6, s[32:33]
    v_add_u32 v6, 1280, v6
    global_load_ushort v82, v6, s[32:33]
    v_add_u32 v6, 1280, v6
    global_load_ushort v83, v6, s[32:33]
    v_add_u32 v6, 1280, v6
    global_load_ushort v84, v6, s[32:33]
    v_add_u32 v6, 1280, v6
    global_load_ushort v85, v6, s[32:33]
    v_add_u32 v6, 1280, v6
    global_load_ushort v86, v6, s[32:33]
    v_add_u32 v6, 1280, v6
    global_load_ushort v87, v6, s[32:33]
    s_mul_i32 s34, s20, 192*640
    s_mul_i32 s35, s21, 160
    s_add_u32 s34, s34, s35
    s_add_u32 s35, s25, 4
    s_min_u32 s35, s35, 9
    s_lshl_b32 s35, s35, 4
    s_add_u32 s34, s34, s35
    v_mul_u32_u24 v6, 640*8, v4
    v_add_u32 v6, v6, v3
    v_add_u32 v6, s34, v6
    v_lshlrev_b32 v6, 1, v6
    global_load_ushort v88, v6, s[32:33]
    v_add_u32 v6, 1280, v6
    global_load_ushort v89, v6, s[32:33]
    v_add_u32 v6, 1280, v6
    global_load_ushort v90, v6, s[32:33]
    v_add_u32 v6, 1280, v6
    global_load_ushort v91, v6, s[32:33]
    v_add_u32 v6, 1280, v6
    global_load_ushort v92, v6, s[32:33]
    v_add_u32 v6, 1280, v6
    global_load_ushort v93, v6, s[32:33]
    v_add_u32 v6, 1280, v6
    global_load_ushort v94, v6, s[32:33]
    v_add_u32 v6, 1280, v6
    global_load_ushort v95, v6, s[32:33]
    v_add_u32 v6, 32000, v6
    global_load_ushort v96, v6, s[32:33]
    v_add_u32 v6, 1280, v6
    global_load_ushort v97, v6, s[32:33]
    v_add_u32 v6, 1280, v6
    global_load_ushort v98, v6, s[32:33]
    v_add_u32 v6, 1280, v6
    global_load_ushort v99, v6, s[32:33]
    v_add_u32 v6, 1280, v6
    global_load_ushort v100, v6, s[32:33]
    v_add_u32 v6, 1280, v6
    global_load_ushort v101, v6, s[32:33]
    v_add_u32 v6, 1280, v6
    global_load_ushort v102, v6, s[32:33]
    v_add_u32 v6, 1280, v6
    global_load_ushort v103, v6, s[32:33]
    v_add_u32 v6, 32000, v6
    global_load_ushort v104, v6, s[32:33]
    v_add_u32 v6, 1280, v6
    global_load_ushort v105, v6, s[32:33]
    v_add_u32 v6, 1280, v6
    global_load_ushort v106, v6, s[32:33]
    v_add_u32 v6, 1280, v6
    global_load_ushort v107, v6, s[32:33]
    v_add_u32 v6, 1280, v6
    global_load_ushort v108, v6, s[32:33]
    v_add_u32 v6, 1280, v6
    global_load_ushort v109, v6, s[32:33]
    v_add_u32 v6, 1280, v6
    global_load_ushort v110, v6, s[32:33]
    v_add_u32 v6, 1280, v6
    global_load_ushort v111, v6, s[32:33]
    v_add_u32 v6, 32000, v6
    global_load_ushort v112, v6, s[32:33]
    v_add_u32 v6, 1280, v6
    global_load_ushort v113, v6, s[32:33]
    v_add_u32 v6, 1280, v6
    global_load_ushort v114, v6, s[32:33]
    v_add_u32 v6, 1280, v6
    global_load_ushort v115, v6, s[32:33]
    v_add_u32 v6, 1280, v6
    global_load_ushort v116, v6, s[32:33]
    v_add_u32 v6, 1280, v6
    global_load_ushort v117, v6, s[32:33]
    v_add_u32 v6, 1280, v6
    global_load_ushort v118, v6, s[32:33]
    v_add_u32 v6, 1280, v6
    global_load_ushort v119, v6, s[32:33]
    v_add_u32 v6, 32000, v6
    global_load_ushort v120, v6, s[32:33]
    v_add_u32 v6, 1280, v6
    global_load_ushort v121, v6, s[32:33]
    v_add_u32 v6, 1280, v6
    global_load_ushort v122, v6, s[32:33]
    v_add_u32 v6, 1280, v6
    global_load_ushort v123, v6, s[32:33]
    v_add_u32 v6, 1280, v6
    global_load_ushort v124, v6, s[32:33]
    v_add_u32 v6, 1280, v6
    global_load_ushort v125, v6, s[32:33]
    v_add_u32 v6, 1280, v6
    global_load_ushort v126, v6, s[32:33]
    v_add_u32 v6, 1280, v6
    global_load_ushort v127, v6, s[32:33]
    v_add_u32 v6, 32000, v6
    global_load_ushort v128, v6, s[32:33]
    v_add_u32 v6, 1280, v6
    global_load_ushort v129, v6, s[32:33]
    v_add_u32 v6, 1280, v6
    global_load_ushort v130, v6, s[32:33]
    v_add_u32 v6, 1280, v6
    global_load_ushort v131, v6, s[32:33]
    v_add_u32 v6, 1280, v6
    global_load_ushort v132, v6, s[32:33]
    v_add_u32 v6, 1280, v6
    global_load_ushort v133, v6, s[32:33]
    v_add_u32 v6, 1280, v6
    global_load_ushort v134, v6, s[32:33]
    v_add_u32 v6, 1280, v6
    global_load_ushort v135, v6, s[32:33]
    s_mul_i32 s34, s20, 192*640
    s_mul_i32 s35, s21, 160
    s_add_u32 s34, s34, s35
    s_add_u32 s35, s25, 8
    s_min_u32 s35, s35, 9
    s_lshl_b32 s35, s35, 4
    s_add_u32 s34, s34, s35
    v_mul_u32_u24 v6, 640*8, v4
    v_add_u32 v6, v6, v3
    v_add_u32 v6, s34, v6
    v_lshlrev_b32 v6, 1, v6
    global_load_ushort v136, v6, s[32:33]
    v_add_u32 v6, 1280, v6
    global_load_ushort v137, v6, s[32:33]
    v_add_u32 v6, 1280, v6
    global_load_ushort v138, v6, s[32:33]
    v_add_u32 v6, 1280, v6
    global_load_ushort v139, v6, s[32:33]
    v_add_u32 v6, 1280, v6
    global_load_ushort v140, v6, s[32:33]
    v_add_u32 v6, 1280, v6
    global_load_ushort v141, v6, s[32:33]
    v_add_u32 v6, 1280, v6
    global_load_ushort v142, v6, s[32:33]
    v_add_u32 v6, 1280, v6
    global_load_ushort v143, v6, s[32:33]
    v_add_u32 v6, 32000, v6
    global_load_ushort v144, v6, s[32:33]
    v_add_u32 v6, 1280, v6
    global_load_ushort v145, v6, s[32:33]
    v_add_u32 v6, 1280, v6
    global_load_ushort v146, v6, s[32:33]
    v_add_u32 v6, 1280, v6
    global_load_ushort v147, v6, s[32:33]
    v_add_u32 v6, 1280, v6
    global_load_ushort v148, v6, s[32:33]
    v_add_u32 v6, 1280, v6
    global_load_ushort v149, v6, s[32:33]
    v_add_u32 v6, 1280, v6
    global_load_ushort v150, v6, s[32:33]
    v_add_u32 v6, 1280, v6
    global_load_ushort v151, v6, s[32:33]
    v_add_u32 v6, 32000, v6
    global_load_ushort v152, v6, s[32:33]
    v_add_u32 v6, 1280, v6
    global_load_ushort v153, v6, s[32:33]
    v_add_u32 v6, 1280, v6
    global_load_ushort v154, v6, s[32:33]
    v_add_u32 v6, 1280, v6
    global_load_ushort v155, v6, s[32:33]
    v_add_u32 v6, 1280, v6
    global_load_ushort v156, v6, s[32:33]
    v_add_u32 v6, 1280, v6
    global_load_ushort v157, v6, s[32:33]
    v_add_u32 v6, 1280, v6
    global_load_ushort v158, v6, s[32:33]
    v_add_u32 v6, 1280, v6
    global_load_ushort v159, v6, s[32:33]
    v_add_u32 v6, 32000, v6
    global_load_ushort v160, v6, s[32:33]
    v_add_u32 v6, 1280, v6
    global_load_ushort v161, v6, s[32:33]
    v_add_u32 v6, 1280, v6
    global_load_ushort v162, v6, s[32:33]
    v_add_u32 v6, 1280, v6
    global_load_ushort v163, v6, s[32:33]
    v_add_u32 v6, 1280, v6
    global_load_ushort v164, v6, s[32:33]
    v_add_u32 v6, 1280, v6
    global_load_ushort v165, v6, s[32:33]
    v_add_u32 v6, 1280, v6
    global_load_ushort v166, v6, s[32:33]
    v_add_u32 v6, 1280, v6
    global_load_ushort v167, v6, s[32:33]
    v_add_u32 v6, 32000, v6
    global_load_ushort v168, v6, s[32:33]
    v_add_u32 v6, 1280, v6
    global_load_ushort v169, v6, s[32:33]
    v_add_u32 v6, 1280, v6
    global_load_ushort v170, v6, s[32:33]
    v_add_u32 v6, 1280, v6
    global_load_ushort v171, v6, s[32:33]
    v_add_u32 v6, 1280, v6
    global_load_ushort v172, v6, s[32:33]
    v_add_u32 v6, 1280, v6
    global_load_ushort v173, v6, s[32:33]
    v_add_u32 v6, 1280, v6
    global_load_ushort v174, v6, s[32:33]
    v_add_u32 v6, 1280, v6
    global_load_ushort v175, v6, s[32:33]
    v_add_u32 v6, 32000, v6
    global_load_ushort v176, v6, s[32:33]
    v_add_u32 v6, 1280, v6
    global_load_ushort v177, v6, s[32:33]
    v_add_u32 v6, 1280, v6
    global_load_ushort v178, v6, s[32:33]
    v_add_u32 v6, 1280, v6
    global_load_ushort v179, v6, s[32:33]
    v_add_u32 v6, 1280, v6
    global_load_ushort v180, v6, s[32:33]
    v_add_u32 v6, 1280, v6
    global_load_ushort v181, v6, s[32:33]
    v_add_u32 v6, 1280, v6
    global_load_ushort v182, v6, s[32:33]
    v_add_u32 v6, 1280, v6
    global_load_ushort v183, v6, s[32:33]
    s_waitcnt vmcnt(63)
    v_lshl_or_b32 v40, v41, 16, v40
    v_accvgpr_write_b32 a180, v40
    v_lshl_or_b32 v42, v43, 16, v42
    v_accvgpr_write_b32 a181, v42
    v_lshl_or_b32 v44, v45, 16, v44
    v_accvgpr_write_b32 a182, v44
    v_lshl_or_b32 v46, v47, 16, v46
    v_accvgpr_write_b32 a183, v46
    v_lshl_or_b32 v48, v49, 16, v48
    v_accvgpr_write_b32 a184, v48
    v_lshl_or_b32 v50, v51, 16, v50
    v_accvgpr_write_b32 a185, v50
    v_lshl_or_b32 v52, v53, 16, v52
    v_accvgpr_write_b32 a186, v52
    v_lshl_or_b32 v54, v55, 16, v54
    v_accvgpr_write_b32 a187, v54
    v_lshl_or_b32 v56, v57, 16, v56
    v_accvgpr_write_b32 a188, v56
    v_lshl_or_b32 v58, v59, 16, v58
    v_accvgpr_write_b32 a189, v58
    v_lshl_or_b32 v60, v61, 16, v60
    v_accvgpr_write_b32 a190, v60
    v_lshl_or_b32 v62, v63, 16, v62
    v_accvgpr_write_b32 a191, v62
    v_lshl_or_b32 v64, v65, 16, v64
    v_accvgpr_write_b32 a192, v64
    v_lshl_or_b32 v66, v67, 16, v66
    v_accvgpr_write_b32 a193, v66
    v_lshl_or_b32 v68, v69, 16, v68
    v_accvgpr_write_b32 a194, v68
    v_lshl_or_b32 v70, v71, 16, v70
    v_accvgpr_write_b32 a195, v70
    v_lshl_or_b32 v72, v73, 16, v72
    v_accvgpr_write_b32 a196, v72
    v_lshl_or_b32 v74, v75, 16, v74
    v_accvgpr_write_b32 a197, v74
    v_lshl_or_b32 v76, v77, 16, v76
    v_accvgpr_write_b32 a198, v76
    v_lshl_or_b32 v78, v79, 16, v78
    v_accvgpr_write_b32 a199, v78
    v_lshl_or_b32 v80, v81, 16, v80
    v_accvgpr_write_b32 a200, v80
    v_lshl_or_b32 v82, v83, 16, v82
    v_accvgpr_write_b32 a201, v82
    v_lshl_or_b32 v84, v85, 16, v84
    v_accvgpr_write_b32 a202, v84
    v_lshl_or_b32 v86, v87, 16, v86
    v_accvgpr_write_b32 a203, v86
    s_waitcnt vmcnt(48)
    v_lshl_or_b32 v88, v89, 16, v88
    v_accvgpr_write_b32 a204, v88
    v_lshl_or_b32 v90, v91, 16, v90
    v_accvgpr_write_b32 a205, v90
    v_lshl_or_b32 v92, v93, 16, v92
    v_accvgpr_write_b32 a206, v92
    v_lshl_or_b32 v94, v95, 16, v94
    v_accvgpr_write_b32 a207, v94
    v_lshl_or_b32 v96, v97, 16, v96
    v_accvgpr_write_b32 a208, v96
    v_lshl_or_b32 v98, v99, 16, v98
    v_accvgpr_write_b32 a209, v98
    v_lshl_or_b32 v100, v101, 16, v100
    v_accvgpr_write_b32 a210, v100
    v_lshl_or_b32 v102, v103, 16, v102
    v_accvgpr_write_b32 a211, v102
    v_lshl_or_b32 v104, v105, 16, v104
    v_accvgpr_write_b32 a212, v104
    v_lshl_or_b32 v106, v107, 16, v106
    v_accvgpr_write_b32 a213, v106
    v_lshl_or_b32 v108, v109, 16, v108
    v_accvgpr_write_b32 a214, v108
    v_lshl_or_b32 v110, v111, 16, v110
    v_accvgpr_write_b32 a215, v110
    v_lshl_or_b32 v112, v113, 16, v112
    v_accvgpr_write_b32 a216, v112
    v_lshl_or_b32 v114, v115, 16, v114
    v_accvgpr_write_b32 a217, v114
    v_lshl_or_b32 v116, v117, 16, v116
    v_accvgpr_write_b32 a218, v116
    v_lshl_or_b32 v118, v119, 16, v118
    v_accvgpr_write_b32 a219, v118
    v_lshl_or_b32 v120, v121, 16, v120
    v_accvgpr_write_b32 a220, v120
    v_lshl_or_b32 v122, v123, 16, v122
    v_accvgpr_write_b32 a221, v122
    v_lshl_or_b32 v124, v125, 16, v124
    v_accvgpr_write_b32 a222, v124
    v_lshl_or_b32 v126, v127, 16, v126
    v_accvgpr_write_b32 a223, v126
    v_lshl_or_b32 v128, v129, 16, v128
    v_accvgpr_write_b32 a224, v128
    v_lshl_or_b32 v130, v131, 16, v130
    v_accvgpr_write_b32 a225, v130
    v_lshl_or_b32 v132, v133, 16, v132
    v_accvgpr_write_b32 a226, v132
    v_lshl_or_b32 v134, v135, 16, v134
    v_accvgpr_write_b32 a227, v134
    s_waitcnt vmcnt(0)
    v_lshl_or_b32 v136, v137, 16, v136
    v_accvgpr_write_b32 a228, v136
    v_lshl_or_b32 v138, v139, 16, v138
    v_accvgpr_write_b32 a229, v138
    v_lshl_or_b32 v140, v141, 16, v140
    v_accvgpr_write_b32 a230, v140
    v_lshl_or_b32 v142, v143, 16, v142
    v_accvgpr_write_b32 a231, v142
    v_lshl_or_b32 v144, v145, 16, v144
    v_accvgpr_write_b32 a232, v144
    v_lshl_or_b32 v146, v147, 16, v146
    v_accvgpr_write_b32 a233, v146
    v_lshl_or_b32 v148, v149, 16, v148
    v_accvgpr_write_b32 a234, v148
    v_lshl_or_b32 v150, v151, 16, v150
    v_accvgpr_write_b32 a235, v150
    v_lshl_or_b32 v152, v153, 16, v152
    v_accvgpr_write_b32 a236, v152
    v_lshl_or_b32 v154, v155, 16, v154
    v_accvgpr_write_b32 a237, v154
    v_lshl_or_b32 v156, v157, 16, v156
    v_accvgpr_write_b32 a238, v156
    v_lshl_or_b32 v158, v159, 16, v158
    v_accvgpr_write_b32 a239, v158
    v_lshl_or_b32 v160, v161, 16, v160
    v_accvgpr_write_b32 a240, v160
    v_lshl_or_b32 v162, v163, 16, v162
    v_accvgpr_write_b32 a241, v162
    v_lshl_or_b32 v164, v165, 16, v164
    v_accvgpr_write_b32 a242, v164
    v_lshl_or_b32 v166, v167, 16, v166
    v_accvgpr_write_b32 a243, v166
    v_lshl_or_b32 v168, v169, 16, v168
    v_accvgpr_write_b32 a244, v168
    v_lshl_or_b32 v170, v171, 16, v170
    v_accvgpr_write_b32 a245, v170
    v_lshl_or_b32 v172, v173, 16, v172
    v_accvgpr_write_b32 a246, v172
    v_lshl_or_b32 v174, v175, 16, v174
    v_accvgpr_write_b32 a247, v174
    v_lshl_or_b32 v176, v177, 16, v176
    v_accvgpr_write_b32 a248, v176
    v_lshl_or_b32 v178, v179, 16, v178
    v_accvgpr_write_b32 a249, v178
    v_lshl_or_b32 v180, v181, 16, v180
    v_accvgpr_write_b32 a250, v180
    v_lshl_or_b32 v182, v183, 16, v182
    v_accvgpr_write_b32 a251, v182
    v_and_b32 v32, 7, v1
    v_mul_u32_u24 v5, 1296, v32
    v_mul_u32_u24 v33, 320, v2
    v_add_u32 v5, v5, v33
    v_lshlrev_b32 v33, 4, v4
    v_add_u32 v5, v5, v33
    v_mul_u32_u24 v6, 3200, v2
    v_mul_u32_u24 v33, 400, v32
    v_add_u32 v6, v6, v33
    v_lshlrev_b32 v33, 4, v4
    v_add_u32 v6, v6, v33
    v_add_u32 v6, 10496, v6
    v_mul_u32_u24 v7, 1536, v2
    v_lshlrev_b32 v33, 5, v3
    v_add_u32 v7, v7, v33
    v_and_b32 v33, 1, v4
    v_lshlrev_b32 v33, 4, v33
    v_add_u32 v7, v7, v33
    v_add_u32 v7, 23296, v7
    v_mul_u32_u24 v33, 43, v1
    v_lshrrev_b32 v33, 8, v33
    v_mul_u32_u24 v34, 6, v33
    v_sub_u32 v34, v1, v34
    v_mul_u32_u24 v35, 400, v33
    v_lshlrev_b32 v36, 5, v34
    v_add_u32 v35, v35, v36
    v_subrev_u32 v41, 1, v2
    v_mul_u32_u24 v36, 192, v41
    v_add_u32 v35, v35, v36
    v_add_u32 v35, 10496, v35
    s_mul_i32 s34, s20, 24
    s_mul_i32 s35, s21, 6
    s_add_u32 s34, s34, s35
    v_add_u32 v36, s34, v34
    v_lshlrev_b32 v36, 3, v36
    v_add_u32 v36, v36, v33
    v_lshlrev_b32 v36, 4, v36
    s_mov_b32 s34, -12582912
    v_mul_lo_u32 v37, v41, s34
    v_add_u32 v36, v36, v37
    v_add_u32 v36, 100057088, v36
    v_lshlrev_b32 v39, 5, v1
    v_add_u32 v39, 23296, v39
    s_mul_i32 s34, s20, 192
    s_mul_i32 s35, s21, 48
    s_add_u32 s34, s34, s35
    v_add_u32 v40, s34, v1
    v_lshlrev_b32 v40, 4, v40
    v_add_u32 v40, 93765632, v40
    v_cmp_gt_u32 vcc, 3, v2
    s_nop 1
    v_cndmask_b32 v8, v39, v35, vcc
    v_cndmask_b32 v9, v40, v36, vcc
    s_mov_b32 s34, -13762560
    s_mov_b32 s35, -1081344
    s_mov_b32 s36, -7274496
    s_cmp_eq_u32 s25, 2
    s_cselect_b32 s34, s35, s34
    s_cmp_eq_u32 s25, 3
    s_cselect_b32 s34, s36, s34
    v_add_u32 v58, s34, v9
    s_mul_i32 s34, s20, 192
    v_lshlrev_b32 v35, 3, v4
    v_add_u32 v35, v35, v32
    v_add_u32 v35, s34, v35
    v_lshlrev_b32 v10, 4, v35
    v_add_u32 v35, s34, v3
    v_lshlrev_b32 v13, 4, v35
    v_and_b32 v36, 1, v4
    v_lshlrev_b32 v36, 3, v36
    v_add_u32 v13, v13, v36
    v_mul_u32_u24 v14, 400, v32
    v_lshlrev_b32 v35, 3, v4
    v_add_u32 v14, v14, v35
    v_add_u32 v14, 29440, v14
    v_mul_u32_u24 v15, 400, v32
    v_lshlrev_b32 v35, 4, v4
    v_add_u32 v15, v15, v35
    v_add_u32 v15, 29440, v15
    s_lshl_b32 s34, s21, 5
    s_add_u32 s34, s34, s20
    s_lshl_b32 s34, s34, 3
    v_add_u32 v35, s34, v32
    v_mul_u32_u24 v16, 640, v35
    v_lshlrev_b32 v35, 6, v2
    v_add_u32 v16, v16, v35
    v_lshlrev_b32 v35, 4, v4
    v_add_u32 v16, v16, v35
    v_add_u32 v16, 84819968, v16
    s_lshl_b32 s34, s21, 8
    s_lshr_b32 s35, s20, 2
    s_add_u32 s34, s34, s35
    s_mul_i32 s34, s34, 640
    s_and_b32 s35, s20, 3
    s_mul_i32 s35, s35, 160
    s_add_u32 s34, s34, s35
    s_add_u32 s34, s34, 84819968
    v_min_u32 v35, 39, v1
    v_lshlrev_b32 v35, 2, v35
    v_add_u32 v17, s34, v35
    s_lshr_b32 s35, s20, 2
    s_mul_i32 s34, s35, 1280
    s_mul_i32 s35, s21, 320
    s_add_u32 s34, s34, s35
    s_and_b32 s35, s20, 3
    s_mul_i32 s35, s35, 80
    s_add_u32 s34, s34, s35
    s_add_u32 s34, s34, 86130688
    v_lshlrev_b32 v35, 1, v1
    v_add_u32 v18, s34, v35
    v_lshlrev_b32 v19, 4, v1
    v_add_u32 v35, 0, v1
    v_mul_u32_u24 v36, 52429, v35
    v_lshrrev_b32 v36, 22, v36
    v_mul_u32_u24 v37, 80, v36
    v_sub_u32 v37, v35, v37
    v_mul_u32_u24 v20, 1296, v36
    v_lshlrev_b32 v37, 4, v37
    v_add_u32 v20, v20, v37
    v_add_u32 v35, 64, v1
    v_mul_u32_u24 v36, 52429, v35
    v_lshrrev_b32 v36, 22, v36
    v_mul_u32_u24 v37, 80, v36
    v_sub_u32 v37, v35, v37
    v_mul_u32_u24 v21, 1296, v36
    v_lshlrev_b32 v37, 4, v37
    v_add_u32 v21, v21, v37
    v_add_u32 v35, 128, v1
    v_mul_u32_u24 v36, 52429, v35
    v_lshrrev_b32 v36, 22, v36
    v_mul_u32_u24 v37, 80, v36
    v_sub_u32 v37, v35, v37
    v_mul_u32_u24 v22, 1296, v36
    v_lshlrev_b32 v37, 4, v37
    v_add_u32 v22, v22, v37
    v_add_u32 v35, 192, v1
    v_mul_u32_u24 v36, 52429, v35
    v_lshrrev_b32 v36, 22, v36
    v_mul_u32_u24 v37, 80, v36
    v_sub_u32 v37, v35, v37
    v_mul_u32_u24 v23, 1296, v36
    v_lshlrev_b32 v37, 4, v37
    v_add_u32 v23, v23, v37
    v_add_u32 v35, 256, v1
    v_mul_u32_u24 v36, 52429, v35
    v_lshrrev_b32 v36, 22, v36
    v_mul_u32_u24 v37, 80, v36
    v_sub_u32 v37, v35, v37
    v_mul_u32_u24 v24, 1296, v36
    v_lshlrev_b32 v37, 4, v37
    v_add_u32 v24, v24, v37
    v_add_u32 v35, 320, v1
    v_mul_u32_u24 v36, 52429, v35
    v_lshrrev_b32 v36, 22, v36
    v_mul_u32_u24 v37, 80, v36
    v_sub_u32 v37, v35, v37
    v_mul_u32_u24 v25, 1296, v36
    v_lshlrev_b32 v37, 4, v37
    v_add_u32 v25, v25, v37
    v_add_u32 v35, 384, v1
    v_mul_u32_u24 v36, 52429, v35
    v_lshrrev_b32 v36, 22, v36
    v_mul_u32_u24 v37, 80, v36
    v_sub_u32 v37, v35, v37
    v_mul_u32_u24 v26, 1296, v36
    v_lshlrev_b32 v37, 4, v37
    v_add_u32 v26, v26, v37
    v_add_u32 v35, 448, v1
    v_mul_u32_u24 v36, 52429, v35
    v_lshrrev_b32 v36, 22, v36
    v_mul_u32_u24 v37, 80, v36
    v_sub_u32 v37, v35, v37
    v_mul_u32_u24 v27, 1296, v36
    v_lshlrev_b32 v37, 4, v37
    v_add_u32 v27, v27, v37
    v_add_u32 v35, 512, v1
    v_mul_u32_u24 v36, 52429, v35
    v_lshrrev_b32 v36, 22, v36
    v_mul_u32_u24 v37, 80, v36
    v_sub_u32 v37, v35, v37
    v_mul_u32_u24 v28, 1296, v36
    v_lshlrev_b32 v37, 4, v37
    v_add_u32 v28, v28, v37
    v_add_u32 v35, 576, v1
    v_mul_u32_u24 v36, 52429, v35
    v_lshrrev_b32 v36, 22, v36
    v_mul_u32_u24 v37, 80, v36
    v_sub_u32 v37, v35, v37
    v_mul_u32_u24 v29, 1296, v36
    v_lshlrev_b32 v37, 4, v37
    v_add_u32 v29, v29, v37
    s_mul_i32 s34, s20, 12288
    v_lshlrev_b32 v31, 4, v1
    v_add_u32 v31, s34, v31
    v_lshlrev_b32 v33, 5, v4
    v_add_u32 v33, v33, v3
    v_lshlrev_b32 v11, 4, v33
    v_add_u32 v11, 32768, v11
    v_lshlrev_b32 v12, 6, v3
    v_lshlrev_b32 v33, 3, v4
    v_add_u32 v12, v12, v33
    v_add_u32 v12, 45056, v12
    v_cmp_gt_u32 vcc, 48, v1
    s_mov_b64 s[40:41], vcc
    v_cmp_gt_u32 vcc, 8, v3
    s_mov_b64 s[42:43], vcc
    s_mov_b32 s44, 0x55555555
    s_mov_b32 s45, 0x55
    v_add_u32 v39, 0, v19
    buffer_load_dwordx4 v[64:67], v39, s[12:15], 0 offen
    v_add_u32 v39, 1024, v19
    buffer_load_dwordx4 v[68:71], v39, s[12:15], 0 offen
    v_add_u32 v39, 2048, v19
    buffer_load_dwordx4 v[72:75], v39, s[12:15], 0 offen
    v_add_u32 v39, 3072, v19
    buffer_load_dwordx4 v[76:79], v39, s[12:15], 0 offen
    v_add_u32 v39, 4096, v19
    buffer_load_dwordx4 v[80:83], v39, s[12:15], 0 offen
    v_add_u32 v39, 5120, v19
    buffer_load_dwordx4 v[84:87], v39, s[12:15], 0 offen
    v_add_u32 v39, 6144, v19
    buffer_load_dwordx4 v[88:91], v39, s[12:15], 0 offen
    v_add_u32 v39, 7168, v19
    buffer_load_dwordx4 v[92:95], v39, s[12:15], 0 offen
    v_add_u32 v39, 8192, v19
    buffer_load_dwordx4 v[96:99], v39, s[12:15], 0 offen
    v_add_u32 v39, 9216, v19
    buffer_load_dwordx4 v[100:103], v39, s[12:15], 0 offen
    s_waitcnt vmcnt(0)
    ds_write_b128 v20, v[64:67]
    ds_write_b128 v21, v[68:71]
    ds_write_b128 v22, v[72:75]
    ds_write_b128 v23, v[76:79]
    ds_write_b128 v24, v[80:83]
    ds_write_b128 v25, v[84:87]
    ds_write_b128 v26, v[88:91]
    ds_write_b128 v27, v[92:95]
    ds_write_b128 v28, v[96:99]
    ds_write_b128 v29, v[100:103]
    s_mov_b32 s50, 0
    s_cmp_lg_u32 s25, 3
    s_cbranch_scc1 mega_kernel_sk04
    s_and_b32 s58, s50, 3
    s_cmp_lg_u32 s58, 0
    s_cbranch_scc1 mega_kernel_skw5
    s_lshr_b32 s58, s50, 2
    s_lshl_b32 s58, s58, 7
    s_add_u32 s58, s58, 16384
    v_mov_b32 v33, s58
    s_mov_b32 s55, 0
mega_kernel_wkv6:
    buffer_load_dword v34, v33, s[4:7], 0 offen sc1
    s_waitcnt vmcnt(0)
    v_cmp_gt_u32 vcc, 96, v34
    s_nop 0
    s_cbranch_vccz mega_kernel_wkvd7
    s_sleep 8
    s_sleep 1
    s_add_u32 s55, s55, 1
    s_cmp_lt_u32 s55, 300000
    s_cbranch_scc1 mega_kernel_wkv6
    s_mov_b32 s56, 4
    s_branch mega_kernel_fail3
mega_kernel_wkvd7:
mega_kernel_skw5:
    s_and_b32 s58, s50, 1
    s_mul_i32 s58, s58, 24576
    s_add_u32 s58, s58, 32768
    s_mul_i32 s52, s50, 32*12288
    s_add_u32 s52, s52, 34488320
    s_add_u32 m0, s58, 0
    s_add_u32 s53, s52, 0
    buffer_load_dwordx4 v31, s[4:7], s53 offen lds
    s_add_u32 m0, s58, 1024
    s_add_u32 s53, s52, 1024
    buffer_load_dwordx4 v31, s[4:7], s53 offen lds
    s_add_u32 m0, s58, 2048
    s_add_u32 s53, s52, 2048
    buffer_load_dwordx4 v31, s[4:7], s53 offen lds
    s_add_u32 m0, s58, 3072
    s_add_u32 s53, s52, 3072
    buffer_load_dwordx4 v31, s[4:7], s53 offen lds
    s_add_u32 m0, s58, 4096
    s_add_u32 s53, s52, 4096
    buffer_load_dwordx4 v31, s[4:7], s53 offen lds
    s_add_u32 m0, s58, 5120
    s_add_u32 s53, s52, 5120
    buffer_load_dwordx4 v31, s[4:7], s53 offen lds
    s_add_u32 m0, s58, 6144
    s_add_u32 s53, s52, 6144
    buffer_load_dwordx4 v31, s[4:7], s53 offen lds
    s_add_u32 m0, s58, 7168
    s_add_u32 s53, s52, 7168
    buffer_load_dwordx4 v31, s[4:7], s53 offen lds
    s_add_u32 m0, s58, 8192
    s_add_u32 s53, s52, 8192
    buffer_load_dwordx4 v31, s[4:7], s53 offen lds
    s_add_u32 m0, s58, 9216
    s_add_u32 s53, s52, 9216
    buffer_load_dwordx4 v31, s[4:7], s53 offen lds
    s_add_u32 m0, s58, 10240
    s_add_u32 s53, s52, 10240
    buffer_load_dwordx4 v31, s[4:7], s53 offen lds
    s_add_u32 m0, s58, 11264
    s_add_u32 s53, s52, 11264
    buffer_load_dwordx4 v31, s[4:7], s53 offen lds
    s_mul_i32 s52, s50, 32*192*64
    s_add_u32 s52, s52, 59654144
    s_add_u32 m0, s58, 12288
    s_add_u32 s53, s52, 0
    buffer_load_dwordx4 v31, s[4:7], s53 offen lds
    s_add_u32 m0, s58, 13312
    s_add_u32 s53, s52, 1024
    buffer_load_dwordx4 v31, s[4:7], s53 offen lds
    s_add_u32 m0, s58, 14336
    s_add_u32 s53, s52, 2048
    buffer_load_dwordx4 v31, s[4:7], s53 offen lds
    s_add_u32 m0, s58, 15360
    s_add_u32 s53, s52, 3072
    buffer_load_dwordx4 v31, s[4:7], s53 offen lds
    s_add_u32 m0, s58, 16384
    s_add_u32 s53, s52, 4096
    buffer_load_dwordx4 v31, s[4:7], s53 offen lds
    s_add_u32 m0, s58, 17408
    s_add_u32 s53, s52, 5120
    buffer_load_dwordx4 v31, s[4:7], s53 offen lds
    s_add_u32 m0, s58, 18432
    s_add_u32 s53, s52, 6144
    buffer_load_dwordx4 v31, s[4:7], s53 offen lds
    s_add_u32 m0, s58, 19456
    s_add_u32 s53, s52, 7168
    buffer_load_dwordx4 v31, s[4:7], s53 offen lds
    s_add_u32 m0, s58, 20480
    s_add_u32 s53, s52, 8192
    buffer_load_dwordx4 v31, s[4:7], s53 offen lds
    s_add_u32 m0, s58, 21504
    s_add_u32 s53, s52, 9216
    buffer_load_dwordx4 v31, s[4:7], s53 offen lds
    s_add_u32 m0, s58, 22528
    s_add_u32 s53, s52, 10240
    buffer_load_dwordx4 v31, s[4:7], s53 offen lds
    s_add_u32 m0, s58, 23552
    s_add_u32 s53, s52, 11264
    buffer_load_dwordx4 v31, s[4:7], s53 offen lds
    s_waitcnt vmcnt(0)
mega_kernel_sk04:
    s_waitcnt lgkmcnt(0)
    s_barrier
    ds_read_b128 v[104:107], v5 offset:0
    ds_read_b128 v[108:111], v5 offset:64
    ds_read_b128 v[112:115], v5 offset:128
    ds_read_b128 v[116:119], v5 offset:192
    ds_read_b128 v[120:123], v5 offset:256
    s_waitcnt lgkmcnt(0)
    v_and_b32 v32, 7, v1
    v_mul_u32_u24 v19, 1280, v32
    v_mul_u32_u24 v33, 320, v2
    v_add_u32 v19, v19, v33
    v_lshlrev_b32 v33, 4, v4
    v_add_u32 v19, v19, v33
    s_nop 1
mega_kernel_loop8:
    s_mul_i32 s51, s50, 98304
    s_and_b32 s63, s50, 3
    s_mul_i32 s63, s63, 294912
    v_mfma_f32_16x16x32_bf16 v[64:67], a[0:3], v[104:107], 0
    v_mfma_f32_16x16x32_bf16 v[68:71], a[4:7], v[104:107], 0
    v_mfma_f32_16x16x32_bf16 v[72:75], a[8:11], v[104:107], 0
    v_mfma_f32_16x16x32_bf16 v[76:79], a[12:15], v[104:107], 0
    v_mfma_f32_16x16x32_bf16 v[80:83], a[16:19], v[104:107], 0
    v_mfma_f32_16x16x32_bf16 v[84:87], a[20:23], v[104:107], 0
    v_mfma_f32_16x16x32_bf16 v[64:67], a[36:39], v[108:111], v[64:67]
    v_mfma_f32_16x16x32_bf16 v[68:71], a[40:43], v[108:111], v[68:71]
    v_mfma_f32_16x16x32_bf16 v[72:75], a[44:47], v[108:111], v[72:75]
    v_mfma_f32_16x16x32_bf16 v[76:79], a[48:51], v[108:111], v[76:79]
    v_mfma_f32_16x16x32_bf16 v[80:83], a[52:55], v[108:111], v[80:83]
    v_mfma_f32_16x16x32_bf16 v[84:87], a[56:59], v[108:111], v[84:87]
    v_mfma_f32_16x16x32_bf16 v[64:67], a[72:75], v[112:115], v[64:67]
    v_mfma_f32_16x16x32_bf16 v[68:71], a[76:79], v[112:115], v[68:71]
    v_mfma_f32_16x16x32_bf16 v[72:75], a[80:83], v[112:115], v[72:75]
    v_mfma_f32_16x16x32_bf16 v[76:79], a[84:87], v[112:115], v[76:79]
    v_mfma_f32_16x16x32_bf16 v[80:83], a[88:91], v[112:115], v[80:83]
    v_mfma_f32_16x16x32_bf16 v[84:87], a[92:95], v[112:115], v[84:87]
    v_mfma_f32_16x16x32_bf16 v[64:67], a[108:111], v[116:119], v[64:67]
    v_mfma_f32_16x16x32_bf16 v[68:71], a[112:115], v[116:119], v[68:71]
    v_mfma_f32_16x16x32_bf16 v[72:75], a[116:119], v[116:119], v[72:75]
    v_mfma_f32_16x16x32_bf16 v[76:79], a[120:123], v[116:119], v[76:79]
    v_mfma_f32_16x16x32_bf16 v[80:83], a[124:127], v[116:119], v[80:83]
    v_mfma_f32_16x16x32_bf16 v[84:87], a[128:131], v[116:119], v[84:87]
    v_mfma_f32_16x16x32_bf16 v[64:67], a[144:147], v[120:123], v[64:67]
    v_mfma_f32_16x16x32_bf16 v[68:71], a[148:151], v[120:123], v[68:71]
    v_mfma_f32_16x16x32_bf16 v[72:75], a[152:155], v[120:123], v[72:75]
    v_mfma_f32_16x16x32_bf16 v[76:79], a[156:159], v[120:123], v[76:79]
    v_mfma_f32_16x16x32_bf16 v[80:83], a[160:163], v[120:123], v[80:83]
    v_mfma_f32_16x16x32_bf16 v[84:87], a[164:167], v[120:123], v[84:87]
    s_nop 7
    ds_write_b128 v6, v[64:67] offset:0
    ds_write_b128 v6, v[68:71] offset:64
    ds_write_b128 v6, v[72:75] offset:128
    ds_write_b128 v6, v[76:79] offset:192
    ds_write_b128 v6, v[80:83] offset:256
    ds_write_b128 v6, v[84:87] offset:320
    s_waitcnt lgkmcnt(0)
    s_barrier
    s_cmp_eq_u32 s25, 0
    s_cbranch_scc1 mega_kernel_nqk10
    s_cmp_eq_u32 s25, 3
    s_cbranch_scc1 mega_kernel_nqk10
    s_mov_b64 exec, s[40:41]
    v_mov_b32 v62, 3200
    v_add_u32 v60, v62, v8
    v_add_u32 v61, v62, v60
    v_add_u32 v62, v62, v61
    ds_read_b128 v[32:35], v8
    ds_read_b128 v[36:39], v8 offset:16
    ds_read_b128 v[40:43], v60
    ds_read_b128 v[44:47], v60 offset:16
    ds_read_b128 v[48:51], v61
    ds_read_b128 v[52:55], v61 offset:16
    ds_read_b128 v[208:211], v62
    ds_read_b128 v[212:215], v62 offset:16
    s_waitcnt lgkmcnt(0)
    v_add_f32 v32, v32, v40
    v_add_f32 v48, v48, v208
    v_add_f32 v32, v32, v48
    v_add_f32 v33, v33, v41
    v_add_f32 v49, v49, v209
    v_add_f32 v33, v33, v49
    v_add_f32 v34, v34, v42
    v_add_f32 v50, v50, v210
    v_add_f32 v34, v34, v50
    v_add_f32 v35, v35, v43
    v_add_f32 v51, v51, v211
    v_add_f32 v35, v35, v51
    v_add_f32 v36, v36, v44
    v_add_f32 v52, v52, v212
    v_add_f32 v36, v36, v52
    v_add_f32 v37, v37, v45
    v_add_f32 v53, v53, v213
    v_add_f32 v37, v37, v53
    v_add_f32 v38, v38, v46
    v_add_f32 v54, v54, v214
    v_add_f32 v38, v38, v54
    v_add_f32 v39, v39, v47
    v_add_f32 v55, v55, v215
    v_add_f32 v39, v39, v55
    v_cvt_pk_bf16_f32 v40, v32, v33
    v_cvt_pk_bf16_f32 v41, v34, v35
    v_cvt_pk_bf16_f32 v42, v36, v37
    v_cvt_pk_bf16_f32 v43, v38, v39
    buffer_store_dwordx4 v[40:43], v58, s[4:7], s63 offen sc0 sc1
    s_cmp_lg_u32 s50, 63
    s_cbranch_scc1 mega_kernel_lastst11
    buffer_store_dwordx4 v[40:43], v9, s[4:7], s51 offen sc0 sc1
mega_kernel_lastst11:
    s_mov_b64 exec, -1
mega_kernel_nqk10:
    v_mfma_f32_16x16x32_bf16 v[88:91], v[104:107], a[24:27], 0
    v_mfma_f32_16x16x32_bf16 v[92:95], v[104:107], a[28:31], 0
    v_mfma_f32_16x16x32_bf16 v[96:99], v[104:107], a[32:35], 0
    v_mfma_f32_16x16x32_bf16 v[88:91], v[108:111], a[60:63], v[88:91]
    v_mfma_f32_16x16x32_bf16 v[92:95], v[108:111], a[64:67], v[92:95]
    v_mfma_f32_16x16x32_bf16 v[96:99], v[108:111], a[68:71], v[96:99]
    v_mfma_f32_16x16x32_bf16 v[88:91], v[112:115], a[96:99], v[88:91]
    v_mfma_f32_16x16x32_bf16 v[92:95], v[112:115], a[100:103], v[92:95]
    v_mfma_f32_16x16x32_bf16 v[96:99], v[112:115], a[104:107], v[96:99]
    v_mfma_f32_16x16x32_bf16 v[88:91], v[116:119], a[132:135], v[88:91]
    v_mfma_f32_16x16x32_bf16 v[92:95], v[116:119], a[136:139], v[92:95]
    v_mfma_f32_16x16x32_bf16 v[96:99], v[116:119], a[140:143], v[96:99]
    v_mfma_f32_16x16x32_bf16 v[88:91], v[120:123], a[168:171], v[88:91]
    v_mfma_f32_16x16x32_bf16 v[92:95], v[120:123], a[172:175], v[92:95]
    v_mfma_f32_16x16x32_bf16 v[96:99], v[120:123], a[176:179], v[96:99]
    s_nop 7
    ds_write_b128 v7, v[88:91] offset:0
    ds_write_b128 v7, v[92:95] offset:512
    ds_write_b128 v7, v[96:99] offset:1024
    s_waitcnt lgkmcnt(0)
    s_barrier
    s_cmp_lg_u32 s25, 3
    s_cbranch_scc1 mega_kernel_redd9
    s_mov_b64 exec, s[40:41]
    v_mov_b32 v62, 1536
    v_add_u32 v60, v62, v8
    v_add_u32 v61, v62, v60
    v_add_u32 v62, v62, v61
    ds_read_b128 v[32:35], v8
    ds_read_b128 v[36:39], v8 offset:16
    ds_read_b128 v[40:43], v60
    ds_read_b128 v[44:47], v60 offset:16
    ds_read_b128 v[48:51], v61
    ds_read_b128 v[52:55], v61 offset:16
    ds_read_b128 v[208:211], v62
    ds_read_b128 v[212:215], v62 offset:16
    s_waitcnt lgkmcnt(0)
    v_add_f32 v32, v32, v40
    v_add_f32 v48, v48, v208
    v_add_f32 v32, v32, v48
    v_add_f32 v33, v33, v41
    v_add_f32 v49, v49, v209
    v_add_f32 v33, v33, v49
    v_add_f32 v34, v34, v42
    v_add_f32 v50, v50, v210
    v_add_f32 v34, v34, v50
    v_add_f32 v35, v35, v43
    v_add_f32 v51, v51, v211
    v_add_f32 v35, v35, v51
    v_add_f32 v36, v36, v44
    v_add_f32 v52, v52, v212
    v_add_f32 v36, v36, v52
    v_add_f32 v37, v37, v45
    v_add_f32 v53, v53, v213
    v_add_f32 v37, v37, v53
    v_add_f32 v38, v38, v46
    v_add_f32 v54, v54, v214
    v_add_f32 v38, v38, v54
    v_add_f32 v39, v39, v47
    v_add_f32 v55, v55, v215
    v_add_f32 v39, v39, v55
    v_cvt_pk_bf16_f32 v40, v32, v33
    v_cvt_pk_bf16_f32 v41, v34, v35
    v_cvt_pk_bf16_f32 v42, v36, v37
    v_cvt_pk_bf16_f32 v43, v38, v39
    buffer_store_dwordx4 v[40:43], v58, s[4:7], s63 offen sc0 sc1
    s_cmp_lg_u32 s50, 63
    s_cbranch_scc1 mega_kernel_lastst12
    buffer_store_dwordx4 v[40:43], v9, s[4:7], s51 offen sc0 sc1
mega_kernel_lastst12:
    s_mov_b64 exec, -1
mega_kernel_redd9:
    s_cmp_eq_u32 s50, 63
    s_cbranch_scc1 mega_kernel_done1
    s_cmp_eq_u32 s25, 0
    s_cbranch_scc1 mega_kernel_attw014
    s_barrier
    s_mov_b64 exec, s[40:41]
    s_cmp_eq_u32 s25, 1
    s_cbranch_scc1 mega_kernel_skq15
    buffer_store_dwordx4 v[40:43], v9, s[4:7], s51 offen sc0 sc1
mega_kernel_skq15:
    s_add_u32 s53, s50, 2
    s_and_b32 s53, s53, 3
    s_mul_i32 s53, s53, 294912
    v_mov_b32 v44, -1
    v_mov_b32 v45, -1
    v_mov_b32 v46, -1
    v_mov_b32 v47, -1
    buffer_store_dwordx4 v[44:47], v58, s[4:7], s53 offen sc0 sc1
    s_mov_b64 exec, -1
    s_cmp_lg_u32 s25, 1
    s_cbranch_scc1 mega_kernel_nw116
    s_cmp_eq_u32 s50, 0
    s_cbranch_scc1 mega_kernel_attd13
    s_add_u32 s52, s50, 1
    s_and_b32 s52, s52, 1
    s_mul_i32 s52, s52, 655360
    s_mov_b32 s58, -1
    s_mov_b32 s59, 0xff
    s_mov_b64 exec, s[58:59]
    v_mov_b32 v33, -1
    s_add_u32 s53, s52, 0
    buffer_store_dword v33, v17, s[4:7], s53 offen sc0 sc1
    s_add_u32 s53, s52, 5120
    buffer_store_dword v33, v17, s[4:7], s53 offen sc0 sc1
    s_add_u32 s53, s52, 10240
    buffer_store_dword v33, v17, s[4:7], s53 offen sc0 sc1
    s_add_u32 s53, s52, 15360
    buffer_store_dword v33, v17, s[4:7], s53 offen sc0 sc1
    s_add_u32 s53, s52, 20480
    buffer_store_dword v33, v17, s[4:7], s53 offen sc0 sc1
    s_add_u32 s53, s52, 25600
    buffer_store_dword v33, v17, s[4:7], s53 offen sc0 sc1
    s_add_u32 s53, s52, 30720
    buffer_store_dword v33, v17, s[4:7], s53 offen sc0 sc1
    s_add_u32 s53, s52, 35840
    buffer_store_dword v33, v17, s[4:7], s53 offen sc0 sc1
    s_add_u32 s53, s52, 40960
    buffer_store_dword v33, v17, s[4:7], s53 offen sc0 sc1
    s_add_u32 s53, s52, 46080
    buffer_store_dword v33, v17, s[4:7], s53 offen sc0 sc1
    s_add_u32 s53, s52, 51200
    buffer_store_dword v33, v17, s[4:7], s53 offen sc0 sc1
    s_add_u32 s53, s52, 56320
    buffer_store_dword v33, v17, s[4:7], s53 offen sc0 sc1
    s_add_u32 s53, s52, 61440
    buffer_store_dword v33, v17, s[4:7], s53 offen sc0 sc1
    s_add_u32 s53, s52, 66560
    buffer_store_dword v33, v17, s[4:7], s53 offen sc0 sc1
    s_add_u32 s53, s52, 71680
    buffer_store_dword v33, v17, s[4:7], s53 offen sc0 sc1
    s_add_u32 s53, s52, 76800
    buffer_store_dword v33, v17, s[4:7], s53 offen sc0 sc1
    s_add_u32 s53, s52, 81920
    buffer_store_dword v33, v17, s[4:7], s53 offen sc0 sc1
    s_add_u32 s53, s52, 87040
    buffer_store_dword v33, v17, s[4:7], s53 offen sc0 sc1
    s_add_u32 s53, s52, 92160
    buffer_store_dword v33, v17, s[4:7], s53 offen sc0 sc1
    s_add_u32 s53, s52, 97280
    buffer_store_dword v33, v17, s[4:7], s53 offen sc0 sc1
    s_add_u32 s53, s52, 102400
    buffer_store_dword v33, v17, s[4:7], s53 offen sc0 sc1
    s_add_u32 s53, s52, 107520
    buffer_store_dword v33, v17, s[4:7], s53 offen sc0 sc1
    s_add_u32 s53, s52, 112640
    buffer_store_dword v33, v17, s[4:7], s53 offen sc0 sc1
    s_add_u32 s53, s52, 117760
    buffer_store_dword v33, v17, s[4:7], s53 offen sc0 sc1
    s_add_u32 s53, s52, 122880
    buffer_store_dword v33, v17, s[4:7], s53 offen sc0 sc1
    s_add_u32 s53, s52, 128000
    buffer_store_dword v33, v17, s[4:7], s53 offen sc0 sc1
    s_add_u32 s53, s52, 133120
    buffer_store_dword v33, v17, s[4:7], s53 offen sc0 sc1
    s_add_u32 s53, s52, 138240
    buffer_store_dword v33, v17, s[4:7], s53 offen sc0 sc1
    s_add_u32 s53, s52, 143360
    buffer_store_dword v33, v17, s[4:7], s53 offen sc0 sc1
    s_add_u32 s53, s52, 148480
    buffer_store_dword v33, v17, s[4:7], s53 offen sc0 sc1
    s_add_u32 s53, s52, 153600
    buffer_store_dword v33, v17, s[4:7], s53 offen sc0 sc1
    s_add_u32 s53, s52, 158720
    buffer_store_dword v33, v17, s[4:7], s53 offen sc0 sc1
    s_mov_b64 exec, -1
    s_branch mega_kernel_attd13
mega_kernel_nw116:
    s_cmp_lg_u32 s25, 3
    s_cbranch_scc1 mega_kernel_attd13
    s_cmp_ge_u32 s50, 62
    s_cbranch_scc1 mega_kernel_attd13
    s_add_u32 s57, s50, 1
    s_and_b32 s58, s57, 3
    s_cmp_lg_u32 s58, 0
    s_cbranch_scc1 mega_kernel_skw17
    s_lshr_b32 s58, s57, 2
    s_lshl_b32 s58, s58, 7
    s_add_u32 s58, s58, 16384
    v_mov_b32 v33, s58
    s_mov_b32 s55, 0
mega_kernel_wkv18:
    buffer_load_dword v34, v33, s[4:7], 0 offen sc1
    s_waitcnt vmcnt(0)
    v_cmp_gt_u32 vcc, 96, v34
    s_nop 0
    s_cbranch_vccz mega_kernel_wkvd19
    s_sleep 8
    s_sleep 1
    s_add_u32 s55, s55, 1
    s_cmp_lt_u32 s55, 300000
    s_cbranch_scc1 mega_kernel_wkv18
    s_mov_b32 s56, 4
    s_branch mega_kernel_fail3
mega_kernel_wkvd19:
mega_kernel_skw17:
    s_and_b32 s58, s57, 1
    s_mul_i32 s58, s58, 24576
    s_add_u32 s58, s58, 32768
    s_mul_i32 s52, s57, 32*12288
    s_add_u32 s52, s52, 34488320
    s_add_u32 m0, s58, 0
    s_add_u32 s53, s52, 0
    buffer_load_dwordx4 v31, s[4:7], s53 offen lds
    s_add_u32 m0, s58, 1024
    s_add_u32 s53, s52, 1024
    buffer_load_dwordx4 v31, s[4:7], s53 offen lds
    s_add_u32 m0, s58, 2048
    s_add_u32 s53, s52, 2048
    buffer_load_dwordx4 v31, s[4:7], s53 offen lds
    s_add_u32 m0, s58, 3072
    s_add_u32 s53, s52, 3072
    buffer_load_dwordx4 v31, s[4:7], s53 offen lds
    s_add_u32 m0, s58, 4096
    s_add_u32 s53, s52, 4096
    buffer_load_dwordx4 v31, s[4:7], s53 offen lds
    s_add_u32 m0, s58, 5120
    s_add_u32 s53, s52, 5120
    buffer_load_dwordx4 v31, s[4:7], s53 offen lds
    s_add_u32 m0, s58, 6144
    s_add_u32 s53, s52, 6144
    buffer_load_dwordx4 v31, s[4:7], s53 offen lds
    s_add_u32 m0, s58, 7168
    s_add_u32 s53, s52, 7168
    buffer_load_dwordx4 v31, s[4:7], s53 offen lds
    s_add_u32 m0, s58, 8192
    s_add_u32 s53, s52, 8192
    buffer_load_dwordx4 v31, s[4:7], s53 offen lds
    s_add_u32 m0, s58, 9216
    s_add_u32 s53, s52, 9216
    buffer_load_dwordx4 v31, s[4:7], s53 offen lds
    s_add_u32 m0, s58, 10240
    s_add_u32 s53, s52, 10240
    buffer_load_dwordx4 v31, s[4:7], s53 offen lds
    s_add_u32 m0, s58, 11264
    s_add_u32 s53, s52, 11264
    buffer_load_dwordx4 v31, s[4:7], s53 offen lds
    s_mul_i32 s52, s57, 32*192*64
    s_add_u32 s52, s52, 59654144
    s_add_u32 m0, s58, 12288
    s_add_u32 s53, s52, 0
    buffer_load_dwordx4 v31, s[4:7], s53 offen lds
    s_add_u32 m0, s58, 13312
    s_add_u32 s53, s52, 1024
    buffer_load_dwordx4 v31, s[4:7], s53 offen lds
    s_add_u32 m0, s58, 14336
    s_add_u32 s53, s52, 2048
    buffer_load_dwordx4 v31, s[4:7], s53 offen lds
    s_add_u32 m0, s58, 15360
    s_add_u32 s53, s52, 3072
    buffer_load_dwordx4 v31, s[4:7], s53 offen lds
    s_add_u32 m0, s58, 16384
    s_add_u32 s53, s52, 4096
    buffer_load_dwordx4 v31, s[4:7], s53 offen lds
    s_add_u32 m0, s58, 17408
    s_add_u32 s53, s52, 5120
    buffer_load_dwordx4 v31, s[4:7], s53 offen lds
    s_add_u32 m0, s58, 18432
    s_add_u32 s53, s52, 6144
    buffer_load_dwordx4 v31, s[4:7], s53 offen lds
    s_add_u32 m0, s58, 19456
    s_add_u32 s53, s52, 7168
    buffer_load_dwordx4 v31, s[4:7], s53 offen lds
    s_add_u32 m0, s58, 20480
    s_add_u32 s53, s52, 8192
    buffer_load_dwordx4 v31, s[4:7], s53 offen lds
    s_add_u32 m0, s58, 21504
    s_add_u32 s53, s52, 9216
    buffer_load_dwordx4 v31, s[4:7], s53 offen lds
    s_add_u32 m0, s58, 22528
    s_add_u32 s53, s52, 10240
    buffer_load_dwordx4 v31, s[4:7], s53 offen lds
    s_add_u32 m0, s58, 23552
    s_add_u32 s53, s52, 11264
    buffer_load_dwordx4 v31, s[4:7], s53 offen lds
    s_branch mega_kernel_attd13
mega_kernel_attw014:
    s_add_u32 s52, s63, 86294528
    s_add_u32 s53, s63, 86392832
    s_add_u32 s54, s63, 86491136
    s_and_b32 s58, s50, 1
    s_mul_i32 s58, s58, 24576
    v_add_u32 v34, s58, v11
    v_add_u32 v35, s58, v12
    ds_read_b128 v[136:139], v34 offset:0
    ds_read_b128 v[140:143], v34 offset:2048
    ds_read_b128 v[144:147], v34 offset:4096
    ds_read_b128 v[148:151], v34 offset:6144
    ds_read_b128 v[152:155], v34 offset:8192
    ds_read_b128 v[156:159], v34 offset:10240
    ds_read_b128 v[160:163], v34 offset:256
    ds_read_b128 v[164:167], v34 offset:2304
    ds_read_b128 v[168:171], v34 offset:4352
    ds_read_b128 v[172:175], v34 offset:6400
    ds_read_b128 v[176:179], v34 offset:8448
    ds_read_b128 v[180:183], v34 offset:10496
    s_mov_b32 s55, 0
mega_kernel_pollg20:
    buffer_load_dwordx4 v[64:67], v10, s[4:7], s52 offen offset:0 sc0 sc1
    buffer_load_dwordx4 v[88:91], v10, s[4:7], s53 offen offset:0 sc0 sc1
    buffer_load_dwordx4 v[68:71], v10, s[4:7], s52 offen offset:512 sc0 sc1
    buffer_load_dwordx4 v[92:95], v10, s[4:7], s53 offen offset:512 sc0 sc1
    buffer_load_dwordx4 v[72:75], v10, s[4:7], s52 offen offset:1024 sc0 sc1
    buffer_load_dwordx4 v[96:99], v10, s[4:7], s53 offen offset:1024 sc0 sc1
    buffer_load_dwordx4 v[76:79], v10, s[4:7], s52 offen offset:1536 sc0 sc1
    buffer_load_dwordx4 v[100:103], v10, s[4:7], s53 offen offset:1536 sc0 sc1
    buffer_load_dwordx4 v[80:83], v10, s[4:7], s52 offen offset:2048 sc0 sc1
    buffer_load_dwordx4 v[104:107], v10, s[4:7], s53 offen offset:2048 sc0 sc1
    buffer_load_dwordx4 v[84:87], v10, s[4:7], s52 offen offset:2560 sc0 sc1
    buffer_load_dwordx4 v[108:111], v10, s[4:7], s53 offen offset:2560 sc0 sc1
    s_waitcnt vmcnt(0)
    v_max_u32 v32, v64, v65
    v_max3_u32 v32, v32, v66, v67
    v_max3_u32 v32, v32, v68, v69
    v_max3_u32 v32, v32, v70, v71
    v_max3_u32 v32, v32, v72, v73
    v_max3_u32 v32, v32, v74, v75
    v_max3_u32 v32, v32, v76, v77
    v_max3_u32 v32, v32, v78, v79
    v_max3_u32 v32, v32, v80, v81
    v_max3_u32 v32, v32, v82, v83
    v_max3_u32 v32, v32, v84, v85
    v_max3_u32 v32, v32, v86, v87
    v_max3_u32 v32, v32, v88, v89
    v_max3_u32 v32, v32, v90, v91
    v_max3_u32 v32, v32, v92, v93
    v_max3_u32 v32, v32, v94, v95
    v_max3_u32 v32, v32, v96, v97
    v_max3_u32 v32, v32, v98, v99
    v_max3_u32 v32, v32, v100, v101
    v_max3_u32 v32, v32, v102, v103
    v_max3_u32 v32, v32, v104, v105
    v_max3_u32 v32, v32, v106, v107
    v_max3_u32 v32, v32, v108, v109
    v_max3_u32 v32, v32, v110, v111
    v_cmp_eq_u32 vcc, -1, v32
    s_nop 0
    s_cbranch_vccz mega_kernel_pollgd21
    s_sleep 1
    s_add_u32 s55, s55, 1
    s_cmp_lt_u32 s55, 300000
    s_cbranch_scc1 mega_kernel_pollg20
    s_mov_b32 s56, 1
    s_branch mega_kernel_fail3
mega_kernel_pollgd21:
    buffer_load_dwordx2 v[112:113], v13, s[4:7], s54 offen offset:0 sc0 sc1
    buffer_load_dwordx2 v[114:115], v13, s[4:7], s54 offen offset:256 sc0 sc1
    buffer_load_dwordx2 v[116:117], v13, s[4:7], s54 offen offset:512 sc0 sc1
    buffer_load_dwordx2 v[118:119], v13, s[4:7], s54 offen offset:768 sc0 sc1
    buffer_load_dwordx2 v[120:121], v13, s[4:7], s54 offen offset:1024 sc0 sc1
    buffer_load_dwordx2 v[122:123], v13, s[4:7], s54 offen offset:1280 sc0 sc1
    buffer_load_dwordx2 v[124:125], v13, s[4:7], s54 offen offset:1536 sc0 sc1
    buffer_load_dwordx2 v[126:127], v13, s[4:7], s54 offen offset:1792 sc0 sc1
    buffer_load_dwordx2 v[128:129], v13, s[4:7], s54 offen offset:2048 sc0 sc1
    buffer_load_dwordx2 v[130:131], v13, s[4:7], s54 offen offset:2304 sc0 sc1
    buffer_load_dwordx2 v[132:133], v13, s[4:7], s54 offen offset:2560 sc0 sc1
    buffer_load_dwordx2 v[134:135], v13, s[4:7], s54 offen offset:2816 sc0 sc1
    s_barrier
    s_waitcnt lgkmcnt(0)
    v_mfma_f32_16x16x32_bf16 v[184:187], v[136:139], v[64:67], 0
    v_mfma_f32_16x16x32_bf16 v[188:191], v[160:163], v[64:67], 0
    v_mfma_f32_16x16x32_bf16 v[192:195], v[88:91], v[64:67], 0
    v_mfma_f32_16x16x32_bf16 v[184:187], v[140:143], v[68:71], v[184:187]
    v_mfma_f32_16x16x32_bf16 v[188:191], v[164:167], v[68:71], v[188:191]
    v_mfma_f32_16x16x32_bf16 v[192:195], v[92:95], v[68:71], v[192:195]
    v_mfma_f32_16x16x32_bf16 v[184:187], v[144:147], v[72:75], v[184:187]
    v_mfma_f32_16x16x32_bf16 v[188:191], v[168:171], v[72:75], v[188:191]
    v_mfma_f32_16x16x32_bf16 v[192:195], v[96:99], v[72:75], v[192:195]
    v_mfma_f32_16x16x32_bf16 v[184:187], v[148:151], v[76:79], v[184:187]
    v_mfma_f32_16x16x32_bf16 v[188:191], v[172:175], v[76:79], v[188:191]
    v_mfma_f32_16x16x32_bf16 v[192:195], v[100:103], v[76:79], v[192:195]
    v_mfma_f32_16x16x32_bf16 v[184:187], v[152:155], v[80:83], v[184:187]
    v_mfma_f32_16x16x32_bf16 v[188:191], v[176:179], v[80:83], v[188:191]
    v_mfma_f32_16x16x32_bf16 v[192:195], v[104:107], v[80:83], v[192:195]
    v_mfma_f32_16x16x32_bf16 v[184:187], v[156:159], v[84:87], v[184:187]
    v_mfma_f32_16x16x32_bf16 v[188:191], v[180:183], v[84:87], v[188:191]
    v_mfma_f32_16x16x32_bf16 v[192:195], v[108:111], v[84:87], v[192:195]
    ds_read_b64 v[64:65], v35 offset:0
    ds_read_b64 v[66:67], v35 offset:32
    ds_read_b64 v[68:69], v35 offset:1024
    ds_read_b64 v[70:71], v35 offset:1056
    ds_read_b64 v[72:73], v35 offset:2048
    ds_read_b64 v[74:75], v35 offset:2080
    ds_read_b64 v[76:77], v35 offset:3072
    ds_read_b64 v[78:79], v35 offset:3104
    ds_read_b64 v[80:81], v35 offset:4096
    ds_read_b64 v[82:83], v35 offset:4128
    ds_read_b64 v[84:85], v35 offset:5120
    ds_read_b64 v[86:87], v35 offset:5152
    ds_read_b64 v[88:89], v35 offset:6144
    ds_read_b64 v[90:91], v35 offset:6176
    ds_read_b64 v[92:93], v35 offset:7168
    ds_read_b64 v[94:95], v35 offset:7200
    ds_read_b64 v[96:97], v35 offset:8192
    ds_read_b64 v[98:99], v35 offset:8224
    ds_read_b64 v[100:101], v35 offset:9216
    ds_read_b64 v[102:103], v35 offset:9248
    ds_read_b64 v[104:105], v35 offset:10240
    ds_read_b64 v[106:107], v35 offset:10272
    ds_read_b64 v[108:109], v35 offset:11264
    ds_read_b64 v[110:111], v35 offset:11296
    s_nop 3
    s_nop 3
    v_cmp_gt_u32 vcc, 2, v4
    v_mov_b32 v32, 0xf149f2ca
    s_nop 0
    v_cndmask_b32 v192, v32, v192, vcc
    v_cndmask_b32 v193, v32, v193, vcc
    v_cndmask_b32 v194, v32, v194, vcc
    v_cndmask_b32 v195, v32, v195, vcc
    v_max3_f32 v33, v184, v185, v186
    v_max3_f32 v33, v33, v187, v188
    v_max3_f32 v33, v33, v189, v190
    v_max3_f32 v33, v33, v191, v192
    v_max3_f32 v33, v33, v193, v194
    v_max_f32 v33, v33, v195
    v_mov_b32 v34, v33
    s_nop 1
    v_permlane16_swap_b32 v34, v33
    s_nop 0
    v_max_f32 v33, v33, v34
    v_mov_b32 v34, v33
    s_nop 1
    v_permlane32_swap_b32 v34, v33
    s_nop 0
    v_max_f32 v33, v33, v34
    s_mov_b32 s58, 0x3dd53b95
    v_mul_f32 v33, s58, v33
    v_fma_f32 v184, v184, s58, -v33
    v_exp_f32 v184, v184
    v_fma_f32 v185, v185, s58, -v33
    v_exp_f32 v185, v185
    v_fma_f32 v186, v186, s58, -v33
    v_exp_f32 v186, v186
    v_fma_f32 v187, v187, s58, -v33
    v_exp_f32 v187, v187
    v_fma_f32 v188, v188, s58, -v33
    v_exp_f32 v188, v188
    v_fma_f32 v189, v189, s58, -v33
    v_exp_f32 v189, v189
    v_fma_f32 v190, v190, s58, -v33
    v_exp_f32 v190, v190
    v_fma_f32 v191, v191, s58, -v33
    v_exp_f32 v191, v191
    v_fma_f32 v192, v192, s58, -v33
    v_exp_f32 v192, v192
    v_fma_f32 v193, v193, s58, -v33
    v_exp_f32 v193, v193
    v_fma_f32 v194, v194, s58, -v33
    v_exp_f32 v194, v194
    v_fma_f32 v195, v195, s58, -v33
    v_exp_f32 v195, v195
    s_nop 0
    v_add_f32 v36, v184, v185
    v_add_f32 v36, v36, v186
    v_add_f32 v36, v36, v187
    v_add_f32 v36, v36, v188
    v_add_f32 v36, v36, v189
    v_add_f32 v36, v36, v190
    v_add_f32 v36, v36, v191
    v_add_f32 v36, v36, v192
    v_add_f32 v36, v36, v193
    v_add_f32 v36, v36, v194
    v_add_f32 v36, v36, v195
    v_mov_b32 v34, v36
    s_nop 1
    v_permlane16_swap_b32 v34, v36
    s_nop 0
    v_add_f32 v36, v36, v34
    v_mov_b32 v34, v36
    s_nop 1
    v_permlane32_swap_b32 v34, v36
    s_nop 0
    v_add_f32 v36, v36, v34
    v_rcp_f32 v36, v36
    s_nop 0
    v_mul_f32 v184, v184, v36
    v_mul_f32 v185, v185, v36
    v_mul_f32 v186, v186, v36
    v_mul_f32 v187, v187, v36
    v_mul_f32 v188, v188, v36
    v_mul_f32 v189, v189, v36
    v_mul_f32 v190, v190, v36
    v_mul_f32 v191, v191, v36
    v_mul_f32 v192, v192, v36
    v_mul_f32 v193, v193, v36
    v_mul_f32 v194, v194, v36
    v_mul_f32 v195, v195, v36
    v_cvt_pk_bf16_f32 v196, v184, v185
    v_cvt_pk_bf16_f32 v197, v186, v187
    v_cvt_pk_bf16_f32 v198, v188, v189
    v_cvt_pk_bf16_f32 v199, v190, v191
    v_cvt_pk_bf16_f32 v200, v192, v193
    v_cvt_pk_bf16_f32 v201, v194, v195
    s_mov_b32 s55, 0
mega_kernel_vpl22:
    s_waitcnt vmcnt(0)
    v_max_u32 v32, v112, v113
    v_max3_u32 v32, v32, v114, v115
    v_max3_u32 v32, v32, v116, v117
    v_max3_u32 v32, v32, v118, v119
    v_max3_u32 v32, v32, v120, v121
    v_max3_u32 v32, v32, v122, v123
    v_max3_u32 v32, v32, v124, v125
    v_max3_u32 v32, v32, v126, v127
    v_max3_u32 v32, v32, v128, v129
    v_max3_u32 v32, v32, v130, v131
    v_max3_u32 v32, v32, v132, v133
    v_max3_u32 v32, v32, v134, v135
    v_cmp_eq_u32 vcc, -1, v32
    s_nop 0
    s_cbranch_vccz mega_kernel_vpd23
    buffer_load_dwordx2 v[112:113], v13, s[4:7], s54 offen offset:0 sc0 sc1
    buffer_load_dwordx2 v[114:115], v13, s[4:7], s54 offen offset:256 sc0 sc1
    buffer_load_dwordx2 v[116:117], v13, s[4:7], s54 offen offset:512 sc0 sc1
    buffer_load_dwordx2 v[118:119], v13, s[4:7], s54 offen offset:768 sc0 sc1
    buffer_load_dwordx2 v[120:121], v13, s[4:7], s54 offen offset:1024 sc0 sc1
    buffer_load_dwordx2 v[122:123], v13, s[4:7], s54 offen offset:1280 sc0 sc1
    buffer_load_dwordx2 v[124:125], v13, s[4:7], s54 offen offset:1536 sc0 sc1
    buffer_load_dwordx2 v[126:127], v13, s[4:7], s54 offen offset:1792 sc0 sc1
    buffer_load_dwordx2 v[128:129], v13, s[4:7], s54 offen offset:2048 sc0 sc1
    buffer_load_dwordx2 v[130:131], v13, s[4:7], s54 offen offset:2304 sc0 sc1
    buffer_load_dwordx2 v[132:133], v13, s[4:7], s54 offen offset:2560 sc0 sc1
    buffer_load_dwordx2 v[134:135], v13, s[4:7], s54 offen offset:2816 sc0 sc1
    s_sleep 1
    s_add_u32 s55, s55, 1
    s_cmp_lt_u32 s55, 300000
    s_cbranch_scc1 mega_kernel_vpl22
    s_mov_b32 s56, 6
    s_branch mega_kernel_fail3
mega_kernel_vpd23:
    s_waitcnt lgkmcnt(0)
    s_nop 1
    v_mfma_f32_16x16x32_bf16 v[136:139], v[64:67], v[196:199], 0
    v_mfma_f32_16x16x32_bf16 v[140:143], v[68:71], v[196:199], 0
    v_mfma_f32_16x16x32_bf16 v[144:147], v[72:75], v[196:199], 0
    v_mfma_f32_16x16x32_bf16 v[148:151], v[76:79], v[196:199], 0
    v_mfma_f32_16x16x32_bf16 v[152:155], v[80:83], v[196:199], 0
    v_mfma_f32_16x16x32_bf16 v[156:159], v[84:87], v[196:199], 0
    v_mfma_f32_16x16x32_bf16 v[160:163], v[88:91], v[196:199], 0
    v_mfma_f32_16x16x32_bf16 v[164:167], v[92:95], v[196:199], 0
    v_mfma_f32_16x16x32_bf16 v[168:171], v[96:99], v[196:199], 0
    v_mfma_f32_16x16x32_bf16 v[172:175], v[100:103], v[196:199], 0
    v_mfma_f32_16x16x32_bf16 v[176:179], v[104:107], v[196:199], 0
    v_mfma_f32_16x16x32_bf16 v[180:183], v[108:111], v[196:199], 0
    v_mfma_f32_16x16x16_bf16 v[136:139], v[112:113], v[200:201], v[136:139]
    v_mfma_f32_16x16x16_bf16 v[140:143], v[114:115], v[200:201], v[140:143]
    v_mfma_f32_16x16x16_bf16 v[144:147], v[116:117], v[200:201], v[144:147]
    v_mfma_f32_16x16x16_bf16 v[148:151], v[118:119], v[200:201], v[148:151]
    v_mfma_f32_16x16x16_bf16 v[152:155], v[120:121], v[200:201], v[152:155]
    v_mfma_f32_16x16x16_bf16 v[156:159], v[122:123], v[200:201], v[156:159]
    v_mfma_f32_16x16x16_bf16 v[160:163], v[124:125], v[200:201], v[160:163]
    v_mfma_f32_16x16x16_bf16 v[164:167], v[126:127], v[200:201], v[164:167]
    v_mfma_f32_16x16x16_bf16 v[168:171], v[128:129], v[200:201], v[168:171]
    v_mfma_f32_16x16x16_bf16 v[172:175], v[130:131], v[200:201], v[172:175]
    v_mfma_f32_16x16x16_bf16 v[176:179], v[132:133], v[200:201], v[176:179]
    v_mfma_f32_16x16x16_bf16 v[180:183], v[134:135], v[200:201], v[180:183]
    s_nop 5
    v_cvt_pk_bf16_f32 v32, v136, v137
    v_cvt_pk_bf16_f32 v33, v138, v139
    ds_write_b64 v14, v[32:33] offset:0
    v_cvt_pk_bf16_f32 v34, v140, v141
    v_cvt_pk_bf16_f32 v35, v142, v143
    ds_write_b64 v14, v[34:35] offset:32
    v_cvt_pk_bf16_f32 v36, v144, v145
    v_cvt_pk_bf16_f32 v37, v146, v147
    ds_write_b64 v14, v[36:37] offset:64
    v_cvt_pk_bf16_f32 v38, v148, v149
    v_cvt_pk_bf16_f32 v39, v150, v151
    ds_write_b64 v14, v[38:39] offset:96
    v_cvt_pk_bf16_f32 v32, v152, v153
    v_cvt_pk_bf16_f32 v33, v154, v155
    ds_write_b64 v14, v[32:33] offset:128
    v_cvt_pk_bf16_f32 v34, v156, v157
    v_cvt_pk_bf16_f32 v35, v158, v159
    ds_write_b64 v14, v[34:35] offset:160
    v_cvt_pk_bf16_f32 v36, v160, v161
    v_cvt_pk_bf16_f32 v37, v162, v163
    ds_write_b64 v14, v[36:37] offset:192
    v_cvt_pk_bf16_f32 v38, v164, v165
    v_cvt_pk_bf16_f32 v39, v166, v167
    ds_write_b64 v14, v[38:39] offset:224
    v_cvt_pk_bf16_f32 v32, v168, v169
    v_cvt_pk_bf16_f32 v33, v170, v171
    ds_write_b64 v14, v[32:33] offset:256
    v_cvt_pk_bf16_f32 v34, v172, v173
    v_cvt_pk_bf16_f32 v35, v174, v175
    ds_write_b64 v14, v[34:35] offset:288
    v_cvt_pk_bf16_f32 v36, v176, v177
    v_cvt_pk_bf16_f32 v37, v178, v179
    ds_write_b64 v14, v[36:37] offset:320
    v_cvt_pk_bf16_f32 v38, v180, v181
    v_cvt_pk_bf16_f32 v39, v182, v183
    ds_write_b64 v14, v[38:39] offset:352
mega_kernel_attd13:
    s_waitcnt lgkmcnt(0)
    s_barrier
    ds_read_b128 v[216:219], v15 offset:0
    ds_read_b128 v[220:223], v15 offset:64
    ds_read_b128 v[224:227], v15 offset:128
    ds_read_b128 v[228:231], v15 offset:192
    ds_read_b128 v[232:235], v15 offset:256
    ds_read_b128 v[236:239], v15 offset:320
    s_waitcnt lgkmcnt(0)
    v_mfma_f32_16x16x32_bf16 v[64:67], a[180:183], v[216:219], 0
    v_mfma_f32_16x16x32_bf16 v[68:71], a[204:207], v[216:219], 0
    v_mfma_f32_16x16x32_bf16 v[72:75], a[228:231], v[216:219], 0
    v_mfma_f32_16x16x32_bf16 v[64:67], a[184:187], v[220:223], v[64:67]
    v_mfma_f32_16x16x32_bf16 v[68:71], a[208:211], v[220:223], v[68:71]
    v_mfma_f32_16x16x32_bf16 v[72:75], a[232:235], v[220:223], v[72:75]
    v_mfma_f32_16x16x32_bf16 v[64:67], a[188:191], v[224:227], v[64:67]
    v_mfma_f32_16x16x32_bf16 v[68:71], a[212:215], v[224:227], v[68:71]
    v_mfma_f32_16x16x32_bf16 v[72:75], a[236:239], v[224:227], v[72:75]
    v_mfma_f32_16x16x32_bf16 v[64:67], a[192:195], v[228:231], v[64:67]
    v_mfma_f32_16x16x32_bf16 v[68:71], a[216:219], v[228:231], v[68:71]
    v_mfma_f32_16x16x32_bf16 v[72:75], a[240:243], v[228:231], v[72:75]
    v_mfma_f32_16x16x32_bf16 v[64:67], a[196:199], v[232:235], v[64:67]
    v_mfma_f32_16x16x32_bf16 v[68:71], a[220:223], v[232:235], v[68:71]
    v_mfma_f32_16x16x32_bf16 v[72:75], a[244:247], v[232:235], v[72:75]
    v_mfma_f32_16x16x32_bf16 v[64:67], a[200:203], v[236:239], v[64:67]
    v_mfma_f32_16x16x32_bf16 v[68:71], a[224:227], v[236:239], v[68:71]
    v_mfma_f32_16x16x32_bf16 v[72:75], a[248:251], v[236:239], v[72:75]
    s_and_b32 s52, s50, 1
    s_mul_i32 s52, s52, 655360
    s_lshr_b32 s59, s50, 1
    s_and_b32 s59, s59, 1
    s_mov_b32 s58, 0xfffffffe
    s_mov_b64 exec, s[42:43]
    s_nop 2
    s_nop 1
    buffer_store_dwordx4 v[64:67], v16, s[4:7], s52 offen sc0 sc1
    buffer_store_dwordx4 v[68:71], v16, s[4:7], s52 offen offset:256 sc0 sc1
    s_cmp_ge_u32 s25, 2
    s_cbranch_scc1 mega_kernel_sk224
    buffer_store_dwordx4 v[72:75], v16, s[4:7], s52 offen offset:512 sc0 sc1
mega_kernel_sk224:
    s_mov_b64 exec, -1
    s_mov_b32 s55, 0
    s_mul_i32 s54, s25, 8*5120
    s_add_u32 s54, s54, s52
    s_sleep 13
mega_kernel_pollr26:
    s_add_u32 s53, s54, 0
    buffer_load_dword v136, v17, s[4:7], s53 offen sc0 sc1
    s_add_u32 s53, s54, 5120
    buffer_load_dword v137, v17, s[4:7], s53 offen sc0 sc1
    s_add_u32 s53, s54, 10240
    buffer_load_dword v138, v17, s[4:7], s53 offen sc0 sc1
    s_add_u32 s53, s54, 15360
    buffer_load_dword v139, v17, s[4:7], s53 offen sc0 sc1
    s_add_u32 s53, s54, 20480
    buffer_load_dword v140, v17, s[4:7], s53 offen sc0 sc1
    s_add_u32 s53, s54, 25600
    buffer_load_dword v141, v17, s[4:7], s53 offen sc0 sc1
    s_add_u32 s53, s54, 30720
    buffer_load_dword v142, v17, s[4:7], s53 offen sc0 sc1
    s_add_u32 s53, s54, 35840
    buffer_load_dword v143, v17, s[4:7], s53 offen sc0 sc1
    s_waitcnt vmcnt(0)
    v_max_u32 v32, v136, v137
    v_max3_u32 v32, v32, v138, v139
    v_max3_u32 v32, v32, v140, v141
    v_max3_u32 v32, v32, v142, v143
    v_cmp_eq_u32 vcc, -1, v32
    s_nop 0
    s_cbranch_vccz mega_kernel_pollrd27
    s_sleep 1
    s_add_u32 s55, s55, 1
    s_cmp_lt_u32 s55, 300000
    s_cbranch_scc1 mega_kernel_pollr26
    s_mov_b32 s56, 2
    s_branch mega_kernel_fail3
mega_kernel_pollrd27:
    v_add_f32 v136, v136, v137
    v_add_f32 v138, v138, v139
    v_add_f32 v140, v140, v141
    v_add_f32 v142, v142, v143
    v_add_f32 v136, v136, v138
    v_add_f32 v140, v140, v142
    v_add_f32 v136, v136, v140
    v_lshlrev_b32 v34, 2, v0
    v_add_u32 v34, 86016, v34
    ds_write_b32 v34, v136
    s_waitcnt lgkmcnt(0)
    s_barrier
    s_cmp_lg_u32 s25, 0
    s_cbranch_scc1 mega_kernel_skipb25
    ds_read_b32 v136, v34 offset:0
    ds_read_b32 v137, v34 offset:256
    ds_read_b32 v138, v34 offset:512
    ds_read_b32 v139, v34 offset:768
    s_waitcnt lgkmcnt(0)
    v_add_f32 v136, v136, v137
    v_add_f32 v138, v138, v139
    v_add_f32 v136, v136, v138
    s_nop 1
    v_mov_b32_dpp v33, v136 quad_perm:[1,0,3,2] row_mask:0xf bank_mask:0xf
    s_nop 0
    v_cvt_pk_bf16_f32 v32, v136, v33
    s_add_u32 s57, s50, 1
    s_and_b32 s57, s57, 3
    s_mul_i32 s53, s57, 10240
    s_mov_b64 exec, s[44:45]
    buffer_store_dword v32, v18, s[4:7], s53 offen sc0 sc1
    s_add_u32 s53, s53, 40960
    buffer_store_dword v32, v18, s[4:7], s53 offen sc0 sc1
    s_add_u32 s53, s53, 40960
    buffer_store_dword v32, v18, s[4:7], s53 offen sc0 sc1
    s_add_u32 s53, s53, 40960
    buffer_store_dword v32, v18, s[4:7], s53 offen sc0 sc1
    s_add_u32 s57, s50, 3
    s_and_b32 s57, s57, 3
    s_mul_i32 s53, s57, 10240
    v_mov_b32 v33, -1
    buffer_store_dword v33, v18, s[4:7], s53 offen sc0 sc1
    s_add_u32 s53, s53, 40960
    buffer_store_dword v33, v18, s[4:7], s53 offen sc0 sc1
    s_add_u32 s53, s53, 40960
    buffer_store_dword v33, v18, s[4:7], s53 offen sc0 sc1
    s_add_u32 s53, s53, 40960
    buffer_store_dword v33, v18, s[4:7], s53 offen sc0 sc1
mega_kernel_skipb25:
    s_mov_b64 exec, -1
    s_cmp_lg_u32 s25, 3
    s_cbranch_scc1 mega_kernel_w3w28
    s_waitcnt vmcnt(0)
mega_kernel_w3w28:
    s_barrier
    s_add_u32 s57, s50, 1
    s_and_b32 s57, s57, 3
    s_mul_i32 s53, s57, 10240
    s_add_u32 s53, s53, 86130688
    s_and_b32 s54, s19, 3
    s_mul_i32 s54, s54, 40960
    s_add_u32 s53, s53, s54
    s_mov_b32 s55, 0
    s_sleep 15
mega_kernel_pollm29:
    buffer_load_dwordx4 v[104:107], v19, s[4:7], s53 offen offset:0 sc0 sc1
    buffer_load_dwordx4 v[108:111], v19, s[4:7], s53 offen offset:64 sc0 sc1
    buffer_load_dwordx4 v[112:115], v19, s[4:7], s53 offen offset:128 sc0 sc1
    buffer_load_dwordx4 v[116:119], v19, s[4:7], s53 offen offset:192 sc0 sc1
    buffer_load_dwordx4 v[120:123], v19, s[4:7], s53 offen offset:256 sc0 sc1
    s_waitcnt vmcnt(0)
    v_max_u32 v32, v104, v105
    v_max3_u32 v32, v32, v106, v107
    v_max3_u32 v32, v32, v108, v109
    v_max3_u32 v32, v32, v110, v111
    v_max3_u32 v32, v32, v112, v113
    v_max3_u32 v32, v32, v114, v115
    v_max3_u32 v32, v32, v116, v117
    v_max3_u32 v32, v32, v118, v119
    v_max3_u32 v32, v32, v120, v121
    v_max3_u32 v32, v32, v122, v123
    v_cmp_eq_u32 vcc, -1, v32
    s_nop 0
    s_cbranch_vccz mega_kernel_pollmd30
    s_sleep 1
    s_add_u32 s55, s55, 1
    s_cmp_lt_u32 s55, 300000
    s_cbranch_scc1 mega_kernel_pollm29
    s_mov_b32 s56, 3
    s_branch mega_kernel_fail3
mega_kernel_pollmd30:
    s_add_u32 s50, s50, 1
    s_branch mega_kernel_loop8
mega_kernel_fail3:
    v_mov_b32 v32, s56
    v_mov_b32 v33, s50
    v_mov_b32 v34, s2
    v_mov_b32 v35, 0
    s_mov_b64 exec, 1
    buffer_store_dwordx3 v[32:34], v35, s[8:11], 0 offen
    s_branch mega_kernel_done1
mega_kernel_worker2:
    s_load_dwordx16 s[48:63], s[0:1], 0
    s_load_dwordx16 s[64:79], s[0:1], 64
    s_waitcnt lgkmcnt(0)
    s_mov_b64 s[80:81], s[78:79]
    s_and_b32 s81, s81, 0xffff
    s_mov_b32 s82, 268435456
    s_mov_b32 s83, 0x00020000
    v_lshrrev_b32 v1, 6, v0
    s_nop 0
    v_readfirstlane_b32 s94, v1
    s_nop 3
    s_lshl_b32 s13, s90, 4
    s_mov_b32 s31, s13
    s_mov_b64 s[8:9], s[48:49]
    s_and_b32 s9, s9, 0xffff
    s_mov_b32 s10, 2621440
    s_mov_b32 s11, 0x00020000
    s_mov_b64 s[12:13], s[78:79]
    s_and_b32 s13, s13, 0xffff
    s_mov_b32 s14, 15360
    s_mov_b32 s15, 0x00020000
    s_mov_b64 s[20:21], s[78:79]
    s_add_u32 s20, s20, 6701056
    s_addc_u32 s21, s21, 0
    s_and_b32 s21, s21, 0xffff
    s_mov_b32 s22, 2621440
    s_mov_b32 s23, 0x00020000
    v_and_b32 v1, 63, v0
    v_lshrrev_b32 v2, 6, v0
    v_lshlrev_b32 v2, 2, v2
    v_add_u32 v2, s31, v2
    s_movk_i32 s28, 1280
    v_mul_lo_u32 v2, v2, s28
    v_lshlrev_b32 v3, 2, v1
    v_add_u32 v2, v2, v3
    v_lshlrev_b32 v3, 3, v1
    s_mov_b32 s32, 0
    s_mov_b32 s33, 1280
    s_mov_b32 s34, 2560
    s_mov_b32 s35, 3840
    buffer_load_dword v100, v2, s[8:11], s32 offen offset:0
    buffer_load_dword v101, v2, s[8:11], s32 offen offset:256
    buffer_load_dword v102, v2, s[8:11], s32 offen offset:512
    buffer_load_dword v103, v2, s[8:11], s32 offen offset:768
    buffer_load_dword v104, v2, s[8:11], s32 offen offset:1024
    buffer_load_dword v108, v2, s[8:11], s33 offen offset:0
    buffer_load_dword v109, v2, s[8:11], s33 offen offset:256
    buffer_load_dword v110, v2, s[8:11], s33 offen offset:512
    buffer_load_dword v111, v2, s[8:11], s33 offen offset:768
    buffer_load_dword v112, v2, s[8:11], s33 offen offset:1024
    buffer_load_dword v116, v2, s[8:11], s34 offen offset:0
    buffer_load_dword v117, v2, s[8:11], s34 offen offset:256
    buffer_load_dword v118, v2, s[8:11], s34 offen offset:512
    buffer_load_dword v119, v2, s[8:11], s34 offen offset:768
    buffer_load_dword v120, v2, s[8:11], s34 offen offset:1024
    buffer_load_dword v124, v2, s[8:11], s35 offen offset:0
    buffer_load_dword v125, v2, s[8:11], s35 offen offset:256
    buffer_load_dword v126, v2, s[8:11], s35 offen offset:512
    buffer_load_dword v127, v2, s[8:11], s35 offen offset:768
    buffer_load_dword v128, v2, s[8:11], s35 offen offset:1024
    s_mov_b32 s29, 2560
    buffer_load_dwordx2 v[32:33], v3, s[12:15], s29 offen offset:0
    buffer_load_dwordx2 v[34:35], v3, s[12:15], s29 offen offset:512
    buffer_load_dwordx2 v[36:37], v3, s[12:15], s29 offen offset:1024
    buffer_load_dwordx2 v[38:39], v3, s[12:15], s29 offen offset:1536
    buffer_load_dwordx2 v[40:41], v3, s[12:15], s29 offen offset:2048
    s_mov_b32 s29, 0
    buffer_load_dwordx2 v[44:45], v3, s[12:15], s29 offen offset:0
    buffer_load_dwordx2 v[46:47], v3, s[12:15], s29 offen offset:512
    buffer_load_dwordx2 v[48:49], v3, s[12:15], s29 offen offset:1024
    buffer_load_dwordx2 v[50:51], v3, s[12:15], s29 offen offset:1536
    buffer_load_dwordx2 v[52:53], v3, s[12:15], s29 offen offset:2048
    s_waitcnt vmcnt(10)
    v_lshlrev_b32 v170, 16, v100
    v_and_b32 v171, 0xffff0000, v100
    v_lshlrev_b32 v172, 16, v101
    v_and_b32 v173, 0xffff0000, v101
    v_lshlrev_b32 v174, 16, v102
    v_and_b32 v175, 0xffff0000, v102
    v_lshlrev_b32 v176, 16, v103
    v_and_b32 v177, 0xffff0000, v103
    v_lshlrev_b32 v178, 16, v104
    v_and_b32 v179, 0xffff0000, v104
    v_add_f32 v4, v170, v171
    v_add_f32 v4, v4, v172
    v_add_f32 v4, v4, v173
    v_add_f32 v4, v4, v174
    v_add_f32 v4, v4, v175
    v_add_f32 v4, v4, v176
    v_add_f32 v4, v4, v177
    v_add_f32 v4, v4, v178
    v_add_f32 v4, v4, v179
    v_lshlrev_b32 v180, 16, v108
    v_and_b32 v181, 0xffff0000, v108
    v_lshlrev_b32 v182, 16, v109
    v_and_b32 v183, 0xffff0000, v109
    v_lshlrev_b32 v184, 16, v110
    v_and_b32 v185, 0xffff0000, v110
    v_lshlrev_b32 v186, 16, v111
    v_and_b32 v187, 0xffff0000, v111
    v_lshlrev_b32 v188, 16, v112
    v_and_b32 v189, 0xffff0000, v112
    v_add_f32 v5, v180, v181
    v_add_f32 v5, v5, v182
    v_add_f32 v5, v5, v183
    v_add_f32 v5, v5, v184
    v_add_f32 v5, v5, v185
    v_add_f32 v5, v5, v186
    v_add_f32 v5, v5, v187
    v_add_f32 v5, v5, v188
    v_add_f32 v5, v5, v189
    v_lshlrev_b32 v190, 16, v116
    v_and_b32 v191, 0xffff0000, v116
    v_lshlrev_b32 v192, 16, v117
    v_and_b32 v193, 0xffff0000, v117
    v_lshlrev_b32 v194, 16, v118
    v_and_b32 v195, 0xffff0000, v118
    v_lshlrev_b32 v196, 16, v119
    v_and_b32 v197, 0xffff0000, v119
    v_lshlrev_b32 v198, 16, v120
    v_and_b32 v199, 0xffff0000, v120
    v_add_f32 v6, v190, v191
    v_add_f32 v6, v6, v192
    v_add_f32 v6, v6, v193
    v_add_f32 v6, v6, v194
    v_add_f32 v6, v6, v195
    v_add_f32 v6, v6, v196
    v_add_f32 v6, v6, v197
    v_add_f32 v6, v6, v198
    v_add_f32 v6, v6, v199
    v_lshlrev_b32 v200, 16, v124
    v_and_b32 v201, 0xffff0000, v124
    v_lshlrev_b32 v202, 16, v125
    v_and_b32 v203, 0xffff0000, v125
    v_lshlrev_b32 v204, 16, v126
    v_and_b32 v205, 0xffff0000, v126
    v_lshlrev_b32 v206, 16, v127
    v_and_b32 v207, 0xffff0000, v127
    v_lshlrev_b32 v208, 16, v128
    v_and_b32 v209, 0xffff0000, v128
    v_add_f32 v7, v200, v201
    v_add_f32 v7, v7, v202
    v_add_f32 v7, v7, v203
    v_add_f32 v7, v7, v204
    v_add_f32 v7, v7, v205
    v_add_f32 v7, v7, v206
    v_add_f32 v7, v7, v207
    v_add_f32 v7, v7, v208
    v_add_f32 v7, v7, v209
    ds_swizzle_b32 v8, v4 offset:1055
    ds_swizzle_b32 v9, v5 offset:1055
    ds_swizzle_b32 v10, v6 offset:1055
    ds_swizzle_b32 v11, v7 offset:1055
    s_waitcnt lgkmcnt(0)
    v_add_f32 v4, v4, v8
    v_add_f32 v5, v5, v9
    v_add_f32 v6, v6, v10
    v_add_f32 v7, v7, v11
    ds_swizzle_b32 v8, v4 offset:2079
    ds_swizzle_b32 v9, v5 offset:2079
    ds_swizzle_b32 v10, v6 offset:2079
    ds_swizzle_b32 v11, v7 offset:2079
    s_waitcnt lgkmcnt(0)
    v_add_f32 v4, v4, v8
    v_add_f32 v5, v5, v9
    v_add_f32 v6, v6, v10
    v_add_f32 v7, v7, v11
    ds_swizzle_b32 v8, v4 offset:4127
    ds_swizzle_b32 v9, v5 offset:4127
    ds_swizzle_b32 v10, v6 offset:4127
    ds_swizzle_b32 v11, v7 offset:4127
    s_waitcnt lgkmcnt(0)
    v_add_f32 v4, v4, v8
    v_add_f32 v5, v5, v9
    v_add_f32 v6, v6, v10
    v_add_f32 v7, v7, v11
    ds_swizzle_b32 v8, v4 offset:8223
    ds_swizzle_b32 v9, v5 offset:8223
    ds_swizzle_b32 v10, v6 offset:8223
    ds_swizzle_b32 v11, v7 offset:8223
    s_waitcnt lgkmcnt(0)
    v_add_f32 v4, v4, v8
    v_add_f32 v5, v5, v9
    v_add_f32 v6, v6, v10
    v_add_f32 v7, v7, v11
    ds_swizzle_b32 v8, v4 offset:16415
    ds_swizzle_b32 v9, v5 offset:16415
    ds_swizzle_b32 v10, v6 offset:16415
    ds_swizzle_b32 v11, v7 offset:16415
    s_waitcnt lgkmcnt(0)
    v_add_f32 v4, v4, v8
    v_add_f32 v5, v5, v9
    v_add_f32 v6, v6, v10
    v_add_f32 v7, v7, v11
    v_mov_b32 v8, v4
    v_mov_b32 v9, v5
    v_mov_b32 v10, v6
    v_mov_b32 v11, v7
    s_nop 1
    v_permlane32_swap_b32 v8, v4
    v_permlane32_swap_b32 v9, v5
    v_permlane32_swap_b32 v10, v6
    v_permlane32_swap_b32 v11, v7
    s_nop 0
    v_add_f32 v4, v4, v8
    v_add_f32 v5, v5, v9
    v_add_f32 v6, v6, v10
    v_add_f32 v7, v7, v11
    v_mul_f32 v4, 0x3acccccd, v4
    v_mov_b32 v12, 0
    v_sub_f32 v16, v170, v4
    v_fmac_f32 v12, v16, v16
    v_sub_f32 v16, v171, v4
    v_fmac_f32 v12, v16, v16
    v_sub_f32 v16, v172, v4
    v_fmac_f32 v12, v16, v16
    v_sub_f32 v16, v173, v4
    v_fmac_f32 v12, v16, v16
    v_sub_f32 v16, v174, v4
    v_fmac_f32 v12, v16, v16
    v_sub_f32 v16, v175, v4
    v_fmac_f32 v12, v16, v16
    v_sub_f32 v16, v176, v4
    v_fmac_f32 v12, v16, v16
    v_sub_f32 v16, v177, v4
    v_fmac_f32 v12, v16, v16
    v_sub_f32 v16, v178, v4
    v_fmac_f32 v12, v16, v16
    v_sub_f32 v16, v179, v4
    v_fmac_f32 v12, v16, v16
    v_mul_f32 v5, 0x3acccccd, v5
    v_mov_b32 v13, 0
    v_sub_f32 v16, v180, v5
    v_fmac_f32 v13, v16, v16
    v_sub_f32 v16, v181, v5
    v_fmac_f32 v13, v16, v16
    v_sub_f32 v16, v182, v5
    v_fmac_f32 v13, v16, v16
    v_sub_f32 v16, v183, v5
    v_fmac_f32 v13, v16, v16
    v_sub_f32 v16, v184, v5
    v_fmac_f32 v13, v16, v16
    v_sub_f32 v16, v185, v5
    v_fmac_f32 v13, v16, v16
    v_sub_f32 v16, v186, v5
    v_fmac_f32 v13, v16, v16
    v_sub_f32 v16, v187, v5
    v_fmac_f32 v13, v16, v16
    v_sub_f32 v16, v188, v5
    v_fmac_f32 v13, v16, v16
    v_sub_f32 v16, v189, v5
    v_fmac_f32 v13, v16, v16
    v_mul_f32 v6, 0x3acccccd, v6
    v_mov_b32 v14, 0
    v_sub_f32 v16, v190, v6
    v_fmac_f32 v14, v16, v16
    v_sub_f32 v16, v191, v6
    v_fmac_f32 v14, v16, v16
    v_sub_f32 v16, v192, v6
    v_fmac_f32 v14, v16, v16
    v_sub_f32 v16, v193, v6
    v_fmac_f32 v14, v16, v16
    v_sub_f32 v16, v194, v6
    v_fmac_f32 v14, v16, v16
    v_sub_f32 v16, v195, v6
    v_fmac_f32 v14, v16, v16
    v_sub_f32 v16, v196, v6
    v_fmac_f32 v14, v16, v16
    v_sub_f32 v16, v197, v6
    v_fmac_f32 v14, v16, v16
    v_sub_f32 v16, v198, v6
    v_fmac_f32 v14, v16, v16
    v_sub_f32 v16, v199, v6
    v_fmac_f32 v14, v16, v16
    v_mul_f32 v7, 0x3acccccd, v7
    v_mov_b32 v15, 0
    v_sub_f32 v16, v200, v7
    v_fmac_f32 v15, v16, v16
    v_sub_f32 v16, v201, v7
    v_fmac_f32 v15, v16, v16
    v_sub_f32 v16, v202, v7
    v_fmac_f32 v15, v16, v16
    v_sub_f32 v16, v203, v7
    v_fmac_f32 v15, v16, v16
    v_sub_f32 v16, v204, v7
    v_fmac_f32 v15, v16, v16
    v_sub_f32 v16, v205, v7
    v_fmac_f32 v15, v16, v16
    v_sub_f32 v16, v206, v7
    v_fmac_f32 v15, v16, v16
    v_sub_f32 v16, v207, v7
    v_fmac_f32 v15, v16, v16
    v_sub_f32 v16, v208, v7
    v_fmac_f32 v15, v16, v16
    v_sub_f32 v16, v209, v7
    v_fmac_f32 v15, v16, v16
    ds_swizzle_b32 v8, v12 offset:1055
    ds_swizzle_b32 v9, v13 offset:1055
    ds_swizzle_b32 v10, v14 offset:1055
    ds_swizzle_b32 v11, v15 offset:1055
    s_waitcnt lgkmcnt(0)
    v_add_f32 v12, v12, v8
    v_add_f32 v13, v13, v9
    v_add_f32 v14, v14, v10
    v_add_f32 v15, v15, v11
    ds_swizzle_b32 v8, v12 offset:2079
    ds_swizzle_b32 v9, v13 offset:2079
    ds_swizzle_b32 v10, v14 offset:2079
    ds_swizzle_b32 v11, v15 offset:2079
    s_waitcnt lgkmcnt(0)
    v_add_f32 v12, v12, v8
    v_add_f32 v13, v13, v9
    v_add_f32 v14, v14, v10
    v_add_f32 v15, v15, v11
    ds_swizzle_b32 v8, v12 offset:4127
    ds_swizzle_b32 v9, v13 offset:4127
    ds_swizzle_b32 v10, v14 offset:4127
    ds_swizzle_b32 v11, v15 offset:4127
    s_waitcnt lgkmcnt(0)
    v_add_f32 v12, v12, v8
    v_add_f32 v13, v13, v9
    v_add_f32 v14, v14, v10
    v_add_f32 v15, v15, v11
    ds_swizzle_b32 v8, v12 offset:8223
    ds_swizzle_b32 v9, v13 offset:8223
    ds_swizzle_b32 v10, v14 offset:8223
    ds_swizzle_b32 v11, v15 offset:8223
    s_waitcnt lgkmcnt(0)
    v_add_f32 v12, v12, v8
    v_add_f32 v13, v13, v9
    v_add_f32 v14, v14, v10
    v_add_f32 v15, v15, v11
    ds_swizzle_b32 v8, v12 offset:16415
    ds_swizzle_b32 v9, v13 offset:16415
    ds_swizzle_b32 v10, v14 offset:16415
    ds_swizzle_b32 v11, v15 offset:16415
    s_waitcnt lgkmcnt(0)
    v_add_f32 v12, v12, v8
    v_add_f32 v13, v13, v9
    v_add_f32 v14, v14, v10
    v_add_f32 v15, v15, v11
    v_mov_b32 v8, v12
    v_mov_b32 v9, v13
    v_mov_b32 v10, v14
    v_mov_b32 v11, v15
    s_nop 1
    v_permlane32_swap_b32 v8, v12
    v_permlane32_swap_b32 v9, v13
    v_permlane32_swap_b32 v10, v14
    v_permlane32_swap_b32 v11, v15
    s_nop 0
    v_add_f32 v12, v12, v8
    v_add_f32 v13, v13, v9
    v_add_f32 v14, v14, v10
    v_add_f32 v15, v15, v11
    s_waitcnt vmcnt(0)
    v_mul_f32 v12, 0x3acccccd, v12
    v_cvt_pk_bf16_f32 v4, v4, v4
    v_and_b32 v4, 0xffff0000, v4
    v_cvt_pk_bf16_f32 v12, v12, v12
    v_and_b32 v12, 0xffff0000, v12
    v_add_f32 v12, 0x3727c5ac, v12
    v_cvt_pk_bf16_f32 v12, v12, v12
    v_and_b32 v12, 0xffff0000, v12
    v_sqrt_f32 v12, v12
    s_nop 0
    v_cvt_pk_bf16_f32 v12, v12, v12
    v_and_b32 v12, 0xffff0000, v12
    v_rcp_f32 v12, v12
    s_nop 0
    v_sub_f32 v170, v170, v4
    v_cvt_pk_bf16_f32 v170, v170, v170
    v_and_b32 v170, 0xffff0000, v170
    v_mul_f32 v170, v170, v12
    v_cvt_pk_bf16_f32 v170, v170, v170
    v_and_b32 v170, 0xffff0000, v170
    v_mul_f32 v170, v170, v32
    v_cvt_pk_bf16_f32 v170, v170, v170
    v_and_b32 v170, 0xffff0000, v170
    v_add_f32 v170, v170, v44
    v_sub_f32 v171, v171, v4
    v_cvt_pk_bf16_f32 v171, v171, v171
    v_and_b32 v171, 0xffff0000, v171
    v_mul_f32 v171, v171, v12
    v_cvt_pk_bf16_f32 v171, v171, v171
    v_and_b32 v171, 0xffff0000, v171
    v_mul_f32 v171, v171, v33
    v_cvt_pk_bf16_f32 v171, v171, v171
    v_and_b32 v171, 0xffff0000, v171
    v_add_f32 v171, v171, v45
    v_sub_f32 v172, v172, v4
    v_cvt_pk_bf16_f32 v172, v172, v172
    v_and_b32 v172, 0xffff0000, v172
    v_mul_f32 v172, v172, v12
    v_cvt_pk_bf16_f32 v172, v172, v172
    v_and_b32 v172, 0xffff0000, v172
    v_mul_f32 v172, v172, v34
    v_cvt_pk_bf16_f32 v172, v172, v172
    v_and_b32 v172, 0xffff0000, v172
    v_add_f32 v172, v172, v46
    v_sub_f32 v173, v173, v4
    v_cvt_pk_bf16_f32 v173, v173, v173
    v_and_b32 v173, 0xffff0000, v173
    v_mul_f32 v173, v173, v12
    v_cvt_pk_bf16_f32 v173, v173, v173
    v_and_b32 v173, 0xffff0000, v173
    v_mul_f32 v173, v173, v35
    v_cvt_pk_bf16_f32 v173, v173, v173
    v_and_b32 v173, 0xffff0000, v173
    v_add_f32 v173, v173, v47
    v_sub_f32 v174, v174, v4
    v_cvt_pk_bf16_f32 v174, v174, v174
    v_and_b32 v174, 0xffff0000, v174
    v_mul_f32 v174, v174, v12
    v_cvt_pk_bf16_f32 v174, v174, v174
    v_and_b32 v174, 0xffff0000, v174
    v_mul_f32 v174, v174, v36
    v_cvt_pk_bf16_f32 v174, v174, v174
    v_and_b32 v174, 0xffff0000, v174
    v_add_f32 v174, v174, v48
    v_sub_f32 v175, v175, v4
    v_cvt_pk_bf16_f32 v175, v175, v175
    v_and_b32 v175, 0xffff0000, v175
    v_mul_f32 v175, v175, v12
    v_cvt_pk_bf16_f32 v175, v175, v175
    v_and_b32 v175, 0xffff0000, v175
    v_mul_f32 v175, v175, v37
    v_cvt_pk_bf16_f32 v175, v175, v175
    v_and_b32 v175, 0xffff0000, v175
    v_add_f32 v175, v175, v49
    v_sub_f32 v176, v176, v4
    v_cvt_pk_bf16_f32 v176, v176, v176
    v_and_b32 v176, 0xffff0000, v176
    v_mul_f32 v176, v176, v12
    v_cvt_pk_bf16_f32 v176, v176, v176
    v_and_b32 v176, 0xffff0000, v176
    v_mul_f32 v176, v176, v38
    v_cvt_pk_bf16_f32 v176, v176, v176
    v_and_b32 v176, 0xffff0000, v176
    v_add_f32 v176, v176, v50
    v_sub_f32 v177, v177, v4
    v_cvt_pk_bf16_f32 v177, v177, v177
    v_and_b32 v177, 0xffff0000, v177
    v_mul_f32 v177, v177, v12
    v_cvt_pk_bf16_f32 v177, v177, v177
    v_and_b32 v177, 0xffff0000, v177
    v_mul_f32 v177, v177, v39
    v_cvt_pk_bf16_f32 v177, v177, v177
    v_and_b32 v177, 0xffff0000, v177
    v_add_f32 v177, v177, v51
    v_sub_f32 v178, v178, v4
    v_cvt_pk_bf16_f32 v178, v178, v178
    v_and_b32 v178, 0xffff0000, v178
    v_mul_f32 v178, v178, v12
    v_cvt_pk_bf16_f32 v178, v178, v178
    v_and_b32 v178, 0xffff0000, v178
    v_mul_f32 v178, v178, v40
    v_cvt_pk_bf16_f32 v178, v178, v178
    v_and_b32 v178, 0xffff0000, v178
    v_add_f32 v178, v178, v52
    v_sub_f32 v179, v179, v4
    v_cvt_pk_bf16_f32 v179, v179, v179
    v_and_b32 v179, 0xffff0000, v179
    v_mul_f32 v179, v179, v12
    v_cvt_pk_bf16_f32 v179, v179, v179
    v_and_b32 v179, 0xffff0000, v179
    v_mul_f32 v179, v179, v41
    v_cvt_pk_bf16_f32 v179, v179, v179
    v_and_b32 v179, 0xffff0000, v179
    v_add_f32 v179, v179, v53
    v_cvt_pk_bf16_f32 v80, v170, v171
    v_cvt_pk_bf16_f32 v81, v172, v173
    v_cvt_pk_bf16_f32 v82, v174, v175
    v_cvt_pk_bf16_f32 v83, v176, v177
    v_cvt_pk_bf16_f32 v84, v178, v179
    buffer_store_dword v80, v2, s[20:23], s32 offen offset:0 sc0 sc1
    buffer_store_dword v81, v2, s[20:23], s32 offen offset:256 sc0 sc1
    buffer_store_dword v82, v2, s[20:23], s32 offen offset:512 sc0 sc1
    buffer_store_dword v83, v2, s[20:23], s32 offen offset:768 sc0 sc1
    buffer_store_dword v84, v2, s[20:23], s32 offen offset:1024 sc0 sc1
    v_mul_f32 v13, 0x3acccccd, v13
    v_cvt_pk_bf16_f32 v5, v5, v5
    v_and_b32 v5, 0xffff0000, v5
    v_cvt_pk_bf16_f32 v13, v13, v13
    v_and_b32 v13, 0xffff0000, v13
    v_add_f32 v13, 0x3727c5ac, v13
    v_cvt_pk_bf16_f32 v13, v13, v13
    v_and_b32 v13, 0xffff0000, v13
    v_sqrt_f32 v13, v13
    s_nop 0
    v_cvt_pk_bf16_f32 v13, v13, v13
    v_and_b32 v13, 0xffff0000, v13
    v_rcp_f32 v13, v13
    s_nop 0
    v_sub_f32 v180, v180, v5
    v_cvt_pk_bf16_f32 v180, v180, v180
    v_and_b32 v180, 0xffff0000, v180
    v_mul_f32 v180, v180, v13
    v_cvt_pk_bf16_f32 v180, v180, v180
    v_and_b32 v180, 0xffff0000, v180
    v_mul_f32 v180, v180, v32
    v_cvt_pk_bf16_f32 v180, v180, v180
    v_and_b32 v180, 0xffff0000, v180
    v_add_f32 v180, v180, v44
    v_sub_f32 v181, v181, v5
    v_cvt_pk_bf16_f32 v181, v181, v181
    v_and_b32 v181, 0xffff0000, v181
    v_mul_f32 v181, v181, v13
    v_cvt_pk_bf16_f32 v181, v181, v181
    v_and_b32 v181, 0xffff0000, v181
    v_mul_f32 v181, v181, v33
    v_cvt_pk_bf16_f32 v181, v181, v181
    v_and_b32 v181, 0xffff0000, v181
    v_add_f32 v181, v181, v45
    v_sub_f32 v182, v182, v5
    v_cvt_pk_bf16_f32 v182, v182, v182
    v_and_b32 v182, 0xffff0000, v182
    v_mul_f32 v182, v182, v13
    v_cvt_pk_bf16_f32 v182, v182, v182
    v_and_b32 v182, 0xffff0000, v182
    v_mul_f32 v182, v182, v34
    v_cvt_pk_bf16_f32 v182, v182, v182
    v_and_b32 v182, 0xffff0000, v182
    v_add_f32 v182, v182, v46
    v_sub_f32 v183, v183, v5
    v_cvt_pk_bf16_f32 v183, v183, v183
    v_and_b32 v183, 0xffff0000, v183
    v_mul_f32 v183, v183, v13
    v_cvt_pk_bf16_f32 v183, v183, v183
    v_and_b32 v183, 0xffff0000, v183
    v_mul_f32 v183, v183, v35
    v_cvt_pk_bf16_f32 v183, v183, v183
    v_and_b32 v183, 0xffff0000, v183
    v_add_f32 v183, v183, v47
    v_sub_f32 v184, v184, v5
    v_cvt_pk_bf16_f32 v184, v184, v184
    v_and_b32 v184, 0xffff0000, v184
    v_mul_f32 v184, v184, v13
    v_cvt_pk_bf16_f32 v184, v184, v184
    v_and_b32 v184, 0xffff0000, v184
    v_mul_f32 v184, v184, v36
    v_cvt_pk_bf16_f32 v184, v184, v184
    v_and_b32 v184, 0xffff0000, v184
    v_add_f32 v184, v184, v48
    v_sub_f32 v185, v185, v5
    v_cvt_pk_bf16_f32 v185, v185, v185
    v_and_b32 v185, 0xffff0000, v185
    v_mul_f32 v185, v185, v13
    v_cvt_pk_bf16_f32 v185, v185, v185
    v_and_b32 v185, 0xffff0000, v185
    v_mul_f32 v185, v185, v37
    v_cvt_pk_bf16_f32 v185, v185, v185
    v_and_b32 v185, 0xffff0000, v185
    v_add_f32 v185, v185, v49
    v_sub_f32 v186, v186, v5
    v_cvt_pk_bf16_f32 v186, v186, v186
    v_and_b32 v186, 0xffff0000, v186
    v_mul_f32 v186, v186, v13
    v_cvt_pk_bf16_f32 v186, v186, v186
    v_and_b32 v186, 0xffff0000, v186
    v_mul_f32 v186, v186, v38
    v_cvt_pk_bf16_f32 v186, v186, v186
    v_and_b32 v186, 0xffff0000, v186
    v_add_f32 v186, v186, v50
    v_sub_f32 v187, v187, v5
    v_cvt_pk_bf16_f32 v187, v187, v187
    v_and_b32 v187, 0xffff0000, v187
    v_mul_f32 v187, v187, v13
    v_cvt_pk_bf16_f32 v187, v187, v187
    v_and_b32 v187, 0xffff0000, v187
    v_mul_f32 v187, v187, v39
    v_cvt_pk_bf16_f32 v187, v187, v187
    v_and_b32 v187, 0xffff0000, v187
    v_add_f32 v187, v187, v51
    v_sub_f32 v188, v188, v5
    v_cvt_pk_bf16_f32 v188, v188, v188
    v_and_b32 v188, 0xffff0000, v188
    v_mul_f32 v188, v188, v13
    v_cvt_pk_bf16_f32 v188, v188, v188
    v_and_b32 v188, 0xffff0000, v188
    v_mul_f32 v188, v188, v40
    v_cvt_pk_bf16_f32 v188, v188, v188
    v_and_b32 v188, 0xffff0000, v188
    v_add_f32 v188, v188, v52
    v_sub_f32 v189, v189, v5
    v_cvt_pk_bf16_f32 v189, v189, v189
    v_and_b32 v189, 0xffff0000, v189
    v_mul_f32 v189, v189, v13
    v_cvt_pk_bf16_f32 v189, v189, v189
    v_and_b32 v189, 0xffff0000, v189
    v_mul_f32 v189, v189, v41
    v_cvt_pk_bf16_f32 v189, v189, v189
    v_and_b32 v189, 0xffff0000, v189
    v_add_f32 v189, v189, v53
    v_cvt_pk_bf16_f32 v85, v180, v181
    v_cvt_pk_bf16_f32 v86, v182, v183
    v_cvt_pk_bf16_f32 v87, v184, v185
    v_cvt_pk_bf16_f32 v88, v186, v187
    v_cvt_pk_bf16_f32 v89, v188, v189
    buffer_store_dword v85, v2, s[20:23], s33 offen offset:0 sc0 sc1
    buffer_store_dword v86, v2, s[20:23], s33 offen offset:256 sc0 sc1
    buffer_store_dword v87, v2, s[20:23], s33 offen offset:512 sc0 sc1
    buffer_store_dword v88, v2, s[20:23], s33 offen offset:768 sc0 sc1
    buffer_store_dword v89, v2, s[20:23], s33 offen offset:1024 sc0 sc1
    v_mul_f32 v14, 0x3acccccd, v14
    v_cvt_pk_bf16_f32 v6, v6, v6
    v_and_b32 v6, 0xffff0000, v6
    v_cvt_pk_bf16_f32 v14, v14, v14
    v_and_b32 v14, 0xffff0000, v14
    v_add_f32 v14, 0x3727c5ac, v14
    v_cvt_pk_bf16_f32 v14, v14, v14
    v_and_b32 v14, 0xffff0000, v14
    v_sqrt_f32 v14, v14
    s_nop 0
    v_cvt_pk_bf16_f32 v14, v14, v14
    v_and_b32 v14, 0xffff0000, v14
    v_rcp_f32 v14, v14
    s_nop 0
    v_sub_f32 v190, v190, v6
    v_cvt_pk_bf16_f32 v190, v190, v190
    v_and_b32 v190, 0xffff0000, v190
    v_mul_f32 v190, v190, v14
    v_cvt_pk_bf16_f32 v190, v190, v190
    v_and_b32 v190, 0xffff0000, v190
    v_mul_f32 v190, v190, v32
    v_cvt_pk_bf16_f32 v190, v190, v190
    v_and_b32 v190, 0xffff0000, v190
    v_add_f32 v190, v190, v44
    v_sub_f32 v191, v191, v6
    v_cvt_pk_bf16_f32 v191, v191, v191
    v_and_b32 v191, 0xffff0000, v191
    v_mul_f32 v191, v191, v14
    v_cvt_pk_bf16_f32 v191, v191, v191
    v_and_b32 v191, 0xffff0000, v191
    v_mul_f32 v191, v191, v33
    v_cvt_pk_bf16_f32 v191, v191, v191
    v_and_b32 v191, 0xffff0000, v191
    v_add_f32 v191, v191, v45
    v_sub_f32 v192, v192, v6
    v_cvt_pk_bf16_f32 v192, v192, v192
    v_and_b32 v192, 0xffff0000, v192
    v_mul_f32 v192, v192, v14
    v_cvt_pk_bf16_f32 v192, v192, v192
    v_and_b32 v192, 0xffff0000, v192
    v_mul_f32 v192, v192, v34
    v_cvt_pk_bf16_f32 v192, v192, v192
    v_and_b32 v192, 0xffff0000, v192
    v_add_f32 v192, v192, v46
    v_sub_f32 v193, v193, v6
    v_cvt_pk_bf16_f32 v193, v193, v193
    v_and_b32 v193, 0xffff0000, v193
    v_mul_f32 v193, v193, v14
    v_cvt_pk_bf16_f32 v193, v193, v193
    v_and_b32 v193, 0xffff0000, v193
    v_mul_f32 v193, v193, v35
    v_cvt_pk_bf16_f32 v193, v193, v193
    v_and_b32 v193, 0xffff0000, v193
    v_add_f32 v193, v193, v47
    v_sub_f32 v194, v194, v6
    v_cvt_pk_bf16_f32 v194, v194, v194
    v_and_b32 v194, 0xffff0000, v194
    v_mul_f32 v194, v194, v14
    v_cvt_pk_bf16_f32 v194, v194, v194
    v_and_b32 v194, 0xffff0000, v194
    v_mul_f32 v194, v194, v36
    v_cvt_pk_bf16_f32 v194, v194, v194
    v_and_b32 v194, 0xffff0000, v194
    v_add_f32 v194, v194, v48
    v_sub_f32 v195, v195, v6
    v_cvt_pk_bf16_f32 v195, v195, v195
    v_and_b32 v195, 0xffff0000, v195
    v_mul_f32 v195, v195, v14
    v_cvt_pk_bf16_f32 v195, v195, v195
    v_and_b32 v195, 0xffff0000, v195
    v_mul_f32 v195, v195, v37
    v_cvt_pk_bf16_f32 v195, v195, v195
    v_and_b32 v195, 0xffff0000, v195
    v_add_f32 v195, v195, v49
    v_sub_f32 v196, v196, v6
    v_cvt_pk_bf16_f32 v196, v196, v196
    v_and_b32 v196, 0xffff0000, v196
    v_mul_f32 v196, v196, v14
    v_cvt_pk_bf16_f32 v196, v196, v196
    v_and_b32 v196, 0xffff0000, v196
    v_mul_f32 v196, v196, v38
    v_cvt_pk_bf16_f32 v196, v196, v196
    v_and_b32 v196, 0xffff0000, v196
    v_add_f32 v196, v196, v50
    v_sub_f32 v197, v197, v6
    v_cvt_pk_bf16_f32 v197, v197, v197
    v_and_b32 v197, 0xffff0000, v197
    v_mul_f32 v197, v197, v14
    v_cvt_pk_bf16_f32 v197, v197, v197
    v_and_b32 v197, 0xffff0000, v197
    v_mul_f32 v197, v197, v39
    v_cvt_pk_bf16_f32 v197, v197, v197
    v_and_b32 v197, 0xffff0000, v197
    v_add_f32 v197, v197, v51
    v_sub_f32 v198, v198, v6
    v_cvt_pk_bf16_f32 v198, v198, v198
    v_and_b32 v198, 0xffff0000, v198
    v_mul_f32 v198, v198, v14
    v_cvt_pk_bf16_f32 v198, v198, v198
    v_and_b32 v198, 0xffff0000, v198
    v_mul_f32 v198, v198, v40
    v_cvt_pk_bf16_f32 v198, v198, v198
    v_and_b32 v198, 0xffff0000, v198
    v_add_f32 v198, v198, v52
    v_sub_f32 v199, v199, v6
    v_cvt_pk_bf16_f32 v199, v199, v199
    v_and_b32 v199, 0xffff0000, v199
    v_mul_f32 v199, v199, v14
    v_cvt_pk_bf16_f32 v199, v199, v199
    v_and_b32 v199, 0xffff0000, v199
    v_mul_f32 v199, v199, v41
    v_cvt_pk_bf16_f32 v199, v199, v199
    v_and_b32 v199, 0xffff0000, v199
    v_add_f32 v199, v199, v53
    v_cvt_pk_bf16_f32 v90, v190, v191
    v_cvt_pk_bf16_f32 v91, v192, v193
    v_cvt_pk_bf16_f32 v92, v194, v195
    v_cvt_pk_bf16_f32 v93, v196, v197
    v_cvt_pk_bf16_f32 v94, v198, v199
    buffer_store_dword v90, v2, s[20:23], s34 offen offset:0 sc0 sc1
    buffer_store_dword v91, v2, s[20:23], s34 offen offset:256 sc0 sc1
    buffer_store_dword v92, v2, s[20:23], s34 offen offset:512 sc0 sc1
    buffer_store_dword v93, v2, s[20:23], s34 offen offset:768 sc0 sc1
    buffer_store_dword v94, v2, s[20:23], s34 offen offset:1024 sc0 sc1
    v_mul_f32 v15, 0x3acccccd, v15
    v_cvt_pk_bf16_f32 v7, v7, v7
    v_and_b32 v7, 0xffff0000, v7
    v_cvt_pk_bf16_f32 v15, v15, v15
    v_and_b32 v15, 0xffff0000, v15
    v_add_f32 v15, 0x3727c5ac, v15
    v_cvt_pk_bf16_f32 v15, v15, v15
    v_and_b32 v15, 0xffff0000, v15
    v_sqrt_f32 v15, v15
    s_nop 0
    v_cvt_pk_bf16_f32 v15, v15, v15
    v_and_b32 v15, 0xffff0000, v15
    v_rcp_f32 v15, v15
    s_nop 0
    v_sub_f32 v200, v200, v7
    v_cvt_pk_bf16_f32 v200, v200, v200
    v_and_b32 v200, 0xffff0000, v200
    v_mul_f32 v200, v200, v15
    v_cvt_pk_bf16_f32 v200, v200, v200
    v_and_b32 v200, 0xffff0000, v200
    v_mul_f32 v200, v200, v32
    v_cvt_pk_bf16_f32 v200, v200, v200
    v_and_b32 v200, 0xffff0000, v200
    v_add_f32 v200, v200, v44
    v_sub_f32 v201, v201, v7
    v_cvt_pk_bf16_f32 v201, v201, v201
    v_and_b32 v201, 0xffff0000, v201
    v_mul_f32 v201, v201, v15
    v_cvt_pk_bf16_f32 v201, v201, v201
    v_and_b32 v201, 0xffff0000, v201
    v_mul_f32 v201, v201, v33
    v_cvt_pk_bf16_f32 v201, v201, v201
    v_and_b32 v201, 0xffff0000, v201
    v_add_f32 v201, v201, v45
    v_sub_f32 v202, v202, v7
    v_cvt_pk_bf16_f32 v202, v202, v202
    v_and_b32 v202, 0xffff0000, v202
    v_mul_f32 v202, v202, v15
    v_cvt_pk_bf16_f32 v202, v202, v202
    v_and_b32 v202, 0xffff0000, v202
    v_mul_f32 v202, v202, v34
    v_cvt_pk_bf16_f32 v202, v202, v202
    v_and_b32 v202, 0xffff0000, v202
    v_add_f32 v202, v202, v46
    v_sub_f32 v203, v203, v7
    v_cvt_pk_bf16_f32 v203, v203, v203
    v_and_b32 v203, 0xffff0000, v203
    v_mul_f32 v203, v203, v15
    v_cvt_pk_bf16_f32 v203, v203, v203
    v_and_b32 v203, 0xffff0000, v203
    v_mul_f32 v203, v203, v35
    v_cvt_pk_bf16_f32 v203, v203, v203
    v_and_b32 v203, 0xffff0000, v203
    v_add_f32 v203, v203, v47
    v_sub_f32 v204, v204, v7
    v_cvt_pk_bf16_f32 v204, v204, v204
    v_and_b32 v204, 0xffff0000, v204
    v_mul_f32 v204, v204, v15
    v_cvt_pk_bf16_f32 v204, v204, v204
    v_and_b32 v204, 0xffff0000, v204
    v_mul_f32 v204, v204, v36
    v_cvt_pk_bf16_f32 v204, v204, v204
    v_and_b32 v204, 0xffff0000, v204
    v_add_f32 v204, v204, v48
    v_sub_f32 v205, v205, v7
    v_cvt_pk_bf16_f32 v205, v205, v205
    v_and_b32 v205, 0xffff0000, v205
    v_mul_f32 v205, v205, v15
    v_cvt_pk_bf16_f32 v205, v205, v205
    v_and_b32 v205, 0xffff0000, v205
    v_mul_f32 v205, v205, v37
    v_cvt_pk_bf16_f32 v205, v205, v205
    v_and_b32 v205, 0xffff0000, v205
    v_add_f32 v205, v205, v49
    v_sub_f32 v206, v206, v7
    v_cvt_pk_bf16_f32 v206, v206, v206
    v_and_b32 v206, 0xffff0000, v206
    v_mul_f32 v206, v206, v15
    v_cvt_pk_bf16_f32 v206, v206, v206
    v_and_b32 v206, 0xffff0000, v206
    v_mul_f32 v206, v206, v38
    v_cvt_pk_bf16_f32 v206, v206, v206
    v_and_b32 v206, 0xffff0000, v206
    v_add_f32 v206, v206, v50
    v_sub_f32 v207, v207, v7
    v_cvt_pk_bf16_f32 v207, v207, v207
    v_and_b32 v207, 0xffff0000, v207
    v_mul_f32 v207, v207, v15
    v_cvt_pk_bf16_f32 v207, v207, v207
    v_and_b32 v207, 0xffff0000, v207
    v_mul_f32 v207, v207, v39
    v_cvt_pk_bf16_f32 v207, v207, v207
    v_and_b32 v207, 0xffff0000, v207
    v_add_f32 v207, v207, v51
    v_sub_f32 v208, v208, v7
    v_cvt_pk_bf16_f32 v208, v208, v208
    v_and_b32 v208, 0xffff0000, v208
    v_mul_f32 v208, v208, v15
    v_cvt_pk_bf16_f32 v208, v208, v208
    v_and_b32 v208, 0xffff0000, v208
    v_mul_f32 v208, v208, v40
    v_cvt_pk_bf16_f32 v208, v208, v208
    v_and_b32 v208, 0xffff0000, v208
    v_add_f32 v208, v208, v52
    v_sub_f32 v209, v209, v7
    v_cvt_pk_bf16_f32 v209, v209, v209
    v_and_b32 v209, 0xffff0000, v209
    v_mul_f32 v209, v209, v15
    v_cvt_pk_bf16_f32 v209, v209, v209
    v_and_b32 v209, 0xffff0000, v209
    v_mul_f32 v209, v209, v41
    v_cvt_pk_bf16_f32 v209, v209, v209
    v_and_b32 v209, 0xffff0000, v209
    v_add_f32 v209, v209, v53
    v_cvt_pk_bf16_f32 v95, v200, v201
    v_cvt_pk_bf16_f32 v96, v202, v203
    v_cvt_pk_bf16_f32 v97, v204, v205
    v_cvt_pk_bf16_f32 v98, v206, v207
    v_cvt_pk_bf16_f32 v99, v208, v209
    buffer_store_dword v95, v2, s[20:23], s35 offen offset:0 sc0 sc1
    buffer_store_dword v96, v2, s[20:23], s35 offen offset:256 sc0 sc1
    buffer_store_dword v97, v2, s[20:23], s35 offen offset:512 sc0 sc1
    buffer_store_dword v98, v2, s[20:23], s35 offen offset:768 sc0 sc1
    buffer_store_dword v99, v2, s[20:23], s35 offen offset:1024 sc0 sc1
    s_lshr_b32 s92, s90, 3
    s_waitcnt vmcnt(0)
    s_barrier
    s_cmp_lg_u32 s94, 0
    s_cbranch_scc1 mega_kernel_sg31
    s_lshl_b32 s93, s92, 7
    s_add_u32 s93, s93, 28672
    v_mov_b32 v1, s93
    v_mov_b32 v2, 1
    s_mov_b64 exec, 1
    buffer_atomic_add v2, v1, s[80:83], 0 offen sc1
    s_mov_b64 exec, -1
mega_kernel_sg31:
    s_mov_b32 s91, s90
mega_kernel_pa32:
    s_cmp_ge_u32 s91, 2304
    s_cbranch_scc1 mega_kernel_pb36
    s_cmp_ge_u32 s91, 1536
    s_cbranch_scc1 mega_kernel_paq33
    s_mul_i32 s13, s91, 43691
    s_lshr_b32 s13, s13, 22
    s_mul_i32 s14, s13, 96
    s_sub_u32 s14, s91, s14
    s_mov_b32 s92, s13
    s_mov_b32 s97, s14
    s_cmp_lg_u32 s94, 0
    s_cbranch_scc1 mega_kernel_wd38
    s_lshl_b32 s93, s92, 7
    s_add_u32 s93, s93, 28672
    v_mov_b32 v1, s93
    s_mov_b32 s95, 0
mega_kernel_wl37:
    buffer_load_dword v2, v1, s[80:83], 0 offen sc1
    s_waitcnt vmcnt(0)
    v_cmp_gt_u32 vcc, 8, v2
    s_nop 0
    s_cbranch_vccz mega_kernel_wok39
    s_sleep 4
    s_add_u32 s95, s95, 1
    s_cmp_lt_u32 s95, 1000000
    s_cbranch_scc1 mega_kernel_wl37
    s_branch mega_kernel_done1
mega_kernel_wok39:
mega_kernel_wd38:
    s_barrier
    s_mov_b32 s13, s92
    s_mov_b32 s14, s97
    s_cmp_ge_u32 s14, 48
    s_cbranch_scc1 mega_kernel_pav34
    s_mov_b64 s[4:5], s[78:79]
    s_mul_i32 s12, s13, 163840
    s_add_u32 s4, s4, 6701056
    s_addc_u32 s5, s5, 0
    s_add_u32 s4, s4, s12
    s_addc_u32 s5, s5, 0
    s_mov_b64 s[6:7], s[54:55]
    s_lshl_b32 s12, s14, 8
    s_add_u32 s6, s6, s12
    s_addc_u32 s7, s7, 0
    s_add_u32 s8, s6, 128
    s_addc_u32 s9, s7, 0
    v_and_b32 v48, 63, v0
    v_lshrrev_b32 v49, 6, v0
    s_nop 1
    v_readfirstlane_b32 s10, v49
    s_nop 3
    s_lshl_b32 s11, s10, 11
    s_mul_i32 s10, s10, 4096
    v_lshrrev_b32 v50, 3, v48
    v_and_b32 v51, 7, v48
    v_lshrrev_b32 v52, 4, v48
    s_mov_b32 s12, 1280
    v_mul_u32_u24 v53, 32, v49
    v_add_u32 v53, 0, v53
    v_add_u32 v53, v53, v50
    v_lshrrev_b32 v54, 1, v53
    v_and_b32 v54, 7, v54
    v_xor_b32 v54, v54, v51
    v_lshlrev_b32 v54, 4, v54
    v_mul_lo_u32 v1, v53, s12
    v_add_u32 v1, v1, v54
    v_mul_u32_u24 v53, 32, v49
    v_add_u32 v53, 8, v53
    v_add_u32 v53, v53, v50
    v_lshrrev_b32 v54, 1, v53
    v_and_b32 v54, 7, v54
    v_xor_b32 v54, v54, v51
    v_lshlrev_b32 v54, 4, v54
    v_mul_lo_u32 v2, v53, s12
    v_add_u32 v2, v2, v54
    v_mul_u32_u24 v53, 32, v49
    v_add_u32 v53, 16, v53
    v_add_u32 v53, v53, v50
    v_lshrrev_b32 v54, 1, v53
    v_and_b32 v54, 7, v54
    v_xor_b32 v54, v54, v51
    v_lshlrev_b32 v54, 4, v54
    v_mul_lo_u32 v3, v53, s12
    v_add_u32 v3, v3, v54
    v_mul_u32_u24 v53, 32, v49
    v_add_u32 v53, 24, v53
    v_add_u32 v53, v53, v50
    v_lshrrev_b32 v54, 1, v53
    v_and_b32 v54, 7, v54
    v_xor_b32 v54, v54, v51
    v_lshlrev_b32 v54, 4, v54
    v_mul_lo_u32 v4, v53, s12
    v_add_u32 v4, v4, v54
    v_lshrrev_b32 v53, 2, v51
    v_and_b32 v54, 1, v52
    v_xor_b32 v53, v53, v54
    v_lshlrev_b32 v53, 2, v53
    v_and_b32 v54, 3, v51
    v_or_b32 v53, v53, v54
    v_lshlrev_b32 v53, 4, v53
    v_lshlrev_b32 v54, 4, v49
    v_add_u32 v54, v54, v50
    s_mov_b32 s12, 12288
    v_mul_lo_u32 v5, v54, s12
    v_add_u32 v5, v5, v53
    v_add_u32 v6, 98304, v5
    v_lshrrev_b32 v53, 1, v49
    v_and_b32 v54, 1, v49
    v_mul_u32_u24 v55, 64, v53
    v_and_b32 v56, 31, v48
    v_add_u32 v55, v55, v56
    v_lshrrev_b32 v56, 1, v55
    v_and_b32 v56, 7, v56
    v_lshrrev_b32 v57, 5, v48
    v_xor_b32 v56, v56, v57
    v_lshlrev_b32 v56, 4, v56
    v_lshlrev_b32 v55, 7, v55
    v_add_u32 v8, v55, v56
    v_xor_b32 v9, 32, v8
    v_xor_b32 v10, 64, v8
    v_xor_b32 v11, 96, v8
    v_and_b32 v55, 15, v48
    v_lshrrev_b32 v55, 2, v55
    v_lshrrev_b32 v56, 5, v48
    v_lshlrev_b32 v56, 3, v56
    v_add_u32 v56, v56, v55
    v_lshrrev_b32 v57, 1, v55
    v_and_b32 v57, 1, v57
    v_lshlrev_b32 v57, 6, v57
    v_lshlrev_b32 v56, 7, v56
    v_add_u32 v56, v56, v57
    v_and_b32 v57, 1, v52
    v_lshlrev_b32 v57, 5, v57
    v_add_u32 v56, v56, v57
    v_and_b32 v57, 3, v48
    v_lshlrev_b32 v57, 3, v57
    v_add_u32 v56, v56, v57
    v_add_u32 v56, 16384, v56
    v_lshlrev_b32 v57, 13, v54
    v_add_u32 v12, v56, v57
    v_xor_b32 v13, 64, v12
    v_add_u32 v128, 65536, v8
    v_add_u32 v129, 65536, v9
    v_add_u32 v130, 65536, v10
    v_add_u32 v131, 65536, v11
    v_add_u32 v132, 65536, v12
    v_add_u32 v133, 65536, v13
    v_mov_b32 v64, 0
    v_mov_b32 v65, 0
    v_mov_b32 v66, 0
    v_mov_b32 v67, 0
    v_mov_b32 v68, 0
    v_mov_b32 v69, 0
    v_mov_b32 v70, 0
    v_mov_b32 v71, 0
    v_mov_b32 v72, 0
    v_mov_b32 v73, 0
    v_mov_b32 v74, 0
    v_mov_b32 v75, 0
    v_mov_b32 v76, 0
    v_mov_b32 v77, 0
    v_mov_b32 v78, 0
    v_mov_b32 v79, 0
    v_mov_b32 v80, 0
    v_mov_b32 v81, 0
    v_mov_b32 v82, 0
    v_mov_b32 v83, 0
    v_mov_b32 v84, 0
    v_mov_b32 v85, 0
    v_mov_b32 v86, 0
    v_mov_b32 v87, 0
    v_mov_b32 v88, 0
    v_mov_b32 v89, 0
    v_mov_b32 v90, 0
    v_mov_b32 v91, 0
    v_mov_b32 v92, 0
    v_mov_b32 v93, 0
    v_mov_b32 v94, 0
    v_mov_b32 v95, 0
    v_mov_b32 v96, 0
    v_mov_b32 v97, 0
    v_mov_b32 v98, 0
    v_mov_b32 v99, 0
    v_mov_b32 v100, 0
    v_mov_b32 v101, 0
    v_mov_b32 v102, 0
    v_mov_b32 v103, 0
    v_mov_b32 v104, 0
    v_mov_b32 v105, 0
    v_mov_b32 v106, 0
    v_mov_b32 v107, 0
    v_mov_b32 v108, 0
    v_mov_b32 v109, 0
    v_mov_b32 v110, 0
    v_mov_b32 v111, 0
    v_mov_b32 v112, 0
    v_mov_b32 v113, 0
    v_mov_b32 v114, 0
    v_mov_b32 v115, 0
    v_mov_b32 v116, 0
    v_mov_b32 v117, 0
    v_mov_b32 v118, 0
    v_mov_b32 v119, 0
    v_mov_b32 v120, 0
    v_mov_b32 v121, 0
    v_mov_b32 v122, 0
    v_mov_b32 v123, 0
    v_mov_b32 v124, 0
    v_mov_b32 v125, 0
    v_mov_b32 v126, 0
    v_mov_b32 v127, 0
    s_add_u32 m0, s10, 0
    s_nop 0
    global_load_lds_dwordx4 v1, s[4:5]
    s_add_u32 m0, s10, 1024
    s_nop 0
    global_load_lds_dwordx4 v2, s[4:5]
    s_add_u32 m0, s10, 2048
    s_nop 0
    global_load_lds_dwordx4 v3, s[4:5]
    s_add_u32 m0, s10, 3072
    s_nop 0
    global_load_lds_dwordx4 v4, s[4:5]
    s_add_u32 m0, s11, 16384
    s_nop 0
    global_load_lds_dwordx4 v5, s[6:7]
    s_add_u32 m0, s11, 17408
    s_nop 0
    global_load_lds_dwordx4 v6, s[6:7]
    s_add_u32 m0, s11, 24576
    s_nop 0
    global_load_lds_dwordx4 v5, s[8:9]
    s_add_u32 m0, s11, 25600
    s_nop 0
    global_load_lds_dwordx4 v6, s[8:9]
    s_add_u32 s4, s4, 128
    s_addc_u32 s5, s5, 0
    s_add_u32 s6, s6, 786432
    s_addc_u32 s7, s7, 0
    s_add_u32 s8, s8, 786432
    s_addc_u32 s9, s9, 0
    s_add_u32 m0, s10, 32768
    s_nop 0
    global_load_lds_dwordx4 v1, s[4:5]
    s_add_u32 m0, s10, 33792
    s_nop 0
    global_load_lds_dwordx4 v2, s[4:5]
    s_add_u32 m0, s10, 34816
    s_nop 0
    global_load_lds_dwordx4 v3, s[4:5]
    s_add_u32 m0, s10, 35840
    s_nop 0
    global_load_lds_dwordx4 v4, s[4:5]
    s_add_u32 m0, s11, 49152
    s_nop 0
    global_load_lds_dwordx4 v5, s[6:7]
    s_add_u32 m0, s11, 50176
    s_nop 0
    global_load_lds_dwordx4 v6, s[6:7]
    s_add_u32 m0, s11, 57344
    s_nop 0
    global_load_lds_dwordx4 v5, s[8:9]
    s_add_u32 m0, s11, 58368
    s_nop 0
    global_load_lds_dwordx4 v6, s[8:9]
    s_add_u32 s4, s4, 128
    s_addc_u32 s5, s5, 0
    s_add_u32 s6, s6, 786432
    s_addc_u32 s7, s7, 0
    s_add_u32 s8, s8, 786432
    s_addc_u32 s9, s9, 0
    s_waitcnt vmcnt(8)
    s_barrier
    ds_read_b128 v[16:19], v8 offset:0
    ds_read_b128 v[20:23], v8 offset:4096
    ds_read_b64_tr_b16 v[24:25], v12 offset:0
    ds_read_b64_tr_b16 v[26:27], v12 offset:512
    ds_read_b64_tr_b16 v[28:29], v13 offset:0
    ds_read_b64_tr_b16 v[30:31], v13 offset:512
    ds_read_b128 v[32:35], v9 offset:0
    ds_read_b128 v[36:39], v9 offset:4096
    ds_read_b64_tr_b16 v[40:41], v12 offset:2048
    ds_read_b64_tr_b16 v[42:43], v12 offset:2560
    ds_read_b64_tr_b16 v[44:45], v13 offset:2048
    ds_read_b64_tr_b16 v[46:47], v13 offset:2560
    s_add_u32 m0, s10, 65536
    s_nop 0
    global_load_lds_dwordx4 v1, s[4:5]
    s_add_u32 m0, s10, 66560
    s_nop 0
    global_load_lds_dwordx4 v2, s[4:5]
    s_add_u32 m0, s10, 67584
    s_nop 0
    global_load_lds_dwordx4 v3, s[4:5]
    s_add_u32 m0, s10, 68608
    s_nop 0
    global_load_lds_dwordx4 v4, s[4:5]
    s_add_u32 m0, s11, 81920
    s_nop 0
    global_load_lds_dwordx4 v5, s[6:7]
    s_add_u32 m0, s11, 82944
    s_nop 0
    global_load_lds_dwordx4 v6, s[6:7]
    s_add_u32 m0, s11, 90112
    s_nop 0
    global_load_lds_dwordx4 v5, s[8:9]
    s_add_u32 m0, s11, 91136
    s_nop 0
    global_load_lds_dwordx4 v6, s[8:9]
    s_add_u32 s4, s4, 128
    s_addc_u32 s5, s5, 0
    s_add_u32 s6, s6, 786432
    s_addc_u32 s7, s7, 0
    s_add_u32 s8, s8, 786432
    s_addc_u32 s9, s9, 0
    s_waitcnt lgkmcnt(6)
    v_mfma_f32_32x32x16_bf16 v[64:79], v[24:27], v[16:19], v[64:79]
    v_mfma_f32_32x32x16_bf16 v[80:95], v[28:31], v[16:19], v[80:95]
    v_mfma_f32_32x32x16_bf16 v[96:111], v[24:27], v[20:23], v[96:111]
    v_mfma_f32_32x32x16_bf16 v[112:127], v[28:31], v[20:23], v[112:127]
    ds_read_b128 v[16:19], v10 offset:0
    ds_read_b128 v[20:23], v10 offset:4096
    ds_read_b64_tr_b16 v[24:25], v12 offset:4096
    ds_read_b64_tr_b16 v[26:27], v12 offset:4608
    ds_read_b64_tr_b16 v[28:29], v13 offset:4096
    ds_read_b64_tr_b16 v[30:31], v13 offset:4608
    s_waitcnt lgkmcnt(6)
    v_mfma_f32_32x32x16_bf16 v[64:79], v[40:43], v[32:35], v[64:79]
    v_mfma_f32_32x32x16_bf16 v[80:95], v[44:47], v[32:35], v[80:95]
    v_mfma_f32_32x32x16_bf16 v[96:111], v[40:43], v[36:39], v[96:111]
    v_mfma_f32_32x32x16_bf16 v[112:127], v[44:47], v[36:39], v[112:127]
    ds_read_b128 v[32:35], v11 offset:0
    ds_read_b128 v[36:39], v11 offset:4096
    ds_read_b64_tr_b16 v[40:41], v12 offset:6144
    ds_read_b64_tr_b16 v[42:43], v12 offset:6656
    ds_read_b64_tr_b16 v[44:45], v13 offset:6144
    ds_read_b64_tr_b16 v[46:47], v13 offset:6656
    s_waitcnt lgkmcnt(6)
    v_mfma_f32_32x32x16_bf16 v[64:79], v[24:27], v[16:19], v[64:79]
    v_mfma_f32_32x32x16_bf16 v[80:95], v[28:31], v[16:19], v[80:95]
    v_mfma_f32_32x32x16_bf16 v[96:111], v[24:27], v[20:23], v[96:111]
    v_mfma_f32_32x32x16_bf16 v[112:127], v[28:31], v[20:23], v[112:127]
    s_waitcnt lgkmcnt(0)
    v_mfma_f32_32x32x16_bf16 v[64:79], v[40:43], v[32:35], v[64:79]
    v_mfma_f32_32x32x16_bf16 v[80:95], v[44:47], v[32:35], v[80:95]
    v_mfma_f32_32x32x16_bf16 v[96:111], v[40:43], v[36:39], v[96:111]
    v_mfma_f32_32x32x16_bf16 v[112:127], v[44:47], v[36:39], v[112:127]
    s_waitcnt vmcnt(8)
    s_barrier
    ds_read_b128 v[16:19], v8 offset:32768
    ds_read_b128 v[20:23], v8 offset:36864
    ds_read_b64_tr_b16 v[24:25], v12 offset:32768
    ds_read_b64_tr_b16 v[26:27], v12 offset:33280
    ds_read_b64_tr_b16 v[28:29], v13 offset:32768
    ds_read_b64_tr_b16 v[30:31], v13 offset:33280
    ds_read_b128 v[32:35], v9 offset:32768
    ds_read_b128 v[36:39], v9 offset:36864
    ds_read_b64_tr_b16 v[40:41], v12 offset:34816
    ds_read_b64_tr_b16 v[42:43], v12 offset:35328
    ds_read_b64_tr_b16 v[44:45], v13 offset:34816
    ds_read_b64_tr_b16 v[46:47], v13 offset:35328
    s_add_u32 m0, s10, 0
    s_nop 0
    global_load_lds_dwordx4 v1, s[4:5]
    s_add_u32 m0, s10, 1024
    s_nop 0
    global_load_lds_dwordx4 v2, s[4:5]
    s_add_u32 m0, s10, 2048
    s_nop 0
    global_load_lds_dwordx4 v3, s[4:5]
    s_add_u32 m0, s10, 3072
    s_nop 0
    global_load_lds_dwordx4 v4, s[4:5]
    s_add_u32 m0, s11, 16384
    s_nop 0
    global_load_lds_dwordx4 v5, s[6:7]
    s_add_u32 m0, s11, 17408
    s_nop 0
    global_load_lds_dwordx4 v6, s[6:7]
    s_add_u32 m0, s11, 24576
    s_nop 0
    global_load_lds_dwordx4 v5, s[8:9]
    s_add_u32 m0, s11, 25600
    s_nop 0
    global_load_lds_dwordx4 v6, s[8:9]
    s_add_u32 s4, s4, 128
    s_addc_u32 s5, s5, 0
    s_add_u32 s6, s6, 786432
    s_addc_u32 s7, s7, 0
    s_add_u32 s8, s8, 786432
    s_addc_u32 s9, s9, 0
    s_waitcnt lgkmcnt(6)
    v_mfma_f32_32x32x16_bf16 v[64:79], v[24:27], v[16:19], v[64:79]
    v_mfma_f32_32x32x16_bf16 v[80:95], v[28:31], v[16:19], v[80:95]
    v_mfma_f32_32x32x16_bf16 v[96:111], v[24:27], v[20:23], v[96:111]
    v_mfma_f32_32x32x16_bf16 v[112:127], v[28:31], v[20:23], v[112:127]
    ds_read_b128 v[16:19], v10 offset:32768
    ds_read_b128 v[20:23], v10 offset:36864
    ds_read_b64_tr_b16 v[24:25], v12 offset:36864
    ds_read_b64_tr_b16 v[26:27], v12 offset:37376
    ds_read_b64_tr_b16 v[28:29], v13 offset:36864
    ds_read_b64_tr_b16 v[30:31], v13 offset:37376
    s_waitcnt lgkmcnt(6)
    v_mfma_f32_32x32x16_bf16 v[64:79], v[40:43], v[32:35], v[64:79]
    v_mfma_f32_32x32x16_bf16 v[80:95], v[44:47], v[32:35], v[80:95]
    v_mfma_f32_32x32x16_bf16 v[96:111], v[40:43], v[36:39], v[96:111]
    v_mfma_f32_32x32x16_bf16 v[112:127], v[44:47], v[36:39], v[112:127]
    ds_read_b128 v[32:35], v11 offset:32768
    ds_read_b128 v[36:39], v11 offset:36864
    ds_read_b64_tr_b16 v[40:41], v12 offset:38912
    ds_read_b64_tr_b16 v[42:43], v12 offset:39424
    ds_read_b64_tr_b16 v[44:45], v13 offset:38912
    ds_read_b64_tr_b16 v[46:47], v13 offset:39424
    s_waitcnt lgkmcnt(6)
    v_mfma_f32_32x32x16_bf16 v[64:79], v[24:27], v[16:19], v[64:79]
    v_mfma_f32_32x32x16_bf16 v[80:95], v[28:31], v[16:19], v[80:95]
    v_mfma_f32_32x32x16_bf16 v[96:111], v[24:27], v[20:23], v[96:111]
    v_mfma_f32_32x32x16_bf16 v[112:127], v[28:31], v[20:23], v[112:127]
    s_waitcnt lgkmcnt(0)
    v_mfma_f32_32x32x16_bf16 v[64:79], v[40:43], v[32:35], v[64:79]
    v_mfma_f32_32x32x16_bf16 v[80:95], v[44:47], v[32:35], v[80:95]
    v_mfma_f32_32x32x16_bf16 v[96:111], v[40:43], v[36:39], v[96:111]
    v_mfma_f32_32x32x16_bf16 v[112:127], v[44:47], v[36:39], v[112:127]
    s_waitcnt vmcnt(8)
    s_barrier
    ds_read_b128 v[16:19], v128 offset:0
    ds_read_b128 v[20:23], v128 offset:4096
    ds_read_b64_tr_b16 v[24:25], v132 offset:0
    ds_read_b64_tr_b16 v[26:27], v132 offset:512
    ds_read_b64_tr_b16 v[28:29], v133 offset:0
    ds_read_b64_tr_b16 v[30:31], v133 offset:512
    ds_read_b128 v[32:35], v129 offset:0
    ds_read_b128 v[36:39], v129 offset:4096
    ds_read_b64_tr_b16 v[40:41], v132 offset:2048
    ds_read_b64_tr_b16 v[42:43], v132 offset:2560
    ds_read_b64_tr_b16 v[44:45], v133 offset:2048
    ds_read_b64_tr_b16 v[46:47], v133 offset:2560
    s_add_u32 m0, s10, 32768
    s_nop 0
    global_load_lds_dwordx4 v1, s[4:5]
    s_add_u32 m0, s10, 33792
    s_nop 0
    global_load_lds_dwordx4 v2, s[4:5]
    s_add_u32 m0, s10, 34816
    s_nop 0
    global_load_lds_dwordx4 v3, s[4:5]
    s_add_u32 m0, s10, 35840
    s_nop 0
    global_load_lds_dwordx4 v4, s[4:5]
    s_add_u32 m0, s11, 49152
    s_nop 0
    global_load_lds_dwordx4 v5, s[6:7]
    s_add_u32 m0, s11, 50176
    s_nop 0
    global_load_lds_dwordx4 v6, s[6:7]
    s_add_u32 m0, s11, 57344
    s_nop 0
    global_load_lds_dwordx4 v5, s[8:9]
    s_add_u32 m0, s11, 58368
    s_nop 0
    global_load_lds_dwordx4 v6, s[8:9]
    s_add_u32 s4, s4, 128
    s_addc_u32 s5, s5, 0
    s_add_u32 s6, s6, 786432
    s_addc_u32 s7, s7, 0
    s_add_u32 s8, s8, 786432
    s_addc_u32 s9, s9, 0
    s_waitcnt lgkmcnt(6)
    v_mfma_f32_32x32x16_bf16 v[64:79], v[24:27], v[16:19], v[64:79]
    v_mfma_f32_32x32x16_bf16 v[80:95], v[28:31], v[16:19], v[80:95]
    v_mfma_f32_32x32x16_bf16 v[96:111], v[24:27], v[20:23], v[96:111]
    v_mfma_f32_32x32x16_bf16 v[112:127], v[28:31], v[20:23], v[112:127]
    ds_read_b128 v[16:19], v130 offset:0
    ds_read_b128 v[20:23], v130 offset:4096
    ds_read_b64_tr_b16 v[24:25], v132 offset:4096
    ds_read_b64_tr_b16 v[26:27], v132 offset:4608
    ds_read_b64_tr_b16 v[28:29], v133 offset:4096
    ds_read_b64_tr_b16 v[30:31], v133 offset:4608
    s_waitcnt lgkmcnt(6)
    v_mfma_f32_32x32x16_bf16 v[64:79], v[40:43], v[32:35], v[64:79]
    v_mfma_f32_32x32x16_bf16 v[80:95], v[44:47], v[32:35], v[80:95]
    v_mfma_f32_32x32x16_bf16 v[96:111], v[40:43], v[36:39], v[96:111]
    v_mfma_f32_32x32x16_bf16 v[112:127], v[44:47], v[36:39], v[112:127]
    ds_read_b128 v[32:35], v131 offset:0
    ds_read_b128 v[36:39], v131 offset:4096
    ds_read_b64_tr_b16 v[40:41], v132 offset:6144
    ds_read_b64_tr_b16 v[42:43], v132 offset:6656
    ds_read_b64_tr_b16 v[44:45], v133 offset:6144
    ds_read_b64_tr_b16 v[46:47], v133 offset:6656
    s_waitcnt lgkmcnt(6)
    v_mfma_f32_32x32x16_bf16 v[64:79], v[24:27], v[16:19], v[64:79]
    v_mfma_f32_32x32x16_bf16 v[80:95], v[28:31], v[16:19], v[80:95]
    v_mfma_f32_32x32x16_bf16 v[96:111], v[24:27], v[20:23], v[96:111]
    v_mfma_f32_32x32x16_bf16 v[112:127], v[28:31], v[20:23], v[112:127]
    s_waitcnt lgkmcnt(0)
    v_mfma_f32_32x32x16_bf16 v[64:79], v[40:43], v[32:35], v[64:79]
    v_mfma_f32_32x32x16_bf16 v[80:95], v[44:47], v[32:35], v[80:95]
    v_mfma_f32_32x32x16_bf16 v[96:111], v[40:43], v[36:39], v[96:111]
    v_mfma_f32_32x32x16_bf16 v[112:127], v[44:47], v[36:39], v[112:127]
    s_waitcnt vmcnt(8)
    s_barrier
    ds_read_b128 v[16:19], v8 offset:0
    ds_read_b128 v[20:23], v8 offset:4096
    ds_read_b64_tr_b16 v[24:25], v12 offset:0
    ds_read_b64_tr_b16 v[26:27], v12 offset:512
    ds_read_b64_tr_b16 v[28:29], v13 offset:0
    ds_read_b64_tr_b16 v[30:31], v13 offset:512
    ds_read_b128 v[32:35], v9 offset:0
    ds_read_b128 v[36:39], v9 offset:4096
    ds_read_b64_tr_b16 v[40:41], v12 offset:2048
    ds_read_b64_tr_b16 v[42:43], v12 offset:2560
    ds_read_b64_tr_b16 v[44:45], v13 offset:2048
    ds_read_b64_tr_b16 v[46:47], v13 offset:2560
    s_add_u32 m0, s10, 65536
    s_nop 0
    global_load_lds_dwordx4 v1, s[4:5]
    s_add_u32 m0, s10, 66560
    s_nop 0
    global_load_lds_dwordx4 v2, s[4:5]
    s_add_u32 m0, s10, 67584
    s_nop 0
    global_load_lds_dwordx4 v3, s[4:5]
    s_add_u32 m0, s10, 68608
    s_nop 0
    global_load_lds_dwordx4 v4, s[4:5]
    s_add_u32 m0, s11, 81920
    s_nop 0
    global_load_lds_dwordx4 v5, s[6:7]
    s_add_u32 m0, s11, 82944
    s_nop 0
    global_load_lds_dwordx4 v6, s[6:7]
    s_add_u32 m0, s11, 90112
    s_nop 0
    global_load_lds_dwordx4 v5, s[8:9]
    s_add_u32 m0, s11, 91136
    s_nop 0
    global_load_lds_dwordx4 v6, s[8:9]
    s_add_u32 s4, s4, 128
    s_addc_u32 s5, s5, 0
    s_add_u32 s6, s6, 786432
    s_addc_u32 s7, s7, 0
    s_add_u32 s8, s8, 786432
    s_addc_u32 s9, s9, 0
    s_waitcnt lgkmcnt(6)
    v_mfma_f32_32x32x16_bf16 v[64:79], v[24:27], v[16:19], v[64:79]
    v_mfma_f32_32x32x16_bf16 v[80:95], v[28:31], v[16:19], v[80:95]
    v_mfma_f32_32x32x16_bf16 v[96:111], v[24:27], v[20:23], v[96:111]
    v_mfma_f32_32x32x16_bf16 v[112:127], v[28:31], v[20:23], v[112:127]
    ds_read_b128 v[16:19], v10 offset:0
    ds_read_b128 v[20:23], v10 offset:4096
    ds_read_b64_tr_b16 v[24:25], v12 offset:4096
    ds_read_b64_tr_b16 v[26:27], v12 offset:4608
    ds_read_b64_tr_b16 v[28:29], v13 offset:4096
    ds_read_b64_tr_b16 v[30:31], v13 offset:4608
    s_waitcnt lgkmcnt(6)
    v_mfma_f32_32x32x16_bf16 v[64:79], v[40:43], v[32:35], v[64:79]
    v_mfma_f32_32x32x16_bf16 v[80:95], v[44:47], v[32:35], v[80:95]
    v_mfma_f32_32x32x16_bf16 v[96:111], v[40:43], v[36:39], v[96:111]
    v_mfma_f32_32x32x16_bf16 v[112:127], v[44:47], v[36:39], v[112:127]
    ds_read_b128 v[32:35], v11 offset:0
    ds_read_b128 v[36:39], v11 offset:4096
    ds_read_b64_tr_b16 v[40:41], v12 offset:6144
    ds_read_b64_tr_b16 v[42:43], v12 offset:6656
    ds_read_b64_tr_b16 v[44:45], v13 offset:6144
    ds_read_b64_tr_b16 v[46:47], v13 offset:6656
    s_waitcnt lgkmcnt(6)
    v_mfma_f32_32x32x16_bf16 v[64:79], v[24:27], v[16:19], v[64:79]
    v_mfma_f32_32x32x16_bf16 v[80:95], v[28:31], v[16:19], v[80:95]
    v_mfma_f32_32x32x16_bf16 v[96:111], v[24:27], v[20:23], v[96:111]
    v_mfma_f32_32x32x16_bf16 v[112:127], v[28:31], v[20:23], v[112:127]
    s_waitcnt lgkmcnt(0)
    v_mfma_f32_32x32x16_bf16 v[64:79], v[40:43], v[32:35], v[64:79]
    v_mfma_f32_32x32x16_bf16 v[80:95], v[44:47], v[32:35], v[80:95]
    v_mfma_f32_32x32x16_bf16 v[96:111], v[40:43], v[36:39], v[96:111]
    v_mfma_f32_32x32x16_bf16 v[112:127], v[44:47], v[36:39], v[112:127]
    s_waitcnt vmcnt(8)
    s_barrier
    ds_read_b128 v[16:19], v8 offset:32768
    ds_read_b128 v[20:23], v8 offset:36864
    ds_read_b64_tr_b16 v[24:25], v12 offset:32768
    ds_read_b64_tr_b16 v[26:27], v12 offset:33280
    ds_read_b64_tr_b16 v[28:29], v13 offset:32768
    ds_read_b64_tr_b16 v[30:31], v13 offset:33280
    ds_read_b128 v[32:35], v9 offset:32768
    ds_read_b128 v[36:39], v9 offset:36864
    ds_read_b64_tr_b16 v[40:41], v12 offset:34816
    ds_read_b64_tr_b16 v[42:43], v12 offset:35328
    ds_read_b64_tr_b16 v[44:45], v13 offset:34816
    ds_read_b64_tr_b16 v[46:47], v13 offset:35328
    s_add_u32 m0, s10, 0
    s_nop 0
    global_load_lds_dwordx4 v1, s[4:5]
    s_add_u32 m0, s10, 1024
    s_nop 0
    global_load_lds_dwordx4 v2, s[4:5]
    s_add_u32 m0, s10, 2048
    s_nop 0
    global_load_lds_dwordx4 v3, s[4:5]
    s_add_u32 m0, s10, 3072
    s_nop 0
    global_load_lds_dwordx4 v4, s[4:5]
    s_add_u32 m0, s11, 16384
    s_nop 0
    global_load_lds_dwordx4 v5, s[6:7]
    s_add_u32 m0, s11, 17408
    s_nop 0
    global_load_lds_dwordx4 v6, s[6:7]
    s_add_u32 m0, s11, 24576
    s_nop 0
    global_load_lds_dwordx4 v5, s[8:9]
    s_add_u32 m0, s11, 25600
    s_nop 0
    global_load_lds_dwordx4 v6, s[8:9]
    s_add_u32 s4, s4, 128
    s_addc_u32 s5, s5, 0
    s_add_u32 s6, s6, 786432
    s_addc_u32 s7, s7, 0
    s_add_u32 s8, s8, 786432
    s_addc_u32 s9, s9, 0
    s_waitcnt lgkmcnt(6)
    v_mfma_f32_32x32x16_bf16 v[64:79], v[24:27], v[16:19], v[64:79]
    v_mfma_f32_32x32x16_bf16 v[80:95], v[28:31], v[16:19], v[80:95]
    v_mfma_f32_32x32x16_bf16 v[96:111], v[24:27], v[20:23], v[96:111]
    v_mfma_f32_32x32x16_bf16 v[112:127], v[28:31], v[20:23], v[112:127]
    ds_read_b128 v[16:19], v10 offset:32768
    ds_read_b128 v[20:23], v10 offset:36864
    ds_read_b64_tr_b16 v[24:25], v12 offset:36864
    ds_read_b64_tr_b16 v[26:27], v12 offset:37376
    ds_read_b64_tr_b16 v[28:29], v13 offset:36864
    ds_read_b64_tr_b16 v[30:31], v13 offset:37376
    s_waitcnt lgkmcnt(6)
    v_mfma_f32_32x32x16_bf16 v[64:79], v[40:43], v[32:35], v[64:79]
    v_mfma_f32_32x32x16_bf16 v[80:95], v[44:47], v[32:35], v[80:95]
    v_mfma_f32_32x32x16_bf16 v[96:111], v[40:43], v[36:39], v[96:111]
    v_mfma_f32_32x32x16_bf16 v[112:127], v[44:47], v[36:39], v[112:127]
    ds_read_b128 v[32:35], v11 offset:32768
    ds_read_b128 v[36:39], v11 offset:36864
    ds_read_b64_tr_b16 v[40:41], v12 offset:38912
    ds_read_b64_tr_b16 v[42:43], v12 offset:39424
    ds_read_b64_tr_b16 v[44:45], v13 offset:38912
    ds_read_b64_tr_b16 v[46:47], v13 offset:39424
    s_waitcnt lgkmcnt(6)
    v_mfma_f32_32x32x16_bf16 v[64:79], v[24:27], v[16:19], v[64:79]
    v_mfma_f32_32x32x16_bf16 v[80:95], v[28:31], v[16:19], v[80:95]
    v_mfma_f32_32x32x16_bf16 v[96:111], v[24:27], v[20:23], v[96:111]
    v_mfma_f32_32x32x16_bf16 v[112:127], v[28:31], v[20:23], v[112:127]
    s_waitcnt lgkmcnt(0)
    v_mfma_f32_32x32x16_bf16 v[64:79], v[40:43], v[32:35], v[64:79]
    v_mfma_f32_32x32x16_bf16 v[80:95], v[44:47], v[32:35], v[80:95]
    v_mfma_f32_32x32x16_bf16 v[96:111], v[40:43], v[36:39], v[96:111]
    v_mfma_f32_32x32x16_bf16 v[112:127], v[44:47], v[36:39], v[112:127]
    s_waitcnt vmcnt(8)
    s_barrier
    ds_read_b128 v[16:19], v128 offset:0
    ds_read_b128 v[20:23], v128 offset:4096
    ds_read_b64_tr_b16 v[24:25], v132 offset:0
    ds_read_b64_tr_b16 v[26:27], v132 offset:512
    ds_read_b64_tr_b16 v[28:29], v133 offset:0
    ds_read_b64_tr_b16 v[30:31], v133 offset:512
    ds_read_b128 v[32:35], v129 offset:0
    ds_read_b128 v[36:39], v129 offset:4096
    ds_read_b64_tr_b16 v[40:41], v132 offset:2048
    ds_read_b64_tr_b16 v[42:43], v132 offset:2560
    ds_read_b64_tr_b16 v[44:45], v133 offset:2048
    ds_read_b64_tr_b16 v[46:47], v133 offset:2560
    s_add_u32 m0, s10, 32768
    s_nop 0
    global_load_lds_dwordx4 v1, s[4:5]
    s_add_u32 m0, s10, 33792
    s_nop 0
    global_load_lds_dwordx4 v2, s[4:5]
    s_add_u32 m0, s10, 34816
    s_nop 0
    global_load_lds_dwordx4 v3, s[4:5]
    s_add_u32 m0, s10, 35840
    s_nop 0
    global_load_lds_dwordx4 v4, s[4:5]
    s_add_u32 m0, s11, 49152
    s_nop 0
    global_load_lds_dwordx4 v5, s[6:7]
    s_add_u32 m0, s11, 50176
    s_nop 0
    global_load_lds_dwordx4 v6, s[6:7]
    s_add_u32 m0, s11, 57344
    s_nop 0
    global_load_lds_dwordx4 v5, s[8:9]
    s_add_u32 m0, s11, 58368
    s_nop 0
    global_load_lds_dwordx4 v6, s[8:9]
    s_add_u32 s4, s4, 128
    s_addc_u32 s5, s5, 0
    s_add_u32 s6, s6, 786432
    s_addc_u32 s7, s7, 0
    s_add_u32 s8, s8, 786432
    s_addc_u32 s9, s9, 0
    s_waitcnt lgkmcnt(6)
    v_mfma_f32_32x32x16_bf16 v[64:79], v[24:27], v[16:19], v[64:79]
    v_mfma_f32_32x32x16_bf16 v[80:95], v[28:31], v[16:19], v[80:95]
    v_mfma_f32_32x32x16_bf16 v[96:111], v[24:27], v[20:23], v[96:111]
    v_mfma_f32_32x32x16_bf16 v[112:127], v[28:31], v[20:23], v[112:127]
    ds_read_b128 v[16:19], v130 offset:0
    ds_read_b128 v[20:23], v130 offset:4096
    ds_read_b64_tr_b16 v[24:25], v132 offset:4096
    ds_read_b64_tr_b16 v[26:27], v132 offset:4608
    ds_read_b64_tr_b16 v[28:29], v133 offset:4096
    ds_read_b64_tr_b16 v[30:31], v133 offset:4608
    s_waitcnt lgkmcnt(6)
    v_mfma_f32_32x32x16_bf16 v[64:79], v[40:43], v[32:35], v[64:79]
    v_mfma_f32_32x32x16_bf16 v[80:95], v[44:47], v[32:35], v[80:95]
    v_mfma_f32_32x32x16_bf16 v[96:111], v[40:43], v[36:39], v[96:111]
    v_mfma_f32_32x32x16_bf16 v[112:127], v[44:47], v[36:39], v[112:127]
    ds_read_b128 v[32:35], v131 offset:0
    ds_read_b128 v[36:39], v131 offset:4096
    ds_read_b64_tr_b16 v[40:41], v132 offset:6144
    ds_read_b64_tr_b16 v[42:43], v132 offset:6656
    ds_read_b64_tr_b16 v[44:45], v133 offset:6144
    ds_read_b64_tr_b16 v[46:47], v133 offset:6656
    s_waitcnt lgkmcnt(6)
    v_mfma_f32_32x32x16_bf16 v[64:79], v[24:27], v[16:19], v[64:79]
    v_mfma_f32_32x32x16_bf16 v[80:95], v[28:31], v[16:19], v[80:95]
    v_mfma_f32_32x32x16_bf16 v[96:111], v[24:27], v[20:23], v[96:111]
    v_mfma_f32_32x32x16_bf16 v[112:127], v[28:31], v[20:23], v[112:127]
    s_waitcnt lgkmcnt(0)
    v_mfma_f32_32x32x16_bf16 v[64:79], v[40:43], v[32:35], v[64:79]
    v_mfma_f32_32x32x16_bf16 v[80:95], v[44:47], v[32:35], v[80:95]
    v_mfma_f32_32x32x16_bf16 v[96:111], v[40:43], v[36:39], v[96:111]
    v_mfma_f32_32x32x16_bf16 v[112:127], v[44:47], v[36:39], v[112:127]
    s_waitcnt vmcnt(8)
    s_barrier
    ds_read_b128 v[16:19], v8 offset:0
    ds_read_b128 v[20:23], v8 offset:4096
    ds_read_b64_tr_b16 v[24:25], v12 offset:0
    ds_read_b64_tr_b16 v[26:27], v12 offset:512
    ds_read_b64_tr_b16 v[28:29], v13 offset:0
    ds_read_b64_tr_b16 v[30:31], v13 offset:512
    ds_read_b128 v[32:35], v9 offset:0
    ds_read_b128 v[36:39], v9 offset:4096
    ds_read_b64_tr_b16 v[40:41], v12 offset:2048
    ds_read_b64_tr_b16 v[42:43], v12 offset:2560
    ds_read_b64_tr_b16 v[44:45], v13 offset:2048
    ds_read_b64_tr_b16 v[46:47], v13 offset:2560
    s_add_u32 m0, s10, 65536
    s_nop 0
    global_load_lds_dwordx4 v1, s[4:5]
    s_add_u32 m0, s10, 66560
    s_nop 0
    global_load_lds_dwordx4 v2, s[4:5]
    s_add_u32 m0, s10, 67584
    s_nop 0
    global_load_lds_dwordx4 v3, s[4:5]
    s_add_u32 m0, s10, 68608
    s_nop 0
    global_load_lds_dwordx4 v4, s[4:5]
    s_add_u32 m0, s11, 81920
    s_nop 0
    global_load_lds_dwordx4 v5, s[6:7]
    s_add_u32 m0, s11, 82944
    s_nop 0
    global_load_lds_dwordx4 v6, s[6:7]
    s_add_u32 m0, s11, 90112
    s_nop 0
    global_load_lds_dwordx4 v5, s[8:9]
    s_add_u32 m0, s11, 91136
    s_nop 0
    global_load_lds_dwordx4 v6, s[8:9]
    s_add_u32 s4, s4, 128
    s_addc_u32 s5, s5, 0
    s_add_u32 s6, s6, 786432
    s_addc_u32 s7, s7, 0
    s_add_u32 s8, s8, 786432
    s_addc_u32 s9, s9, 0
    s_waitcnt lgkmcnt(6)
    v_mfma_f32_32x32x16_bf16 v[64:79], v[24:27], v[16:19], v[64:79]
    v_mfma_f32_32x32x16_bf16 v[80:95], v[28:31], v[16:19], v[80:95]
    v_mfma_f32_32x32x16_bf16 v[96:111], v[24:27], v[20:23], v[96:111]
    v_mfma_f32_32x32x16_bf16 v[112:127], v[28:31], v[20:23], v[112:127]
    ds_read_b128 v[16:19], v10 offset:0
    ds_read_b128 v[20:23], v10 offset:4096
    ds_read_b64_tr_b16 v[24:25], v12 offset:4096
    ds_read_b64_tr_b16 v[26:27], v12 offset:4608
    ds_read_b64_tr_b16 v[28:29], v13 offset:4096
    ds_read_b64_tr_b16 v[30:31], v13 offset:4608
    s_waitcnt lgkmcnt(6)
    v_mfma_f32_32x32x16_bf16 v[64:79], v[40:43], v[32:35], v[64:79]
    v_mfma_f32_32x32x16_bf16 v[80:95], v[44:47], v[32:35], v[80:95]
    v_mfma_f32_32x32x16_bf16 v[96:111], v[40:43], v[36:39], v[96:111]
    v_mfma_f32_32x32x16_bf16 v[112:127], v[44:47], v[36:39], v[112:127]
    ds_read_b128 v[32:35], v11 offset:0
    ds_read_b128 v[36:39], v11 offset:4096
    ds_read_b64_tr_b16 v[40:41], v12 offset:6144
    ds_read_b64_tr_b16 v[42:43], v12 offset:6656
    ds_read_b64_tr_b16 v[44:45], v13 offset:6144
    ds_read_b64_tr_b16 v[46:47], v13 offset:6656
    s_waitcnt lgkmcnt(6)
    v_mfma_f32_32x32x16_bf16 v[64:79], v[24:27], v[16:19], v[64:79]
    v_mfma_f32_32x32x16_bf16 v[80:95], v[28:31], v[16:19], v[80:95]
    v_mfma_f32_32x32x16_bf16 v[96:111], v[24:27], v[20:23], v[96:111]
    v_mfma_f32_32x32x16_bf16 v[112:127], v[28:31], v[20:23], v[112:127]
    s_waitcnt lgkmcnt(0)
    v_mfma_f32_32x32x16_bf16 v[64:79], v[40:43], v[32:35], v[64:79]
    v_mfma_f32_32x32x16_bf16 v[80:95], v[44:47], v[32:35], v[80:95]
    v_mfma_f32_32x32x16_bf16 v[96:111], v[40:43], v[36:39], v[96:111]
    v_mfma_f32_32x32x16_bf16 v[112:127], v[44:47], v[36:39], v[112:127]
    s_waitcnt vmcnt(8)
    s_barrier
    ds_read_b128 v[16:19], v8 offset:32768
    ds_read_b128 v[20:23], v8 offset:36864
    ds_read_b64_tr_b16 v[24:25], v12 offset:32768
    ds_read_b64_tr_b16 v[26:27], v12 offset:33280
    ds_read_b64_tr_b16 v[28:29], v13 offset:32768
    ds_read_b64_tr_b16 v[30:31], v13 offset:33280
    ds_read_b128 v[32:35], v9 offset:32768
    ds_read_b128 v[36:39], v9 offset:36864
    ds_read_b64_tr_b16 v[40:41], v12 offset:34816
    ds_read_b64_tr_b16 v[42:43], v12 offset:35328
    ds_read_b64_tr_b16 v[44:45], v13 offset:34816
    ds_read_b64_tr_b16 v[46:47], v13 offset:35328
    s_add_u32 m0, s10, 0
    s_nop 0
    global_load_lds_dwordx4 v1, s[4:5]
    s_add_u32 m0, s10, 1024
    s_nop 0
    global_load_lds_dwordx4 v2, s[4:5]
    s_add_u32 m0, s10, 2048
    s_nop 0
    global_load_lds_dwordx4 v3, s[4:5]
    s_add_u32 m0, s10, 3072
    s_nop 0
    global_load_lds_dwordx4 v4, s[4:5]
    s_add_u32 m0, s11, 16384
    s_nop 0
    global_load_lds_dwordx4 v5, s[6:7]
    s_add_u32 m0, s11, 17408
    s_nop 0
    global_load_lds_dwordx4 v6, s[6:7]
    s_add_u32 m0, s11, 24576
    s_nop 0
    global_load_lds_dwordx4 v5, s[8:9]
    s_add_u32 m0, s11, 25600
    s_nop 0
    global_load_lds_dwordx4 v6, s[8:9]
    s_add_u32 s4, s4, 128
    s_addc_u32 s5, s5, 0
    s_add_u32 s6, s6, 786432
    s_addc_u32 s7, s7, 0
    s_add_u32 s8, s8, 786432
    s_addc_u32 s9, s9, 0
    s_waitcnt lgkmcnt(6)
    v_mfma_f32_32x32x16_bf16 v[64:79], v[24:27], v[16:19], v[64:79]
    v_mfma_f32_32x32x16_bf16 v[80:95], v[28:31], v[16:19], v[80:95]
    v_mfma_f32_32x32x16_bf16 v[96:111], v[24:27], v[20:23], v[96:111]
    v_mfma_f32_32x32x16_bf16 v[112:127], v[28:31], v[20:23], v[112:127]
    ds_read_b128 v[16:19], v10 offset:32768
    ds_read_b128 v[20:23], v10 offset:36864
    ds_read_b64_tr_b16 v[24:25], v12 offset:36864
    ds_read_b64_tr_b16 v[26:27], v12 offset:37376
    ds_read_b64_tr_b16 v[28:29], v13 offset:36864
    ds_read_b64_tr_b16 v[30:31], v13 offset:37376
    s_waitcnt lgkmcnt(6)
    v_mfma_f32_32x32x16_bf16 v[64:79], v[40:43], v[32:35], v[64:79]
    v_mfma_f32_32x32x16_bf16 v[80:95], v[44:47], v[32:35], v[80:95]
    v_mfma_f32_32x32x16_bf16 v[96:111], v[40:43], v[36:39], v[96:111]
    v_mfma_f32_32x32x16_bf16 v[112:127], v[44:47], v[36:39], v[112:127]
    ds_read_b128 v[32:35], v11 offset:32768
    ds_read_b128 v[36:39], v11 offset:36864
    ds_read_b64_tr_b16 v[40:41], v12 offset:38912
    ds_read_b64_tr_b16 v[42:43], v12 offset:39424
    ds_read_b64_tr_b16 v[44:45], v13 offset:38912
    ds_read_b64_tr_b16 v[46:47], v13 offset:39424
    s_waitcnt lgkmcnt(6)
    v_mfma_f32_32x32x16_bf16 v[64:79], v[24:27], v[16:19], v[64:79]
    v_mfma_f32_32x32x16_bf16 v[80:95], v[28:31], v[16:19], v[80:95]
    v_mfma_f32_32x32x16_bf16 v[96:111], v[24:27], v[20:23], v[96:111]
    v_mfma_f32_32x32x16_bf16 v[112:127], v[28:31], v[20:23], v[112:127]
    s_waitcnt lgkmcnt(0)
    v_mfma_f32_32x32x16_bf16 v[64:79], v[40:43], v[32:35], v[64:79]
    v_mfma_f32_32x32x16_bf16 v[80:95], v[44:47], v[32:35], v[80:95]
    v_mfma_f32_32x32x16_bf16 v[96:111], v[40:43], v[36:39], v[96:111]
    v_mfma_f32_32x32x16_bf16 v[112:127], v[44:47], v[36:39], v[112:127]
    s_waitcnt vmcnt(8)
    s_barrier
    ds_read_b128 v[16:19], v128 offset:0
    ds_read_b128 v[20:23], v128 offset:4096
    ds_read_b64_tr_b16 v[24:25], v132 offset:0
    ds_read_b64_tr_b16 v[26:27], v132 offset:512
    ds_read_b64_tr_b16 v[28:29], v133 offset:0
    ds_read_b64_tr_b16 v[30:31], v133 offset:512
    ds_read_b128 v[32:35], v129 offset:0
    ds_read_b128 v[36:39], v129 offset:4096
    ds_read_b64_tr_b16 v[40:41], v132 offset:2048
    ds_read_b64_tr_b16 v[42:43], v132 offset:2560
    ds_read_b64_tr_b16 v[44:45], v133 offset:2048
    ds_read_b64_tr_b16 v[46:47], v133 offset:2560
    s_waitcnt lgkmcnt(6)
    v_mfma_f32_32x32x16_bf16 v[64:79], v[24:27], v[16:19], v[64:79]
    v_mfma_f32_32x32x16_bf16 v[80:95], v[28:31], v[16:19], v[80:95]
    v_mfma_f32_32x32x16_bf16 v[96:111], v[24:27], v[20:23], v[96:111]
    v_mfma_f32_32x32x16_bf16 v[112:127], v[28:31], v[20:23], v[112:127]
    ds_read_b128 v[16:19], v130 offset:0
    ds_read_b128 v[20:23], v130 offset:4096
    ds_read_b64_tr_b16 v[24:25], v132 offset:4096
    ds_read_b64_tr_b16 v[26:27], v132 offset:4608
    ds_read_b64_tr_b16 v[28:29], v133 offset:4096
    ds_read_b64_tr_b16 v[30:31], v133 offset:4608
    s_waitcnt lgkmcnt(6)
    v_mfma_f32_32x32x16_bf16 v[64:79], v[40:43], v[32:35], v[64:79]
    v_mfma_f32_32x32x16_bf16 v[80:95], v[44:47], v[32:35], v[80:95]
    v_mfma_f32_32x32x16_bf16 v[96:111], v[40:43], v[36:39], v[96:111]
    v_mfma_f32_32x32x16_bf16 v[112:127], v[44:47], v[36:39], v[112:127]
    ds_read_b128 v[32:35], v131 offset:0
    ds_read_b128 v[36:39], v131 offset:4096
    ds_read_b64_tr_b16 v[40:41], v132 offset:6144
    ds_read_b64_tr_b16 v[42:43], v132 offset:6656
    ds_read_b64_tr_b16 v[44:45], v133 offset:6144
    ds_read_b64_tr_b16 v[46:47], v133 offset:6656
    s_waitcnt lgkmcnt(6)
    v_mfma_f32_32x32x16_bf16 v[64:79], v[24:27], v[16:19], v[64:79]
    v_mfma_f32_32x32x16_bf16 v[80:95], v[28:31], v[16:19], v[80:95]
    v_mfma_f32_32x32x16_bf16 v[96:111], v[24:27], v[20:23], v[96:111]
    v_mfma_f32_32x32x16_bf16 v[112:127], v[28:31], v[20:23], v[112:127]
    s_waitcnt lgkmcnt(0)
    v_mfma_f32_32x32x16_bf16 v[64:79], v[40:43], v[32:35], v[64:79]
    v_mfma_f32_32x32x16_bf16 v[80:95], v[44:47], v[32:35], v[80:95]
    v_mfma_f32_32x32x16_bf16 v[96:111], v[40:43], v[36:39], v[96:111]
    v_mfma_f32_32x32x16_bf16 v[112:127], v[44:47], v[36:39], v[112:127]
    s_waitcnt vmcnt(0)
    s_barrier
    ds_read_b128 v[16:19], v8 offset:0
    ds_read_b128 v[20:23], v8 offset:4096
    ds_read_b64_tr_b16 v[24:25], v12 offset:0
    ds_read_b64_tr_b16 v[26:27], v12 offset:512
    ds_read_b64_tr_b16 v[28:29], v13 offset:0
    ds_read_b64_tr_b16 v[30:31], v13 offset:512
    ds_read_b128 v[32:35], v9 offset:0
    ds_read_b128 v[36:39], v9 offset:4096
    ds_read_b64_tr_b16 v[40:41], v12 offset:2048
    ds_read_b64_tr_b16 v[42:43], v12 offset:2560
    ds_read_b64_tr_b16 v[44:45], v13 offset:2048
    ds_read_b64_tr_b16 v[46:47], v13 offset:2560
    s_waitcnt lgkmcnt(6)
    v_mfma_f32_32x32x16_bf16 v[64:79], v[24:27], v[16:19], v[64:79]
    v_mfma_f32_32x32x16_bf16 v[80:95], v[28:31], v[16:19], v[80:95]
    v_mfma_f32_32x32x16_bf16 v[96:111], v[24:27], v[20:23], v[96:111]
    v_mfma_f32_32x32x16_bf16 v[112:127], v[28:31], v[20:23], v[112:127]
    ds_read_b128 v[16:19], v10 offset:0
    ds_read_b128 v[20:23], v10 offset:4096
    ds_read_b64_tr_b16 v[24:25], v12 offset:4096
    ds_read_b64_tr_b16 v[26:27], v12 offset:4608
    ds_read_b64_tr_b16 v[28:29], v13 offset:4096
    ds_read_b64_tr_b16 v[30:31], v13 offset:4608
    s_waitcnt lgkmcnt(6)
    v_mfma_f32_32x32x16_bf16 v[64:79], v[40:43], v[32:35], v[64:79]
    v_mfma_f32_32x32x16_bf16 v[80:95], v[44:47], v[32:35], v[80:95]
    v_mfma_f32_32x32x16_bf16 v[96:111], v[40:43], v[36:39], v[96:111]
    v_mfma_f32_32x32x16_bf16 v[112:127], v[44:47], v[36:39], v[112:127]
    ds_read_b128 v[32:35], v11 offset:0
    ds_read_b128 v[36:39], v11 offset:4096
    ds_read_b64_tr_b16 v[40:41], v12 offset:6144
    ds_read_b64_tr_b16 v[42:43], v12 offset:6656
    ds_read_b64_tr_b16 v[44:45], v13 offset:6144
    ds_read_b64_tr_b16 v[46:47], v13 offset:6656
    s_waitcnt lgkmcnt(6)
    v_mfma_f32_32x32x16_bf16 v[64:79], v[24:27], v[16:19], v[64:79]
    v_mfma_f32_32x32x16_bf16 v[80:95], v[28:31], v[16:19], v[80:95]
    v_mfma_f32_32x32x16_bf16 v[96:111], v[24:27], v[20:23], v[96:111]
    v_mfma_f32_32x32x16_bf16 v[112:127], v[28:31], v[20:23], v[112:127]
    s_waitcnt lgkmcnt(0)
    v_mfma_f32_32x32x16_bf16 v[64:79], v[40:43], v[32:35], v[64:79]
    v_mfma_f32_32x32x16_bf16 v[80:95], v[44:47], v[32:35], v[80:95]
    v_mfma_f32_32x32x16_bf16 v[96:111], v[40:43], v[36:39], v[96:111]
    v_mfma_f32_32x32x16_bf16 v[112:127], v[44:47], v[36:39], v[112:127]
    s_nop 15
    v_and_b32 v48, 63, v0
    v_lshrrev_b32 v49, 6, v0
    v_lshrrev_b32 v53, 1, v49
    v_and_b32 v54, 1, v49
    v_and_b32 v55, 31, v48
    v_lshrrev_b32 v56, 5, v48
    s_mov_b64 s[16:17], s[78:79]
    s_add_u32 s16, s16, 34488320
    s_addc_u32 s17, s17, 0
    s_and_b32 s17, s17, 0xffff
    s_mov_b32 s18, 25165824
    s_mov_b32 s19, 0x00020000
    v_lshlrev_b32 v57, 4, v55
    v_lshlrev_b32 v58, 3, v56
    v_add_u32 v57, v57, v58
    s_mul_i32 s12, s13, 4
    v_mul_u32_u24 v58, 2, v53
    v_add_u32 v58, s12, v58
    v_lshlrev_b32 v58, 5, v58
    s_lshl_b32 s12, s14, 7
    v_lshlrev_b32 v59, 6, v54
    v_add_u32 v59, s12, v59
    v_add_u32 v59, 0, v59
    v_mul_u32_u24 v62, 21846, v59
    v_lshrrev_b32 v62, 22, v62
    v_mul_u32_u24 v63, 192, v62
    v_sub_u32 v63, v59, v63
    v_lshrrev_b32 v63, 3, v63
    v_add_u32 v62, v62, v58
    v_mul_u32_u24 v62, 24, v62
    v_add_u32 v62, v62, v63
    v_lshlrev_b32 v62, 9, v62
    v_add_u32 v4, v62, v57
    s_lshl_b32 s12, s14, 7
    v_lshlrev_b32 v59, 6, v54
    v_add_u32 v59, s12, v59
    v_add_u32 v59, 32, v59
    v_mul_u32_u24 v62, 21846, v59
    v_lshrrev_b32 v62, 22, v62
    v_mul_u32_u24 v63, 192, v62
    v_sub_u32 v63, v59, v63
    v_lshrrev_b32 v63, 3, v63
    v_add_u32 v62, v62, v58
    v_mul_u32_u24 v62, 24, v62
    v_add_u32 v62, v62, v63
    v_lshlrev_b32 v62, 9, v62
    v_add_u32 v5, v62, v57
    s_mov_b32 s12, 0
    v_cvt_pk_bf16_f32 v60, v64, v65
    v_cvt_pk_bf16_f32 v61, v66, v67
    buffer_store_dwordx2 v[60:61], v4, s[16:19], s12 offen offset:0 sc0 sc1
    s_nop 0
    v_cvt_pk_bf16_f32 v60, v68, v69
    v_cvt_pk_bf16_f32 v61, v70, v71
    buffer_store_dwordx2 v[60:61], v4, s[16:19], s12 offen offset:512 sc0 sc1
    s_nop 0
    v_cvt_pk_bf16_f32 v60, v72, v73
    v_cvt_pk_bf16_f32 v61, v74, v75
    buffer_store_dwordx2 v[60:61], v4, s[16:19], s12 offen offset:1024 sc0 sc1
    s_nop 0
    v_cvt_pk_bf16_f32 v60, v76, v77
    v_cvt_pk_bf16_f32 v61, v78, v79
    buffer_store_dwordx2 v[60:61], v4, s[16:19], s12 offen offset:1536 sc0 sc1
    s_nop 0
    s_mov_b32 s12, 0
    v_cvt_pk_bf16_f32 v60, v80, v81
    v_cvt_pk_bf16_f32 v61, v82, v83
    buffer_store_dwordx2 v[60:61], v5, s[16:19], s12 offen offset:0 sc0 sc1
    s_nop 0
    v_cvt_pk_bf16_f32 v60, v84, v85
    v_cvt_pk_bf16_f32 v61, v86, v87
    buffer_store_dwordx2 v[60:61], v5, s[16:19], s12 offen offset:512 sc0 sc1
    s_nop 0
    v_cvt_pk_bf16_f32 v60, v88, v89
    v_cvt_pk_bf16_f32 v61, v90, v91
    buffer_store_dwordx2 v[60:61], v5, s[16:19], s12 offen offset:1024 sc0 sc1
    s_nop 0
    v_cvt_pk_bf16_f32 v60, v92, v93
    v_cvt_pk_bf16_f32 v61, v94, v95
    buffer_store_dwordx2 v[60:61], v5, s[16:19], s12 offen offset:1536 sc0 sc1
    s_nop 0
    s_mov_b32 s12, 393216
    v_cvt_pk_bf16_f32 v60, v96, v97
    v_cvt_pk_bf16_f32 v61, v98, v99
    buffer_store_dwordx2 v[60:61], v4, s[16:19], s12 offen offset:0 sc0 sc1
    s_nop 0
    v_cvt_pk_bf16_f32 v60, v100, v101
    v_cvt_pk_bf16_f32 v61, v102, v103
    buffer_store_dwordx2 v[60:61], v4, s[16:19], s12 offen offset:512 sc0 sc1
    s_nop 0
    v_cvt_pk_bf16_f32 v60, v104, v105
    v_cvt_pk_bf16_f32 v61, v106, v107
    buffer_store_dwordx2 v[60:61], v4, s[16:19], s12 offen offset:1024 sc0 sc1
    s_nop 0
    v_cvt_pk_bf16_f32 v60, v108, v109
    v_cvt_pk_bf16_f32 v61, v110, v111
    buffer_store_dwordx2 v[60:61], v4, s[16:19], s12 offen offset:1536 sc0 sc1
    s_nop 0
    s_mov_b32 s12, 393216
    v_cvt_pk_bf16_f32 v60, v112, v113
    v_cvt_pk_bf16_f32 v61, v114, v115
    buffer_store_dwordx2 v[60:61], v5, s[16:19], s12 offen offset:0 sc0 sc1
    s_nop 0
    v_cvt_pk_bf16_f32 v60, v116, v117
    v_cvt_pk_bf16_f32 v61, v118, v119
    buffer_store_dwordx2 v[60:61], v5, s[16:19], s12 offen offset:512 sc0 sc1
    s_nop 0
    v_cvt_pk_bf16_f32 v60, v120, v121
    v_cvt_pk_bf16_f32 v61, v122, v123
    buffer_store_dwordx2 v[60:61], v5, s[16:19], s12 offen offset:1024 sc0 sc1
    s_nop 0
    v_cvt_pk_bf16_f32 v60, v124, v125
    v_cvt_pk_bf16_f32 v61, v126, v127
    buffer_store_dwordx2 v[60:61], v5, s[16:19], s12 offen offset:1536 sc0 sc1
    s_nop 0
    s_waitcnt vmcnt(0)
    s_barrier
    s_cmp_lg_u32 s94, 0
    s_cbranch_scc1 mega_kernel_sg40
    s_lshl_b32 s93, s92, 7
    s_add_u32 s93, s93, 16384
    v_mov_b32 v1, s93
    v_mov_b32 v2, 1
    s_mov_b64 exec, 1
    buffer_atomic_add v2, v1, s[80:83], 0 offen sc1
    s_mov_b64 exec, -1
mega_kernel_sg40:
    s_branch mega_kernel_pan35
mega_kernel_pav34:
    s_sub_u32 s14, s14, 48
    s_mov_b64 s[4:5], s[78:79]
    s_mul_i32 s12, s13, 163840
    s_add_u32 s4, s4, 6701056
    s_addc_u32 s5, s5, 0
    s_add_u32 s4, s4, s12
    s_addc_u32 s5, s5, 0
    s_mov_b64 s[6:7], s[56:57]
    s_lshl_b32 s12, s14, 8
    s_add_u32 s6, s6, s12
    s_addc_u32 s7, s7, 0
    s_add_u32 s8, s6, 128
    s_addc_u32 s9, s7, 0
    v_and_b32 v48, 63, v0
    v_lshrrev_b32 v49, 6, v0
    s_nop 1
    v_readfirstlane_b32 s10, v49
    s_nop 3
    s_lshl_b32 s11, s10, 11
    s_mul_i32 s10, s10, 4096
    v_lshrrev_b32 v50, 3, v48
    v_and_b32 v51, 7, v48
    v_lshrrev_b32 v52, 4, v48
    s_mov_b32 s12, 1280
    v_mul_u32_u24 v53, 32, v49
    v_add_u32 v53, 0, v53
    v_add_u32 v53, v53, v50
    v_lshrrev_b32 v54, 1, v53
    v_and_b32 v54, 7, v54
    v_xor_b32 v54, v54, v51
    v_lshlrev_b32 v54, 4, v54
    v_mul_lo_u32 v1, v53, s12
    v_add_u32 v1, v1, v54
    v_mul_u32_u24 v53, 32, v49
    v_add_u32 v53, 8, v53
    v_add_u32 v53, v53, v50
    v_lshrrev_b32 v54, 1, v53
    v_and_b32 v54, 7, v54
    v_xor_b32 v54, v54, v51
    v_lshlrev_b32 v54, 4, v54
    v_mul_lo_u32 v2, v53, s12
    v_add_u32 v2, v2, v54
    v_mul_u32_u24 v53, 32, v49
    v_add_u32 v53, 16, v53
    v_add_u32 v53, v53, v50
    v_lshrrev_b32 v54, 1, v53
    v_and_b32 v54, 7, v54
    v_xor_b32 v54, v54, v51
    v_lshlrev_b32 v54, 4, v54
    v_mul_lo_u32 v3, v53, s12
    v_add_u32 v3, v3, v54
    v_mul_u32_u24 v53, 32, v49
    v_add_u32 v53, 24, v53
    v_add_u32 v53, v53, v50
    v_lshrrev_b32 v54, 1, v53
    v_and_b32 v54, 7, v54
    v_xor_b32 v54, v54, v51
    v_lshlrev_b32 v54, 4, v54
    v_mul_lo_u32 v4, v53, s12
    v_add_u32 v4, v4, v54
    v_lshrrev_b32 v53, 2, v51
    v_and_b32 v54, 1, v52
    v_xor_b32 v53, v53, v54
    v_lshlrev_b32 v53, 2, v53
    v_and_b32 v54, 3, v51
    v_or_b32 v53, v53, v54
    v_lshlrev_b32 v53, 4, v53
    v_lshlrev_b32 v54, 4, v49
    v_add_u32 v54, v54, v50
    s_mov_b32 s12, 12288
    v_mul_lo_u32 v5, v54, s12
    v_add_u32 v5, v5, v53
    v_add_u32 v6, 98304, v5
    v_lshrrev_b32 v53, 1, v49
    v_and_b32 v54, 1, v49
    v_mul_u32_u24 v55, 64, v53
    v_and_b32 v56, 31, v48
    v_add_u32 v55, v55, v56
    v_lshrrev_b32 v56, 1, v55
    v_and_b32 v56, 7, v56
    v_lshrrev_b32 v57, 5, v48
    v_xor_b32 v56, v56, v57
    v_lshlrev_b32 v56, 4, v56
    v_lshlrev_b32 v55, 7, v55
    v_add_u32 v8, v55, v56
    v_xor_b32 v9, 32, v8
    v_xor_b32 v10, 64, v8
    v_xor_b32 v11, 96, v8
    v_and_b32 v55, 15, v48
    v_lshrrev_b32 v55, 2, v55
    v_lshrrev_b32 v56, 5, v48
    v_lshlrev_b32 v56, 3, v56
    v_add_u32 v56, v56, v55
    v_lshrrev_b32 v57, 1, v55
    v_and_b32 v57, 1, v57
    v_lshlrev_b32 v57, 6, v57
    v_lshlrev_b32 v56, 7, v56
    v_add_u32 v56, v56, v57
    v_and_b32 v57, 1, v52
    v_lshlrev_b32 v57, 5, v57
    v_add_u32 v56, v56, v57
    v_and_b32 v57, 3, v48
    v_lshlrev_b32 v57, 3, v57
    v_add_u32 v56, v56, v57
    v_add_u32 v56, 16384, v56
    v_lshlrev_b32 v57, 13, v54
    v_add_u32 v12, v56, v57
    v_xor_b32 v13, 64, v12
    v_add_u32 v128, 65536, v8
    v_add_u32 v129, 65536, v9
    v_add_u32 v130, 65536, v10
    v_add_u32 v131, 65536, v11
    v_add_u32 v132, 65536, v12
    v_add_u32 v133, 65536, v13
    v_mov_b32 v64, 0
    v_mov_b32 v65, 0
    v_mov_b32 v66, 0
    v_mov_b32 v67, 0
    v_mov_b32 v68, 0
    v_mov_b32 v69, 0
    v_mov_b32 v70, 0
    v_mov_b32 v71, 0
    v_mov_b32 v72, 0
    v_mov_b32 v73, 0
    v_mov_b32 v74, 0
    v_mov_b32 v75, 0
    v_mov_b32 v76, 0
    v_mov_b32 v77, 0
    v_mov_b32 v78, 0
    v_mov_b32 v79, 0
    v_mov_b32 v80, 0
    v_mov_b32 v81, 0
    v_mov_b32 v82, 0
    v_mov_b32 v83, 0
    v_mov_b32 v84, 0
    v_mov_b32 v85, 0
    v_mov_b32 v86, 0
    v_mov_b32 v87, 0
    v_mov_b32 v88, 0
    v_mov_b32 v89, 0
    v_mov_b32 v90, 0
    v_mov_b32 v91, 0
    v_mov_b32 v92, 0
    v_mov_b32 v93, 0
    v_mov_b32 v94, 0
    v_mov_b32 v95, 0
    v_mov_b32 v96, 0
    v_mov_b32 v97, 0
    v_mov_b32 v98, 0
    v_mov_b32 v99, 0
    v_mov_b32 v100, 0
    v_mov_b32 v101, 0
    v_mov_b32 v102, 0
    v_mov_b32 v103, 0
    v_mov_b32 v104, 0
    v_mov_b32 v105, 0
    v_mov_b32 v106, 0
    v_mov_b32 v107, 0
    v_mov_b32 v108, 0
    v_mov_b32 v109, 0
    v_mov_b32 v110, 0
    v_mov_b32 v111, 0
    v_mov_b32 v112, 0
    v_mov_b32 v113, 0
    v_mov_b32 v114, 0
    v_mov_b32 v115, 0
    v_mov_b32 v116, 0
    v_mov_b32 v117, 0
    v_mov_b32 v118, 0
    v_mov_b32 v119, 0
    v_mov_b32 v120, 0
    v_mov_b32 v121, 0
    v_mov_b32 v122, 0
    v_mov_b32 v123, 0
    v_mov_b32 v124, 0
    v_mov_b32 v125, 0
    v_mov_b32 v126, 0
    v_mov_b32 v127, 0
    s_add_u32 m0, s10, 0
    s_nop 0
    global_load_lds_dwordx4 v1, s[4:5]
    s_add_u32 m0, s10, 1024
    s_nop 0
    global_load_lds_dwordx4 v2, s[4:5]
    s_add_u32 m0, s10, 2048
    s_nop 0
    global_load_lds_dwordx4 v3, s[4:5]
    s_add_u32 m0, s10, 3072
    s_nop 0
    global_load_lds_dwordx4 v4, s[4:5]
    s_add_u32 m0, s11, 16384
    s_nop 0
    global_load_lds_dwordx4 v5, s[6:7]
    s_add_u32 m0, s11, 17408
    s_nop 0
    global_load_lds_dwordx4 v6, s[6:7]
    s_add_u32 m0, s11, 24576
    s_nop 0
    global_load_lds_dwordx4 v5, s[8:9]
    s_add_u32 m0, s11, 25600
    s_nop 0
    global_load_lds_dwordx4 v6, s[8:9]
    s_add_u32 s4, s4, 128
    s_addc_u32 s5, s5, 0
    s_add_u32 s6, s6, 786432
    s_addc_u32 s7, s7, 0
    s_add_u32 s8, s8, 786432
    s_addc_u32 s9, s9, 0
    s_add_u32 m0, s10, 32768
    s_nop 0
    global_load_lds_dwordx4 v1, s[4:5]
    s_add_u32 m0, s10, 33792
    s_nop 0
    global_load_lds_dwordx4 v2, s[4:5]
    s_add_u32 m0, s10, 34816
    s_nop 0
    global_load_lds_dwordx4 v3, s[4:5]
    s_add_u32 m0, s10, 35840
    s_nop 0
    global_load_lds_dwordx4 v4, s[4:5]
    s_add_u32 m0, s11, 49152
    s_nop 0
    global_load_lds_dwordx4 v5, s[6:7]
    s_add_u32 m0, s11, 50176
    s_nop 0
    global_load_lds_dwordx4 v6, s[6:7]
    s_add_u32 m0, s11, 57344
    s_nop 0
    global_load_lds_dwordx4 v5, s[8:9]
    s_add_u32 m0, s11, 58368
    s_nop 0
    global_load_lds_dwordx4 v6, s[8:9]
    s_add_u32 s4, s4, 128
    s_addc_u32 s5, s5, 0
    s_add_u32 s6, s6, 786432
    s_addc_u32 s7, s7, 0
    s_add_u32 s8, s8, 786432
    s_addc_u32 s9, s9, 0
    s_waitcnt vmcnt(8)
    s_barrier
    ds_read_b128 v[16:19], v8 offset:0
    ds_read_b128 v[20:23], v8 offset:4096
    ds_read_b64_tr_b16 v[24:25], v12 offset:0
    ds_read_b64_tr_b16 v[26:27], v12 offset:512
    ds_read_b64_tr_b16 v[28:29], v13 offset:0
    ds_read_b64_tr_b16 v[30:31], v13 offset:512
    ds_read_b128 v[32:35], v9 offset:0
    ds_read_b128 v[36:39], v9 offset:4096
    ds_read_b64_tr_b16 v[40:41], v12 offset:2048
    ds_read_b64_tr_b16 v[42:43], v12 offset:2560
    ds_read_b64_tr_b16 v[44:45], v13 offset:2048
    ds_read_b64_tr_b16 v[46:47], v13 offset:2560
    s_add_u32 m0, s10, 65536
    s_nop 0
    global_load_lds_dwordx4 v1, s[4:5]
    s_add_u32 m0, s10, 66560
    s_nop 0
    global_load_lds_dwordx4 v2, s[4:5]
    s_add_u32 m0, s10, 67584
    s_nop 0
    global_load_lds_dwordx4 v3, s[4:5]
    s_add_u32 m0, s10, 68608
    s_nop 0
    global_load_lds_dwordx4 v4, s[4:5]
    s_add_u32 m0, s11, 81920
    s_nop 0
    global_load_lds_dwordx4 v5, s[6:7]
    s_add_u32 m0, s11, 82944
    s_nop 0
    global_load_lds_dwordx4 v6, s[6:7]
    s_add_u32 m0, s11, 90112
    s_nop 0
    global_load_lds_dwordx4 v5, s[8:9]
    s_add_u32 m0, s11, 91136
    s_nop 0
    global_load_lds_dwordx4 v6, s[8:9]
    s_add_u32 s4, s4, 128
    s_addc_u32 s5, s5, 0
    s_add_u32 s6, s6, 786432
    s_addc_u32 s7, s7, 0
    s_add_u32 s8, s8, 786432
    s_addc_u32 s9, s9, 0
    s_waitcnt lgkmcnt(6)
    v_mfma_f32_32x32x16_bf16 v[64:79], v[16:19], v[24:27], v[64:79]
    v_mfma_f32_32x32x16_bf16 v[80:95], v[16:19], v[28:31], v[80:95]
    v_mfma_f32_32x32x16_bf16 v[96:111], v[20:23], v[24:27], v[96:111]
    v_mfma_f32_32x32x16_bf16 v[112:127], v[20:23], v[28:31], v[112:127]
    ds_read_b128 v[16:19], v10 offset:0
    ds_read_b128 v[20:23], v10 offset:4096
    ds_read_b64_tr_b16 v[24:25], v12 offset:4096
    ds_read_b64_tr_b16 v[26:27], v12 offset:4608
    ds_read_b64_tr_b16 v[28:29], v13 offset:4096
    ds_read_b64_tr_b16 v[30:31], v13 offset:4608
    s_waitcnt lgkmcnt(6)
    v_mfma_f32_32x32x16_bf16 v[64:79], v[32:35], v[40:43], v[64:79]
    v_mfma_f32_32x32x16_bf16 v[80:95], v[32:35], v[44:47], v[80:95]
    v_mfma_f32_32x32x16_bf16 v[96:111], v[36:39], v[40:43], v[96:111]
    v_mfma_f32_32x32x16_bf16 v[112:127], v[36:39], v[44:47], v[112:127]
    ds_read_b128 v[32:35], v11 offset:0
    ds_read_b128 v[36:39], v11 offset:4096
    ds_read_b64_tr_b16 v[40:41], v12 offset:6144
    ds_read_b64_tr_b16 v[42:43], v12 offset:6656
    ds_read_b64_tr_b16 v[44:45], v13 offset:6144
    ds_read_b64_tr_b16 v[46:47], v13 offset:6656
    s_waitcnt lgkmcnt(6)
    v_mfma_f32_32x32x16_bf16 v[64:79], v[16:19], v[24:27], v[64:79]
    v_mfma_f32_32x32x16_bf16 v[80:95], v[16:19], v[28:31], v[80:95]
    v_mfma_f32_32x32x16_bf16 v[96:111], v[20:23], v[24:27], v[96:111]
    v_mfma_f32_32x32x16_bf16 v[112:127], v[20:23], v[28:31], v[112:127]
    s_waitcnt lgkmcnt(0)
    v_mfma_f32_32x32x16_bf16 v[64:79], v[32:35], v[40:43], v[64:79]
    v_mfma_f32_32x32x16_bf16 v[80:95], v[32:35], v[44:47], v[80:95]
    v_mfma_f32_32x32x16_bf16 v[96:111], v[36:39], v[40:43], v[96:111]
    v_mfma_f32_32x32x16_bf16 v[112:127], v[36:39], v[44:47], v[112:127]
    s_waitcnt vmcnt(8)
    s_barrier
    ds_read_b128 v[16:19], v8 offset:32768
    ds_read_b128 v[20:23], v8 offset:36864
    ds_read_b64_tr_b16 v[24:25], v12 offset:32768
    ds_read_b64_tr_b16 v[26:27], v12 offset:33280
    ds_read_b64_tr_b16 v[28:29], v13 offset:32768
    ds_read_b64_tr_b16 v[30:31], v13 offset:33280
    ds_read_b128 v[32:35], v9 offset:32768
    ds_read_b128 v[36:39], v9 offset:36864
    ds_read_b64_tr_b16 v[40:41], v12 offset:34816
    ds_read_b64_tr_b16 v[42:43], v12 offset:35328
    ds_read_b64_tr_b16 v[44:45], v13 offset:34816
    ds_read_b64_tr_b16 v[46:47], v13 offset:35328
    s_add_u32 m0, s10, 0
    s_nop 0
    global_load_lds_dwordx4 v1, s[4:5]
    s_add_u32 m0, s10, 1024
    s_nop 0
    global_load_lds_dwordx4 v2, s[4:5]
    s_add_u32 m0, s10, 2048
    s_nop 0
    global_load_lds_dwordx4 v3, s[4:5]
    s_add_u32 m0, s10, 3072
    s_nop 0
    global_load_lds_dwordx4 v4, s[4:5]
    s_add_u32 m0, s11, 16384
    s_nop 0
    global_load_lds_dwordx4 v5, s[6:7]
    s_add_u32 m0, s11, 17408
    s_nop 0
    global_load_lds_dwordx4 v6, s[6:7]
    s_add_u32 m0, s11, 24576
    s_nop 0
    global_load_lds_dwordx4 v5, s[8:9]
    s_add_u32 m0, s11, 25600
    s_nop 0
    global_load_lds_dwordx4 v6, s[8:9]
    s_add_u32 s4, s4, 128
    s_addc_u32 s5, s5, 0
    s_add_u32 s6, s6, 786432
    s_addc_u32 s7, s7, 0
    s_add_u32 s8, s8, 786432
    s_addc_u32 s9, s9, 0
    s_waitcnt lgkmcnt(6)
    v_mfma_f32_32x32x16_bf16 v[64:79], v[16:19], v[24:27], v[64:79]
    v_mfma_f32_32x32x16_bf16 v[80:95], v[16:19], v[28:31], v[80:95]
    v_mfma_f32_32x32x16_bf16 v[96:111], v[20:23], v[24:27], v[96:111]
    v_mfma_f32_32x32x16_bf16 v[112:127], v[20:23], v[28:31], v[112:127]
    ds_read_b128 v[16:19], v10 offset:32768
    ds_read_b128 v[20:23], v10 offset:36864
    ds_read_b64_tr_b16 v[24:25], v12 offset:36864
    ds_read_b64_tr_b16 v[26:27], v12 offset:37376
    ds_read_b64_tr_b16 v[28:29], v13 offset:36864
    ds_read_b64_tr_b16 v[30:31], v13 offset:37376
    s_waitcnt lgkmcnt(6)
    v_mfma_f32_32x32x16_bf16 v[64:79], v[32:35], v[40:43], v[64:79]
    v_mfma_f32_32x32x16_bf16 v[80:95], v[32:35], v[44:47], v[80:95]
    v_mfma_f32_32x32x16_bf16 v[96:111], v[36:39], v[40:43], v[96:111]
    v_mfma_f32_32x32x16_bf16 v[112:127], v[36:39], v[44:47], v[112:127]
    ds_read_b128 v[32:35], v11 offset:32768
    ds_read_b128 v[36:39], v11 offset:36864
    ds_read_b64_tr_b16 v[40:41], v12 offset:38912
    ds_read_b64_tr_b16 v[42:43], v12 offset:39424
    ds_read_b64_tr_b16 v[44:45], v13 offset:38912
    ds_read_b64_tr_b16 v[46:47], v13 offset:39424
    s_waitcnt lgkmcnt(6)
    v_mfma_f32_32x32x16_bf16 v[64:79], v[16:19], v[24:27], v[64:79]
    v_mfma_f32_32x32x16_bf16 v[80:95], v[16:19], v[28:31], v[80:95]
    v_mfma_f32_32x32x16_bf16 v[96:111], v[20:23], v[24:27], v[96:111]
    v_mfma_f32_32x32x16_bf16 v[112:127], v[20:23], v[28:31], v[112:127]
    s_waitcnt lgkmcnt(0)
    v_mfma_f32_32x32x16_bf16 v[64:79], v[32:35], v[40:43], v[64:79]
    v_mfma_f32_32x32x16_bf16 v[80:95], v[32:35], v[44:47], v[80:95]
    v_mfma_f32_32x32x16_bf16 v[96:111], v[36:39], v[40:43], v[96:111]
    v_mfma_f32_32x32x16_bf16 v[112:127], v[36:39], v[44:47], v[112:127]
    s_waitcnt vmcnt(8)
    s_barrier
    ds_read_b128 v[16:19], v128 offset:0
    ds_read_b128 v[20:23], v128 offset:4096
    ds_read_b64_tr_b16 v[24:25], v132 offset:0
    ds_read_b64_tr_b16 v[26:27], v132 offset:512
    ds_read_b64_tr_b16 v[28:29], v133 offset:0
    ds_read_b64_tr_b16 v[30:31], v133 offset:512
    ds_read_b128 v[32:35], v129 offset:0
    ds_read_b128 v[36:39], v129 offset:4096
    ds_read_b64_tr_b16 v[40:41], v132 offset:2048
    ds_read_b64_tr_b16 v[42:43], v132 offset:2560
    ds_read_b64_tr_b16 v[44:45], v133 offset:2048
    ds_read_b64_tr_b16 v[46:47], v133 offset:2560
    s_add_u32 m0, s10, 32768
    s_nop 0
    global_load_lds_dwordx4 v1, s[4:5]
    s_add_u32 m0, s10, 33792
    s_nop 0
    global_load_lds_dwordx4 v2, s[4:5]
    s_add_u32 m0, s10, 34816
    s_nop 0
    global_load_lds_dwordx4 v3, s[4:5]
    s_add_u32 m0, s10, 35840
    s_nop 0
    global_load_lds_dwordx4 v4, s[4:5]
    s_add_u32 m0, s11, 49152
    s_nop 0
    global_load_lds_dwordx4 v5, s[6:7]
    s_add_u32 m0, s11, 50176
    s_nop 0
    global_load_lds_dwordx4 v6, s[6:7]
    s_add_u32 m0, s11, 57344
    s_nop 0
    global_load_lds_dwordx4 v5, s[8:9]
    s_add_u32 m0, s11, 58368
    s_nop 0
    global_load_lds_dwordx4 v6, s[8:9]
    s_add_u32 s4, s4, 128
    s_addc_u32 s5, s5, 0
    s_add_u32 s6, s6, 786432
    s_addc_u32 s7, s7, 0
    s_add_u32 s8, s8, 786432
    s_addc_u32 s9, s9, 0
    s_waitcnt lgkmcnt(6)
    v_mfma_f32_32x32x16_bf16 v[64:79], v[16:19], v[24:27], v[64:79]
    v_mfma_f32_32x32x16_bf16 v[80:95], v[16:19], v[28:31], v[80:95]
    v_mfma_f32_32x32x16_bf16 v[96:111], v[20:23], v[24:27], v[96:111]
    v_mfma_f32_32x32x16_bf16 v[112:127], v[20:23], v[28:31], v[112:127]
    ds_read_b128 v[16:19], v130 offset:0
    ds_read_b128 v[20:23], v130 offset:4096
    ds_read_b64_tr_b16 v[24:25], v132 offset:4096
    ds_read_b64_tr_b16 v[26:27], v132 offset:4608
    ds_read_b64_tr_b16 v[28:29], v133 offset:4096
    ds_read_b64_tr_b16 v[30:31], v133 offset:4608
    s_waitcnt lgkmcnt(6)
    v_mfma_f32_32x32x16_bf16 v[64:79], v[32:35], v[40:43], v[64:79]
    v_mfma_f32_32x32x16_bf16 v[80:95], v[32:35], v[44:47], v[80:95]
    v_mfma_f32_32x32x16_bf16 v[96:111], v[36:39], v[40:43], v[96:111]
    v_mfma_f32_32x32x16_bf16 v[112:127], v[36:39], v[44:47], v[112:127]
    ds_read_b128 v[32:35], v131 offset:0
    ds_read_b128 v[36:39], v131 offset:4096
    ds_read_b64_tr_b16 v[40:41], v132 offset:6144
    ds_read_b64_tr_b16 v[42:43], v132 offset:6656
    ds_read_b64_tr_b16 v[44:45], v133 offset:6144
    ds_read_b64_tr_b16 v[46:47], v133 offset:6656
    s_waitcnt lgkmcnt(6)
    v_mfma_f32_32x32x16_bf16 v[64:79], v[16:19], v[24:27], v[64:79]
    v_mfma_f32_32x32x16_bf16 v[80:95], v[16:19], v[28:31], v[80:95]
    v_mfma_f32_32x32x16_bf16 v[96:111], v[20:23], v[24:27], v[96:111]
    v_mfma_f32_32x32x16_bf16 v[112:127], v[20:23], v[28:31], v[112:127]
    s_waitcnt lgkmcnt(0)
    v_mfma_f32_32x32x16_bf16 v[64:79], v[32:35], v[40:43], v[64:79]
    v_mfma_f32_32x32x16_bf16 v[80:95], v[32:35], v[44:47], v[80:95]
    v_mfma_f32_32x32x16_bf16 v[96:111], v[36:39], v[40:43], v[96:111]
    v_mfma_f32_32x32x16_bf16 v[112:127], v[36:39], v[44:47], v[112:127]
    s_waitcnt vmcnt(8)
    s_barrier
    ds_read_b128 v[16:19], v8 offset:0
    ds_read_b128 v[20:23], v8 offset:4096
    ds_read_b64_tr_b16 v[24:25], v12 offset:0
    ds_read_b64_tr_b16 v[26:27], v12 offset:512
    ds_read_b64_tr_b16 v[28:29], v13 offset:0
    ds_read_b64_tr_b16 v[30:31], v13 offset:512
    ds_read_b128 v[32:35], v9 offset:0
    ds_read_b128 v[36:39], v9 offset:4096
    ds_read_b64_tr_b16 v[40:41], v12 offset:2048
    ds_read_b64_tr_b16 v[42:43], v12 offset:2560
    ds_read_b64_tr_b16 v[44:45], v13 offset:2048
    ds_read_b64_tr_b16 v[46:47], v13 offset:2560
    s_add_u32 m0, s10, 65536
    s_nop 0
    global_load_lds_dwordx4 v1, s[4:5]
    s_add_u32 m0, s10, 66560
    s_nop 0
    global_load_lds_dwordx4 v2, s[4:5]
    s_add_u32 m0, s10, 67584
    s_nop 0
    global_load_lds_dwordx4 v3, s[4:5]
    s_add_u32 m0, s10, 68608
    s_nop 0
    global_load_lds_dwordx4 v4, s[4:5]
    s_add_u32 m0, s11, 81920
    s_nop 0
    global_load_lds_dwordx4 v5, s[6:7]
    s_add_u32 m0, s11, 82944
    s_nop 0
    global_load_lds_dwordx4 v6, s[6:7]
    s_add_u32 m0, s11, 90112
    s_nop 0
    global_load_lds_dwordx4 v5, s[8:9]
    s_add_u32 m0, s11, 91136
    s_nop 0
    global_load_lds_dwordx4 v6, s[8:9]
    s_add_u32 s4, s4, 128
    s_addc_u32 s5, s5, 0
    s_add_u32 s6, s6, 786432
    s_addc_u32 s7, s7, 0
    s_add_u32 s8, s8, 786432
    s_addc_u32 s9, s9, 0
    s_waitcnt lgkmcnt(6)
    v_mfma_f32_32x32x16_bf16 v[64:79], v[16:19], v[24:27], v[64:79]
    v_mfma_f32_32x32x16_bf16 v[80:95], v[16:19], v[28:31], v[80:95]
    v_mfma_f32_32x32x16_bf16 v[96:111], v[20:23], v[24:27], v[96:111]
    v_mfma_f32_32x32x16_bf16 v[112:127], v[20:23], v[28:31], v[112:127]
    ds_read_b128 v[16:19], v10 offset:0
    ds_read_b128 v[20:23], v10 offset:4096
    ds_read_b64_tr_b16 v[24:25], v12 offset:4096
    ds_read_b64_tr_b16 v[26:27], v12 offset:4608
    ds_read_b64_tr_b16 v[28:29], v13 offset:4096
    ds_read_b64_tr_b16 v[30:31], v13 offset:4608
    s_waitcnt lgkmcnt(6)
    v_mfma_f32_32x32x16_bf16 v[64:79], v[32:35], v[40:43], v[64:79]
    v_mfma_f32_32x32x16_bf16 v[80:95], v[32:35], v[44:47], v[80:95]
    v_mfma_f32_32x32x16_bf16 v[96:111], v[36:39], v[40:43], v[96:111]
    v_mfma_f32_32x32x16_bf16 v[112:127], v[36:39], v[44:47], v[112:127]
    ds_read_b128 v[32:35], v11 offset:0
    ds_read_b128 v[36:39], v11 offset:4096
    ds_read_b64_tr_b16 v[40:41], v12 offset:6144
    ds_read_b64_tr_b16 v[42:43], v12 offset:6656
    ds_read_b64_tr_b16 v[44:45], v13 offset:6144
    ds_read_b64_tr_b16 v[46:47], v13 offset:6656
    s_waitcnt lgkmcnt(6)
    v_mfma_f32_32x32x16_bf16 v[64:79], v[16:19], v[24:27], v[64:79]
    v_mfma_f32_32x32x16_bf16 v[80:95], v[16:19], v[28:31], v[80:95]
    v_mfma_f32_32x32x16_bf16 v[96:111], v[20:23], v[24:27], v[96:111]
    v_mfma_f32_32x32x16_bf16 v[112:127], v[20:23], v[28:31], v[112:127]
    s_waitcnt lgkmcnt(0)
    v_mfma_f32_32x32x16_bf16 v[64:79], v[32:35], v[40:43], v[64:79]
    v_mfma_f32_32x32x16_bf16 v[80:95], v[32:35], v[44:47], v[80:95]
    v_mfma_f32_32x32x16_bf16 v[96:111], v[36:39], v[40:43], v[96:111]
    v_mfma_f32_32x32x16_bf16 v[112:127], v[36:39], v[44:47], v[112:127]
    s_waitcnt vmcnt(8)
    s_barrier
    ds_read_b128 v[16:19], v8 offset:32768
    ds_read_b128 v[20:23], v8 offset:36864
    ds_read_b64_tr_b16 v[24:25], v12 offset:32768
    ds_read_b64_tr_b16 v[26:27], v12 offset:33280
    ds_read_b64_tr_b16 v[28:29], v13 offset:32768
    ds_read_b64_tr_b16 v[30:31], v13 offset:33280
    ds_read_b128 v[32:35], v9 offset:32768
    ds_read_b128 v[36:39], v9 offset:36864
    ds_read_b64_tr_b16 v[40:41], v12 offset:34816
    ds_read_b64_tr_b16 v[42:43], v12 offset:35328
    ds_read_b64_tr_b16 v[44:45], v13 offset:34816
    ds_read_b64_tr_b16 v[46:47], v13 offset:35328
    s_add_u32 m0, s10, 0
    s_nop 0
    global_load_lds_dwordx4 v1, s[4:5]
    s_add_u32 m0, s10, 1024
    s_nop 0
    global_load_lds_dwordx4 v2, s[4:5]
    s_add_u32 m0, s10, 2048
    s_nop 0
    global_load_lds_dwordx4 v3, s[4:5]
    s_add_u32 m0, s10, 3072
    s_nop 0
    global_load_lds_dwordx4 v4, s[4:5]
    s_add_u32 m0, s11, 16384
    s_nop 0
    global_load_lds_dwordx4 v5, s[6:7]
    s_add_u32 m0, s11, 17408
    s_nop 0
    global_load_lds_dwordx4 v6, s[6:7]
    s_add_u32 m0, s11, 24576
    s_nop 0
    global_load_lds_dwordx4 v5, s[8:9]
    s_add_u32 m0, s11, 25600
    s_nop 0
    global_load_lds_dwordx4 v6, s[8:9]
    s_add_u32 s4, s4, 128
    s_addc_u32 s5, s5, 0
    s_add_u32 s6, s6, 786432
    s_addc_u32 s7, s7, 0
    s_add_u32 s8, s8, 786432
    s_addc_u32 s9, s9, 0
    s_waitcnt lgkmcnt(6)
    v_mfma_f32_32x32x16_bf16 v[64:79], v[16:19], v[24:27], v[64:79]
    v_mfma_f32_32x32x16_bf16 v[80:95], v[16:19], v[28:31], v[80:95]
    v_mfma_f32_32x32x16_bf16 v[96:111], v[20:23], v[24:27], v[96:111]
    v_mfma_f32_32x32x16_bf16 v[112:127], v[20:23], v[28:31], v[112:127]
    ds_read_b128 v[16:19], v10 offset:32768
    ds_read_b128 v[20:23], v10 offset:36864
    ds_read_b64_tr_b16 v[24:25], v12 offset:36864
    ds_read_b64_tr_b16 v[26:27], v12 offset:37376
    ds_read_b64_tr_b16 v[28:29], v13 offset:36864
    ds_read_b64_tr_b16 v[30:31], v13 offset:37376
    s_waitcnt lgkmcnt(6)
    v_mfma_f32_32x32x16_bf16 v[64:79], v[32:35], v[40:43], v[64:79]
    v_mfma_f32_32x32x16_bf16 v[80:95], v[32:35], v[44:47], v[80:95]
    v_mfma_f32_32x32x16_bf16 v[96:111], v[36:39], v[40:43], v[96:111]
    v_mfma_f32_32x32x16_bf16 v[112:127], v[36:39], v[44:47], v[112:127]
    ds_read_b128 v[32:35], v11 offset:32768
    ds_read_b128 v[36:39], v11 offset:36864
    ds_read_b64_tr_b16 v[40:41], v12 offset:38912
    ds_read_b64_tr_b16 v[42:43], v12 offset:39424
    ds_read_b64_tr_b16 v[44:45], v13 offset:38912
    ds_read_b64_tr_b16 v[46:47], v13 offset:39424
    s_waitcnt lgkmcnt(6)
    v_mfma_f32_32x32x16_bf16 v[64:79], v[16:19], v[24:27], v[64:79]
    v_mfma_f32_32x32x16_bf16 v[80:95], v[16:19], v[28:31], v[80:95]
    v_mfma_f32_32x32x16_bf16 v[96:111], v[20:23], v[24:27], v[96:111]
    v_mfma_f32_32x32x16_bf16 v[112:127], v[20:23], v[28:31], v[112:127]
    s_waitcnt lgkmcnt(0)
    v_mfma_f32_32x32x16_bf16 v[64:79], v[32:35], v[40:43], v[64:79]
    v_mfma_f32_32x32x16_bf16 v[80:95], v[32:35], v[44:47], v[80:95]
    v_mfma_f32_32x32x16_bf16 v[96:111], v[36:39], v[40:43], v[96:111]
    v_mfma_f32_32x32x16_bf16 v[112:127], v[36:39], v[44:47], v[112:127]
    s_waitcnt vmcnt(8)
    s_barrier
    ds_read_b128 v[16:19], v128 offset:0
    ds_read_b128 v[20:23], v128 offset:4096
    ds_read_b64_tr_b16 v[24:25], v132 offset:0
    ds_read_b64_tr_b16 v[26:27], v132 offset:512
    ds_read_b64_tr_b16 v[28:29], v133 offset:0
    ds_read_b64_tr_b16 v[30:31], v133 offset:512
    ds_read_b128 v[32:35], v129 offset:0
    ds_read_b128 v[36:39], v129 offset:4096
    ds_read_b64_tr_b16 v[40:41], v132 offset:2048
    ds_read_b64_tr_b16 v[42:43], v132 offset:2560
    ds_read_b64_tr_b16 v[44:45], v133 offset:2048
    ds_read_b64_tr_b16 v[46:47], v133 offset:2560
    s_add_u32 m0, s10, 32768
    s_nop 0
    global_load_lds_dwordx4 v1, s[4:5]
    s_add_u32 m0, s10, 33792
    s_nop 0
    global_load_lds_dwordx4 v2, s[4:5]
    s_add_u32 m0, s10, 34816
    s_nop 0
    global_load_lds_dwordx4 v3, s[4:5]
    s_add_u32 m0, s10, 35840
    s_nop 0
    global_load_lds_dwordx4 v4, s[4:5]
    s_add_u32 m0, s11, 49152
    s_nop 0
    global_load_lds_dwordx4 v5, s[6:7]
    s_add_u32 m0, s11, 50176
    s_nop 0
    global_load_lds_dwordx4 v6, s[6:7]
    s_add_u32 m0, s11, 57344
    s_nop 0
    global_load_lds_dwordx4 v5, s[8:9]
    s_add_u32 m0, s11, 58368
    s_nop 0
    global_load_lds_dwordx4 v6, s[8:9]
    s_add_u32 s4, s4, 128
    s_addc_u32 s5, s5, 0
    s_add_u32 s6, s6, 786432
    s_addc_u32 s7, s7, 0
    s_add_u32 s8, s8, 786432
    s_addc_u32 s9, s9, 0
    s_waitcnt lgkmcnt(6)
    v_mfma_f32_32x32x16_bf16 v[64:79], v[16:19], v[24:27], v[64:79]
    v_mfma_f32_32x32x16_bf16 v[80:95], v[16:19], v[28:31], v[80:95]
    v_mfma_f32_32x32x16_bf16 v[96:111], v[20:23], v[24:27], v[96:111]
    v_mfma_f32_32x32x16_bf16 v[112:127], v[20:23], v[28:31], v[112:127]
    ds_read_b128 v[16:19], v130 offset:0
    ds_read_b128 v[20:23], v130 offset:4096
    ds_read_b64_tr_b16 v[24:25], v132 offset:4096
    ds_read_b64_tr_b16 v[26:27], v132 offset:4608
    ds_read_b64_tr_b16 v[28:29], v133 offset:4096
    ds_read_b64_tr_b16 v[30:31], v133 offset:4608
    s_waitcnt lgkmcnt(6)
    v_mfma_f32_32x32x16_bf16 v[64:79], v[32:35], v[40:43], v[64:79]
    v_mfma_f32_32x32x16_bf16 v[80:95], v[32:35], v[44:47], v[80:95]
    v_mfma_f32_32x32x16_bf16 v[96:111], v[36:39], v[40:43], v[96:111]
    v_mfma_f32_32x32x16_bf16 v[112:127], v[36:39], v[44:47], v[112:127]
    ds_read_b128 v[32:35], v131 offset:0
    ds_read_b128 v[36:39], v131 offset:4096
    ds_read_b64_tr_b16 v[40:41], v132 offset:6144
    ds_read_b64_tr_b16 v[42:43], v132 offset:6656
    ds_read_b64_tr_b16 v[44:45], v133 offset:6144
    ds_read_b64_tr_b16 v[46:47], v133 offset:6656
    s_waitcnt lgkmcnt(6)
    v_mfma_f32_32x32x16_bf16 v[64:79], v[16:19], v[24:27], v[64:79]
    v_mfma_f32_32x32x16_bf16 v[80:95], v[16:19], v[28:31], v[80:95]
    v_mfma_f32_32x32x16_bf16 v[96:111], v[20:23], v[24:27], v[96:111]
    v_mfma_f32_32x32x16_bf16 v[112:127], v[20:23], v[28:31], v[112:127]
    s_waitcnt lgkmcnt(0)
    v_mfma_f32_32x32x16_bf16 v[64:79], v[32:35], v[40:43], v[64:79]
    v_mfma_f32_32x32x16_bf16 v[80:95], v[32:35], v[44:47], v[80:95]
    v_mfma_f32_32x32x16_bf16 v[96:111], v[36:39], v[40:43], v[96:111]
    v_mfma_f32_32x32x16_bf16 v[112:127], v[36:39], v[44:47], v[112:127]
    s_waitcnt vmcnt(8)
    s_barrier
    ds_read_b128 v[16:19], v8 offset:0
    ds_read_b128 v[20:23], v8 offset:4096
    ds_read_b64_tr_b16 v[24:25], v12 offset:0
    ds_read_b64_tr_b16 v[26:27], v12 offset:512
    ds_read_b64_tr_b16 v[28:29], v13 offset:0
    ds_read_b64_tr_b16 v[30:31], v13 offset:512
    ds_read_b128 v[32:35], v9 offset:0
    ds_read_b128 v[36:39], v9 offset:4096
    ds_read_b64_tr_b16 v[40:41], v12 offset:2048
    ds_read_b64_tr_b16 v[42:43], v12 offset:2560
    ds_read_b64_tr_b16 v[44:45], v13 offset:2048
    ds_read_b64_tr_b16 v[46:47], v13 offset:2560
    s_add_u32 m0, s10, 65536
    s_nop 0
    global_load_lds_dwordx4 v1, s[4:5]
    s_add_u32 m0, s10, 66560
    s_nop 0
    global_load_lds_dwordx4 v2, s[4:5]
    s_add_u32 m0, s10, 67584
    s_nop 0
    global_load_lds_dwordx4 v3, s[4:5]
    s_add_u32 m0, s10, 68608
    s_nop 0
    global_load_lds_dwordx4 v4, s[4:5]
    s_add_u32 m0, s11, 81920
    s_nop 0
    global_load_lds_dwordx4 v5, s[6:7]
    s_add_u32 m0, s11, 82944
    s_nop 0
    global_load_lds_dwordx4 v6, s[6:7]
    s_add_u32 m0, s11, 90112
    s_nop 0
    global_load_lds_dwordx4 v5, s[8:9]
    s_add_u32 m0, s11, 91136
    s_nop 0
    global_load_lds_dwordx4 v6, s[8:9]
    s_add_u32 s4, s4, 128
    s_addc_u32 s5, s5, 0
    s_add_u32 s6, s6, 786432
    s_addc_u32 s7, s7, 0
    s_add_u32 s8, s8, 786432
    s_addc_u32 s9, s9, 0
    s_waitcnt lgkmcnt(6)
    v_mfma_f32_32x32x16_bf16 v[64:79], v[16:19], v[24:27], v[64:79]
    v_mfma_f32_32x32x16_bf16 v[80:95], v[16:19], v[28:31], v[80:95]
    v_mfma_f32_32x32x16_bf16 v[96:111], v[20:23], v[24:27], v[96:111]
    v_mfma_f32_32x32x16_bf16 v[112:127], v[20:23], v[28:31], v[112:127]
    ds_read_b128 v[16:19], v10 offset:0
    ds_read_b128 v[20:23], v10 offset:4096
    ds_read_b64_tr_b16 v[24:25], v12 offset:4096
    ds_read_b64_tr_b16 v[26:27], v12 offset:4608
    ds_read_b64_tr_b16 v[28:29], v13 offset:4096
    ds_read_b64_tr_b16 v[30:31], v13 offset:4608
    s_waitcnt lgkmcnt(6)
    v_mfma_f32_32x32x16_bf16 v[64:79], v[32:35], v[40:43], v[64:79]
    v_mfma_f32_32x32x16_bf16 v[80:95], v[32:35], v[44:47], v[80:95]
    v_mfma_f32_32x32x16_bf16 v[96:111], v[36:39], v[40:43], v[96:111]
    v_mfma_f32_32x32x16_bf16 v[112:127], v[36:39], v[44:47], v[112:127]
    ds_read_b128 v[32:35], v11 offset:0
    ds_read_b128 v[36:39], v11 offset:4096
    ds_read_b64_tr_b16 v[40:41], v12 offset:6144
    ds_read_b64_tr_b16 v[42:43], v12 offset:6656
    ds_read_b64_tr_b16 v[44:45], v13 offset:6144
    ds_read_b64_tr_b16 v[46:47], v13 offset:6656
    s_waitcnt lgkmcnt(6)
    v_mfma_f32_32x32x16_bf16 v[64:79], v[16:19], v[24:27], v[64:79]
    v_mfma_f32_32x32x16_bf16 v[80:95], v[16:19], v[28:31], v[80:95]
    v_mfma_f32_32x32x16_bf16 v[96:111], v[20:23], v[24:27], v[96:111]
    v_mfma_f32_32x32x16_bf16 v[112:127], v[20:23], v[28:31], v[112:127]
    s_waitcnt lgkmcnt(0)
    v_mfma_f32_32x32x16_bf16 v[64:79], v[32:35], v[40:43], v[64:79]
    v_mfma_f32_32x32x16_bf16 v[80:95], v[32:35], v[44:47], v[80:95]
    v_mfma_f32_32x32x16_bf16 v[96:111], v[36:39], v[40:43], v[96:111]
    v_mfma_f32_32x32x16_bf16 v[112:127], v[36:39], v[44:47], v[112:127]
    s_waitcnt vmcnt(8)
    s_barrier
    ds_read_b128 v[16:19], v8 offset:32768
    ds_read_b128 v[20:23], v8 offset:36864
    ds_read_b64_tr_b16 v[24:25], v12 offset:32768
    ds_read_b64_tr_b16 v[26:27], v12 offset:33280
    ds_read_b64_tr_b16 v[28:29], v13 offset:32768
    ds_read_b64_tr_b16 v[30:31], v13 offset:33280
    ds_read_b128 v[32:35], v9 offset:32768
    ds_read_b128 v[36:39], v9 offset:36864
    ds_read_b64_tr_b16 v[40:41], v12 offset:34816
    ds_read_b64_tr_b16 v[42:43], v12 offset:35328
    ds_read_b64_tr_b16 v[44:45], v13 offset:34816
    ds_read_b64_tr_b16 v[46:47], v13 offset:35328
    s_add_u32 m0, s10, 0
    s_nop 0
    global_load_lds_dwordx4 v1, s[4:5]
    s_add_u32 m0, s10, 1024
    s_nop 0
    global_load_lds_dwordx4 v2, s[4:5]
    s_add_u32 m0, s10, 2048
    s_nop 0
    global_load_lds_dwordx4 v3, s[4:5]
    s_add_u32 m0, s10, 3072
    s_nop 0
    global_load_lds_dwordx4 v4, s[4:5]
    s_add_u32 m0, s11, 16384
    s_nop 0
    global_load_lds_dwordx4 v5, s[6:7]
    s_add_u32 m0, s11, 17408
    s_nop 0
    global_load_lds_dwordx4 v6, s[6:7]
    s_add_u32 m0, s11, 24576
    s_nop 0
    global_load_lds_dwordx4 v5, s[8:9]
    s_add_u32 m0, s11, 25600
    s_nop 0
    global_load_lds_dwordx4 v6, s[8:9]
    s_add_u32 s4, s4, 128
    s_addc_u32 s5, s5, 0
    s_add_u32 s6, s6, 786432
    s_addc_u32 s7, s7, 0
    s_add_u32 s8, s8, 786432
    s_addc_u32 s9, s9, 0
    s_waitcnt lgkmcnt(6)
    v_mfma_f32_32x32x16_bf16 v[64:79], v[16:19], v[24:27], v[64:79]
    v_mfma_f32_32x32x16_bf16 v[80:95], v[16:19], v[28:31], v[80:95]
    v_mfma_f32_32x32x16_bf16 v[96:111], v[20:23], v[24:27], v[96:111]
    v_mfma_f32_32x32x16_bf16 v[112:127], v[20:23], v[28:31], v[112:127]
    ds_read_b128 v[16:19], v10 offset:32768
    ds_read_b128 v[20:23], v10 offset:36864
    ds_read_b64_tr_b16 v[24:25], v12 offset:36864
    ds_read_b64_tr_b16 v[26:27], v12 offset:37376
    ds_read_b64_tr_b16 v[28:29], v13 offset:36864
    ds_read_b64_tr_b16 v[30:31], v13 offset:37376
    s_waitcnt lgkmcnt(6)
    v_mfma_f32_32x32x16_bf16 v[64:79], v[32:35], v[40:43], v[64:79]
    v_mfma_f32_32x32x16_bf16 v[80:95], v[32:35], v[44:47], v[80:95]
    v_mfma_f32_32x32x16_bf16 v[96:111], v[36:39], v[40:43], v[96:111]
    v_mfma_f32_32x32x16_bf16 v[112:127], v[36:39], v[44:47], v[112:127]
    ds_read_b128 v[32:35], v11 offset:32768
    ds_read_b128 v[36:39], v11 offset:36864
    ds_read_b64_tr_b16 v[40:41], v12 offset:38912
    ds_read_b64_tr_b16 v[42:43], v12 offset:39424
    ds_read_b64_tr_b16 v[44:45], v13 offset:38912
    ds_read_b64_tr_b16 v[46:47], v13 offset:39424
    s_waitcnt lgkmcnt(6)
    v_mfma_f32_32x32x16_bf16 v[64:79], v[16:19], v[24:27], v[64:79]
    v_mfma_f32_32x32x16_bf16 v[80:95], v[16:19], v[28:31], v[80:95]
    v_mfma_f32_32x32x16_bf16 v[96:111], v[20:23], v[24:27], v[96:111]
    v_mfma_f32_32x32x16_bf16 v[112:127], v[20:23], v[28:31], v[112:127]
    s_waitcnt lgkmcnt(0)
    v_mfma_f32_32x32x16_bf16 v[64:79], v[32:35], v[40:43], v[64:79]
    v_mfma_f32_32x32x16_bf16 v[80:95], v[32:35], v[44:47], v[80:95]
    v_mfma_f32_32x32x16_bf16 v[96:111], v[36:39], v[40:43], v[96:111]
    v_mfma_f32_32x32x16_bf16 v[112:127], v[36:39], v[44:47], v[112:127]
    s_waitcnt vmcnt(8)
    s_barrier
    ds_read_b128 v[16:19], v128 offset:0
    ds_read_b128 v[20:23], v128 offset:4096
    ds_read_b64_tr_b16 v[24:25], v132 offset:0
    ds_read_b64_tr_b16 v[26:27], v132 offset:512
    ds_read_b64_tr_b16 v[28:29], v133 offset:0
    ds_read_b64_tr_b16 v[30:31], v133 offset:512
    ds_read_b128 v[32:35], v129 offset:0
    ds_read_b128 v[36:39], v129 offset:4096
    ds_read_b64_tr_b16 v[40:41], v132 offset:2048
    ds_read_b64_tr_b16 v[42:43], v132 offset:2560
    ds_read_b64_tr_b16 v[44:45], v133 offset:2048
    ds_read_b64_tr_b16 v[46:47], v133 offset:2560
    s_waitcnt lgkmcnt(6)
    v_mfma_f32_32x32x16_bf16 v[64:79], v[16:19], v[24:27], v[64:79]
    v_mfma_f32_32x32x16_bf16 v[80:95], v[16:19], v[28:31], v[80:95]
    v_mfma_f32_32x32x16_bf16 v[96:111], v[20:23], v[24:27], v[96:111]
    v_mfma_f32_32x32x16_bf16 v[112:127], v[20:23], v[28:31], v[112:127]
    ds_read_b128 v[16:19], v130 offset:0
    ds_read_b128 v[20:23], v130 offset:4096
    ds_read_b64_tr_b16 v[24:25], v132 offset:4096
    ds_read_b64_tr_b16 v[26:27], v132 offset:4608
    ds_read_b64_tr_b16 v[28:29], v133 offset:4096
    ds_read_b64_tr_b16 v[30:31], v133 offset:4608
    s_waitcnt lgkmcnt(6)
    v_mfma_f32_32x32x16_bf16 v[64:79], v[32:35], v[40:43], v[64:79]
    v_mfma_f32_32x32x16_bf16 v[80:95], v[32:35], v[44:47], v[80:95]
    v_mfma_f32_32x32x16_bf16 v[96:111], v[36:39], v[40:43], v[96:111]
    v_mfma_f32_32x32x16_bf16 v[112:127], v[36:39], v[44:47], v[112:127]
    ds_read_b128 v[32:35], v131 offset:0
    ds_read_b128 v[36:39], v131 offset:4096
    ds_read_b64_tr_b16 v[40:41], v132 offset:6144
    ds_read_b64_tr_b16 v[42:43], v132 offset:6656
    ds_read_b64_tr_b16 v[44:45], v133 offset:6144
    ds_read_b64_tr_b16 v[46:47], v133 offset:6656
    s_waitcnt lgkmcnt(6)
    v_mfma_f32_32x32x16_bf16 v[64:79], v[16:19], v[24:27], v[64:79]
    v_mfma_f32_32x32x16_bf16 v[80:95], v[16:19], v[28:31], v[80:95]
    v_mfma_f32_32x32x16_bf16 v[96:111], v[20:23], v[24:27], v[96:111]
    v_mfma_f32_32x32x16_bf16 v[112:127], v[20:23], v[28:31], v[112:127]
    s_waitcnt lgkmcnt(0)
    v_mfma_f32_32x32x16_bf16 v[64:79], v[32:35], v[40:43], v[64:79]
    v_mfma_f32_32x32x16_bf16 v[80:95], v[32:35], v[44:47], v[80:95]
    v_mfma_f32_32x32x16_bf16 v[96:111], v[36:39], v[40:43], v[96:111]
    v_mfma_f32_32x32x16_bf16 v[112:127], v[36:39], v[44:47], v[112:127]
    s_waitcnt vmcnt(0)
    s_barrier
    ds_read_b128 v[16:19], v8 offset:0
    ds_read_b128 v[20:23], v8 offset:4096
    ds_read_b64_tr_b16 v[24:25], v12 offset:0
    ds_read_b64_tr_b16 v[26:27], v12 offset:512
    ds_read_b64_tr_b16 v[28:29], v13 offset:0
    ds_read_b64_tr_b16 v[30:31], v13 offset:512
    ds_read_b128 v[32:35], v9 offset:0
    ds_read_b128 v[36:39], v9 offset:4096
    ds_read_b64_tr_b16 v[40:41], v12 offset:2048
    ds_read_b64_tr_b16 v[42:43], v12 offset:2560
    ds_read_b64_tr_b16 v[44:45], v13 offset:2048
    ds_read_b64_tr_b16 v[46:47], v13 offset:2560
    s_waitcnt lgkmcnt(6)
    v_mfma_f32_32x32x16_bf16 v[64:79], v[16:19], v[24:27], v[64:79]
    v_mfma_f32_32x32x16_bf16 v[80:95], v[16:19], v[28:31], v[80:95]
    v_mfma_f32_32x32x16_bf16 v[96:111], v[20:23], v[24:27], v[96:111]
    v_mfma_f32_32x32x16_bf16 v[112:127], v[20:23], v[28:31], v[112:127]
    ds_read_b128 v[16:19], v10 offset:0
    ds_read_b128 v[20:23], v10 offset:4096
    ds_read_b64_tr_b16 v[24:25], v12 offset:4096
    ds_read_b64_tr_b16 v[26:27], v12 offset:4608
    ds_read_b64_tr_b16 v[28:29], v13 offset:4096
    ds_read_b64_tr_b16 v[30:31], v13 offset:4608
    s_waitcnt lgkmcnt(6)
    v_mfma_f32_32x32x16_bf16 v[64:79], v[32:35], v[40:43], v[64:79]
    v_mfma_f32_32x32x16_bf16 v[80:95], v[32:35], v[44:47], v[80:95]
    v_mfma_f32_32x32x16_bf16 v[96:111], v[36:39], v[40:43], v[96:111]
    v_mfma_f32_32x32x16_bf16 v[112:127], v[36:39], v[44:47], v[112:127]
    ds_read_b128 v[32:35], v11 offset:0
    ds_read_b128 v[36:39], v11 offset:4096
    ds_read_b64_tr_b16 v[40:41], v12 offset:6144
    ds_read_b64_tr_b16 v[42:43], v12 offset:6656
    ds_read_b64_tr_b16 v[44:45], v13 offset:6144
    ds_read_b64_tr_b16 v[46:47], v13 offset:6656
    s_waitcnt lgkmcnt(6)
    v_mfma_f32_32x32x16_bf16 v[64:79], v[16:19], v[24:27], v[64:79]
    v_mfma_f32_32x32x16_bf16 v[80:95], v[16:19], v[28:31], v[80:95]
    v_mfma_f32_32x32x16_bf16 v[96:111], v[20:23], v[24:27], v[96:111]
    v_mfma_f32_32x32x16_bf16 v[112:127], v[20:23], v[28:31], v[112:127]
    s_waitcnt lgkmcnt(0)
    v_mfma_f32_32x32x16_bf16 v[64:79], v[32:35], v[40:43], v[64:79]
    v_mfma_f32_32x32x16_bf16 v[80:95], v[32:35], v[44:47], v[80:95]
    v_mfma_f32_32x32x16_bf16 v[96:111], v[36:39], v[40:43], v[96:111]
    v_mfma_f32_32x32x16_bf16 v[112:127], v[36:39], v[44:47], v[112:127]
    s_nop 15
    v_and_b32 v48, 63, v0
    v_lshrrev_b32 v49, 6, v0
    v_lshrrev_b32 v53, 1, v49
    v_and_b32 v54, 1, v49
    v_and_b32 v55, 31, v48
    v_lshrrev_b32 v56, 5, v48
    s_mov_b64 s[16:17], s[78:79]
    s_add_u32 s16, s16, 59654144
    s_addc_u32 s17, s17, 0
    s_and_b32 s17, s17, 0xffff
    s_mov_b32 s18, 25165824
    s_mov_b32 s19, 0x00020000
    s_lshl_b32 s12, s14, 7
    v_lshlrev_b32 v57, 6, v54
    v_add_u32 v57, v57, v55
    v_add_u32 v57, s12, v57
    s_mul_i32 s12, s13, 4
    v_mul_u32_u24 v58, 2, v53
    v_add_u32 v58, s12, v58
    s_movk_i32 s12, 6144
    v_mul_lo_u32 v58, v58, s12
    v_add_u32 v57, v57, v58
    v_lshlrev_b32 v57, 6, v57
    v_lshlrev_b32 v58, 3, v56
    v_add_u32 v57, v57, v58
    s_mov_b32 s12, 0
    v_cvt_pk_bf16_f32 v60, v64, v65
    v_cvt_pk_bf16_f32 v61, v66, v67
    buffer_store_dwordx2 v[60:61], v57, s[16:19], s12 offen offset:0 sc0 sc1
    s_nop 0
    v_cvt_pk_bf16_f32 v60, v68, v69
    v_cvt_pk_bf16_f32 v61, v70, v71
    buffer_store_dwordx2 v[60:61], v57, s[16:19], s12 offen offset:16 sc0 sc1
    s_nop 0
    v_cvt_pk_bf16_f32 v60, v72, v73
    v_cvt_pk_bf16_f32 v61, v74, v75
    buffer_store_dwordx2 v[60:61], v57, s[16:19], s12 offen offset:32 sc0 sc1
    s_nop 0
    v_cvt_pk_bf16_f32 v60, v76, v77
    v_cvt_pk_bf16_f32 v61, v78, v79
    buffer_store_dwordx2 v[60:61], v57, s[16:19], s12 offen offset:48 sc0 sc1
    s_nop 0
    s_mov_b32 s12, 2048
    v_cvt_pk_bf16_f32 v60, v80, v81
    v_cvt_pk_bf16_f32 v61, v82, v83
    buffer_store_dwordx2 v[60:61], v57, s[16:19], s12 offen offset:0 sc0 sc1
    s_nop 0
    v_cvt_pk_bf16_f32 v60, v84, v85
    v_cvt_pk_bf16_f32 v61, v86, v87
    buffer_store_dwordx2 v[60:61], v57, s[16:19], s12 offen offset:16 sc0 sc1
    s_nop 0
    v_cvt_pk_bf16_f32 v60, v88, v89
    v_cvt_pk_bf16_f32 v61, v90, v91
    buffer_store_dwordx2 v[60:61], v57, s[16:19], s12 offen offset:32 sc0 sc1
    s_nop 0
    v_cvt_pk_bf16_f32 v60, v92, v93
    v_cvt_pk_bf16_f32 v61, v94, v95
    buffer_store_dwordx2 v[60:61], v57, s[16:19], s12 offen offset:48 sc0 sc1
    s_nop 0
    s_mov_b32 s12, 393216
    v_cvt_pk_bf16_f32 v60, v96, v97
    v_cvt_pk_bf16_f32 v61, v98, v99
    buffer_store_dwordx2 v[60:61], v57, s[16:19], s12 offen offset:0 sc0 sc1
    s_nop 0
    v_cvt_pk_bf16_f32 v60, v100, v101
    v_cvt_pk_bf16_f32 v61, v102, v103
    buffer_store_dwordx2 v[60:61], v57, s[16:19], s12 offen offset:16 sc0 sc1
    s_nop 0
    v_cvt_pk_bf16_f32 v60, v104, v105
    v_cvt_pk_bf16_f32 v61, v106, v107
    buffer_store_dwordx2 v[60:61], v57, s[16:19], s12 offen offset:32 sc0 sc1
    s_nop 0
    v_cvt_pk_bf16_f32 v60, v108, v109
    v_cvt_pk_bf16_f32 v61, v110, v111
    buffer_store_dwordx2 v[60:61], v57, s[16:19], s12 offen offset:48 sc0 sc1
    s_nop 0
    s_mov_b32 s12, 395264
    v_cvt_pk_bf16_f32 v60, v112, v113
    v_cvt_pk_bf16_f32 v61, v114, v115
    buffer_store_dwordx2 v[60:61], v57, s[16:19], s12 offen offset:0 sc0 sc1
    s_nop 0
    v_cvt_pk_bf16_f32 v60, v116, v117
    v_cvt_pk_bf16_f32 v61, v118, v119
    buffer_store_dwordx2 v[60:61], v57, s[16:19], s12 offen offset:16 sc0 sc1
    s_nop 0
    v_cvt_pk_bf16_f32 v60, v120, v121
    v_cvt_pk_bf16_f32 v61, v122, v123
    buffer_store_dwordx2 v[60:61], v57, s[16:19], s12 offen offset:32 sc0 sc1
    s_nop 0
    v_cvt_pk_bf16_f32 v60, v124, v125
    v_cvt_pk_bf16_f32 v61, v126, v127
    buffer_store_dwordx2 v[60:61], v57, s[16:19], s12 offen offset:48 sc0 sc1
    s_nop 0
    s_waitcnt vmcnt(0)
    s_barrier
    s_cmp_lg_u32 s94, 0
    s_cbranch_scc1 mega_kernel_sg41
    s_lshl_b32 s93, s92, 7
    s_add_u32 s93, s93, 16384
    v_mov_b32 v1, s93
    v_mov_b32 v2, 1
    s_mov_b64 exec, 1
    buffer_atomic_add v2, v1, s[80:83], 0 offen sc1
    s_mov_b64 exec, -1
mega_kernel_sg41:
    s_branch mega_kernel_pan35
mega_kernel_paq33:
    s_sub_u32 s92, s91, 1536
    s_mul_i32 s13, s92, 43691
    s_lshr_b32 s13, s13, 21
    s_mul_i32 s14, s13, 48
    s_sub_u32 s14, s92, s14
    s_mov_b32 s92, s13
    s_mov_b32 s97, s14
    s_cmp_lg_u32 s94, 0
    s_cbranch_scc1 mega_kernel_wd43
    s_lshl_b32 s93, s92, 7
    s_add_u32 s93, s93, 28672
    v_mov_b32 v1, s93
    s_mov_b32 s95, 0
mega_kernel_wl42:
    buffer_load_dword v2, v1, s[80:83], 0 offen sc1
    s_waitcnt vmcnt(0)
    v_cmp_gt_u32 vcc, 8, v2
    s_nop 0
    s_cbranch_vccz mega_kernel_wok44
    s_sleep 4
    s_add_u32 s95, s95, 1
    s_cmp_lt_u32 s95, 1000000
    s_cbranch_scc1 mega_kernel_wl42
    s_branch mega_kernel_done1
mega_kernel_wok44:
mega_kernel_wd43:
    s_barrier
    s_mov_b32 s13, s92
    s_mov_b32 s14, s97
    s_mov_b64 s[4:5], s[78:79]
    s_mul_i32 s12, s13, 163840
    s_add_u32 s4, s4, 6701056
    s_addc_u32 s5, s5, 0
    s_add_u32 s4, s4, s12
    s_addc_u32 s5, s5, 0
    s_mov_b64 s[6:7], s[52:53]
    s_lshl_b32 s12, s14, 8
    s_add_u32 s6, s6, s12
    s_addc_u32 s7, s7, 0
    s_add_u32 s8, s6, 128
    s_addc_u32 s9, s7, 0
    v_and_b32 v48, 63, v0
    v_lshrrev_b32 v49, 6, v0
    s_nop 1
    v_readfirstlane_b32 s10, v49
    s_nop 3
    s_lshl_b32 s11, s10, 11
    s_mul_i32 s10, s10, 4096
    v_lshrrev_b32 v50, 3, v48
    v_and_b32 v51, 7, v48
    v_lshrrev_b32 v52, 4, v48
    s_mov_b32 s12, 1280
    v_mul_u32_u24 v53, 32, v49
    v_add_u32 v53, 0, v53
    v_add_u32 v53, v53, v50
    v_lshrrev_b32 v54, 1, v53
    v_and_b32 v54, 7, v54
    v_xor_b32 v54, v54, v51
    v_lshlrev_b32 v54, 4, v54
    v_mul_lo_u32 v1, v53, s12
    v_add_u32 v1, v1, v54
    v_mul_u32_u24 v53, 32, v49
    v_add_u32 v53, 8, v53
    v_add_u32 v53, v53, v50
    v_lshrrev_b32 v54, 1, v53
    v_and_b32 v54, 7, v54
    v_xor_b32 v54, v54, v51
    v_lshlrev_b32 v54, 4, v54
    v_mul_lo_u32 v2, v53, s12
    v_add_u32 v2, v2, v54
    v_mul_u32_u24 v53, 32, v49
    v_add_u32 v53, 16, v53
    v_add_u32 v53, v53, v50
    v_lshrrev_b32 v54, 1, v53
    v_and_b32 v54, 7, v54
    v_xor_b32 v54, v54, v51
    v_lshlrev_b32 v54, 4, v54
    v_mul_lo_u32 v3, v53, s12
    v_add_u32 v3, v3, v54
    v_mul_u32_u24 v53, 32, v49
    v_add_u32 v53, 24, v53
    v_add_u32 v53, v53, v50
    v_lshrrev_b32 v54, 1, v53
    v_and_b32 v54, 7, v54
    v_xor_b32 v54, v54, v51
    v_lshlrev_b32 v54, 4, v54
    v_mul_lo_u32 v4, v53, s12
    v_add_u32 v4, v4, v54
    v_lshrrev_b32 v53, 2, v51
    v_and_b32 v54, 1, v52
    v_xor_b32 v53, v53, v54
    v_lshlrev_b32 v53, 2, v53
    v_and_b32 v54, 3, v51
    v_or_b32 v53, v53, v54
    v_lshlrev_b32 v53, 4, v53
    v_lshlrev_b32 v54, 4, v49
    v_add_u32 v54, v54, v50
    s_mov_b32 s12, 12288
    v_mul_lo_u32 v5, v54, s12
    v_add_u32 v5, v5, v53
    v_add_u32 v6, 98304, v5
    v_lshrrev_b32 v53, 1, v49
    v_and_b32 v54, 1, v49
    v_mul_u32_u24 v55, 64, v53
    v_and_b32 v56, 31, v48
    v_add_u32 v55, v55, v56
    v_lshrrev_b32 v56, 1, v55
    v_and_b32 v56, 7, v56
    v_lshrrev_b32 v57, 5, v48
    v_xor_b32 v56, v56, v57
    v_lshlrev_b32 v56, 4, v56
    v_lshlrev_b32 v55, 7, v55
    v_add_u32 v8, v55, v56
    v_xor_b32 v9, 32, v8
    v_xor_b32 v10, 64, v8
    v_xor_b32 v11, 96, v8
    v_and_b32 v55, 15, v48
    v_lshrrev_b32 v55, 2, v55
    v_lshrrev_b32 v56, 5, v48
    v_lshlrev_b32 v56, 3, v56
    v_add_u32 v56, v56, v55
    v_lshrrev_b32 v57, 1, v55
    v_and_b32 v57, 1, v57
    v_lshlrev_b32 v57, 6, v57
    v_lshlrev_b32 v56, 7, v56
    v_add_u32 v56, v56, v57
    v_and_b32 v57, 1, v52
    v_lshlrev_b32 v57, 5, v57
    v_add_u32 v56, v56, v57
    v_and_b32 v57, 3, v48
    v_lshlrev_b32 v57, 3, v57
    v_add_u32 v56, v56, v57
    v_add_u32 v56, 16384, v56
    v_lshlrev_b32 v57, 13, v54
    v_add_u32 v12, v56, v57
    v_xor_b32 v13, 64, v12
    v_add_u32 v128, 65536, v8
    v_add_u32 v129, 65536, v9
    v_add_u32 v130, 65536, v10
    v_add_u32 v131, 65536, v11
    v_add_u32 v132, 65536, v12
    v_add_u32 v133, 65536, v13
    v_mov_b32 v64, 0
    v_mov_b32 v65, 0
    v_mov_b32 v66, 0
    v_mov_b32 v67, 0
    v_mov_b32 v68, 0
    v_mov_b32 v69, 0
    v_mov_b32 v70, 0
    v_mov_b32 v71, 0
    v_mov_b32 v72, 0
    v_mov_b32 v73, 0
    v_mov_b32 v74, 0
    v_mov_b32 v75, 0
    v_mov_b32 v76, 0
    v_mov_b32 v77, 0
    v_mov_b32 v78, 0
    v_mov_b32 v79, 0
    v_mov_b32 v80, 0
    v_mov_b32 v81, 0
    v_mov_b32 v82, 0
    v_mov_b32 v83, 0
    v_mov_b32 v84, 0
    v_mov_b32 v85, 0
    v_mov_b32 v86, 0
    v_mov_b32 v87, 0
    v_mov_b32 v88, 0
    v_mov_b32 v89, 0
    v_mov_b32 v90, 0
    v_mov_b32 v91, 0
    v_mov_b32 v92, 0
    v_mov_b32 v93, 0
    v_mov_b32 v94, 0
    v_mov_b32 v95, 0
    v_mov_b32 v96, 0
    v_mov_b32 v97, 0
    v_mov_b32 v98, 0
    v_mov_b32 v99, 0
    v_mov_b32 v100, 0
    v_mov_b32 v101, 0
    v_mov_b32 v102, 0
    v_mov_b32 v103, 0
    v_mov_b32 v104, 0
    v_mov_b32 v105, 0
    v_mov_b32 v106, 0
    v_mov_b32 v107, 0
    v_mov_b32 v108, 0
    v_mov_b32 v109, 0
    v_mov_b32 v110, 0
    v_mov_b32 v111, 0
    v_mov_b32 v112, 0
    v_mov_b32 v113, 0
    v_mov_b32 v114, 0
    v_mov_b32 v115, 0
    v_mov_b32 v116, 0
    v_mov_b32 v117, 0
    v_mov_b32 v118, 0
    v_mov_b32 v119, 0
    v_mov_b32 v120, 0
    v_mov_b32 v121, 0
    v_mov_b32 v122, 0
    v_mov_b32 v123, 0
    v_mov_b32 v124, 0
    v_mov_b32 v125, 0
    v_mov_b32 v126, 0
    v_mov_b32 v127, 0
    s_add_u32 m0, s10, 0
    s_nop 0
    global_load_lds_dwordx4 v1, s[4:5]
    s_add_u32 m0, s10, 1024
    s_nop 0
    global_load_lds_dwordx4 v2, s[4:5]
    s_add_u32 m0, s10, 2048
    s_nop 0
    global_load_lds_dwordx4 v3, s[4:5]
    s_add_u32 m0, s10, 3072
    s_nop 0
    global_load_lds_dwordx4 v4, s[4:5]
    s_add_u32 m0, s11, 16384
    s_nop 0
    global_load_lds_dwordx4 v5, s[6:7]
    s_add_u32 m0, s11, 17408
    s_nop 0
    global_load_lds_dwordx4 v6, s[6:7]
    s_add_u32 m0, s11, 24576
    s_nop 0
    global_load_lds_dwordx4 v5, s[8:9]
    s_add_u32 m0, s11, 25600
    s_nop 0
    global_load_lds_dwordx4 v6, s[8:9]
    s_add_u32 s4, s4, 128
    s_addc_u32 s5, s5, 0
    s_add_u32 s6, s6, 786432
    s_addc_u32 s7, s7, 0
    s_add_u32 s8, s8, 786432
    s_addc_u32 s9, s9, 0
    s_add_u32 m0, s10, 32768
    s_nop 0
    global_load_lds_dwordx4 v1, s[4:5]
    s_add_u32 m0, s10, 33792
    s_nop 0
    global_load_lds_dwordx4 v2, s[4:5]
    s_add_u32 m0, s10, 34816
    s_nop 0
    global_load_lds_dwordx4 v3, s[4:5]
    s_add_u32 m0, s10, 35840
    s_nop 0
    global_load_lds_dwordx4 v4, s[4:5]
    s_add_u32 m0, s11, 49152
    s_nop 0
    global_load_lds_dwordx4 v5, s[6:7]
    s_add_u32 m0, s11, 50176
    s_nop 0
    global_load_lds_dwordx4 v6, s[6:7]
    s_add_u32 m0, s11, 57344
    s_nop 0
    global_load_lds_dwordx4 v5, s[8:9]
    s_add_u32 m0, s11, 58368
    s_nop 0
    global_load_lds_dwordx4 v6, s[8:9]
    s_add_u32 s4, s4, 128
    s_addc_u32 s5, s5, 0
    s_add_u32 s6, s6, 786432
    s_addc_u32 s7, s7, 0
    s_add_u32 s8, s8, 786432
    s_addc_u32 s9, s9, 0
    s_waitcnt vmcnt(8)
    s_barrier
    ds_read_b128 v[16:19], v8 offset:0
    ds_read_b128 v[20:23], v8 offset:4096
    ds_read_b64_tr_b16 v[24:25], v12 offset:0
    ds_read_b64_tr_b16 v[26:27], v12 offset:512
    ds_read_b64_tr_b16 v[28:29], v13 offset:0
    ds_read_b64_tr_b16 v[30:31], v13 offset:512
    ds_read_b128 v[32:35], v9 offset:0
    ds_read_b128 v[36:39], v9 offset:4096
    ds_read_b64_tr_b16 v[40:41], v12 offset:2048
    ds_read_b64_tr_b16 v[42:43], v12 offset:2560
    ds_read_b64_tr_b16 v[44:45], v13 offset:2048
    ds_read_b64_tr_b16 v[46:47], v13 offset:2560
    s_add_u32 m0, s10, 65536
    s_nop 0
    global_load_lds_dwordx4 v1, s[4:5]
    s_add_u32 m0, s10, 66560
    s_nop 0
    global_load_lds_dwordx4 v2, s[4:5]
    s_add_u32 m0, s10, 67584
    s_nop 0
    global_load_lds_dwordx4 v3, s[4:5]
    s_add_u32 m0, s10, 68608
    s_nop 0
    global_load_lds_dwordx4 v4, s[4:5]
    s_add_u32 m0, s11, 81920
    s_nop 0
    global_load_lds_dwordx4 v5, s[6:7]
    s_add_u32 m0, s11, 82944
    s_nop 0
    global_load_lds_dwordx4 v6, s[6:7]
    s_add_u32 m0, s11, 90112
    s_nop 0
    global_load_lds_dwordx4 v5, s[8:9]
    s_add_u32 m0, s11, 91136
    s_nop 0
    global_load_lds_dwordx4 v6, s[8:9]
    s_add_u32 s4, s4, 128
    s_addc_u32 s5, s5, 0
    s_add_u32 s6, s6, 786432
    s_addc_u32 s7, s7, 0
    s_add_u32 s8, s8, 786432
    s_addc_u32 s9, s9, 0
    s_waitcnt lgkmcnt(6)
    v_mfma_f32_32x32x16_bf16 v[64:79], v[24:27], v[16:19], v[64:79]
    v_mfma_f32_32x32x16_bf16 v[80:95], v[28:31], v[16:19], v[80:95]
    v_mfma_f32_32x32x16_bf16 v[96:111], v[24:27], v[20:23], v[96:111]
    v_mfma_f32_32x32x16_bf16 v[112:127], v[28:31], v[20:23], v[112:127]
    ds_read_b128 v[16:19], v10 offset:0
    ds_read_b128 v[20:23], v10 offset:4096
    ds_read_b64_tr_b16 v[24:25], v12 offset:4096
    ds_read_b64_tr_b16 v[26:27], v12 offset:4608
    ds_read_b64_tr_b16 v[28:29], v13 offset:4096
    ds_read_b64_tr_b16 v[30:31], v13 offset:4608
    s_waitcnt lgkmcnt(6)
    v_mfma_f32_32x32x16_bf16 v[64:79], v[40:43], v[32:35], v[64:79]
    v_mfma_f32_32x32x16_bf16 v[80:95], v[44:47], v[32:35], v[80:95]
    v_mfma_f32_32x32x16_bf16 v[96:111], v[40:43], v[36:39], v[96:111]
    v_mfma_f32_32x32x16_bf16 v[112:127], v[44:47], v[36:39], v[112:127]
    ds_read_b128 v[32:35], v11 offset:0
    ds_read_b128 v[36:39], v11 offset:4096
    ds_read_b64_tr_b16 v[40:41], v12 offset:6144
    ds_read_b64_tr_b16 v[42:43], v12 offset:6656
    ds_read_b64_tr_b16 v[44:45], v13 offset:6144
    ds_read_b64_tr_b16 v[46:47], v13 offset:6656
    s_waitcnt lgkmcnt(6)
    v_mfma_f32_32x32x16_bf16 v[64:79], v[24:27], v[16:19], v[64:79]
    v_mfma_f32_32x32x16_bf16 v[80:95], v[28:31], v[16:19], v[80:95]
    v_mfma_f32_32x32x16_bf16 v[96:111], v[24:27], v[20:23], v[96:111]
    v_mfma_f32_32x32x16_bf16 v[112:127], v[28:31], v[20:23], v[112:127]
    s_waitcnt lgkmcnt(0)
    v_mfma_f32_32x32x16_bf16 v[64:79], v[40:43], v[32:35], v[64:79]
    v_mfma_f32_32x32x16_bf16 v[80:95], v[44:47], v[32:35], v[80:95]
    v_mfma_f32_32x32x16_bf16 v[96:111], v[40:43], v[36:39], v[96:111]
    v_mfma_f32_32x32x16_bf16 v[112:127], v[44:47], v[36:39], v[112:127]
    s_waitcnt vmcnt(8)
    s_barrier
    ds_read_b128 v[16:19], v8 offset:32768
    ds_read_b128 v[20:23], v8 offset:36864
    ds_read_b64_tr_b16 v[24:25], v12 offset:32768
    ds_read_b64_tr_b16 v[26:27], v12 offset:33280
    ds_read_b64_tr_b16 v[28:29], v13 offset:32768
    ds_read_b64_tr_b16 v[30:31], v13 offset:33280
    ds_read_b128 v[32:35], v9 offset:32768
    ds_read_b128 v[36:39], v9 offset:36864
    ds_read_b64_tr_b16 v[40:41], v12 offset:34816
    ds_read_b64_tr_b16 v[42:43], v12 offset:35328
    ds_read_b64_tr_b16 v[44:45], v13 offset:34816
    ds_read_b64_tr_b16 v[46:47], v13 offset:35328
    s_add_u32 m0, s10, 0
    s_nop 0
    global_load_lds_dwordx4 v1, s[4:5]
    s_add_u32 m0, s10, 1024
    s_nop 0
    global_load_lds_dwordx4 v2, s[4:5]
    s_add_u32 m0, s10, 2048
    s_nop 0
    global_load_lds_dwordx4 v3, s[4:5]
    s_add_u32 m0, s10, 3072
    s_nop 0
    global_load_lds_dwordx4 v4, s[4:5]
    s_add_u32 m0, s11, 16384
    s_nop 0
    global_load_lds_dwordx4 v5, s[6:7]
    s_add_u32 m0, s11, 17408
    s_nop 0
    global_load_lds_dwordx4 v6, s[6:7]
    s_add_u32 m0, s11, 24576
    s_nop 0
    global_load_lds_dwordx4 v5, s[8:9]
    s_add_u32 m0, s11, 25600
    s_nop 0
    global_load_lds_dwordx4 v6, s[8:9]
    s_add_u32 s4, s4, 128
    s_addc_u32 s5, s5, 0
    s_add_u32 s6, s6, 786432
    s_addc_u32 s7, s7, 0
    s_add_u32 s8, s8, 786432
    s_addc_u32 s9, s9, 0
    s_waitcnt lgkmcnt(6)
    v_mfma_f32_32x32x16_bf16 v[64:79], v[24:27], v[16:19], v[64:79]
    v_mfma_f32_32x32x16_bf16 v[80:95], v[28:31], v[16:19], v[80:95]
    v_mfma_f32_32x32x16_bf16 v[96:111], v[24:27], v[20:23], v[96:111]
    v_mfma_f32_32x32x16_bf16 v[112:127], v[28:31], v[20:23], v[112:127]
    ds_read_b128 v[16:19], v10 offset:32768
    ds_read_b128 v[20:23], v10 offset:36864
    ds_read_b64_tr_b16 v[24:25], v12 offset:36864
    ds_read_b64_tr_b16 v[26:27], v12 offset:37376
    ds_read_b64_tr_b16 v[28:29], v13 offset:36864
    ds_read_b64_tr_b16 v[30:31], v13 offset:37376
    s_waitcnt lgkmcnt(6)
    v_mfma_f32_32x32x16_bf16 v[64:79], v[40:43], v[32:35], v[64:79]
    v_mfma_f32_32x32x16_bf16 v[80:95], v[44:47], v[32:35], v[80:95]
    v_mfma_f32_32x32x16_bf16 v[96:111], v[40:43], v[36:39], v[96:111]
    v_mfma_f32_32x32x16_bf16 v[112:127], v[44:47], v[36:39], v[112:127]
    ds_read_b128 v[32:35], v11 offset:32768
    ds_read_b128 v[36:39], v11 offset:36864
    ds_read_b64_tr_b16 v[40:41], v12 offset:38912
    ds_read_b64_tr_b16 v[42:43], v12 offset:39424
    ds_read_b64_tr_b16 v[44:45], v13 offset:38912
    ds_read_b64_tr_b16 v[46:47], v13 offset:39424
    s_waitcnt lgkmcnt(6)
    v_mfma_f32_32x32x16_bf16 v[64:79], v[24:27], v[16:19], v[64:79]
    v_mfma_f32_32x32x16_bf16 v[80:95], v[28:31], v[16:19], v[80:95]
    v_mfma_f32_32x32x16_bf16 v[96:111], v[24:27], v[20:23], v[96:111]
    v_mfma_f32_32x32x16_bf16 v[112:127], v[28:31], v[20:23], v[112:127]
    s_waitcnt lgkmcnt(0)
    v_mfma_f32_32x32x16_bf16 v[64:79], v[40:43], v[32:35], v[64:79]
    v_mfma_f32_32x32x16_bf16 v[80:95], v[44:47], v[32:35], v[80:95]
    v_mfma_f32_32x32x16_bf16 v[96:111], v[40:43], v[36:39], v[96:111]
    v_mfma_f32_32x32x16_bf16 v[112:127], v[44:47], v[36:39], v[112:127]
    s_waitcnt vmcnt(8)
    s_barrier
    ds_read_b128 v[16:19], v128 offset:0
    ds_read_b128 v[20:23], v128 offset:4096
    ds_read_b64_tr_b16 v[24:25], v132 offset:0
    ds_read_b64_tr_b16 v[26:27], v132 offset:512
    ds_read_b64_tr_b16 v[28:29], v133 offset:0
    ds_read_b64_tr_b16 v[30:31], v133 offset:512
    ds_read_b128 v[32:35], v129 offset:0
    ds_read_b128 v[36:39], v129 offset:4096
    ds_read_b64_tr_b16 v[40:41], v132 offset:2048
    ds_read_b64_tr_b16 v[42:43], v132 offset:2560
    ds_read_b64_tr_b16 v[44:45], v133 offset:2048
    ds_read_b64_tr_b16 v[46:47], v133 offset:2560
    s_add_u32 m0, s10, 32768
    s_nop 0
    global_load_lds_dwordx4 v1, s[4:5]
    s_add_u32 m0, s10, 33792
    s_nop 0
    global_load_lds_dwordx4 v2, s[4:5]
    s_add_u32 m0, s10, 34816
    s_nop 0
    global_load_lds_dwordx4 v3, s[4:5]
    s_add_u32 m0, s10, 35840
    s_nop 0
    global_load_lds_dwordx4 v4, s[4:5]
    s_add_u32 m0, s11, 49152
    s_nop 0
    global_load_lds_dwordx4 v5, s[6:7]
    s_add_u32 m0, s11, 50176
    s_nop 0
    global_load_lds_dwordx4 v6, s[6:7]
    s_add_u32 m0, s11, 57344
    s_nop 0
    global_load_lds_dwordx4 v5, s[8:9]
    s_add_u32 m0, s11, 58368
    s_nop 0
    global_load_lds_dwordx4 v6, s[8:9]
    s_add_u32 s4, s4, 128
    s_addc_u32 s5, s5, 0
    s_add_u32 s6, s6, 786432
    s_addc_u32 s7, s7, 0
    s_add_u32 s8, s8, 786432
    s_addc_u32 s9, s9, 0
    s_waitcnt lgkmcnt(6)
    v_mfma_f32_32x32x16_bf16 v[64:79], v[24:27], v[16:19], v[64:79]
    v_mfma_f32_32x32x16_bf16 v[80:95], v[28:31], v[16:19], v[80:95]
    v_mfma_f32_32x32x16_bf16 v[96:111], v[24:27], v[20:23], v[96:111]
    v_mfma_f32_32x32x16_bf16 v[112:127], v[28:31], v[20:23], v[112:127]
    ds_read_b128 v[16:19], v130 offset:0
    ds_read_b128 v[20:23], v130 offset:4096
    ds_read_b64_tr_b16 v[24:25], v132 offset:4096
    ds_read_b64_tr_b16 v[26:27], v132 offset:4608
    ds_read_b64_tr_b16 v[28:29], v133 offset:4096
    ds_read_b64_tr_b16 v[30:31], v133 offset:4608
    s_waitcnt lgkmcnt(6)
    v_mfma_f32_32x32x16_bf16 v[64:79], v[40:43], v[32:35], v[64:79]
    v_mfma_f32_32x32x16_bf16 v[80:95], v[44:47], v[32:35], v[80:95]
    v_mfma_f32_32x32x16_bf16 v[96:111], v[40:43], v[36:39], v[96:111]
    v_mfma_f32_32x32x16_bf16 v[112:127], v[44:47], v[36:39], v[112:127]
    ds_read_b128 v[32:35], v131 offset:0
    ds_read_b128 v[36:39], v131 offset:4096
    ds_read_b64_tr_b16 v[40:41], v132 offset:6144
    ds_read_b64_tr_b16 v[42:43], v132 offset:6656
    ds_read_b64_tr_b16 v[44:45], v133 offset:6144
    ds_read_b64_tr_b16 v[46:47], v133 offset:6656
    s_waitcnt lgkmcnt(6)
    v_mfma_f32_32x32x16_bf16 v[64:79], v[24:27], v[16:19], v[64:79]
    v_mfma_f32_32x32x16_bf16 v[80:95], v[28:31], v[16:19], v[80:95]
    v_mfma_f32_32x32x16_bf16 v[96:111], v[24:27], v[20:23], v[96:111]
    v_mfma_f32_32x32x16_bf16 v[112:127], v[28:31], v[20:23], v[112:127]
    s_waitcnt lgkmcnt(0)
    v_mfma_f32_32x32x16_bf16 v[64:79], v[40:43], v[32:35], v[64:79]
    v_mfma_f32_32x32x16_bf16 v[80:95], v[44:47], v[32:35], v[80:95]
    v_mfma_f32_32x32x16_bf16 v[96:111], v[40:43], v[36:39], v[96:111]
    v_mfma_f32_32x32x16_bf16 v[112:127], v[44:47], v[36:39], v[112:127]
    s_waitcnt vmcnt(8)
    s_barrier
    ds_read_b128 v[16:19], v8 offset:0
    ds_read_b128 v[20:23], v8 offset:4096
    ds_read_b64_tr_b16 v[24:25], v12 offset:0
    ds_read_b64_tr_b16 v[26:27], v12 offset:512
    ds_read_b64_tr_b16 v[28:29], v13 offset:0
    ds_read_b64_tr_b16 v[30:31], v13 offset:512
    ds_read_b128 v[32:35], v9 offset:0
    ds_read_b128 v[36:39], v9 offset:4096
    ds_read_b64_tr_b16 v[40:41], v12 offset:2048
    ds_read_b64_tr_b16 v[42:43], v12 offset:2560
    ds_read_b64_tr_b16 v[44:45], v13 offset:2048
    ds_read_b64_tr_b16 v[46:47], v13 offset:2560
    s_add_u32 m0, s10, 65536
    s_nop 0
    global_load_lds_dwordx4 v1, s[4:5]
    s_add_u32 m0, s10, 66560
    s_nop 0
    global_load_lds_dwordx4 v2, s[4:5]
    s_add_u32 m0, s10, 67584
    s_nop 0
    global_load_lds_dwordx4 v3, s[4:5]
    s_add_u32 m0, s10, 68608
    s_nop 0
    global_load_lds_dwordx4 v4, s[4:5]
    s_add_u32 m0, s11, 81920
    s_nop 0
    global_load_lds_dwordx4 v5, s[6:7]
    s_add_u32 m0, s11, 82944
    s_nop 0
    global_load_lds_dwordx4 v6, s[6:7]
    s_add_u32 m0, s11, 90112
    s_nop 0
    global_load_lds_dwordx4 v5, s[8:9]
    s_add_u32 m0, s11, 91136
    s_nop 0
    global_load_lds_dwordx4 v6, s[8:9]
    s_add_u32 s4, s4, 128
    s_addc_u32 s5, s5, 0
    s_add_u32 s6, s6, 786432
    s_addc_u32 s7, s7, 0
    s_add_u32 s8, s8, 786432
    s_addc_u32 s9, s9, 0
    s_waitcnt lgkmcnt(6)
    v_mfma_f32_32x32x16_bf16 v[64:79], v[24:27], v[16:19], v[64:79]
    v_mfma_f32_32x32x16_bf16 v[80:95], v[28:31], v[16:19], v[80:95]
    v_mfma_f32_32x32x16_bf16 v[96:111], v[24:27], v[20:23], v[96:111]
    v_mfma_f32_32x32x16_bf16 v[112:127], v[28:31], v[20:23], v[112:127]
    ds_read_b128 v[16:19], v10 offset:0
    ds_read_b128 v[20:23], v10 offset:4096
    ds_read_b64_tr_b16 v[24:25], v12 offset:4096
    ds_read_b64_tr_b16 v[26:27], v12 offset:4608
    ds_read_b64_tr_b16 v[28:29], v13 offset:4096
    ds_read_b64_tr_b16 v[30:31], v13 offset:4608
    s_waitcnt lgkmcnt(6)
    v_mfma_f32_32x32x16_bf16 v[64:79], v[40:43], v[32:35], v[64:79]
    v_mfma_f32_32x32x16_bf16 v[80:95], v[44:47], v[32:35], v[80:95]
    v_mfma_f32_32x32x16_bf16 v[96:111], v[40:43], v[36:39], v[96:111]
    v_mfma_f32_32x32x16_bf16 v[112:127], v[44:47], v[36:39], v[112:127]
    ds_read_b128 v[32:35], v11 offset:0
    ds_read_b128 v[36:39], v11 offset:4096
    ds_read_b64_tr_b16 v[40:41], v12 offset:6144
    ds_read_b64_tr_b16 v[42:43], v12 offset:6656
    ds_read_b64_tr_b16 v[44:45], v13 offset:6144
    ds_read_b64_tr_b16 v[46:47], v13 offset:6656
    s_waitcnt lgkmcnt(6)
    v_mfma_f32_32x32x16_bf16 v[64:79], v[24:27], v[16:19], v[64:79]
    v_mfma_f32_32x32x16_bf16 v[80:95], v[28:31], v[16:19], v[80:95]
    v_mfma_f32_32x32x16_bf16 v[96:111], v[24:27], v[20:23], v[96:111]
    v_mfma_f32_32x32x16_bf16 v[112:127], v[28:31], v[20:23], v[112:127]
    s_waitcnt lgkmcnt(0)
    v_mfma_f32_32x32x16_bf16 v[64:79], v[40:43], v[32:35], v[64:79]
    v_mfma_f32_32x32x16_bf16 v[80:95], v[44:47], v[32:35], v[80:95]
    v_mfma_f32_32x32x16_bf16 v[96:111], v[40:43], v[36:39], v[96:111]
    v_mfma_f32_32x32x16_bf16 v[112:127], v[44:47], v[36:39], v[112:127]
    s_waitcnt vmcnt(8)
    s_barrier
    ds_read_b128 v[16:19], v8 offset:32768
    ds_read_b128 v[20:23], v8 offset:36864
    ds_read_b64_tr_b16 v[24:25], v12 offset:32768
    ds_read_b64_tr_b16 v[26:27], v12 offset:33280
    ds_read_b64_tr_b16 v[28:29], v13 offset:32768
    ds_read_b64_tr_b16 v[30:31], v13 offset:33280
    ds_read_b128 v[32:35], v9 offset:32768
    ds_read_b128 v[36:39], v9 offset:36864
    ds_read_b64_tr_b16 v[40:41], v12 offset:34816
    ds_read_b64_tr_b16 v[42:43], v12 offset:35328
    ds_read_b64_tr_b16 v[44:45], v13 offset:34816
    ds_read_b64_tr_b16 v[46:47], v13 offset:35328
    s_add_u32 m0, s10, 0
    s_nop 0
    global_load_lds_dwordx4 v1, s[4:5]
    s_add_u32 m0, s10, 1024
    s_nop 0
    global_load_lds_dwordx4 v2, s[4:5]
    s_add_u32 m0, s10, 2048
    s_nop 0
    global_load_lds_dwordx4 v3, s[4:5]
    s_add_u32 m0, s10, 3072
    s_nop 0
    global_load_lds_dwordx4 v4, s[4:5]
    s_add_u32 m0, s11, 16384
    s_nop 0
    global_load_lds_dwordx4 v5, s[6:7]
    s_add_u32 m0, s11, 17408
    s_nop 0
    global_load_lds_dwordx4 v6, s[6:7]
    s_add_u32 m0, s11, 24576
    s_nop 0
    global_load_lds_dwordx4 v5, s[8:9]
    s_add_u32 m0, s11, 25600
    s_nop 0
    global_load_lds_dwordx4 v6, s[8:9]
    s_add_u32 s4, s4, 128
    s_addc_u32 s5, s5, 0
    s_add_u32 s6, s6, 786432
    s_addc_u32 s7, s7, 0
    s_add_u32 s8, s8, 786432
    s_addc_u32 s9, s9, 0
    s_waitcnt lgkmcnt(6)
    v_mfma_f32_32x32x16_bf16 v[64:79], v[24:27], v[16:19], v[64:79]
    v_mfma_f32_32x32x16_bf16 v[80:95], v[28:31], v[16:19], v[80:95]
    v_mfma_f32_32x32x16_bf16 v[96:111], v[24:27], v[20:23], v[96:111]
    v_mfma_f32_32x32x16_bf16 v[112:127], v[28:31], v[20:23], v[112:127]
    ds_read_b128 v[16:19], v10 offset:32768
    ds_read_b128 v[20:23], v10 offset:36864
    ds_read_b64_tr_b16 v[24:25], v12 offset:36864
    ds_read_b64_tr_b16 v[26:27], v12 offset:37376
    ds_read_b64_tr_b16 v[28:29], v13 offset:36864
    ds_read_b64_tr_b16 v[30:31], v13 offset:37376
    s_waitcnt lgkmcnt(6)
    v_mfma_f32_32x32x16_bf16 v[64:79], v[40:43], v[32:35], v[64:79]
    v_mfma_f32_32x32x16_bf16 v[80:95], v[44:47], v[32:35], v[80:95]
    v_mfma_f32_32x32x16_bf16 v[96:111], v[40:43], v[36:39], v[96:111]
    v_mfma_f32_32x32x16_bf16 v[112:127], v[44:47], v[36:39], v[112:127]
    ds_read_b128 v[32:35], v11 offset:32768
    ds_read_b128 v[36:39], v11 offset:36864
    ds_read_b64_tr_b16 v[40:41], v12 offset:38912
    ds_read_b64_tr_b16 v[42:43], v12 offset:39424
    ds_read_b64_tr_b16 v[44:45], v13 offset:38912
    ds_read_b64_tr_b16 v[46:47], v13 offset:39424
    s_waitcnt lgkmcnt(6)
    v_mfma_f32_32x32x16_bf16 v[64:79], v[24:27], v[16:19], v[64:79]
    v_mfma_f32_32x32x16_bf16 v[80:95], v[28:31], v[16:19], v[80:95]
    v_mfma_f32_32x32x16_bf16 v[96:111], v[24:27], v[20:23], v[96:111]
    v_mfma_f32_32x32x16_bf16 v[112:127], v[28:31], v[20:23], v[112:127]
    s_waitcnt lgkmcnt(0)
    v_mfma_f32_32x32x16_bf16 v[64:79], v[40:43], v[32:35], v[64:79]
    v_mfma_f32_32x32x16_bf16 v[80:95], v[44:47], v[32:35], v[80:95]
    v_mfma_f32_32x32x16_bf16 v[96:111], v[40:43], v[36:39], v[96:111]
    v_mfma_f32_32x32x16_bf16 v[112:127], v[44:47], v[36:39], v[112:127]
    s_waitcnt vmcnt(8)
    s_barrier
    ds_read_b128 v[16:19], v128 offset:0
    ds_read_b128 v[20:23], v128 offset:4096
    ds_read_b64_tr_b16 v[24:25], v132 offset:0
    ds_read_b64_tr_b16 v[26:27], v132 offset:512
    ds_read_b64_tr_b16 v[28:29], v133 offset:0
    ds_read_b64_tr_b16 v[30:31], v133 offset:512
    ds_read_b128 v[32:35], v129 offset:0
    ds_read_b128 v[36:39], v129 offset:4096
    ds_read_b64_tr_b16 v[40:41], v132 offset:2048
    ds_read_b64_tr_b16 v[42:43], v132 offset:2560
    ds_read_b64_tr_b16 v[44:45], v133 offset:2048
    ds_read_b64_tr_b16 v[46:47], v133 offset:2560
    s_add_u32 m0, s10, 32768
    s_nop 0
    global_load_lds_dwordx4 v1, s[4:5]
    s_add_u32 m0, s10, 33792
    s_nop 0
    global_load_lds_dwordx4 v2, s[4:5]
    s_add_u32 m0, s10, 34816
    s_nop 0
    global_load_lds_dwordx4 v3, s[4:5]
    s_add_u32 m0, s10, 35840
    s_nop 0
    global_load_lds_dwordx4 v4, s[4:5]
    s_add_u32 m0, s11, 49152
    s_nop 0
    global_load_lds_dwordx4 v5, s[6:7]
    s_add_u32 m0, s11, 50176
    s_nop 0
    global_load_lds_dwordx4 v6, s[6:7]
    s_add_u32 m0, s11, 57344
    s_nop 0
    global_load_lds_dwordx4 v5, s[8:9]
    s_add_u32 m0, s11, 58368
    s_nop 0
    global_load_lds_dwordx4 v6, s[8:9]
    s_add_u32 s4, s4, 128
    s_addc_u32 s5, s5, 0
    s_add_u32 s6, s6, 786432
    s_addc_u32 s7, s7, 0
    s_add_u32 s8, s8, 786432
    s_addc_u32 s9, s9, 0
    s_waitcnt lgkmcnt(6)
    v_mfma_f32_32x32x16_bf16 v[64:79], v[24:27], v[16:19], v[64:79]
    v_mfma_f32_32x32x16_bf16 v[80:95], v[28:31], v[16:19], v[80:95]
    v_mfma_f32_32x32x16_bf16 v[96:111], v[24:27], v[20:23], v[96:111]
    v_mfma_f32_32x32x16_bf16 v[112:127], v[28:31], v[20:23], v[112:127]
    ds_read_b128 v[16:19], v130 offset:0
    ds_read_b128 v[20:23], v130 offset:4096
    ds_read_b64_tr_b16 v[24:25], v132 offset:4096
    ds_read_b64_tr_b16 v[26:27], v132 offset:4608
    ds_read_b64_tr_b16 v[28:29], v133 offset:4096
    ds_read_b64_tr_b16 v[30:31], v133 offset:4608
    s_waitcnt lgkmcnt(6)
    v_mfma_f32_32x32x16_bf16 v[64:79], v[40:43], v[32:35], v[64:79]
    v_mfma_f32_32x32x16_bf16 v[80:95], v[44:47], v[32:35], v[80:95]
    v_mfma_f32_32x32x16_bf16 v[96:111], v[40:43], v[36:39], v[96:111]
    v_mfma_f32_32x32x16_bf16 v[112:127], v[44:47], v[36:39], v[112:127]
    ds_read_b128 v[32:35], v131 offset:0
    ds_read_b128 v[36:39], v131 offset:4096
    ds_read_b64_tr_b16 v[40:41], v132 offset:6144
    ds_read_b64_tr_b16 v[42:43], v132 offset:6656
    ds_read_b64_tr_b16 v[44:45], v133 offset:6144
    ds_read_b64_tr_b16 v[46:47], v133 offset:6656
    s_waitcnt lgkmcnt(6)
    v_mfma_f32_32x32x16_bf16 v[64:79], v[24:27], v[16:19], v[64:79]
    v_mfma_f32_32x32x16_bf16 v[80:95], v[28:31], v[16:19], v[80:95]
    v_mfma_f32_32x32x16_bf16 v[96:111], v[24:27], v[20:23], v[96:111]
    v_mfma_f32_32x32x16_bf16 v[112:127], v[28:31], v[20:23], v[112:127]
    s_waitcnt lgkmcnt(0)
    v_mfma_f32_32x32x16_bf16 v[64:79], v[40:43], v[32:35], v[64:79]
    v_mfma_f32_32x32x16_bf16 v[80:95], v[44:47], v[32:35], v[80:95]
    v_mfma_f32_32x32x16_bf16 v[96:111], v[40:43], v[36:39], v[96:111]
    v_mfma_f32_32x32x16_bf16 v[112:127], v[44:47], v[36:39], v[112:127]
    s_waitcnt vmcnt(8)
    s_barrier
    ds_read_b128 v[16:19], v8 offset:0
    ds_read_b128 v[20:23], v8 offset:4096
    ds_read_b64_tr_b16 v[24:25], v12 offset:0
    ds_read_b64_tr_b16 v[26:27], v12 offset:512
    ds_read_b64_tr_b16 v[28:29], v13 offset:0
    ds_read_b64_tr_b16 v[30:31], v13 offset:512
    ds_read_b128 v[32:35], v9 offset:0
    ds_read_b128 v[36:39], v9 offset:4096
    ds_read_b64_tr_b16 v[40:41], v12 offset:2048
    ds_read_b64_tr_b16 v[42:43], v12 offset:2560
    ds_read_b64_tr_b16 v[44:45], v13 offset:2048
    ds_read_b64_tr_b16 v[46:47], v13 offset:2560
    s_add_u32 m0, s10, 65536
    s_nop 0
    global_load_lds_dwordx4 v1, s[4:5]
    s_add_u32 m0, s10, 66560
    s_nop 0
    global_load_lds_dwordx4 v2, s[4:5]
    s_add_u32 m0, s10, 67584
    s_nop 0
    global_load_lds_dwordx4 v3, s[4:5]
    s_add_u32 m0, s10, 68608
    s_nop 0
    global_load_lds_dwordx4 v4, s[4:5]
    s_add_u32 m0, s11, 81920
    s_nop 0
    global_load_lds_dwordx4 v5, s[6:7]
    s_add_u32 m0, s11, 82944
    s_nop 0
    global_load_lds_dwordx4 v6, s[6:7]
    s_add_u32 m0, s11, 90112
    s_nop 0
    global_load_lds_dwordx4 v5, s[8:9]
    s_add_u32 m0, s11, 91136
    s_nop 0
    global_load_lds_dwordx4 v6, s[8:9]
    s_add_u32 s4, s4, 128
    s_addc_u32 s5, s5, 0
    s_add_u32 s6, s6, 786432
    s_addc_u32 s7, s7, 0
    s_add_u32 s8, s8, 786432
    s_addc_u32 s9, s9, 0
    s_waitcnt lgkmcnt(6)
    v_mfma_f32_32x32x16_bf16 v[64:79], v[24:27], v[16:19], v[64:79]
    v_mfma_f32_32x32x16_bf16 v[80:95], v[28:31], v[16:19], v[80:95]
    v_mfma_f32_32x32x16_bf16 v[96:111], v[24:27], v[20:23], v[96:111]
    v_mfma_f32_32x32x16_bf16 v[112:127], v[28:31], v[20:23], v[112:127]
    ds_read_b128 v[16:19], v10 offset:0
    ds_read_b128 v[20:23], v10 offset:4096
    ds_read_b64_tr_b16 v[24:25], v12 offset:4096
    ds_read_b64_tr_b16 v[26:27], v12 offset:4608
    ds_read_b64_tr_b16 v[28:29], v13 offset:4096
    ds_read_b64_tr_b16 v[30:31], v13 offset:4608
    s_waitcnt lgkmcnt(6)
    v_mfma_f32_32x32x16_bf16 v[64:79], v[40:43], v[32:35], v[64:79]
    v_mfma_f32_32x32x16_bf16 v[80:95], v[44:47], v[32:35], v[80:95]
    v_mfma_f32_32x32x16_bf16 v[96:111], v[40:43], v[36:39], v[96:111]
    v_mfma_f32_32x32x16_bf16 v[112:127], v[44:47], v[36:39], v[112:127]
    ds_read_b128 v[32:35], v11 offset:0
    ds_read_b128 v[36:39], v11 offset:4096
    ds_read_b64_tr_b16 v[40:41], v12 offset:6144
    ds_read_b64_tr_b16 v[42:43], v12 offset:6656
    ds_read_b64_tr_b16 v[44:45], v13 offset:6144
    ds_read_b64_tr_b16 v[46:47], v13 offset:6656
    s_waitcnt lgkmcnt(6)
    v_mfma_f32_32x32x16_bf16 v[64:79], v[24:27], v[16:19], v[64:79]
    v_mfma_f32_32x32x16_bf16 v[80:95], v[28:31], v[16:19], v[80:95]
    v_mfma_f32_32x32x16_bf16 v[96:111], v[24:27], v[20:23], v[96:111]
    v_mfma_f32_32x32x16_bf16 v[112:127], v[28:31], v[20:23], v[112:127]
    s_waitcnt lgkmcnt(0)
    v_mfma_f32_32x32x16_bf16 v[64:79], v[40:43], v[32:35], v[64:79]
    v_mfma_f32_32x32x16_bf16 v[80:95], v[44:47], v[32:35], v[80:95]
    v_mfma_f32_32x32x16_bf16 v[96:111], v[40:43], v[36:39], v[96:111]
    v_mfma_f32_32x32x16_bf16 v[112:127], v[44:47], v[36:39], v[112:127]
    s_waitcnt vmcnt(8)
    s_barrier
    ds_read_b128 v[16:19], v8 offset:32768
    ds_read_b128 v[20:23], v8 offset:36864
    ds_read_b64_tr_b16 v[24:25], v12 offset:32768
    ds_read_b64_tr_b16 v[26:27], v12 offset:33280
    ds_read_b64_tr_b16 v[28:29], v13 offset:32768
    ds_read_b64_tr_b16 v[30:31], v13 offset:33280
    ds_read_b128 v[32:35], v9 offset:32768
    ds_read_b128 v[36:39], v9 offset:36864
    ds_read_b64_tr_b16 v[40:41], v12 offset:34816
    ds_read_b64_tr_b16 v[42:43], v12 offset:35328
    ds_read_b64_tr_b16 v[44:45], v13 offset:34816
    ds_read_b64_tr_b16 v[46:47], v13 offset:35328
    s_add_u32 m0, s10, 0
    s_nop 0
    global_load_lds_dwordx4 v1, s[4:5]
    s_add_u32 m0, s10, 1024
    s_nop 0
    global_load_lds_dwordx4 v2, s[4:5]
    s_add_u32 m0, s10, 2048
    s_nop 0
    global_load_lds_dwordx4 v3, s[4:5]
    s_add_u32 m0, s10, 3072
    s_nop 0
    global_load_lds_dwordx4 v4, s[4:5]
    s_add_u32 m0, s11, 16384
    s_nop 0
    global_load_lds_dwordx4 v5, s[6:7]
    s_add_u32 m0, s11, 17408
    s_nop 0
    global_load_lds_dwordx4 v6, s[6:7]
    s_add_u32 m0, s11, 24576
    s_nop 0
    global_load_lds_dwordx4 v5, s[8:9]
    s_add_u32 m0, s11, 25600
    s_nop 0
    global_load_lds_dwordx4 v6, s[8:9]
    s_add_u32 s4, s4, 128
    s_addc_u32 s5, s5, 0
    s_add_u32 s6, s6, 786432
    s_addc_u32 s7, s7, 0
    s_add_u32 s8, s8, 786432
    s_addc_u32 s9, s9, 0
    s_waitcnt lgkmcnt(6)
    v_mfma_f32_32x32x16_bf16 v[64:79], v[24:27], v[16:19], v[64:79]
    v_mfma_f32_32x32x16_bf16 v[80:95], v[28:31], v[16:19], v[80:95]
    v_mfma_f32_32x32x16_bf16 v[96:111], v[24:27], v[20:23], v[96:111]
    v_mfma_f32_32x32x16_bf16 v[112:127], v[28:31], v[20:23], v[112:127]
    ds_read_b128 v[16:19], v10 offset:32768
    ds_read_b128 v[20:23], v10 offset:36864
    ds_read_b64_tr_b16 v[24:25], v12 offset:36864
    ds_read_b64_tr_b16 v[26:27], v12 offset:37376
    ds_read_b64_tr_b16 v[28:29], v13 offset:36864
    ds_read_b64_tr_b16 v[30:31], v13 offset:37376
    s_waitcnt lgkmcnt(6)
    v_mfma_f32_32x32x16_bf16 v[64:79], v[40:43], v[32:35], v[64:79]
    v_mfma_f32_32x32x16_bf16 v[80:95], v[44:47], v[32:35], v[80:95]
    v_mfma_f32_32x32x16_bf16 v[96:111], v[40:43], v[36:39], v[96:111]
    v_mfma_f32_32x32x16_bf16 v[112:127], v[44:47], v[36:39], v[112:127]
    ds_read_b128 v[32:35], v11 offset:32768
    ds_read_b128 v[36:39], v11 offset:36864
    ds_read_b64_tr_b16 v[40:41], v12 offset:38912
    ds_read_b64_tr_b16 v[42:43], v12 offset:39424
    ds_read_b64_tr_b16 v[44:45], v13 offset:38912
    ds_read_b64_tr_b16 v[46:47], v13 offset:39424
    s_waitcnt lgkmcnt(6)
    v_mfma_f32_32x32x16_bf16 v[64:79], v[24:27], v[16:19], v[64:79]
    v_mfma_f32_32x32x16_bf16 v[80:95], v[28:31], v[16:19], v[80:95]
    v_mfma_f32_32x32x16_bf16 v[96:111], v[24:27], v[20:23], v[96:111]
    v_mfma_f32_32x32x16_bf16 v[112:127], v[28:31], v[20:23], v[112:127]
    s_waitcnt lgkmcnt(0)
    v_mfma_f32_32x32x16_bf16 v[64:79], v[40:43], v[32:35], v[64:79]
    v_mfma_f32_32x32x16_bf16 v[80:95], v[44:47], v[32:35], v[80:95]
    v_mfma_f32_32x32x16_bf16 v[96:111], v[40:43], v[36:39], v[96:111]
    v_mfma_f32_32x32x16_bf16 v[112:127], v[44:47], v[36:39], v[112:127]
    s_waitcnt vmcnt(8)
    s_barrier
    ds_read_b128 v[16:19], v128 offset:0
    ds_read_b128 v[20:23], v128 offset:4096
    ds_read_b64_tr_b16 v[24:25], v132 offset:0
    ds_read_b64_tr_b16 v[26:27], v132 offset:512
    ds_read_b64_tr_b16 v[28:29], v133 offset:0
    ds_read_b64_tr_b16 v[30:31], v133 offset:512
    ds_read_b128 v[32:35], v129 offset:0
    ds_read_b128 v[36:39], v129 offset:4096
    ds_read_b64_tr_b16 v[40:41], v132 offset:2048
    ds_read_b64_tr_b16 v[42:43], v132 offset:2560
    ds_read_b64_tr_b16 v[44:45], v133 offset:2048
    ds_read_b64_tr_b16 v[46:47], v133 offset:2560
    s_waitcnt lgkmcnt(6)
    v_mfma_f32_32x32x16_bf16 v[64:79], v[24:27], v[16:19], v[64:79]
    v_mfma_f32_32x32x16_bf16 v[80:95], v[28:31], v[16:19], v[80:95]
    v_mfma_f32_32x32x16_bf16 v[96:111], v[24:27], v[20:23], v[96:111]
    v_mfma_f32_32x32x16_bf16 v[112:127], v[28:31], v[20:23], v[112:127]
    ds_read_b128 v[16:19], v130 offset:0
    ds_read_b128 v[20:23], v130 offset:4096
    ds_read_b64_tr_b16 v[24:25], v132 offset:4096
    ds_read_b64_tr_b16 v[26:27], v132 offset:4608
    ds_read_b64_tr_b16 v[28:29], v133 offset:4096
    ds_read_b64_tr_b16 v[30:31], v133 offset:4608
    s_waitcnt lgkmcnt(6)
    v_mfma_f32_32x32x16_bf16 v[64:79], v[40:43], v[32:35], v[64:79]
    v_mfma_f32_32x32x16_bf16 v[80:95], v[44:47], v[32:35], v[80:95]
    v_mfma_f32_32x32x16_bf16 v[96:111], v[40:43], v[36:39], v[96:111]
    v_mfma_f32_32x32x16_bf16 v[112:127], v[44:47], v[36:39], v[112:127]
    ds_read_b128 v[32:35], v131 offset:0
    ds_read_b128 v[36:39], v131 offset:4096
    ds_read_b64_tr_b16 v[40:41], v132 offset:6144
    ds_read_b64_tr_b16 v[42:43], v132 offset:6656
    ds_read_b64_tr_b16 v[44:45], v133 offset:6144
    ds_read_b64_tr_b16 v[46:47], v133 offset:6656
    s_waitcnt lgkmcnt(6)
    v_mfma_f32_32x32x16_bf16 v[64:79], v[24:27], v[16:19], v[64:79]
    v_mfma_f32_32x32x16_bf16 v[80:95], v[28:31], v[16:19], v[80:95]
    v_mfma_f32_32x32x16_bf16 v[96:111], v[24:27], v[20:23], v[96:111]
    v_mfma_f32_32x32x16_bf16 v[112:127], v[28:31], v[20:23], v[112:127]
    s_waitcnt lgkmcnt(0)
    v_mfma_f32_32x32x16_bf16 v[64:79], v[40:43], v[32:35], v[64:79]
    v_mfma_f32_32x32x16_bf16 v[80:95], v[44:47], v[32:35], v[80:95]
    v_mfma_f32_32x32x16_bf16 v[96:111], v[40:43], v[36:39], v[96:111]
    v_mfma_f32_32x32x16_bf16 v[112:127], v[44:47], v[36:39], v[112:127]
    s_waitcnt vmcnt(0)
    s_barrier
    ds_read_b128 v[16:19], v8 offset:0
    ds_read_b128 v[20:23], v8 offset:4096
    ds_read_b64_tr_b16 v[24:25], v12 offset:0
    ds_read_b64_tr_b16 v[26:27], v12 offset:512
    ds_read_b64_tr_b16 v[28:29], v13 offset:0
    ds_read_b64_tr_b16 v[30:31], v13 offset:512
    ds_read_b128 v[32:35], v9 offset:0
    ds_read_b128 v[36:39], v9 offset:4096
    ds_read_b64_tr_b16 v[40:41], v12 offset:2048
    ds_read_b64_tr_b16 v[42:43], v12 offset:2560
    ds_read_b64_tr_b16 v[44:45], v13 offset:2048
    ds_read_b64_tr_b16 v[46:47], v13 offset:2560
    s_waitcnt lgkmcnt(6)
    v_mfma_f32_32x32x16_bf16 v[64:79], v[24:27], v[16:19], v[64:79]
    v_mfma_f32_32x32x16_bf16 v[80:95], v[28:31], v[16:19], v[80:95]
    v_mfma_f32_32x32x16_bf16 v[96:111], v[24:27], v[20:23], v[96:111]
    v_mfma_f32_32x32x16_bf16 v[112:127], v[28:31], v[20:23], v[112:127]
    ds_read_b128 v[16:19], v10 offset:0
    ds_read_b128 v[20:23], v10 offset:4096
    ds_read_b64_tr_b16 v[24:25], v12 offset:4096
    ds_read_b64_tr_b16 v[26:27], v12 offset:4608
    ds_read_b64_tr_b16 v[28:29], v13 offset:4096
    ds_read_b64_tr_b16 v[30:31], v13 offset:4608
    s_waitcnt lgkmcnt(6)
    v_mfma_f32_32x32x16_bf16 v[64:79], v[40:43], v[32:35], v[64:79]
    v_mfma_f32_32x32x16_bf16 v[80:95], v[44:47], v[32:35], v[80:95]
    v_mfma_f32_32x32x16_bf16 v[96:111], v[40:43], v[36:39], v[96:111]
    v_mfma_f32_32x32x16_bf16 v[112:127], v[44:47], v[36:39], v[112:127]
    ds_read_b128 v[32:35], v11 offset:0
    ds_read_b128 v[36:39], v11 offset:4096
    ds_read_b64_tr_b16 v[40:41], v12 offset:6144
    ds_read_b64_tr_b16 v[42:43], v12 offset:6656
    ds_read_b64_tr_b16 v[44:45], v13 offset:6144
    ds_read_b64_tr_b16 v[46:47], v13 offset:6656
    s_waitcnt lgkmcnt(6)
    v_mfma_f32_32x32x16_bf16 v[64:79], v[24:27], v[16:19], v[64:79]
    v_mfma_f32_32x32x16_bf16 v[80:95], v[28:31], v[16:19], v[80:95]
    v_mfma_f32_32x32x16_bf16 v[96:111], v[24:27], v[20:23], v[96:111]
    v_mfma_f32_32x32x16_bf16 v[112:127], v[28:31], v[20:23], v[112:127]
    s_waitcnt lgkmcnt(0)
    v_mfma_f32_32x32x16_bf16 v[64:79], v[40:43], v[32:35], v[64:79]
    v_mfma_f32_32x32x16_bf16 v[80:95], v[44:47], v[32:35], v[80:95]
    v_mfma_f32_32x32x16_bf16 v[96:111], v[40:43], v[36:39], v[96:111]
    v_mfma_f32_32x32x16_bf16 v[112:127], v[44:47], v[36:39], v[112:127]
    s_nop 15
    v_and_b32 v48, 63, v0
    v_lshrrev_b32 v49, 6, v0
    v_lshrrev_b32 v53, 1, v49
    v_and_b32 v54, 1, v49
    v_and_b32 v55, 31, v48
    v_lshrrev_b32 v56, 5, v48
    s_mov_b64 s[16:17], s[78:79]
    s_add_u32 s16, s16, 9322496
    s_addc_u32 s17, s17, 0
    s_and_b32 s17, s17, 0xffff
    s_mov_b32 s18, 25165824
    s_mov_b32 s19, 0x00020000
    v_lshlrev_b32 v57, 4, v55
    v_lshlrev_b32 v58, 3, v56
    v_add_u32 v57, v57, v58
    s_mul_i32 s12, s13, 4
    v_mul_u32_u24 v58, 2, v53
    v_add_u32 v58, s12, v58
    v_lshlrev_b32 v58, 5, v58
    s_lshl_b32 s12, s14, 7
    v_lshlrev_b32 v59, 6, v54
    v_add_u32 v59, s12, v59
    v_add_u32 v59, 0, v59
    v_mul_u32_u24 v62, 21846, v59
    v_lshrrev_b32 v62, 22, v62
    v_mul_u32_u24 v63, 192, v62
    v_sub_u32 v63, v59, v63
    v_lshrrev_b32 v63, 3, v63
    v_add_u32 v62, v62, v58
    v_mul_u32_u24 v62, 24, v62
    v_add_u32 v62, v62, v63
    v_lshlrev_b32 v62, 9, v62
    v_add_u32 v4, v62, v57
    s_lshl_b32 s12, s14, 7
    v_lshlrev_b32 v59, 6, v54
    v_add_u32 v59, s12, v59
    v_add_u32 v59, 32, v59
    v_mul_u32_u24 v62, 21846, v59
    v_lshrrev_b32 v62, 22, v62
    v_mul_u32_u24 v63, 192, v62
    v_sub_u32 v63, v59, v63
    v_lshrrev_b32 v63, 3, v63
    v_add_u32 v62, v62, v58
    v_mul_u32_u24 v62, 24, v62
    v_add_u32 v62, v62, v63
    v_lshlrev_b32 v62, 9, v62
    v_add_u32 v5, v62, v57
    s_mov_b32 s12, 0
    v_cvt_pk_bf16_f32 v60, v64, v65
    v_cvt_pk_bf16_f32 v61, v66, v67
    buffer_store_dwordx2 v[60:61], v4, s[16:19], s12 offen offset:0 sc0 sc1
    s_nop 0
    v_cvt_pk_bf16_f32 v60, v68, v69
    v_cvt_pk_bf16_f32 v61, v70, v71
    buffer_store_dwordx2 v[60:61], v4, s[16:19], s12 offen offset:512 sc0 sc1
    s_nop 0
    v_cvt_pk_bf16_f32 v60, v72, v73
    v_cvt_pk_bf16_f32 v61, v74, v75
    buffer_store_dwordx2 v[60:61], v4, s[16:19], s12 offen offset:1024 sc0 sc1
    s_nop 0
    v_cvt_pk_bf16_f32 v60, v76, v77
    v_cvt_pk_bf16_f32 v61, v78, v79
    buffer_store_dwordx2 v[60:61], v4, s[16:19], s12 offen offset:1536 sc0 sc1
    s_nop 0
    s_mov_b32 s12, 0
    v_cvt_pk_bf16_f32 v60, v80, v81
    v_cvt_pk_bf16_f32 v61, v82, v83
    buffer_store_dwordx2 v[60:61], v5, s[16:19], s12 offen offset:0 sc0 sc1
    s_nop 0
    v_cvt_pk_bf16_f32 v60, v84, v85
    v_cvt_pk_bf16_f32 v61, v86, v87
    buffer_store_dwordx2 v[60:61], v5, s[16:19], s12 offen offset:512 sc0 sc1
    s_nop 0
    v_cvt_pk_bf16_f32 v60, v88, v89
    v_cvt_pk_bf16_f32 v61, v90, v91
    buffer_store_dwordx2 v[60:61], v5, s[16:19], s12 offen offset:1024 sc0 sc1
    s_nop 0
    v_cvt_pk_bf16_f32 v60, v92, v93
    v_cvt_pk_bf16_f32 v61, v94, v95
    buffer_store_dwordx2 v[60:61], v5, s[16:19], s12 offen offset:1536 sc0 sc1
    s_nop 0
    s_mov_b32 s12, 393216
    v_cvt_pk_bf16_f32 v60, v96, v97
    v_cvt_pk_bf16_f32 v61, v98, v99
    buffer_store_dwordx2 v[60:61], v4, s[16:19], s12 offen offset:0 sc0 sc1
    s_nop 0
    v_cvt_pk_bf16_f32 v60, v100, v101
    v_cvt_pk_bf16_f32 v61, v102, v103
    buffer_store_dwordx2 v[60:61], v4, s[16:19], s12 offen offset:512 sc0 sc1
    s_nop 0
    v_cvt_pk_bf16_f32 v60, v104, v105
    v_cvt_pk_bf16_f32 v61, v106, v107
    buffer_store_dwordx2 v[60:61], v4, s[16:19], s12 offen offset:1024 sc0 sc1
    s_nop 0
    v_cvt_pk_bf16_f32 v60, v108, v109
    v_cvt_pk_bf16_f32 v61, v110, v111
    buffer_store_dwordx2 v[60:61], v4, s[16:19], s12 offen offset:1536 sc0 sc1
    s_nop 0
    s_mov_b32 s12, 393216
    v_cvt_pk_bf16_f32 v60, v112, v113
    v_cvt_pk_bf16_f32 v61, v114, v115
    buffer_store_dwordx2 v[60:61], v5, s[16:19], s12 offen offset:0 sc0 sc1
    s_nop 0
    v_cvt_pk_bf16_f32 v60, v116, v117
    v_cvt_pk_bf16_f32 v61, v118, v119
    buffer_store_dwordx2 v[60:61], v5, s[16:19], s12 offen offset:512 sc0 sc1
    s_nop 0
    v_cvt_pk_bf16_f32 v60, v120, v121
    v_cvt_pk_bf16_f32 v61, v122, v123
    buffer_store_dwordx2 v[60:61], v5, s[16:19], s12 offen offset:1024 sc0 sc1
    s_nop 0
    v_cvt_pk_bf16_f32 v60, v124, v125
    v_cvt_pk_bf16_f32 v61, v126, v127
    buffer_store_dwordx2 v[60:61], v5, s[16:19], s12 offen offset:1536 sc0 sc1
    s_nop 0
    s_waitcnt vmcnt(0)
    s_barrier
    s_cmp_lg_u32 s94, 0
    s_cbranch_scc1 mega_kernel_sg45
    s_lshl_b32 s93, s92, 7
    s_add_u32 s93, s93, 18432
    v_mov_b32 v1, s93
    v_mov_b32 v2, 1
    s_mov_b64 exec, 1
    buffer_atomic_add v2, v1, s[80:83], 0 offen sc1
    s_mov_b64 exec, -1
mega_kernel_sg45:
mega_kernel_pan35:
    s_add_u32 s91, s91, 128
    s_branch mega_kernel_pa32
mega_kernel_pb36:
    s_cmp_ge_u32 s90, 114
    s_cbranch_scc1 mega_kernel_done1
    s_cmp_ge_u32 s90, 104
    s_cbranch_scc1 mega_kernel_bf249
    s_cmp_ge_u32 s90, 80
    s_cbranch_scc1 mega_kernel_bf148
    s_cmp_ge_u32 s90, 72
    s_cbranch_scc1 mega_kernel_bln47
    s_cmp_ge_u32 s90, 32
    s_cbranch_scc1 mega_kernel_bwo46
    s_mov_b32 s91, 0
mega_kernel_latt50:
    s_cmp_lg_u32 s94, 0
    s_cbranch_scc1 mega_kernel_wd52
    s_lshl_b32 s93, s91, 7
    s_add_u32 s93, s93, 18432
    v_mov_b32 v1, s93
    s_mov_b32 s95, 0
mega_kernel_wl51:
    buffer_load_dword v2, v1, s[80:83], 0 offen sc1
    s_waitcnt vmcnt(0)
    v_cmp_gt_u32 vcc, 48, v2
    s_nop 0
    s_cbranch_vccz mega_kernel_wok53
    s_cmp_ge_u32 s91, 14
    s_cbranch_scc1 mega_kernel_wfast54
    s_sleep 48
mega_kernel_wfast54:
    s_sleep 4
    s_add_u32 s95, s95, 1
    s_cmp_lt_u32 s95, 1000000
    s_cbranch_scc1 mega_kernel_wl51
    s_branch mega_kernel_done1
mega_kernel_wok53:
mega_kernel_wd52:
    s_barrier
    s_cmp_lg_u32 s94, 0
    s_cbranch_scc1 mega_kernel_wd56
    s_lshl_b32 s93, s91, 7
    s_add_u32 s93, s93, 16384
    v_mov_b32 v1, s93
    s_mov_b32 s95, 0
mega_kernel_wl55:
    buffer_load_dword v2, v1, s[80:83], 0 offen sc1
    s_waitcnt vmcnt(0)
    v_cmp_gt_u32 vcc, 96, v2
    s_nop 0
    s_cbranch_vccz mega_kernel_wok57
    s_cmp_ge_u32 s91, 14
    s_cbranch_scc1 mega_kernel_wfast58
    s_sleep 48
mega_kernel_wfast58:
    s_sleep 4
    s_add_u32 s95, s95, 1
    s_cmp_lt_u32 s95, 1000000
    s_cbranch_scc1 mega_kernel_wl55
    s_branch mega_kernel_done1
mega_kernel_wok57:
mega_kernel_wd56:
    s_barrier
    s_lshl_b32 s20, s91, 2
    s_lshr_b32 s21, s90, 3
    s_add_u32 s20, s20, s21
    s_and_b32 s21, s90, 7
    s_mov_b64 s[4:5], s[78:79]
    s_and_b32 s5, s5, 0xffff
    s_mov_b32 s6, 268435456
    s_mov_b32 s7, 0x00020000
    v_and_b32 v1, 63, v0
    v_lshrrev_b32 v2, 6, v0
    v_and_b32 v3, 15, v1
    v_lshrrev_b32 v4, 4, v1
    s_nop 0
    v_readfirstlane_b32 s25, v2
    s_nop 3
    s_lshl_b32 s21, s21, 2
    s_add_u32 s21, s21, s25
    v_lshlrev_b32 v5, 9, v4
    v_lshlrev_b32 v6, 4, v3
    v_add_u32 v5, v5, v6
    s_mul_i32 s23, s20, 32*12288
    s_mul_i32 s22, s21, 12288
    s_add_u32 s22, s22, s23
    s_add_u32 s24, s22, 9322496
    buffer_load_dwordx4 v[16:19], v5, s[4:7], s24 offen offset:0
    buffer_load_dwordx4 v[40:43], v5, s[4:7], s24 offen offset:256
    buffer_load_dwordx4 v[20:23], v5, s[4:7], s24 offen offset:2048
    buffer_load_dwordx4 v[44:47], v5, s[4:7], s24 offen offset:2304
    s_add_u32 s24, s22, 9326592
    buffer_load_dwordx4 v[24:27], v5, s[4:7], s24 offen offset:0
    buffer_load_dwordx4 v[48:51], v5, s[4:7], s24 offen offset:256
    buffer_load_dwordx4 v[28:31], v5, s[4:7], s24 offen offset:2048
    buffer_load_dwordx4 v[52:55], v5, s[4:7], s24 offen offset:2304
    s_add_u32 s24, s22, 9330688
    buffer_load_dwordx4 v[32:35], v5, s[4:7], s24 offen offset:0
    buffer_load_dwordx4 v[56:59], v5, s[4:7], s24 offen offset:256
    buffer_load_dwordx4 v[36:39], v5, s[4:7], s24 offen offset:2048
    buffer_load_dwordx4 v[60:63], v5, s[4:7], s24 offen offset:2304
    s_add_u32 s24, s22, 34488320
    buffer_load_dwordx4 v[64:67], v5, s[4:7], s24 offen offset:0
    buffer_load_dwordx4 v[88:91], v5, s[4:7], s24 offen offset:256
    buffer_load_dwordx4 v[68:71], v5, s[4:7], s24 offen offset:2048
    buffer_load_dwordx4 v[92:95], v5, s[4:7], s24 offen offset:2304
    s_add_u32 s24, s22, 34492416
    buffer_load_dwordx4 v[72:75], v5, s[4:7], s24 offen offset:0
    buffer_load_dwordx4 v[96:99], v5, s[4:7], s24 offen offset:256
    buffer_load_dwordx4 v[76:79], v5, s[4:7], s24 offen offset:2048
    buffer_load_dwordx4 v[100:103], v5, s[4:7], s24 offen offset:2304
    s_add_u32 s24, s22, 34496512
    buffer_load_dwordx4 v[80:83], v5, s[4:7], s24 offen offset:0
    buffer_load_dwordx4 v[104:107], v5, s[4:7], s24 offen offset:256
    buffer_load_dwordx4 v[84:87], v5, s[4:7], s24 offen offset:2048
    buffer_load_dwordx4 v[108:111], v5, s[4:7], s24 offen offset:2304
    v_and_b32 v7, 7, v3
    v_lshlrev_b32 v6, 3, v4
    v_add_u32 v7, v7, v6
    v_lshlrev_b32 v7, 4, v7
    s_lshl_b32 s24, s20, 5
    s_add_u32 s24, s24, s21
    s_mul_i32 s26, s24, 3072
    s_add_u32 s26, s26, 87474176
    s_mov_b32 s28, s26
    v_lshlrev_b32 v8, 6, v3
    v_lshlrev_b32 v9, 3, v4
    v_add_u32 v8, v8, v9
    s_mul_i32 s26, s24, 192*64
    s_add_u32 s26, s26, 59654144
    s_add_u32 s27, s26, 0
    buffer_load_dwordx2 v[176:177], v8, s[4:7], s27 offen
    buffer_load_dwordx2 v[178:179], v8, s[4:7], s27 offen offset:32
    s_add_u32 s27, s26, 1024
    buffer_load_dwordx2 v[180:181], v8, s[4:7], s27 offen
    buffer_load_dwordx2 v[182:183], v8, s[4:7], s27 offen offset:32
    s_add_u32 s27, s26, 2048
    buffer_load_dwordx2 v[184:185], v8, s[4:7], s27 offen
    buffer_load_dwordx2 v[186:187], v8, s[4:7], s27 offen offset:32
    s_add_u32 s27, s26, 3072
    buffer_load_dwordx2 v[188:189], v8, s[4:7], s27 offen
    buffer_load_dwordx2 v[190:191], v8, s[4:7], s27 offen offset:32
    s_add_u32 s27, s26, 4096
    buffer_load_dwordx2 v[192:193], v8, s[4:7], s27 offen
    buffer_load_dwordx2 v[194:195], v8, s[4:7], s27 offen offset:32
    s_add_u32 s27, s26, 5120
    buffer_load_dwordx2 v[196:197], v8, s[4:7], s27 offen
    buffer_load_dwordx2 v[198:199], v8, s[4:7], s27 offen offset:32
    s_add_u32 s27, s26, 6144
    buffer_load_dwordx2 v[200:201], v8, s[4:7], s27 offen
    buffer_load_dwordx2 v[202:203], v8, s[4:7], s27 offen offset:32
    s_add_u32 s27, s26, 7168
    buffer_load_dwordx2 v[204:205], v8, s[4:7], s27 offen
    buffer_load_dwordx2 v[206:207], v8, s[4:7], s27 offen offset:32
    s_add_u32 s27, s26, 8192
    buffer_load_dwordx2 v[208:209], v8, s[4:7], s27 offen
    buffer_load_dwordx2 v[210:211], v8, s[4:7], s27 offen offset:32
    s_add_u32 s27, s26, 9216
    buffer_load_dwordx2 v[212:213], v8, s[4:7], s27 offen
    buffer_load_dwordx2 v[214:215], v8, s[4:7], s27 offen offset:32
    s_add_u32 s27, s26, 10240
    buffer_load_dwordx2 v[216:217], v8, s[4:7], s27 offen
    buffer_load_dwordx2 v[218:219], v8, s[4:7], s27 offen offset:32
    s_add_u32 s27, s26, 11264
    buffer_load_dwordx2 v[220:221], v8, s[4:7], s27 offen
    buffer_load_dwordx2 v[222:223], v8, s[4:7], s27 offen offset:32
    v_lshlrev_b32 v9, 4, v3
    v_and_b32 v10, 1, v4
    v_lshlrev_b32 v10, 3, v10
    v_add_u32 v9, v9, v10
    s_mul_i32 s26, s24, 192*16
    s_add_u32 s26, s26, 93765632
    v_mov_b32 v136, 0
    v_mov_b32 v137, 0
    v_mov_b32 v138, 0
    v_mov_b32 v139, 0
    v_mov_b32 v140, 0
    v_mov_b32 v141, 0
    v_mov_b32 v142, 0
    v_mov_b32 v143, 0
    v_mov_b32 v144, 0
    v_mov_b32 v145, 0
    v_mov_b32 v146, 0
    v_mov_b32 v147, 0
    v_mov_b32 v148, 0
    v_mov_b32 v149, 0
    v_mov_b32 v150, 0
    v_mov_b32 v151, 0
    v_mov_b32 v152, 0
    v_mov_b32 v153, 0
    v_mov_b32 v154, 0
    v_mov_b32 v155, 0
    v_mov_b32 v156, 0
    v_mov_b32 v157, 0
    v_mov_b32 v158, 0
    v_mov_b32 v159, 0
    s_mov_b32 s29, 0
mega_kernel_apoll59:
    buffer_load_dwordx4 v[112:115], v7, s[4:7], s28 offen offset:0 sc0 sc1
    buffer_load_dwordx4 v[116:119], v7, s[4:7], s28 offen offset:512 sc0 sc1
    buffer_load_dwordx4 v[120:123], v7, s[4:7], s28 offen offset:1024 sc0 sc1
    buffer_load_dwordx4 v[124:127], v7, s[4:7], s28 offen offset:1536 sc0 sc1
    buffer_load_dwordx4 v[128:131], v7, s[4:7], s28 offen offset:2048 sc0 sc1
    buffer_load_dwordx4 v[132:135], v7, s[4:7], s28 offen offset:2560 sc0 sc1
    buffer_load_dwordx2 v[224:225], v9, s[4:7], s26 offen offset:0 sc0 sc1
    buffer_load_dwordx2 v[226:227], v9, s[4:7], s26 offen offset:256 sc0 sc1
    buffer_load_dwordx2 v[228:229], v9, s[4:7], s26 offen offset:512 sc0 sc1
    buffer_load_dwordx2 v[230:231], v9, s[4:7], s26 offen offset:768 sc0 sc1
    buffer_load_dwordx2 v[232:233], v9, s[4:7], s26 offen offset:1024 sc0 sc1
    buffer_load_dwordx2 v[234:235], v9, s[4:7], s26 offen offset:1280 sc0 sc1
    buffer_load_dwordx2 v[236:237], v9, s[4:7], s26 offen offset:1536 sc0 sc1
    buffer_load_dwordx2 v[238:239], v9, s[4:7], s26 offen offset:1792 sc0 sc1
    buffer_load_dwordx2 v[240:241], v9, s[4:7], s26 offen offset:2048 sc0 sc1
    buffer_load_dwordx2 v[242:243], v9, s[4:7], s26 offen offset:2304 sc0 sc1
    buffer_load_dwordx2 v[244:245], v9, s[4:7], s26 offen offset:2560 sc0 sc1
    buffer_load_dwordx2 v[246:247], v9, s[4:7], s26 offen offset:2816 sc0 sc1
    s_waitcnt vmcnt(0)
    v_max_u32 v11, v112, v113
    v_max3_u32 v11, v11, v114, v115
    v_max3_u32 v11, v11, v116, v117
    v_max3_u32 v11, v11, v118, v119
    v_max3_u32 v11, v11, v120, v121
    v_max3_u32 v11, v11, v122, v123
    v_max3_u32 v11, v11, v124, v125
    v_max3_u32 v11, v11, v126, v127
    v_max3_u32 v11, v11, v128, v129
    v_max3_u32 v11, v11, v130, v131
    v_max3_u32 v11, v11, v132, v133
    v_max3_u32 v11, v11, v134, v135
    v_max3_u32 v11, v11, v224, v225
    v_max3_u32 v11, v11, v226, v227
    v_max3_u32 v11, v11, v228, v229
    v_max3_u32 v11, v11, v230, v231
    v_max3_u32 v11, v11, v232, v233
    v_max3_u32 v11, v11, v234, v235
    v_max3_u32 v11, v11, v236, v237
    v_max3_u32 v11, v11, v238, v239
    v_max3_u32 v11, v11, v240, v241
    v_max3_u32 v11, v11, v242, v243
    v_max3_u32 v11, v11, v244, v245
    v_max3_u32 v11, v11, v246, v247
    v_cmp_eq_u32 vcc, -1, v11
    s_nop 0
    s_cbranch_vccz mega_kernel_apolld60
    s_cmp_ge_u32 s20, 62
    s_cbranch_scc1 mega_kernel_afast61
    s_sleep 48
mega_kernel_afast61:
    s_sleep 4
    s_add_u32 s29, s29, 1
    s_cmp_lt_u32 s29, 1000000
    s_cbranch_scc1 mega_kernel_apoll59
    s_branch mega_kernel_done1
mega_kernel_apolld60:
    v_mfma_f32_16x16x32_bf16 v[136:139], v[64:67], v[16:19], v[136:139]
    v_mfma_f32_16x16x32_bf16 v[140:143], v[64:67], v[40:43], v[140:143]
    v_mfma_f32_16x16x32_bf16 v[144:147], v[88:91], v[16:19], v[144:147]
    v_mfma_f32_16x16x32_bf16 v[148:151], v[88:91], v[40:43], v[148:151]
    v_mfma_f32_16x16x32_bf16 v[152:155], v[112:115], v[16:19], v[152:155]
    v_mfma_f32_16x16x32_bf16 v[156:159], v[112:115], v[40:43], v[156:159]
    v_mfma_f32_16x16x32_bf16 v[136:139], v[68:71], v[20:23], v[136:139]
    v_mfma_f32_16x16x32_bf16 v[140:143], v[68:71], v[44:47], v[140:143]
    v_mfma_f32_16x16x32_bf16 v[144:147], v[92:95], v[20:23], v[144:147]
    v_mfma_f32_16x16x32_bf16 v[148:151], v[92:95], v[44:47], v[148:151]
    v_mfma_f32_16x16x32_bf16 v[152:155], v[116:119], v[20:23], v[152:155]
    v_mfma_f32_16x16x32_bf16 v[156:159], v[116:119], v[44:47], v[156:159]
    v_mfma_f32_16x16x32_bf16 v[136:139], v[72:75], v[24:27], v[136:139]
    v_mfma_f32_16x16x32_bf16 v[140:143], v[72:75], v[48:51], v[140:143]
    v_mfma_f32_16x16x32_bf16 v[144:147], v[96:99], v[24:27], v[144:147]
    v_mfma_f32_16x16x32_bf16 v[148:151], v[96:99], v[48:51], v[148:151]
    v_mfma_f32_16x16x32_bf16 v[152:155], v[120:123], v[24:27], v[152:155]
    v_mfma_f32_16x16x32_bf16 v[156:159], v[120:123], v[48:51], v[156:159]
    v_mfma_f32_16x16x32_bf16 v[136:139], v[76:79], v[28:31], v[136:139]
    v_mfma_f32_16x16x32_bf16 v[140:143], v[76:79], v[52:55], v[140:143]
    v_mfma_f32_16x16x32_bf16 v[144:147], v[100:103], v[28:31], v[144:147]
    v_mfma_f32_16x16x32_bf16 v[148:151], v[100:103], v[52:55], v[148:151]
    v_mfma_f32_16x16x32_bf16 v[152:155], v[124:127], v[28:31], v[152:155]
    v_mfma_f32_16x16x32_bf16 v[156:159], v[124:127], v[52:55], v[156:159]
    v_mfma_f32_16x16x32_bf16 v[136:139], v[80:83], v[32:35], v[136:139]
    v_mfma_f32_16x16x32_bf16 v[140:143], v[80:83], v[56:59], v[140:143]
    v_mfma_f32_16x16x32_bf16 v[144:147], v[104:107], v[32:35], v[144:147]
    v_mfma_f32_16x16x32_bf16 v[148:151], v[104:107], v[56:59], v[148:151]
    v_mfma_f32_16x16x32_bf16 v[152:155], v[128:131], v[32:35], v[152:155]
    v_mfma_f32_16x16x32_bf16 v[156:159], v[128:131], v[56:59], v[156:159]
    v_mfma_f32_16x16x32_bf16 v[136:139], v[84:87], v[36:39], v[136:139]
    v_mfma_f32_16x16x32_bf16 v[140:143], v[84:87], v[60:63], v[140:143]
    v_mfma_f32_16x16x32_bf16 v[144:147], v[108:111], v[36:39], v[144:147]
    v_mfma_f32_16x16x32_bf16 v[148:151], v[108:111], v[60:63], v[148:151]
    v_mfma_f32_16x16x32_bf16 v[152:155], v[132:135], v[36:39], v[152:155]
    v_mfma_f32_16x16x32_bf16 v[156:159], v[132:135], v[60:63], v[156:159]
    s_nop 7
    v_cvt_pk_bf16_f32 v136, v136, v136
    v_and_b32 v136, 0xffff0000, v136
    v_mul_f32 v136, 0x3d93cd3a, v136
    v_cvt_pk_bf16_f32 v136, v136, v136
    v_and_b32 v136, 0xffff0000, v136
    v_cvt_pk_bf16_f32 v137, v137, v137
    v_and_b32 v137, 0xffff0000, v137
    v_mul_f32 v137, 0x3d93cd3a, v137
    v_cvt_pk_bf16_f32 v137, v137, v137
    v_and_b32 v137, 0xffff0000, v137
    v_cvt_pk_bf16_f32 v138, v138, v138
    v_and_b32 v138, 0xffff0000, v138
    v_mul_f32 v138, 0x3d93cd3a, v138
    v_cvt_pk_bf16_f32 v138, v138, v138
    v_and_b32 v138, 0xffff0000, v138
    v_cvt_pk_bf16_f32 v139, v139, v139
    v_and_b32 v139, 0xffff0000, v139
    v_mul_f32 v139, 0x3d93cd3a, v139
    v_cvt_pk_bf16_f32 v139, v139, v139
    v_and_b32 v139, 0xffff0000, v139
    v_cvt_pk_bf16_f32 v140, v140, v140
    v_and_b32 v140, 0xffff0000, v140
    v_mul_f32 v140, 0x3d93cd3a, v140
    v_cvt_pk_bf16_f32 v140, v140, v140
    v_and_b32 v140, 0xffff0000, v140
    v_cvt_pk_bf16_f32 v141, v141, v141
    v_and_b32 v141, 0xffff0000, v141
    v_mul_f32 v141, 0x3d93cd3a, v141
    v_cvt_pk_bf16_f32 v141, v141, v141
    v_and_b32 v141, 0xffff0000, v141
    v_cvt_pk_bf16_f32 v142, v142, v142
    v_and_b32 v142, 0xffff0000, v142
    v_mul_f32 v142, 0x3d93cd3a, v142
    v_cvt_pk_bf16_f32 v142, v142, v142
    v_and_b32 v142, 0xffff0000, v142
    v_cvt_pk_bf16_f32 v143, v143, v143
    v_and_b32 v143, 0xffff0000, v143
    v_mul_f32 v143, 0x3d93cd3a, v143
    v_cvt_pk_bf16_f32 v143, v143, v143
    v_and_b32 v143, 0xffff0000, v143
    v_cvt_pk_bf16_f32 v144, v144, v144
    v_and_b32 v144, 0xffff0000, v144
    v_mul_f32 v144, 0x3d93cd3a, v144
    v_cvt_pk_bf16_f32 v144, v144, v144
    v_and_b32 v144, 0xffff0000, v144
    v_cvt_pk_bf16_f32 v145, v145, v145
    v_and_b32 v145, 0xffff0000, v145
    v_mul_f32 v145, 0x3d93cd3a, v145
    v_cvt_pk_bf16_f32 v145, v145, v145
    v_and_b32 v145, 0xffff0000, v145
    v_cvt_pk_bf16_f32 v146, v146, v146
    v_and_b32 v146, 0xffff0000, v146
    v_mul_f32 v146, 0x3d93cd3a, v146
    v_cvt_pk_bf16_f32 v146, v146, v146
    v_and_b32 v146, 0xffff0000, v146
    v_cvt_pk_bf16_f32 v147, v147, v147
    v_and_b32 v147, 0xffff0000, v147
    v_mul_f32 v147, 0x3d93cd3a, v147
    v_cvt_pk_bf16_f32 v147, v147, v147
    v_and_b32 v147, 0xffff0000, v147
    v_cvt_pk_bf16_f32 v148, v148, v148
    v_and_b32 v148, 0xffff0000, v148
    v_mul_f32 v148, 0x3d93cd3a, v148
    v_cvt_pk_bf16_f32 v148, v148, v148
    v_and_b32 v148, 0xffff0000, v148
    v_cvt_pk_bf16_f32 v149, v149, v149
    v_and_b32 v149, 0xffff0000, v149
    v_mul_f32 v149, 0x3d93cd3a, v149
    v_cvt_pk_bf16_f32 v149, v149, v149
    v_and_b32 v149, 0xffff0000, v149
    v_cvt_pk_bf16_f32 v150, v150, v150
    v_and_b32 v150, 0xffff0000, v150
    v_mul_f32 v150, 0x3d93cd3a, v150
    v_cvt_pk_bf16_f32 v150, v150, v150
    v_and_b32 v150, 0xffff0000, v150
    v_cvt_pk_bf16_f32 v151, v151, v151
    v_and_b32 v151, 0xffff0000, v151
    v_mul_f32 v151, 0x3d93cd3a, v151
    v_cvt_pk_bf16_f32 v151, v151, v151
    v_and_b32 v151, 0xffff0000, v151
    v_cvt_pk_bf16_f32 v152, v152, v152
    v_and_b32 v152, 0xffff0000, v152
    v_mul_f32 v152, 0x3d93cd3a, v152
    v_cvt_pk_bf16_f32 v152, v152, v152
    v_and_b32 v152, 0xffff0000, v152
    v_cvt_pk_bf16_f32 v153, v153, v153
    v_and_b32 v153, 0xffff0000, v153
    v_mul_f32 v153, 0x3d93cd3a, v153
    v_cvt_pk_bf16_f32 v153, v153, v153
    v_and_b32 v153, 0xffff0000, v153
    v_cvt_pk_bf16_f32 v154, v154, v154
    v_and_b32 v154, 0xffff0000, v154
    v_mul_f32 v154, 0x3d93cd3a, v154
    v_cvt_pk_bf16_f32 v154, v154, v154
    v_and_b32 v154, 0xffff0000, v154
    v_cvt_pk_bf16_f32 v155, v155, v155
    v_and_b32 v155, 0xffff0000, v155
    v_mul_f32 v155, 0x3d93cd3a, v155
    v_cvt_pk_bf16_f32 v155, v155, v155
    v_and_b32 v155, 0xffff0000, v155
    v_cvt_pk_bf16_f32 v156, v156, v156
    v_and_b32 v156, 0xffff0000, v156
    v_mul_f32 v156, 0x3d93cd3a, v156
    v_cvt_pk_bf16_f32 v156, v156, v156
    v_and_b32 v156, 0xffff0000, v156
    v_cvt_pk_bf16_f32 v157, v157, v157
    v_and_b32 v157, 0xffff0000, v157
    v_mul_f32 v157, 0x3d93cd3a, v157
    v_cvt_pk_bf16_f32 v157, v157, v157
    v_and_b32 v157, 0xffff0000, v157
    v_cvt_pk_bf16_f32 v158, v158, v158
    v_and_b32 v158, 0xffff0000, v158
    v_mul_f32 v158, 0x3d93cd3a, v158
    v_cvt_pk_bf16_f32 v158, v158, v158
    v_and_b32 v158, 0xffff0000, v158
    v_cvt_pk_bf16_f32 v159, v159, v159
    v_and_b32 v159, 0xffff0000, v159
    v_mul_f32 v159, 0x3d93cd3a, v159
    v_cvt_pk_bf16_f32 v159, v159, v159
    v_and_b32 v159, 0xffff0000, v159
    v_mov_b32 v11, 0xf149f2ca
    v_lshlrev_b32 v12, 2, v4
    v_sub_u32 v12, v3, v12
    v_cmp_le_i32 vcc, 0, v12
    s_nop 1
    v_cndmask_b32 v136, v11, v136, vcc
    v_cmp_le_i32 vcc, 1, v12
    s_nop 1
    v_cndmask_b32 v137, v11, v137, vcc
    v_cmp_le_i32 vcc, 2, v12
    s_nop 1
    v_cndmask_b32 v138, v11, v138, vcc
    v_cmp_le_i32 vcc, 3, v12
    s_nop 1
    v_cndmask_b32 v139, v11, v139, vcc
    v_mov_b32 v144, v11
    v_mov_b32 v145, v11
    v_mov_b32 v146, v11
    v_mov_b32 v147, v11
    v_cmp_le_i32 vcc, 0, v12
    s_nop 1
    v_cndmask_b32 v148, v11, v148, vcc
    v_cmp_le_i32 vcc, 1, v12
    s_nop 1
    v_cndmask_b32 v149, v11, v149, vcc
    v_cmp_le_i32 vcc, 2, v12
    s_nop 1
    v_cndmask_b32 v150, v11, v150, vcc
    v_cmp_le_i32 vcc, 3, v12
    s_nop 1
    v_cndmask_b32 v151, v11, v151, vcc
    v_cmp_gt_u32 vcc, 2, v4
    s_nop 1
    v_cndmask_b32 v152, v11, v152, vcc
    v_cndmask_b32 v153, v11, v153, vcc
    v_cndmask_b32 v154, v11, v154, vcc
    v_cndmask_b32 v155, v11, v155, vcc
    v_cndmask_b32 v156, v11, v156, vcc
    v_cndmask_b32 v157, v11, v157, vcc
    v_cndmask_b32 v158, v11, v158, vcc
    v_cndmask_b32 v159, v11, v159, vcc
    v_max_f32 v13, v136, v137
    v_max_f32 v13, v13, v138
    v_max_f32 v13, v13, v139
    v_max_f32 v13, v13, v144
    v_max_f32 v13, v13, v145
    v_max_f32 v13, v13, v146
    v_max_f32 v13, v13, v147
    v_max_f32 v13, v13, v152
    v_max_f32 v13, v13, v153
    v_max_f32 v13, v13, v154
    v_max_f32 v13, v13, v155
    ds_swizzle_b32 v14, v13 offset:0x401F
    s_waitcnt lgkmcnt(0)
    v_max_f32 v13, v13, v14
    v_mov_b32 v14, v13
    s_nop 1
    v_permlane32_swap_b32 v14, v13
    s_nop 0
    v_max_f32 v13, v13, v14
    v_mov_b32 v15, 0
    v_sub_f32 v136, v136, v13
    v_mul_f32 v136, 0x3fb8aa3b, v136
    v_exp_f32 v136, v136
    v_sub_f32 v137, v137, v13
    v_mul_f32 v137, 0x3fb8aa3b, v137
    v_exp_f32 v137, v137
    v_sub_f32 v138, v138, v13
    v_mul_f32 v138, 0x3fb8aa3b, v138
    v_exp_f32 v138, v138
    v_sub_f32 v139, v139, v13
    v_mul_f32 v139, 0x3fb8aa3b, v139
    v_exp_f32 v139, v139
    v_sub_f32 v144, v144, v13
    v_mul_f32 v144, 0x3fb8aa3b, v144
    v_exp_f32 v144, v144
    v_sub_f32 v145, v145, v13
    v_mul_f32 v145, 0x3fb8aa3b, v145
    v_exp_f32 v145, v145
    v_sub_f32 v146, v146, v13
    v_mul_f32 v146, 0x3fb8aa3b, v146
    v_exp_f32 v146, v146
    v_sub_f32 v147, v147, v13
    v_mul_f32 v147, 0x3fb8aa3b, v147
    v_exp_f32 v147, v147
    v_sub_f32 v152, v152, v13
    v_mul_f32 v152, 0x3fb8aa3b, v152
    v_exp_f32 v152, v152
    v_sub_f32 v153, v153, v13
    v_mul_f32 v153, 0x3fb8aa3b, v153
    v_exp_f32 v153, v153
    v_sub_f32 v154, v154, v13
    v_mul_f32 v154, 0x3fb8aa3b, v154
    v_exp_f32 v154, v154
    v_sub_f32 v155, v155, v13
    v_mul_f32 v155, 0x3fb8aa3b, v155
    v_exp_f32 v155, v155
    s_nop 0
    v_add_f32 v15, v15, v136
    v_add_f32 v15, v15, v137
    v_add_f32 v15, v15, v138
    v_add_f32 v15, v15, v139
    v_add_f32 v15, v15, v144
    v_add_f32 v15, v15, v145
    v_add_f32 v15, v15, v146
    v_add_f32 v15, v15, v147
    v_add_f32 v15, v15, v152
    v_add_f32 v15, v15, v153
    v_add_f32 v15, v15, v154
    v_add_f32 v15, v15, v155
    ds_swizzle_b32 v14, v15 offset:0x401F
    s_waitcnt lgkmcnt(0)
    v_add_f32 v15, v15, v14
    v_mov_b32 v14, v15
    s_nop 1
    v_permlane32_swap_b32 v14, v15
    s_nop 0
    v_add_f32 v15, v15, v14
    v_rcp_f32 v15, v15
    s_nop 0
    v_mul_f32 v136, v136, v15
    v_mul_f32 v137, v137, v15
    v_mul_f32 v138, v138, v15
    v_mul_f32 v139, v139, v15
    v_mul_f32 v144, v144, v15
    v_mul_f32 v145, v145, v15
    v_mul_f32 v146, v146, v15
    v_mul_f32 v147, v147, v15
    v_mul_f32 v152, v152, v15
    v_mul_f32 v153, v153, v15
    v_mul_f32 v154, v154, v15
    v_mul_f32 v155, v155, v15
    v_cvt_pk_bf16_f32 v160, v136, v137
    v_cvt_pk_bf16_f32 v161, v138, v139
    v_cvt_pk_bf16_f32 v162, v144, v145
    v_cvt_pk_bf16_f32 v163, v146, v147
    v_cvt_pk_bf16_f32 v164, v152, v153
    v_cvt_pk_bf16_f32 v165, v154, v155
    v_max_f32 v13, v140, v141
    v_max_f32 v13, v13, v142
    v_max_f32 v13, v13, v143
    v_max_f32 v13, v13, v148
    v_max_f32 v13, v13, v149
    v_max_f32 v13, v13, v150
    v_max_f32 v13, v13, v151
    v_max_f32 v13, v13, v156
    v_max_f32 v13, v13, v157
    v_max_f32 v13, v13, v158
    v_max_f32 v13, v13, v159
    ds_swizzle_b32 v14, v13 offset:0x401F
    s_waitcnt lgkmcnt(0)
    v_max_f32 v13, v13, v14
    v_mov_b32 v14, v13
    s_nop 1
    v_permlane32_swap_b32 v14, v13
    s_nop 0
    v_max_f32 v13, v13, v14
    v_mov_b32 v15, 0
    v_sub_f32 v140, v140, v13
    v_mul_f32 v140, 0x3fb8aa3b, v140
    v_exp_f32 v140, v140
    v_sub_f32 v141, v141, v13
    v_mul_f32 v141, 0x3fb8aa3b, v141
    v_exp_f32 v141, v141
    v_sub_f32 v142, v142, v13
    v_mul_f32 v142, 0x3fb8aa3b, v142
    v_exp_f32 v142, v142
    v_sub_f32 v143, v143, v13
    v_mul_f32 v143, 0x3fb8aa3b, v143
    v_exp_f32 v143, v143
    v_sub_f32 v148, v148, v13
    v_mul_f32 v148, 0x3fb8aa3b, v148
    v_exp_f32 v148, v148
    v_sub_f32 v149, v149, v13
    v_mul_f32 v149, 0x3fb8aa3b, v149
    v_exp_f32 v149, v149
    v_sub_f32 v150, v150, v13
    v_mul_f32 v150, 0x3fb8aa3b, v150
    v_exp_f32 v150, v150
    v_sub_f32 v151, v151, v13
    v_mul_f32 v151, 0x3fb8aa3b, v151
    v_exp_f32 v151, v151
    v_sub_f32 v156, v156, v13
    v_mul_f32 v156, 0x3fb8aa3b, v156
    v_exp_f32 v156, v156
    v_sub_f32 v157, v157, v13
    v_mul_f32 v157, 0x3fb8aa3b, v157
    v_exp_f32 v157, v157
    v_sub_f32 v158, v158, v13
    v_mul_f32 v158, 0x3fb8aa3b, v158
    v_exp_f32 v158, v158
    v_sub_f32 v159, v159, v13
    v_mul_f32 v159, 0x3fb8aa3b, v159
    v_exp_f32 v159, v159
    s_nop 0
    v_add_f32 v15, v15, v140
    v_add_f32 v15, v15, v141
    v_add_f32 v15, v15, v142
    v_add_f32 v15, v15, v143
    v_add_f32 v15, v15, v148
    v_add_f32 v15, v15, v149
    v_add_f32 v15, v15, v150
    v_add_f32 v15, v15, v151
    v_add_f32 v15, v15, v156
    v_add_f32 v15, v15, v157
    v_add_f32 v15, v15, v158
    v_add_f32 v15, v15, v159
    ds_swizzle_b32 v14, v15 offset:0x401F
    s_waitcnt lgkmcnt(0)
    v_add_f32 v15, v15, v14
    v_mov_b32 v14, v15
    s_nop 1
    v_permlane32_swap_b32 v14, v15
    s_nop 0
    v_add_f32 v15, v15, v14
    v_rcp_f32 v15, v15
    s_nop 0
    v_mul_f32 v140, v140, v15
    v_mul_f32 v141, v141, v15
    v_mul_f32 v142, v142, v15
    v_mul_f32 v143, v143, v15
    v_mul_f32 v148, v148, v15
    v_mul_f32 v149, v149, v15
    v_mul_f32 v150, v150, v15
    v_mul_f32 v151, v151, v15
    v_mul_f32 v156, v156, v15
    v_mul_f32 v157, v157, v15
    v_mul_f32 v158, v158, v15
    v_mul_f32 v159, v159, v15
    v_cvt_pk_bf16_f32 v168, v140, v141
    v_cvt_pk_bf16_f32 v169, v142, v143
    v_cvt_pk_bf16_f32 v170, v148, v149
    v_cvt_pk_bf16_f32 v171, v150, v151
    v_cvt_pk_bf16_f32 v172, v156, v157
    v_cvt_pk_bf16_f32 v173, v158, v159
    v_mov_b32 v16, 0
    v_mov_b32 v17, 0
    v_mov_b32 v18, 0
    v_mov_b32 v19, 0
    v_mov_b32 v20, 0
    v_mov_b32 v21, 0
    v_mov_b32 v22, 0
    v_mov_b32 v23, 0
    v_mov_b32 v24, 0
    v_mov_b32 v25, 0
    v_mov_b32 v26, 0
    v_mov_b32 v27, 0
    v_mov_b32 v28, 0
    v_mov_b32 v29, 0
    v_mov_b32 v30, 0
    v_mov_b32 v31, 0
    v_mov_b32 v32, 0
    v_mov_b32 v33, 0
    v_mov_b32 v34, 0
    v_mov_b32 v35, 0
    v_mov_b32 v36, 0
    v_mov_b32 v37, 0
    v_mov_b32 v38, 0
    v_mov_b32 v39, 0
    v_mov_b32 v40, 0
    v_mov_b32 v41, 0
    v_mov_b32 v42, 0
    v_mov_b32 v43, 0
    v_mov_b32 v44, 0
    v_mov_b32 v45, 0
    v_mov_b32 v46, 0
    v_mov_b32 v47, 0
    v_mov_b32 v48, 0
    v_mov_b32 v49, 0
    v_mov_b32 v50, 0
    v_mov_b32 v51, 0
    v_mov_b32 v52, 0
    v_mov_b32 v53, 0
    v_mov_b32 v54, 0
    v_mov_b32 v55, 0
    v_mov_b32 v56, 0
    v_mov_b32 v57, 0
    v_mov_b32 v58, 0
    v_mov_b32 v59, 0
    v_mov_b32 v60, 0
    v_mov_b32 v61, 0
    v_mov_b32 v62, 0
    v_mov_b32 v63, 0
    v_mov_b32 v64, 0
    v_mov_b32 v65, 0
    v_mov_b32 v66, 0
    v_mov_b32 v67, 0
    v_mov_b32 v68, 0
    v_mov_b32 v69, 0
    v_mov_b32 v70, 0
    v_mov_b32 v71, 0
    v_mov_b32 v72, 0
    v_mov_b32 v73, 0
    v_mov_b32 v74, 0
    v_mov_b32 v75, 0
    v_mov_b32 v76, 0
    v_mov_b32 v77, 0
    v_mov_b32 v78, 0
    v_mov_b32 v79, 0
    v_mov_b32 v80, 0
    v_mov_b32 v81, 0
    v_mov_b32 v82, 0
    v_mov_b32 v83, 0
    v_mov_b32 v84, 0
    v_mov_b32 v85, 0
    v_mov_b32 v86, 0
    v_mov_b32 v87, 0
    v_mov_b32 v88, 0
    v_mov_b32 v89, 0
    v_mov_b32 v90, 0
    v_mov_b32 v91, 0
    v_mov_b32 v92, 0
    v_mov_b32 v93, 0
    v_mov_b32 v94, 0
    v_mov_b32 v95, 0
    v_mov_b32 v96, 0
    v_mov_b32 v97, 0
    v_mov_b32 v98, 0
    v_mov_b32 v99, 0
    v_mov_b32 v100, 0
    v_mov_b32 v101, 0
    v_mov_b32 v102, 0
    v_mov_b32 v103, 0
    v_mov_b32 v104, 0
    v_mov_b32 v105, 0
    v_mov_b32 v106, 0
    v_mov_b32 v107, 0
    v_mov_b32 v108, 0
    v_mov_b32 v109, 0
    v_mov_b32 v110, 0
    v_mov_b32 v111, 0
    s_waitcnt vmcnt(0)
    s_nop 1
    v_mfma_f32_16x16x32_bf16 v[16:19], v[176:179], v[160:163], v[16:19]
    v_mfma_f32_16x16x32_bf16 v[20:23], v[176:179], v[168:171], v[20:23]
    v_mfma_f32_16x16x32_bf16 v[24:27], v[180:183], v[160:163], v[24:27]
    v_mfma_f32_16x16x32_bf16 v[28:31], v[180:183], v[168:171], v[28:31]
    v_mfma_f32_16x16x32_bf16 v[32:35], v[184:187], v[160:163], v[32:35]
    v_mfma_f32_16x16x32_bf16 v[36:39], v[184:187], v[168:171], v[36:39]
    v_mfma_f32_16x16x32_bf16 v[40:43], v[188:191], v[160:163], v[40:43]
    v_mfma_f32_16x16x32_bf16 v[44:47], v[188:191], v[168:171], v[44:47]
    v_mfma_f32_16x16x32_bf16 v[48:51], v[192:195], v[160:163], v[48:51]
    v_mfma_f32_16x16x32_bf16 v[52:55], v[192:195], v[168:171], v[52:55]
    v_mfma_f32_16x16x32_bf16 v[56:59], v[196:199], v[160:163], v[56:59]
    v_mfma_f32_16x16x32_bf16 v[60:63], v[196:199], v[168:171], v[60:63]
    v_mfma_f32_16x16x32_bf16 v[64:67], v[200:203], v[160:163], v[64:67]
    v_mfma_f32_16x16x32_bf16 v[68:71], v[200:203], v[168:171], v[68:71]
    v_mfma_f32_16x16x32_bf16 v[72:75], v[204:207], v[160:163], v[72:75]
    v_mfma_f32_16x16x32_bf16 v[76:79], v[204:207], v[168:171], v[76:79]
    v_mfma_f32_16x16x32_bf16 v[80:83], v[208:211], v[160:163], v[80:83]
    v_mfma_f32_16x16x32_bf16 v[84:87], v[208:211], v[168:171], v[84:87]
    v_mfma_f32_16x16x32_bf16 v[88:91], v[212:215], v[160:163], v[88:91]
    v_mfma_f32_16x16x32_bf16 v[92:95], v[212:215], v[168:171], v[92:95]
    v_mfma_f32_16x16x32_bf16 v[96:99], v[216:219], v[160:163], v[96:99]
    v_mfma_f32_16x16x32_bf16 v[100:103], v[216:219], v[168:171], v[100:103]
    v_mfma_f32_16x16x32_bf16 v[104:107], v[220:223], v[160:163], v[104:107]
    v_mfma_f32_16x16x32_bf16 v[108:111], v[220:223], v[168:171], v[108:111]
    v_mfma_f32_16x16x16_bf16 v[16:19], v[224:225], v[164:165], v[16:19]
    v_mfma_f32_16x16x16_bf16 v[20:23], v[224:225], v[172:173], v[20:23]
    v_mfma_f32_16x16x16_bf16 v[24:27], v[226:227], v[164:165], v[24:27]
    v_mfma_f32_16x16x16_bf16 v[28:31], v[226:227], v[172:173], v[28:31]
    v_mfma_f32_16x16x16_bf16 v[32:35], v[228:229], v[164:165], v[32:35]
    v_mfma_f32_16x16x16_bf16 v[36:39], v[228:229], v[172:173], v[36:39]
    v_mfma_f32_16x16x16_bf16 v[40:43], v[230:231], v[164:165], v[40:43]
    v_mfma_f32_16x16x16_bf16 v[44:47], v[230:231], v[172:173], v[44:47]
    v_mfma_f32_16x16x16_bf16 v[48:51], v[232:233], v[164:165], v[48:51]
    v_mfma_f32_16x16x16_bf16 v[52:55], v[232:233], v[172:173], v[52:55]
    v_mfma_f32_16x16x16_bf16 v[56:59], v[234:235], v[164:165], v[56:59]
    v_mfma_f32_16x16x16_bf16 v[60:63], v[234:235], v[172:173], v[60:63]
    v_mfma_f32_16x16x16_bf16 v[64:67], v[236:237], v[164:165], v[64:67]
    v_mfma_f32_16x16x16_bf16 v[68:71], v[236:237], v[172:173], v[68:71]
    v_mfma_f32_16x16x16_bf16 v[72:75], v[238:239], v[164:165], v[72:75]
    v_mfma_f32_16x16x16_bf16 v[76:79], v[238:239], v[172:173], v[76:79]
    v_mfma_f32_16x16x16_bf16 v[80:83], v[240:241], v[164:165], v[80:83]
    v_mfma_f32_16x16x16_bf16 v[84:87], v[240:241], v[172:173], v[84:87]
    v_mfma_f32_16x16x16_bf16 v[88:91], v[242:243], v[164:165], v[88:91]
    v_mfma_f32_16x16x16_bf16 v[92:95], v[242:243], v[172:173], v[92:95]
    v_mfma_f32_16x16x16_bf16 v[96:99], v[244:245], v[164:165], v[96:99]
    v_mfma_f32_16x16x16_bf16 v[100:103], v[244:245], v[172:173], v[100:103]
    v_mfma_f32_16x16x16_bf16 v[104:107], v[246:247], v[164:165], v[104:107]
    v_mfma_f32_16x16x16_bf16 v[108:111], v[246:247], v[172:173], v[108:111]
    s_nop 9
    v_mul_u32_u24 v5, 12288, v3
    s_mul_i32 s22, s21, 384
    v_add_u32 v5, s22, v5
    v_lshlrev_b32 v6, 3, v4
    v_add_u32 v5, v5, v6
    s_add_u32 s24, s23, 106348544
    v_cvt_pk_bf16_f32 v160, v16, v17
    v_cvt_pk_bf16_f32 v161, v18, v19
    buffer_store_dwordx2 v[160:161], v5, s[4:7], s24 offen offset:0 sc0 sc1
    s_nop 0
    v_cvt_pk_bf16_f32 v160, v24, v25
    v_cvt_pk_bf16_f32 v161, v26, v27
    buffer_store_dwordx2 v[160:161], v5, s[4:7], s24 offen offset:32 sc0 sc1
    s_nop 0
    v_cvt_pk_bf16_f32 v160, v32, v33
    v_cvt_pk_bf16_f32 v161, v34, v35
    buffer_store_dwordx2 v[160:161], v5, s[4:7], s24 offen offset:64 sc0 sc1
    s_nop 0
    v_cvt_pk_bf16_f32 v160, v40, v41
    v_cvt_pk_bf16_f32 v161, v42, v43
    buffer_store_dwordx2 v[160:161], v5, s[4:7], s24 offen offset:96 sc0 sc1
    s_nop 0
    v_cvt_pk_bf16_f32 v160, v48, v49
    v_cvt_pk_bf16_f32 v161, v50, v51
    buffer_store_dwordx2 v[160:161], v5, s[4:7], s24 offen offset:128 sc0 sc1
    s_nop 0
    v_cvt_pk_bf16_f32 v160, v56, v57
    v_cvt_pk_bf16_f32 v161, v58, v59
    buffer_store_dwordx2 v[160:161], v5, s[4:7], s24 offen offset:160 sc0 sc1
    s_nop 0
    v_cvt_pk_bf16_f32 v160, v64, v65
    v_cvt_pk_bf16_f32 v161, v66, v67
    buffer_store_dwordx2 v[160:161], v5, s[4:7], s24 offen offset:192 sc0 sc1
    s_nop 0
    v_cvt_pk_bf16_f32 v160, v72, v73
    v_cvt_pk_bf16_f32 v161, v74, v75
    buffer_store_dwordx2 v[160:161], v5, s[4:7], s24 offen offset:224 sc0 sc1
    s_nop 0
    v_cvt_pk_bf16_f32 v160, v80, v81
    v_cvt_pk_bf16_f32 v161, v82, v83
    buffer_store_dwordx2 v[160:161], v5, s[4:7], s24 offen offset:256 sc0 sc1
    s_nop 0
    v_cvt_pk_bf16_f32 v160, v88, v89
    v_cvt_pk_bf16_f32 v161, v90, v91
    buffer_store_dwordx2 v[160:161], v5, s[4:7], s24 offen offset:288 sc0 sc1
    s_nop 0
    v_cvt_pk_bf16_f32 v160, v96, v97
    v_cvt_pk_bf16_f32 v161, v98, v99
    buffer_store_dwordx2 v[160:161], v5, s[4:7], s24 offen offset:320 sc0 sc1
    s_nop 0
    v_cvt_pk_bf16_f32 v160, v104, v105
    v_cvt_pk_bf16_f32 v161, v106, v107
    buffer_store_dwordx2 v[160:161], v5, s[4:7], s24 offen offset:352 sc0 sc1
    s_nop 0
    s_add_u32 s24, s23, 106545152
    v_cvt_pk_bf16_f32 v160, v20, v21
    v_cvt_pk_bf16_f32 v161, v22, v23
    buffer_store_dwordx2 v[160:161], v5, s[4:7], s24 offen offset:0 sc0 sc1
    s_nop 0
    v_cvt_pk_bf16_f32 v160, v28, v29
    v_cvt_pk_bf16_f32 v161, v30, v31
    buffer_store_dwordx2 v[160:161], v5, s[4:7], s24 offen offset:32 sc0 sc1
    s_nop 0
    v_cvt_pk_bf16_f32 v160, v36, v37
    v_cvt_pk_bf16_f32 v161, v38, v39
    buffer_store_dwordx2 v[160:161], v5, s[4:7], s24 offen offset:64 sc0 sc1
    s_nop 0
    v_cvt_pk_bf16_f32 v160, v44, v45
    v_cvt_pk_bf16_f32 v161, v46, v47
    buffer_store_dwordx2 v[160:161], v5, s[4:7], s24 offen offset:96 sc0 sc1
    s_nop 0
    v_cvt_pk_bf16_f32 v160, v52, v53
    v_cvt_pk_bf16_f32 v161, v54, v55
    buffer_store_dwordx2 v[160:161], v5, s[4:7], s24 offen offset:128 sc0 sc1
    s_nop 0
    v_cvt_pk_bf16_f32 v160, v60, v61
    v_cvt_pk_bf16_f32 v161, v62, v63
    buffer_store_dwordx2 v[160:161], v5, s[4:7], s24 offen offset:160 sc0 sc1
    s_nop 0
    v_cvt_pk_bf16_f32 v160, v68, v69
    v_cvt_pk_bf16_f32 v161, v70, v71
    buffer_store_dwordx2 v[160:161], v5, s[4:7], s24 offen offset:192 sc0 sc1
    s_nop 0
    v_cvt_pk_bf16_f32 v160, v76, v77
    v_cvt_pk_bf16_f32 v161, v78, v79
    buffer_store_dwordx2 v[160:161], v5, s[4:7], s24 offen offset:224 sc0 sc1
    s_nop 0
    v_cvt_pk_bf16_f32 v160, v84, v85
    v_cvt_pk_bf16_f32 v161, v86, v87
    buffer_store_dwordx2 v[160:161], v5, s[4:7], s24 offen offset:256 sc0 sc1
    s_nop 0
    v_cvt_pk_bf16_f32 v160, v92, v93
    v_cvt_pk_bf16_f32 v161, v94, v95
    buffer_store_dwordx2 v[160:161], v5, s[4:7], s24 offen offset:288 sc0 sc1
    s_nop 0
    v_cvt_pk_bf16_f32 v160, v100, v101
    v_cvt_pk_bf16_f32 v161, v102, v103
    buffer_store_dwordx2 v[160:161], v5, s[4:7], s24 offen offset:320 sc0 sc1
    s_nop 0
    v_cvt_pk_bf16_f32 v160, v108, v109
    v_cvt_pk_bf16_f32 v161, v110, v111
    buffer_store_dwordx2 v[160:161], v5, s[4:7], s24 offen offset:352 sc0 sc1
    s_nop 0
    s_waitcnt vmcnt(0)
    s_barrier
    s_cmp_lg_u32 s94, 0
    s_cbranch_scc1 mega_kernel_sg62
    s_lshl_b32 s93, s91, 7
    s_add_u32 s93, s93, 20480
    v_mov_b32 v1, s93
    v_mov_b32 v2, 1
    s_mov_b64 exec, 1
    buffer_atomic_add v2, v1, s[80:83], 0 offen sc1
    s_mov_b64 exec, -1
mega_kernel_sg62:
    s_add_u32 s91, s91, 1
    s_cmp_lt_u32 s91, 16
    s_cbranch_scc1 mega_kernel_latt50
    s_branch mega_kernel_done1
mega_kernel_bwo46:
    s_mov_b32 s91, 0
mega_kernel_lwo63:
    s_cmp_lg_u32 s94, 0
    s_cbranch_scc1 mega_kernel_wd65
    s_lshl_b32 s93, s91, 7
    s_add_u32 s93, s93, 20480
    v_mov_b32 v1, s93
    s_mov_b32 s95, 0
mega_kernel_wl64:
    buffer_load_dword v2, v1, s[80:83], 0 offen sc1
    s_waitcnt vmcnt(0)
    v_cmp_gt_u32 vcc, 32, v2
    s_nop 0
    s_cbranch_vccz mega_kernel_wok66
    s_cmp_ge_u32 s91, 14
    s_cbranch_scc1 mega_kernel_wfast67
    s_sleep 48
mega_kernel_wfast67:
    s_sleep 4
    s_add_u32 s95, s95, 1
    s_cmp_lt_u32 s95, 1000000
    s_cbranch_scc1 mega_kernel_wl64
    s_branch mega_kernel_done1
mega_kernel_wok66:
mega_kernel_wd65:
    s_barrier
    s_sub_u32 s92, s90, 32
    s_and_b32 s15, s92, 3
    s_lshr_b32 s92, s92, 2
    s_lshl_b32 s13, s91, 1
    s_mov_b32 s14, s92
    s_cmp_lt_u32 s92, 5
    s_cbranch_scc1 mega_kernel_wot68
    s_add_u32 s13, s13, 1
    s_sub_u32 s14, s92, 5
mega_kernel_wot68:
    s_mov_b64 s[4:5], s[78:79]
    s_mul_i32 s12, s13, 786432
    s_add_u32 s4, s4, 106348544
    s_addc_u32 s5, s5, 0
    s_add_u32 s4, s4, s12
    s_addc_u32 s5, s5, 0
    s_mov_b64 s[6:7], s[58:59]
    s_lshl_b32 s12, s14, 8
    s_add_u32 s6, s6, s12
    s_addc_u32 s7, s7, 0
    s_add_u32 s8, s6, 128
    s_addc_u32 s9, s7, 0
    s_mul_i32 s12, s15, 3072
    s_add_u32 s4, s4, s12
    s_addc_u32 s5, s5, 0
    s_mul_i32 s12, s15, 1966080
    s_add_u32 s6, s6, s12
    s_addc_u32 s7, s7, 0
    s_add_u32 s8, s8, s12
    s_addc_u32 s9, s9, 0
    v_and_b32 v48, 63, v0
    v_lshrrev_b32 v49, 6, v0
    s_nop 1
    v_readfirstlane_b32 s10, v49
    s_nop 3
    s_lshl_b32 s11, s10, 11
    s_mul_i32 s10, s10, 2048
    v_lshrrev_b32 v50, 3, v48
    v_and_b32 v51, 7, v48
    v_lshrrev_b32 v52, 4, v48
    s_mov_b32 s12, 12288
    v_mul_u32_u24 v53, 16, v49
    v_add_u32 v53, 0, v53
    v_add_u32 v53, v53, v50
    v_lshrrev_b32 v54, 1, v53
    v_and_b32 v54, 7, v54
    v_xor_b32 v54, v54, v51
    v_lshlrev_b32 v54, 4, v54
    v_mul_lo_u32 v1, v53, s12
    v_add_u32 v1, v1, v54
    v_mul_u32_u24 v53, 16, v49
    v_add_u32 v53, 8, v53
    v_add_u32 v53, v53, v50
    v_lshrrev_b32 v54, 1, v53
    v_and_b32 v54, 7, v54
    v_xor_b32 v54, v54, v51
    v_lshlrev_b32 v54, 4, v54
    v_mul_lo_u32 v2, v53, s12
    v_add_u32 v2, v2, v54
    v_lshrrev_b32 v53, 2, v51
    v_and_b32 v54, 1, v52
    v_xor_b32 v53, v53, v54
    v_lshlrev_b32 v53, 2, v53
    v_and_b32 v54, 3, v51
    v_or_b32 v53, v53, v54
    v_lshlrev_b32 v53, 4, v53
    v_lshlrev_b32 v54, 4, v49
    v_add_u32 v54, v54, v50
    s_mov_b32 s12, 1280
    v_mul_lo_u32 v5, v54, s12
    v_add_u32 v5, v5, v53
    v_add_u32 v6, 10240, v5
    v_lshrrev_b32 v53, 1, v49
    v_and_b32 v54, 1, v49
    v_mul_u32_u24 v55, 32, v53
    v_and_b32 v56, 31, v48
    v_add_u32 v55, v55, v56
    v_lshrrev_b32 v56, 1, v55
    v_and_b32 v56, 7, v56
    v_lshrrev_b32 v57, 5, v48
    v_xor_b32 v56, v56, v57
    v_lshlrev_b32 v56, 4, v56
    v_lshlrev_b32 v55, 7, v55
    v_add_u32 v8, v55, v56
    v_xor_b32 v9, 32, v8
    v_xor_b32 v10, 64, v8
    v_xor_b32 v11, 96, v8
    v_and_b32 v55, 15, v48
    v_lshrrev_b32 v55, 2, v55
    v_lshrrev_b32 v56, 5, v48
    v_lshlrev_b32 v56, 3, v56
    v_add_u32 v56, v56, v55
    v_lshrrev_b32 v57, 1, v55
    v_and_b32 v57, 1, v57
    v_lshlrev_b32 v57, 6, v57
    v_lshlrev_b32 v56, 7, v56
    v_add_u32 v56, v56, v57
    v_and_b32 v57, 1, v52
    v_lshlrev_b32 v57, 5, v57
    v_add_u32 v56, v56, v57
    v_and_b32 v57, 3, v48
    v_lshlrev_b32 v57, 3, v57
    v_add_u32 v56, v56, v57
    v_add_u32 v56, 8192, v56
    v_lshlrev_b32 v57, 13, v54
    v_add_u32 v12, v56, v57
    v_xor_b32 v13, 64, v12
    v_add_u32 v128, 49152, v8
    v_add_u32 v129, 49152, v9
    v_add_u32 v130, 49152, v10
    v_add_u32 v131, 49152, v11
    v_add_u32 v132, 49152, v12
    v_add_u32 v133, 49152, v13
    v_mov_b32 v64, 0
    v_mov_b32 v65, 0
    v_mov_b32 v66, 0
    v_mov_b32 v67, 0
    v_mov_b32 v68, 0
    v_mov_b32 v69, 0
    v_mov_b32 v70, 0
    v_mov_b32 v71, 0
    v_mov_b32 v72, 0
    v_mov_b32 v73, 0
    v_mov_b32 v74, 0
    v_mov_b32 v75, 0
    v_mov_b32 v76, 0
    v_mov_b32 v77, 0
    v_mov_b32 v78, 0
    v_mov_b32 v79, 0
    v_mov_b32 v80, 0
    v_mov_b32 v81, 0
    v_mov_b32 v82, 0
    v_mov_b32 v83, 0
    v_mov_b32 v84, 0
    v_mov_b32 v85, 0
    v_mov_b32 v86, 0
    v_mov_b32 v87, 0
    v_mov_b32 v88, 0
    v_mov_b32 v89, 0
    v_mov_b32 v90, 0
    v_mov_b32 v91, 0
    v_mov_b32 v92, 0
    v_mov_b32 v93, 0
    v_mov_b32 v94, 0
    v_mov_b32 v95, 0
    s_add_u32 m0, s10, 0
    s_nop 0
    global_load_lds_dwordx4 v1, s[4:5]
    s_add_u32 m0, s10, 1024
    s_nop 0
    global_load_lds_dwordx4 v2, s[4:5]
    s_add_u32 m0, s11, 8192
    s_nop 0
    global_load_lds_dwordx4 v5, s[6:7]
    s_add_u32 m0, s11, 9216
    s_nop 0
    global_load_lds_dwordx4 v6, s[6:7]
    s_add_u32 m0, s11, 16384
    s_nop 0
    global_load_lds_dwordx4 v5, s[8:9]
    s_add_u32 m0, s11, 17408
    s_nop 0
    global_load_lds_dwordx4 v6, s[8:9]
    s_add_u32 s4, s4, 128
    s_addc_u32 s5, s5, 0
    s_add_u32 s6, s6, 81920
    s_addc_u32 s7, s7, 0
    s_add_u32 s8, s8, 81920
    s_addc_u32 s9, s9, 0
    s_add_u32 m0, s10, 24576
    s_nop 0
    global_load_lds_dwordx4 v1, s[4:5]
    s_add_u32 m0, s10, 25600
    s_nop 0
    global_load_lds_dwordx4 v2, s[4:5]
    s_add_u32 m0, s11, 32768
    s_nop 0
    global_load_lds_dwordx4 v5, s[6:7]
    s_add_u32 m0, s11, 33792
    s_nop 0
    global_load_lds_dwordx4 v6, s[6:7]
    s_add_u32 m0, s11, 40960
    s_nop 0
    global_load_lds_dwordx4 v5, s[8:9]
    s_add_u32 m0, s11, 41984
    s_nop 0
    global_load_lds_dwordx4 v6, s[8:9]
    s_add_u32 s4, s4, 128
    s_addc_u32 s5, s5, 0
    s_add_u32 s6, s6, 81920
    s_addc_u32 s7, s7, 0
    s_add_u32 s8, s8, 81920
    s_addc_u32 s9, s9, 0
    s_add_u32 m0, s10, 49152
    s_nop 0
    global_load_lds_dwordx4 v1, s[4:5]
    s_add_u32 m0, s10, 50176
    s_nop 0
    global_load_lds_dwordx4 v2, s[4:5]
    s_add_u32 m0, s11, 57344
    s_nop 0
    global_load_lds_dwordx4 v5, s[6:7]
    s_add_u32 m0, s11, 58368
    s_nop 0
    global_load_lds_dwordx4 v6, s[6:7]
    s_add_u32 m0, s11, 65536
    s_nop 0
    global_load_lds_dwordx4 v5, s[8:9]
    s_add_u32 m0, s11, 66560
    s_nop 0
    global_load_lds_dwordx4 v6, s[8:9]
    s_add_u32 s4, s4, 128
    s_addc_u32 s5, s5, 0
    s_add_u32 s6, s6, 81920
    s_addc_u32 s7, s7, 0
    s_add_u32 s8, s8, 81920
    s_addc_u32 s9, s9, 0
    s_waitcnt vmcnt(12)
    s_barrier
    ds_read_b128 v[16:19], v8 offset:0
    ds_read_b64_tr_b16 v[24:25], v12 offset:0
    ds_read_b64_tr_b16 v[26:27], v12 offset:512
    ds_read_b64_tr_b16 v[28:29], v13 offset:0
    ds_read_b64_tr_b16 v[30:31], v13 offset:512
    ds_read_b128 v[32:35], v9 offset:0
    ds_read_b64_tr_b16 v[40:41], v12 offset:2048
    ds_read_b64_tr_b16 v[42:43], v12 offset:2560
    ds_read_b64_tr_b16 v[44:45], v13 offset:2048
    ds_read_b64_tr_b16 v[46:47], v13 offset:2560
    s_add_u32 m0, s10, 73728
    s_nop 0
    global_load_lds_dwordx4 v1, s[4:5]
    s_add_u32 m0, s10, 74752
    s_nop 0
    global_load_lds_dwordx4 v2, s[4:5]
    s_add_u32 m0, s11, 81920
    s_nop 0
    global_load_lds_dwordx4 v5, s[6:7]
    s_add_u32 m0, s11, 82944
    s_nop 0
    global_load_lds_dwordx4 v6, s[6:7]
    s_add_u32 m0, s11, 90112
    s_nop 0
    global_load_lds_dwordx4 v5, s[8:9]
    s_add_u32 m0, s11, 91136
    s_nop 0
    global_load_lds_dwordx4 v6, s[8:9]
    s_add_u32 s4, s4, 128
    s_addc_u32 s5, s5, 0
    s_add_u32 s6, s6, 81920
    s_addc_u32 s7, s7, 0
    s_add_u32 s8, s8, 81920
    s_addc_u32 s9, s9, 0
    s_waitcnt lgkmcnt(5)
    v_mfma_f32_32x32x16_bf16 v[64:79], v[16:19], v[24:27], v[64:79]
    v_mfma_f32_32x32x16_bf16 v[80:95], v[16:19], v[28:31], v[80:95]
    ds_read_b128 v[16:19], v10 offset:0
    ds_read_b64_tr_b16 v[24:25], v12 offset:4096
    ds_read_b64_tr_b16 v[26:27], v12 offset:4608
    ds_read_b64_tr_b16 v[28:29], v13 offset:4096
    ds_read_b64_tr_b16 v[30:31], v13 offset:4608
    s_waitcnt lgkmcnt(5)
    v_mfma_f32_32x32x16_bf16 v[64:79], v[32:35], v[40:43], v[64:79]
    v_mfma_f32_32x32x16_bf16 v[80:95], v[32:35], v[44:47], v[80:95]
    ds_read_b128 v[32:35], v11 offset:0
    ds_read_b64_tr_b16 v[40:41], v12 offset:6144
    ds_read_b64_tr_b16 v[42:43], v12 offset:6656
    ds_read_b64_tr_b16 v[44:45], v13 offset:6144
    ds_read_b64_tr_b16 v[46:47], v13 offset:6656
    s_waitcnt lgkmcnt(5)
    v_mfma_f32_32x32x16_bf16 v[64:79], v[16:19], v[24:27], v[64:79]
    v_mfma_f32_32x32x16_bf16 v[80:95], v[16:19], v[28:31], v[80:95]
    s_waitcnt lgkmcnt(0)
    v_mfma_f32_32x32x16_bf16 v[64:79], v[32:35], v[40:43], v[64:79]
    v_mfma_f32_32x32x16_bf16 v[80:95], v[32:35], v[44:47], v[80:95]
    s_mov_b32 s12, 5
mega_kernel_loop69:
    s_waitcnt vmcnt(12)
    s_barrier
    ds_read_b128 v[16:19], v8 offset:24576
    ds_read_b64_tr_b16 v[24:25], v12 offset:24576
    ds_read_b64_tr_b16 v[26:27], v12 offset:25088
    ds_read_b64_tr_b16 v[28:29], v13 offset:24576
    ds_read_b64_tr_b16 v[30:31], v13 offset:25088
    ds_read_b128 v[32:35], v9 offset:24576
    ds_read_b64_tr_b16 v[40:41], v12 offset:26624
    ds_read_b64_tr_b16 v[42:43], v12 offset:27136
    ds_read_b64_tr_b16 v[44:45], v13 offset:26624
    ds_read_b64_tr_b16 v[46:47], v13 offset:27136
    s_add_u32 m0, s10, 0
    s_nop 0
    global_load_lds_dwordx4 v1, s[4:5]
    s_add_u32 m0, s10, 1024
    s_nop 0
    global_load_lds_dwordx4 v2, s[4:5]
    s_add_u32 m0, s11, 8192
    s_nop 0
    global_load_lds_dwordx4 v5, s[6:7]
    s_add_u32 m0, s11, 9216
    s_nop 0
    global_load_lds_dwordx4 v6, s[6:7]
    s_add_u32 m0, s11, 16384
    s_nop 0
    global_load_lds_dwordx4 v5, s[8:9]
    s_add_u32 m0, s11, 17408
    s_nop 0
    global_load_lds_dwordx4 v6, s[8:9]
    s_add_u32 s4, s4, 128
    s_addc_u32 s5, s5, 0
    s_add_u32 s6, s6, 81920
    s_addc_u32 s7, s7, 0
    s_add_u32 s8, s8, 81920
    s_addc_u32 s9, s9, 0
    s_waitcnt lgkmcnt(5)
    v_mfma_f32_32x32x16_bf16 v[64:79], v[16:19], v[24:27], v[64:79]
    v_mfma_f32_32x32x16_bf16 v[80:95], v[16:19], v[28:31], v[80:95]
    ds_read_b128 v[16:19], v10 offset:24576
    ds_read_b64_tr_b16 v[24:25], v12 offset:28672
    ds_read_b64_tr_b16 v[26:27], v12 offset:29184
    ds_read_b64_tr_b16 v[28:29], v13 offset:28672
    ds_read_b64_tr_b16 v[30:31], v13 offset:29184
    s_waitcnt lgkmcnt(5)
    v_mfma_f32_32x32x16_bf16 v[64:79], v[32:35], v[40:43], v[64:79]
    v_mfma_f32_32x32x16_bf16 v[80:95], v[32:35], v[44:47], v[80:95]
    ds_read_b128 v[32:35], v11 offset:24576
    ds_read_b64_tr_b16 v[40:41], v12 offset:30720
    ds_read_b64_tr_b16 v[42:43], v12 offset:31232
    ds_read_b64_tr_b16 v[44:45], v13 offset:30720
    ds_read_b64_tr_b16 v[46:47], v13 offset:31232
    s_waitcnt lgkmcnt(5)
    v_mfma_f32_32x32x16_bf16 v[64:79], v[16:19], v[24:27], v[64:79]
    v_mfma_f32_32x32x16_bf16 v[80:95], v[16:19], v[28:31], v[80:95]
    s_waitcnt lgkmcnt(0)
    v_mfma_f32_32x32x16_bf16 v[64:79], v[32:35], v[40:43], v[64:79]
    v_mfma_f32_32x32x16_bf16 v[80:95], v[32:35], v[44:47], v[80:95]
    s_waitcnt vmcnt(12)
    s_barrier
    ds_read_b128 v[16:19], v128 offset:0
    ds_read_b64_tr_b16 v[24:25], v132 offset:0
    ds_read_b64_tr_b16 v[26:27], v132 offset:512
    ds_read_b64_tr_b16 v[28:29], v133 offset:0
    ds_read_b64_tr_b16 v[30:31], v133 offset:512
    ds_read_b128 v[32:35], v129 offset:0
    ds_read_b64_tr_b16 v[40:41], v132 offset:2048
    ds_read_b64_tr_b16 v[42:43], v132 offset:2560
    ds_read_b64_tr_b16 v[44:45], v133 offset:2048
    ds_read_b64_tr_b16 v[46:47], v133 offset:2560
    s_add_u32 m0, s10, 24576
    s_nop 0
    global_load_lds_dwordx4 v1, s[4:5]
    s_add_u32 m0, s10, 25600
    s_nop 0
    global_load_lds_dwordx4 v2, s[4:5]
    s_add_u32 m0, s11, 32768
    s_nop 0
    global_load_lds_dwordx4 v5, s[6:7]
    s_add_u32 m0, s11, 33792
    s_nop 0
    global_load_lds_dwordx4 v6, s[6:7]
    s_add_u32 m0, s11, 40960
    s_nop 0
    global_load_lds_dwordx4 v5, s[8:9]
    s_add_u32 m0, s11, 41984
    s_nop 0
    global_load_lds_dwordx4 v6, s[8:9]
    s_add_u32 s4, s4, 128
    s_addc_u32 s5, s5, 0
    s_add_u32 s6, s6, 81920
    s_addc_u32 s7, s7, 0
    s_add_u32 s8, s8, 81920
    s_addc_u32 s9, s9, 0
    s_waitcnt lgkmcnt(5)
    v_mfma_f32_32x32x16_bf16 v[64:79], v[16:19], v[24:27], v[64:79]
    v_mfma_f32_32x32x16_bf16 v[80:95], v[16:19], v[28:31], v[80:95]
    ds_read_b128 v[16:19], v130 offset:0
    ds_read_b64_tr_b16 v[24:25], v132 offset:4096
    ds_read_b64_tr_b16 v[26:27], v132 offset:4608
    ds_read_b64_tr_b16 v[28:29], v133 offset:4096
    ds_read_b64_tr_b16 v[30:31], v133 offset:4608
    s_waitcnt lgkmcnt(5)
    v_mfma_f32_32x32x16_bf16 v[64:79], v[32:35], v[40:43], v[64:79]
    v_mfma_f32_32x32x16_bf16 v[80:95], v[32:35], v[44:47], v[80:95]
    ds_read_b128 v[32:35], v131 offset:0
    ds_read_b64_tr_b16 v[40:41], v132 offset:6144
    ds_read_b64_tr_b16 v[42:43], v132 offset:6656
    ds_read_b64_tr_b16 v[44:45], v133 offset:6144
    ds_read_b64_tr_b16 v[46:47], v133 offset:6656
    s_waitcnt lgkmcnt(5)
    v_mfma_f32_32x32x16_bf16 v[64:79], v[16:19], v[24:27], v[64:79]
    v_mfma_f32_32x32x16_bf16 v[80:95], v[16:19], v[28:31], v[80:95]
    s_waitcnt lgkmcnt(0)
    v_mfma_f32_32x32x16_bf16 v[64:79], v[32:35], v[40:43], v[64:79]
    v_mfma_f32_32x32x16_bf16 v[80:95], v[32:35], v[44:47], v[80:95]
    s_waitcnt vmcnt(12)
    s_barrier
    ds_read_b128 v[16:19], v128 offset:24576
    ds_read_b64_tr_b16 v[24:25], v132 offset:24576
    ds_read_b64_tr_b16 v[26:27], v132 offset:25088
    ds_read_b64_tr_b16 v[28:29], v133 offset:24576
    ds_read_b64_tr_b16 v[30:31], v133 offset:25088
    ds_read_b128 v[32:35], v129 offset:24576
    ds_read_b64_tr_b16 v[40:41], v132 offset:26624
    ds_read_b64_tr_b16 v[42:43], v132 offset:27136
    ds_read_b64_tr_b16 v[44:45], v133 offset:26624
    ds_read_b64_tr_b16 v[46:47], v133 offset:27136
    s_add_u32 m0, s10, 49152
    s_nop 0
    global_load_lds_dwordx4 v1, s[4:5]
    s_add_u32 m0, s10, 50176
    s_nop 0
    global_load_lds_dwordx4 v2, s[4:5]
    s_add_u32 m0, s11, 57344
    s_nop 0
    global_load_lds_dwordx4 v5, s[6:7]
    s_add_u32 m0, s11, 58368
    s_nop 0
    global_load_lds_dwordx4 v6, s[6:7]
    s_add_u32 m0, s11, 65536
    s_nop 0
    global_load_lds_dwordx4 v5, s[8:9]
    s_add_u32 m0, s11, 66560
    s_nop 0
    global_load_lds_dwordx4 v6, s[8:9]
    s_add_u32 s4, s4, 128
    s_addc_u32 s5, s5, 0
    s_add_u32 s6, s6, 81920
    s_addc_u32 s7, s7, 0
    s_add_u32 s8, s8, 81920
    s_addc_u32 s9, s9, 0
    s_waitcnt lgkmcnt(5)
    v_mfma_f32_32x32x16_bf16 v[64:79], v[16:19], v[24:27], v[64:79]
    v_mfma_f32_32x32x16_bf16 v[80:95], v[16:19], v[28:31], v[80:95]
    ds_read_b128 v[16:19], v130 offset:24576
    ds_read_b64_tr_b16 v[24:25], v132 offset:28672
    ds_read_b64_tr_b16 v[26:27], v132 offset:29184
    ds_read_b64_tr_b16 v[28:29], v133 offset:28672
    ds_read_b64_tr_b16 v[30:31], v133 offset:29184
    s_waitcnt lgkmcnt(5)
    v_mfma_f32_32x32x16_bf16 v[64:79], v[32:35], v[40:43], v[64:79]
    v_mfma_f32_32x32x16_bf16 v[80:95], v[32:35], v[44:47], v[80:95]
    ds_read_b128 v[32:35], v131 offset:24576
    ds_read_b64_tr_b16 v[40:41], v132 offset:30720
    ds_read_b64_tr_b16 v[42:43], v132 offset:31232
    ds_read_b64_tr_b16 v[44:45], v133 offset:30720
    ds_read_b64_tr_b16 v[46:47], v133 offset:31232
    s_waitcnt lgkmcnt(5)
    v_mfma_f32_32x32x16_bf16 v[64:79], v[16:19], v[24:27], v[64:79]
    v_mfma_f32_32x32x16_bf16 v[80:95], v[16:19], v[28:31], v[80:95]
    s_waitcnt lgkmcnt(0)
    v_mfma_f32_32x32x16_bf16 v[64:79], v[32:35], v[40:43], v[64:79]
    v_mfma_f32_32x32x16_bf16 v[80:95], v[32:35], v[44:47], v[80:95]
    s_waitcnt vmcnt(12)
    s_barrier
    ds_read_b128 v[16:19], v8 offset:0
    ds_read_b64_tr_b16 v[24:25], v12 offset:0
    ds_read_b64_tr_b16 v[26:27], v12 offset:512
    ds_read_b64_tr_b16 v[28:29], v13 offset:0
    ds_read_b64_tr_b16 v[30:31], v13 offset:512
    ds_read_b128 v[32:35], v9 offset:0
    ds_read_b64_tr_b16 v[40:41], v12 offset:2048
    ds_read_b64_tr_b16 v[42:43], v12 offset:2560
    ds_read_b64_tr_b16 v[44:45], v13 offset:2048
    ds_read_b64_tr_b16 v[46:47], v13 offset:2560
    s_add_u32 m0, s10, 73728
    s_nop 0
    global_load_lds_dwordx4 v1, s[4:5]
    s_add_u32 m0, s10, 74752
    s_nop 0
    global_load_lds_dwordx4 v2, s[4:5]
    s_add_u32 m0, s11, 81920
    s_nop 0
    global_load_lds_dwordx4 v5, s[6:7]
    s_add_u32 m0, s11, 82944
    s_nop 0
    global_load_lds_dwordx4 v6, s[6:7]
    s_add_u32 m0, s11, 90112
    s_nop 0
    global_load_lds_dwordx4 v5, s[8:9]
    s_add_u32 m0, s11, 91136
    s_nop 0
    global_load_lds_dwordx4 v6, s[8:9]
    s_add_u32 s4, s4, 128
    s_addc_u32 s5, s5, 0
    s_add_u32 s6, s6, 81920
    s_addc_u32 s7, s7, 0
    s_add_u32 s8, s8, 81920
    s_addc_u32 s9, s9, 0
    s_waitcnt lgkmcnt(5)
    v_mfma_f32_32x32x16_bf16 v[64:79], v[16:19], v[24:27], v[64:79]
    v_mfma_f32_32x32x16_bf16 v[80:95], v[16:19], v[28:31], v[80:95]
    ds_read_b128 v[16:19], v10 offset:0
    ds_read_b64_tr_b16 v[24:25], v12 offset:4096
    ds_read_b64_tr_b16 v[26:27], v12 offset:4608
    ds_read_b64_tr_b16 v[28:29], v13 offset:4096
    ds_read_b64_tr_b16 v[30:31], v13 offset:4608
    s_waitcnt lgkmcnt(5)
    v_mfma_f32_32x32x16_bf16 v[64:79], v[32:35], v[40:43], v[64:79]
    v_mfma_f32_32x32x16_bf16 v[80:95], v[32:35], v[44:47], v[80:95]
    ds_read_b128 v[32:35], v11 offset:0
    ds_read_b64_tr_b16 v[40:41], v12 offset:6144
    ds_read_b64_tr_b16 v[42:43], v12 offset:6656
    ds_read_b64_tr_b16 v[44:45], v13 offset:6144
    ds_read_b64_tr_b16 v[46:47], v13 offset:6656
    s_waitcnt lgkmcnt(5)
    v_mfma_f32_32x32x16_bf16 v[64:79], v[16:19], v[24:27], v[64:79]
    v_mfma_f32_32x32x16_bf16 v[80:95], v[16:19], v[28:31], v[80:95]
    s_waitcnt lgkmcnt(0)
    v_mfma_f32_32x32x16_bf16 v[64:79], v[32:35], v[40:43], v[64:79]
    v_mfma_f32_32x32x16_bf16 v[80:95], v[32:35], v[44:47], v[80:95]
    s_sub_u32 s12, s12, 1
    s_cmp_lg_u32 s12, 0
    s_cbranch_scc1 mega_kernel_loop69
    s_waitcnt vmcnt(12)
    s_barrier
    ds_read_b128 v[16:19], v8 offset:24576
    ds_read_b64_tr_b16 v[24:25], v12 offset:24576
    ds_read_b64_tr_b16 v[26:27], v12 offset:25088
    ds_read_b64_tr_b16 v[28:29], v13 offset:24576
    ds_read_b64_tr_b16 v[30:31], v13 offset:25088
    ds_read_b128 v[32:35], v9 offset:24576
    ds_read_b64_tr_b16 v[40:41], v12 offset:26624
    ds_read_b64_tr_b16 v[42:43], v12 offset:27136
    ds_read_b64_tr_b16 v[44:45], v13 offset:26624
    ds_read_b64_tr_b16 v[46:47], v13 offset:27136
    s_waitcnt lgkmcnt(5)
    v_mfma_f32_32x32x16_bf16 v[64:79], v[16:19], v[24:27], v[64:79]
    v_mfma_f32_32x32x16_bf16 v[80:95], v[16:19], v[28:31], v[80:95]
    ds_read_b128 v[16:19], v10 offset:24576
    ds_read_b64_tr_b16 v[24:25], v12 offset:28672
    ds_read_b64_tr_b16 v[26:27], v12 offset:29184
    ds_read_b64_tr_b16 v[28:29], v13 offset:28672
    ds_read_b64_tr_b16 v[30:31], v13 offset:29184
    s_waitcnt lgkmcnt(5)
    v_mfma_f32_32x32x16_bf16 v[64:79], v[32:35], v[40:43], v[64:79]
    v_mfma_f32_32x32x16_bf16 v[80:95], v[32:35], v[44:47], v[80:95]
    ds_read_b128 v[32:35], v11 offset:24576
    ds_read_b64_tr_b16 v[40:41], v12 offset:30720
    ds_read_b64_tr_b16 v[42:43], v12 offset:31232
    ds_read_b64_tr_b16 v[44:45], v13 offset:30720
    ds_read_b64_tr_b16 v[46:47], v13 offset:31232
    s_waitcnt lgkmcnt(5)
    v_mfma_f32_32x32x16_bf16 v[64:79], v[16:19], v[24:27], v[64:79]
    v_mfma_f32_32x32x16_bf16 v[80:95], v[16:19], v[28:31], v[80:95]
    s_waitcnt lgkmcnt(0)
    v_mfma_f32_32x32x16_bf16 v[64:79], v[32:35], v[40:43], v[64:79]
    v_mfma_f32_32x32x16_bf16 v[80:95], v[32:35], v[44:47], v[80:95]
    s_waitcnt vmcnt(6)
    s_barrier
    ds_read_b128 v[16:19], v128 offset:0
    ds_read_b64_tr_b16 v[24:25], v132 offset:0
    ds_read_b64_tr_b16 v[26:27], v132 offset:512
    ds_read_b64_tr_b16 v[28:29], v133 offset:0
    ds_read_b64_tr_b16 v[30:31], v133 offset:512
    ds_read_b128 v[32:35], v129 offset:0
    ds_read_b64_tr_b16 v[40:41], v132 offset:2048
    ds_read_b64_tr_b16 v[42:43], v132 offset:2560
    ds_read_b64_tr_b16 v[44:45], v133 offset:2048
    ds_read_b64_tr_b16 v[46:47], v133 offset:2560
    s_waitcnt lgkmcnt(5)
    v_mfma_f32_32x32x16_bf16 v[64:79], v[16:19], v[24:27], v[64:79]
    v_mfma_f32_32x32x16_bf16 v[80:95], v[16:19], v[28:31], v[80:95]
    ds_read_b128 v[16:19], v130 offset:0
    ds_read_b64_tr_b16 v[24:25], v132 offset:4096
    ds_read_b64_tr_b16 v[26:27], v132 offset:4608
    ds_read_b64_tr_b16 v[28:29], v133 offset:4096
    ds_read_b64_tr_b16 v[30:31], v133 offset:4608
    s_waitcnt lgkmcnt(5)
    v_mfma_f32_32x32x16_bf16 v[64:79], v[32:35], v[40:43], v[64:79]
    v_mfma_f32_32x32x16_bf16 v[80:95], v[32:35], v[44:47], v[80:95]
    ds_read_b128 v[32:35], v131 offset:0
    ds_read_b64_tr_b16 v[40:41], v132 offset:6144
    ds_read_b64_tr_b16 v[42:43], v132 offset:6656
    ds_read_b64_tr_b16 v[44:45], v133 offset:6144
    ds_read_b64_tr_b16 v[46:47], v133 offset:6656
    s_waitcnt lgkmcnt(5)
    v_mfma_f32_32x32x16_bf16 v[64:79], v[16:19], v[24:27], v[64:79]
    v_mfma_f32_32x32x16_bf16 v[80:95], v[16:19], v[28:31], v[80:95]
    s_waitcnt lgkmcnt(0)
    v_mfma_f32_32x32x16_bf16 v[64:79], v[32:35], v[40:43], v[64:79]
    v_mfma_f32_32x32x16_bf16 v[80:95], v[32:35], v[44:47], v[80:95]
    s_waitcnt vmcnt(0)
    s_barrier
    ds_read_b128 v[16:19], v128 offset:24576
    ds_read_b64_tr_b16 v[24:25], v132 offset:24576
    ds_read_b64_tr_b16 v[26:27], v132 offset:25088
    ds_read_b64_tr_b16 v[28:29], v133 offset:24576
    ds_read_b64_tr_b16 v[30:31], v133 offset:25088
    ds_read_b128 v[32:35], v129 offset:24576
    ds_read_b64_tr_b16 v[40:41], v132 offset:26624
    ds_read_b64_tr_b16 v[42:43], v132 offset:27136
    ds_read_b64_tr_b16 v[44:45], v133 offset:26624
    ds_read_b64_tr_b16 v[46:47], v133 offset:27136
    s_waitcnt lgkmcnt(5)
    v_mfma_f32_32x32x16_bf16 v[64:79], v[16:19], v[24:27], v[64:79]
    v_mfma_f32_32x32x16_bf16 v[80:95], v[16:19], v[28:31], v[80:95]
    ds_read_b128 v[16:19], v130 offset:24576
    ds_read_b64_tr_b16 v[24:25], v132 offset:28672
    ds_read_b64_tr_b16 v[26:27], v132 offset:29184
    ds_read_b64_tr_b16 v[28:29], v133 offset:28672
    ds_read_b64_tr_b16 v[30:31], v133 offset:29184
    s_waitcnt lgkmcnt(5)
    v_mfma_f32_32x32x16_bf16 v[64:79], v[32:35], v[40:43], v[64:79]
    v_mfma_f32_32x32x16_bf16 v[80:95], v[32:35], v[44:47], v[80:95]
    ds_read_b128 v[32:35], v131 offset:24576
    ds_read_b64_tr_b16 v[40:41], v132 offset:30720
    ds_read_b64_tr_b16 v[42:43], v132 offset:31232
    ds_read_b64_tr_b16 v[44:45], v133 offset:30720
    ds_read_b64_tr_b16 v[46:47], v133 offset:31232
    s_waitcnt lgkmcnt(5)
    v_mfma_f32_32x32x16_bf16 v[64:79], v[16:19], v[24:27], v[64:79]
    v_mfma_f32_32x32x16_bf16 v[80:95], v[16:19], v[28:31], v[80:95]
    s_waitcnt lgkmcnt(0)
    v_mfma_f32_32x32x16_bf16 v[64:79], v[32:35], v[40:43], v[64:79]
    v_mfma_f32_32x32x16_bf16 v[80:95], v[32:35], v[44:47], v[80:95]
    s_nop 15
    v_and_b32 v48, 63, v0
    v_lshrrev_b32 v49, 6, v0
    v_lshrrev_b32 v53, 1, v49
    v_and_b32 v54, 1, v49
    v_and_b32 v55, 31, v48
    v_lshrrev_b32 v56, 5, v48
    s_mov_b64 s[16:17], s[78:79]
    s_add_u32 s16, s16, 1458176
    s_addc_u32 s17, s17, 0
    s_and_b32 s17, s17, 0xffff
    s_mov_b32 s18, 5242880
    s_mov_b32 s19, 0x00020000
    s_mul_i32 s12, s13, 64
    v_mul_u32_u24 v57, 32, v53
    v_lshlrev_b32 v58, 2, v56
    v_add_u32 v57, v57, v58
    v_add_u32 v57, s12, v57
    s_movk_i32 s12, 2560
    v_mul_lo_u32 v57, v57, s12
    v_lshlrev_b32 v58, 6, v54
    v_add_u32 v58, v58, v55
    s_lshl_b32 s12, s14, 7
    v_add_u32 v58, s12, v58
    v_lshlrev_b32 v58, 2, v58
    v_add_u32 v57, v57, v58
    s_mov_b32 s12, 0
    buffer_atomic_add_f32 v64, v57, s[16:19], s12 offen
    s_mov_b32 s12, 2560
    buffer_atomic_add_f32 v65, v57, s[16:19], s12 offen
    s_mov_b32 s12, 5120
    buffer_atomic_add_f32 v66, v57, s[16:19], s12 offen
    s_mov_b32 s12, 7680
    buffer_atomic_add_f32 v67, v57, s[16:19], s12 offen
    s_mov_b32 s12, 20480
    buffer_atomic_add_f32 v68, v57, s[16:19], s12 offen
    s_mov_b32 s12, 23040
    buffer_atomic_add_f32 v69, v57, s[16:19], s12 offen
    s_mov_b32 s12, 25600
    buffer_atomic_add_f32 v70, v57, s[16:19], s12 offen
    s_mov_b32 s12, 28160
    buffer_atomic_add_f32 v71, v57, s[16:19], s12 offen
    s_mov_b32 s12, 40960
    buffer_atomic_add_f32 v72, v57, s[16:19], s12 offen
    s_mov_b32 s12, 43520
    buffer_atomic_add_f32 v73, v57, s[16:19], s12 offen
    s_mov_b32 s12, 46080
    buffer_atomic_add_f32 v74, v57, s[16:19], s12 offen
    s_mov_b32 s12, 48640
    buffer_atomic_add_f32 v75, v57, s[16:19], s12 offen
    s_mov_b32 s12, 61440
    buffer_atomic_add_f32 v76, v57, s[16:19], s12 offen
    s_mov_b32 s12, 64000
    buffer_atomic_add_f32 v77, v57, s[16:19], s12 offen
    s_mov_b32 s12, 66560
    buffer_atomic_add_f32 v78, v57, s[16:19], s12 offen
    s_mov_b32 s12, 69120
    buffer_atomic_add_f32 v79, v57, s[16:19], s12 offen
    s_mov_b32 s12, 128
    buffer_atomic_add_f32 v80, v57, s[16:19], s12 offen
    s_mov_b32 s12, 2688
    buffer_atomic_add_f32 v81, v57, s[16:19], s12 offen
    s_mov_b32 s12, 5248
    buffer_atomic_add_f32 v82, v57, s[16:19], s12 offen
    s_mov_b32 s12, 7808
    buffer_atomic_add_f32 v83, v57, s[16:19], s12 offen
    s_mov_b32 s12, 20608
    buffer_atomic_add_f32 v84, v57, s[16:19], s12 offen
    s_mov_b32 s12, 23168
    buffer_atomic_add_f32 v85, v57, s[16:19], s12 offen
    s_mov_b32 s12, 25728
    buffer_atomic_add_f32 v86, v57, s[16:19], s12 offen
    s_mov_b32 s12, 28288
    buffer_atomic_add_f32 v87, v57, s[16:19], s12 offen
    s_mov_b32 s12, 41088
    buffer_atomic_add_f32 v88, v57, s[16:19], s12 offen
    s_mov_b32 s12, 43648
    buffer_atomic_add_f32 v89, v57, s[16:19], s12 offen
    s_mov_b32 s12, 46208
    buffer_atomic_add_f32 v90, v57, s[16:19], s12 offen
    s_mov_b32 s12, 48768
    buffer_atomic_add_f32 v91, v57, s[16:19], s12 offen
    s_mov_b32 s12, 61568
    buffer_atomic_add_f32 v92, v57, s[16:19], s12 offen
    s_mov_b32 s12, 64128
    buffer_atomic_add_f32 v93, v57, s[16:19], s12 offen
    s_mov_b32 s12, 66688
    buffer_atomic_add_f32 v94, v57, s[16:19], s12 offen
    s_mov_b32 s12, 69248
    buffer_atomic_add_f32 v95, v57, s[16:19], s12 offen
    s_waitcnt vmcnt(0)
    s_barrier
    s_cmp_lg_u32 s94, 0
    s_cbranch_scc1 mega_kernel_sg70
    s_lshl_b32 s93, s91, 7
    s_add_u32 s93, s93, 22528
    v_mov_b32 v1, s93
    v_mov_b32 v2, 1
    s_mov_b64 exec, 1
    buffer_atomic_add v2, v1, s[80:83], 0 offen sc1
    s_mov_b64 exec, -1
mega_kernel_sg70:
    s_add_u32 s91, s91, 1
    s_cmp_lt_u32 s91, 16
    s_cbranch_scc1 mega_kernel_lwo63
    s_branch mega_kernel_done1
mega_kernel_bln47:
    s_mov_b32 s91, 0
mega_kernel_lln71:
    s_cmp_lg_u32 s94, 0
    s_cbranch_scc1 mega_kernel_wd73
    s_lshl_b32 s93, s91, 7
    s_add_u32 s93, s93, 22528
    v_mov_b32 v1, s93
    s_mov_b32 s95, 0
mega_kernel_wl72:
    buffer_load_dword v2, v1, s[80:83], 0 offen sc1
    s_waitcnt vmcnt(0)
    v_cmp_gt_u32 vcc, 40, v2
    s_nop 0
    s_cbranch_vccz mega_kernel_wok74
    s_cmp_ge_u32 s91, 14
    s_cbranch_scc1 mega_kernel_wfast75
    s_sleep 48
mega_kernel_wfast75:
    s_sleep 4
    s_add_u32 s95, s95, 1
    s_cmp_lt_u32 s95, 1000000
    s_cbranch_scc1 mega_kernel_wl72
    s_branch mega_kernel_done1
mega_kernel_wok74:
mega_kernel_wd73:
    s_barrier
    s_sub_u32 s92, s90, 72
    s_lshl_b32 s13, s91, 7
    s_lshl_b32 s92, s92, 4
    s_add_u32 s13, s13, s92
    s_mov_b32 s31, s13
    s_mov_b64 s[8:9], s[48:49]
    s_and_b32 s9, s9, 0xffff
    s_mov_b32 s10, 2621440
    s_mov_b32 s11, 0x00020000
    s_mov_b64 s[12:13], s[78:79]
    s_and_b32 s13, s13, 0xffff
    s_mov_b32 s14, 15360
    s_mov_b32 s15, 0x00020000
    s_mov_b64 s[16:17], s[78:79]
    s_add_u32 s16, s16, 131514368
    s_addc_u32 s17, s17, 0
    s_and_b32 s17, s17, 0xffff
    s_mov_b32 s18, 2621440
    s_mov_b32 s19, 0x00020000
    s_mov_b64 s[20:21], s[78:79]
    s_add_u32 s20, s20, 134135808
    s_addc_u32 s21, s21, 0
    s_and_b32 s21, s21, 0xffff
    s_mov_b32 s22, 2621440
    s_mov_b32 s23, 0x00020000
    s_mov_b64 s[24:25], s[78:79]
    s_add_u32 s24, s24, 1458176
    s_addc_u32 s25, s25, 0
    s_and_b32 s25, s25, 0xffff
    s_mov_b32 s26, 5242880
    s_mov_b32 s27, 0x00020000
    v_and_b32 v1, 63, v0
    v_lshrrev_b32 v2, 6, v0
    v_lshlrev_b32 v2, 2, v2
    v_add_u32 v2, s31, v2
    s_movk_i32 s28, 1280
    v_mul_lo_u32 v2, v2, s28
    v_lshlrev_b32 v3, 2, v1
    v_add_u32 v2, v2, v3
    v_lshlrev_b32 v58, 1, v2
    v_lshlrev_b32 v3, 3, v1
    s_mov_b32 s32, 0
    s_mov_b32 s36, 0
    s_mov_b32 s33, 1280
    s_mov_b32 s37, 2560
    s_mov_b32 s34, 2560
    s_mov_b32 s38, 5120
    s_mov_b32 s35, 3840
    s_mov_b32 s39, 7680
    buffer_load_dwordx2 v[106:107], v58, s[24:27], s36 offen offset:0
    buffer_load_dwordx2 v[108:109], v58, s[24:27], s36 offen offset:512
    buffer_load_dwordx2 v[110:111], v58, s[24:27], s36 offen offset:1024
    buffer_load_dwordx2 v[112:113], v58, s[24:27], s36 offen offset:1536
    buffer_load_dwordx2 v[114:115], v58, s[24:27], s36 offen offset:2048
    buffer_load_dword v100, v2, s[8:11], s32 offen offset:0
    buffer_load_dword v101, v2, s[8:11], s32 offen offset:256
    buffer_load_dword v102, v2, s[8:11], s32 offen offset:512
    buffer_load_dword v103, v2, s[8:11], s32 offen offset:768
    buffer_load_dword v104, v2, s[8:11], s32 offen offset:1024
    buffer_load_dwordx2 v[122:123], v58, s[24:27], s37 offen offset:0
    buffer_load_dwordx2 v[124:125], v58, s[24:27], s37 offen offset:512
    buffer_load_dwordx2 v[126:127], v58, s[24:27], s37 offen offset:1024
    buffer_load_dwordx2 v[128:129], v58, s[24:27], s37 offen offset:1536
    buffer_load_dwordx2 v[130:131], v58, s[24:27], s37 offen offset:2048
    buffer_load_dword v116, v2, s[8:11], s33 offen offset:0
    buffer_load_dword v117, v2, s[8:11], s33 offen offset:256
    buffer_load_dword v118, v2, s[8:11], s33 offen offset:512
    buffer_load_dword v119, v2, s[8:11], s33 offen offset:768
    buffer_load_dword v120, v2, s[8:11], s33 offen offset:1024
    buffer_load_dwordx2 v[138:139], v58, s[24:27], s38 offen offset:0
    buffer_load_dwordx2 v[140:141], v58, s[24:27], s38 offen offset:512
    buffer_load_dwordx2 v[142:143], v58, s[24:27], s38 offen offset:1024
    buffer_load_dwordx2 v[144:145], v58, s[24:27], s38 offen offset:1536
    buffer_load_dwordx2 v[146:147], v58, s[24:27], s38 offen offset:2048
    buffer_load_dword v132, v2, s[8:11], s34 offen offset:0
    buffer_load_dword v133, v2, s[8:11], s34 offen offset:256
    buffer_load_dword v134, v2, s[8:11], s34 offen offset:512
    buffer_load_dword v135, v2, s[8:11], s34 offen offset:768
    buffer_load_dword v136, v2, s[8:11], s34 offen offset:1024
    buffer_load_dwordx2 v[154:155], v58, s[24:27], s39 offen offset:0
    buffer_load_dwordx2 v[156:157], v58, s[24:27], s39 offen offset:512
    buffer_load_dwordx2 v[158:159], v58, s[24:27], s39 offen offset:1024
    buffer_load_dwordx2 v[160:161], v58, s[24:27], s39 offen offset:1536
    buffer_load_dwordx2 v[162:163], v58, s[24:27], s39 offen offset:2048
    buffer_load_dword v148, v2, s[8:11], s35 offen offset:0
    buffer_load_dword v149, v2, s[8:11], s35 offen offset:256
    buffer_load_dword v150, v2, s[8:11], s35 offen offset:512
    buffer_load_dword v151, v2, s[8:11], s35 offen offset:768
    buffer_load_dword v152, v2, s[8:11], s35 offen offset:1024
    s_mov_b32 s29, 5120
    buffer_load_dwordx2 v[60:61], v3, s[12:15], s29 offen offset:0
    buffer_load_dwordx2 v[62:63], v3, s[12:15], s29 offen offset:512
    buffer_load_dwordx2 v[64:65], v3, s[12:15], s29 offen offset:1024
    buffer_load_dwordx2 v[66:67], v3, s[12:15], s29 offen offset:1536
    buffer_load_dwordx2 v[68:69], v3, s[12:15], s29 offen offset:2048
    s_mov_b32 s29, 10240
    buffer_load_dwordx2 v[32:33], v3, s[12:15], s29 offen offset:0
    buffer_load_dwordx2 v[34:35], v3, s[12:15], s29 offen offset:512
    buffer_load_dwordx2 v[36:37], v3, s[12:15], s29 offen offset:1024
    buffer_load_dwordx2 v[38:39], v3, s[12:15], s29 offen offset:1536
    buffer_load_dwordx2 v[40:41], v3, s[12:15], s29 offen offset:2048
    s_mov_b32 s29, 7680
    buffer_load_dwordx2 v[44:45], v3, s[12:15], s29 offen offset:0
    buffer_load_dwordx2 v[46:47], v3, s[12:15], s29 offen offset:512
    buffer_load_dwordx2 v[48:49], v3, s[12:15], s29 offen offset:1024
    buffer_load_dwordx2 v[50:51], v3, s[12:15], s29 offen offset:1536
    buffer_load_dwordx2 v[52:53], v3, s[12:15], s29 offen offset:2048
    s_waitcnt vmcnt(0)
    v_cvt_pk_bf16_f32 v106, v106, v106
    v_and_b32 v106, 0xffff0000, v106
    v_mul_f32 v106, v106, v60
    v_cvt_pk_bf16_f32 v106, v106, v106
    v_and_b32 v106, 0xffff0000, v106
    v_lshlrev_b32 v170, 16, v100
    v_add_f32 v170, v170, v106
    v_cvt_pk_bf16_f32 v170, v170, v170
    v_and_b32 v170, 0xffff0000, v170
    v_cvt_pk_bf16_f32 v107, v107, v107
    v_and_b32 v107, 0xffff0000, v107
    v_mul_f32 v107, v107, v61
    v_cvt_pk_bf16_f32 v107, v107, v107
    v_and_b32 v107, 0xffff0000, v107
    v_and_b32 v171, 0xffff0000, v100
    v_add_f32 v171, v171, v107
    v_cvt_pk_bf16_f32 v171, v171, v171
    v_and_b32 v171, 0xffff0000, v171
    v_cvt_pk_bf16_f32 v108, v108, v108
    v_and_b32 v108, 0xffff0000, v108
    v_mul_f32 v108, v108, v62
    v_cvt_pk_bf16_f32 v108, v108, v108
    v_and_b32 v108, 0xffff0000, v108
    v_lshlrev_b32 v172, 16, v101
    v_add_f32 v172, v172, v108
    v_cvt_pk_bf16_f32 v172, v172, v172
    v_and_b32 v172, 0xffff0000, v172
    v_cvt_pk_bf16_f32 v109, v109, v109
    v_and_b32 v109, 0xffff0000, v109
    v_mul_f32 v109, v109, v63
    v_cvt_pk_bf16_f32 v109, v109, v109
    v_and_b32 v109, 0xffff0000, v109
    v_and_b32 v173, 0xffff0000, v101
    v_add_f32 v173, v173, v109
    v_cvt_pk_bf16_f32 v173, v173, v173
    v_and_b32 v173, 0xffff0000, v173
    v_cvt_pk_bf16_f32 v110, v110, v110
    v_and_b32 v110, 0xffff0000, v110
    v_mul_f32 v110, v110, v64
    v_cvt_pk_bf16_f32 v110, v110, v110
    v_and_b32 v110, 0xffff0000, v110
    v_lshlrev_b32 v174, 16, v102
    v_add_f32 v174, v174, v110
    v_cvt_pk_bf16_f32 v174, v174, v174
    v_and_b32 v174, 0xffff0000, v174
    v_cvt_pk_bf16_f32 v111, v111, v111
    v_and_b32 v111, 0xffff0000, v111
    v_mul_f32 v111, v111, v65
    v_cvt_pk_bf16_f32 v111, v111, v111
    v_and_b32 v111, 0xffff0000, v111
    v_and_b32 v175, 0xffff0000, v102
    v_add_f32 v175, v175, v111
    v_cvt_pk_bf16_f32 v175, v175, v175
    v_and_b32 v175, 0xffff0000, v175
    v_cvt_pk_bf16_f32 v112, v112, v112
    v_and_b32 v112, 0xffff0000, v112
    v_mul_f32 v112, v112, v66
    v_cvt_pk_bf16_f32 v112, v112, v112
    v_and_b32 v112, 0xffff0000, v112
    v_lshlrev_b32 v176, 16, v103
    v_add_f32 v176, v176, v112
    v_cvt_pk_bf16_f32 v176, v176, v176
    v_and_b32 v176, 0xffff0000, v176
    v_cvt_pk_bf16_f32 v113, v113, v113
    v_and_b32 v113, 0xffff0000, v113
    v_mul_f32 v113, v113, v67
    v_cvt_pk_bf16_f32 v113, v113, v113
    v_and_b32 v113, 0xffff0000, v113
    v_and_b32 v177, 0xffff0000, v103
    v_add_f32 v177, v177, v113
    v_cvt_pk_bf16_f32 v177, v177, v177
    v_and_b32 v177, 0xffff0000, v177
    v_cvt_pk_bf16_f32 v114, v114, v114
    v_and_b32 v114, 0xffff0000, v114
    v_mul_f32 v114, v114, v68
    v_cvt_pk_bf16_f32 v114, v114, v114
    v_and_b32 v114, 0xffff0000, v114
    v_lshlrev_b32 v178, 16, v104
    v_add_f32 v178, v178, v114
    v_cvt_pk_bf16_f32 v178, v178, v178
    v_and_b32 v178, 0xffff0000, v178
    v_cvt_pk_bf16_f32 v115, v115, v115
    v_and_b32 v115, 0xffff0000, v115
    v_mul_f32 v115, v115, v69
    v_cvt_pk_bf16_f32 v115, v115, v115
    v_and_b32 v115, 0xffff0000, v115
    v_and_b32 v179, 0xffff0000, v104
    v_add_f32 v179, v179, v115
    v_cvt_pk_bf16_f32 v179, v179, v179
    v_and_b32 v179, 0xffff0000, v179
    v_cvt_pk_bf16_f32 v100, v170, v171
    v_cvt_pk_bf16_f32 v101, v172, v173
    v_cvt_pk_bf16_f32 v102, v174, v175
    v_cvt_pk_bf16_f32 v103, v176, v177
    v_cvt_pk_bf16_f32 v104, v178, v179
    buffer_store_dword v100, v2, s[16:19], s32 offen offset:0 sc0 sc1
    buffer_store_dword v101, v2, s[16:19], s32 offen offset:256 sc0 sc1
    buffer_store_dword v102, v2, s[16:19], s32 offen offset:512 sc0 sc1
    buffer_store_dword v103, v2, s[16:19], s32 offen offset:768 sc0 sc1
    buffer_store_dword v104, v2, s[16:19], s32 offen offset:1024 sc0 sc1
    v_add_f32 v4, v170, v171
    v_add_f32 v4, v4, v172
    v_add_f32 v4, v4, v173
    v_add_f32 v4, v4, v174
    v_add_f32 v4, v4, v175
    v_add_f32 v4, v4, v176
    v_add_f32 v4, v4, v177
    v_add_f32 v4, v4, v178
    v_add_f32 v4, v4, v179
    v_cvt_pk_bf16_f32 v122, v122, v122
    v_and_b32 v122, 0xffff0000, v122
    v_mul_f32 v122, v122, v60
    v_cvt_pk_bf16_f32 v122, v122, v122
    v_and_b32 v122, 0xffff0000, v122
    v_lshlrev_b32 v180, 16, v116
    v_add_f32 v180, v180, v122
    v_cvt_pk_bf16_f32 v180, v180, v180
    v_and_b32 v180, 0xffff0000, v180
    v_cvt_pk_bf16_f32 v123, v123, v123
    v_and_b32 v123, 0xffff0000, v123
    v_mul_f32 v123, v123, v61
    v_cvt_pk_bf16_f32 v123, v123, v123
    v_and_b32 v123, 0xffff0000, v123
    v_and_b32 v181, 0xffff0000, v116
    v_add_f32 v181, v181, v123
    v_cvt_pk_bf16_f32 v181, v181, v181
    v_and_b32 v181, 0xffff0000, v181
    v_cvt_pk_bf16_f32 v124, v124, v124
    v_and_b32 v124, 0xffff0000, v124
    v_mul_f32 v124, v124, v62
    v_cvt_pk_bf16_f32 v124, v124, v124
    v_and_b32 v124, 0xffff0000, v124
    v_lshlrev_b32 v182, 16, v117
    v_add_f32 v182, v182, v124
    v_cvt_pk_bf16_f32 v182, v182, v182
    v_and_b32 v182, 0xffff0000, v182
    v_cvt_pk_bf16_f32 v125, v125, v125
    v_and_b32 v125, 0xffff0000, v125
    v_mul_f32 v125, v125, v63
    v_cvt_pk_bf16_f32 v125, v125, v125
    v_and_b32 v125, 0xffff0000, v125
    v_and_b32 v183, 0xffff0000, v117
    v_add_f32 v183, v183, v125
    v_cvt_pk_bf16_f32 v183, v183, v183
    v_and_b32 v183, 0xffff0000, v183
    v_cvt_pk_bf16_f32 v126, v126, v126
    v_and_b32 v126, 0xffff0000, v126
    v_mul_f32 v126, v126, v64
    v_cvt_pk_bf16_f32 v126, v126, v126
    v_and_b32 v126, 0xffff0000, v126
    v_lshlrev_b32 v184, 16, v118
    v_add_f32 v184, v184, v126
    v_cvt_pk_bf16_f32 v184, v184, v184
    v_and_b32 v184, 0xffff0000, v184
    v_cvt_pk_bf16_f32 v127, v127, v127
    v_and_b32 v127, 0xffff0000, v127
    v_mul_f32 v127, v127, v65
    v_cvt_pk_bf16_f32 v127, v127, v127
    v_and_b32 v127, 0xffff0000, v127
    v_and_b32 v185, 0xffff0000, v118
    v_add_f32 v185, v185, v127
    v_cvt_pk_bf16_f32 v185, v185, v185
    v_and_b32 v185, 0xffff0000, v185
    v_cvt_pk_bf16_f32 v128, v128, v128
    v_and_b32 v128, 0xffff0000, v128
    v_mul_f32 v128, v128, v66
    v_cvt_pk_bf16_f32 v128, v128, v128
    v_and_b32 v128, 0xffff0000, v128
    v_lshlrev_b32 v186, 16, v119
    v_add_f32 v186, v186, v128
    v_cvt_pk_bf16_f32 v186, v186, v186
    v_and_b32 v186, 0xffff0000, v186
    v_cvt_pk_bf16_f32 v129, v129, v129
    v_and_b32 v129, 0xffff0000, v129
    v_mul_f32 v129, v129, v67
    v_cvt_pk_bf16_f32 v129, v129, v129
    v_and_b32 v129, 0xffff0000, v129
    v_and_b32 v187, 0xffff0000, v119
    v_add_f32 v187, v187, v129
    v_cvt_pk_bf16_f32 v187, v187, v187
    v_and_b32 v187, 0xffff0000, v187
    v_cvt_pk_bf16_f32 v130, v130, v130
    v_and_b32 v130, 0xffff0000, v130
    v_mul_f32 v130, v130, v68
    v_cvt_pk_bf16_f32 v130, v130, v130
    v_and_b32 v130, 0xffff0000, v130
    v_lshlrev_b32 v188, 16, v120
    v_add_f32 v188, v188, v130
    v_cvt_pk_bf16_f32 v188, v188, v188
    v_and_b32 v188, 0xffff0000, v188
    v_cvt_pk_bf16_f32 v131, v131, v131
    v_and_b32 v131, 0xffff0000, v131
    v_mul_f32 v131, v131, v69
    v_cvt_pk_bf16_f32 v131, v131, v131
    v_and_b32 v131, 0xffff0000, v131
    v_and_b32 v189, 0xffff0000, v120
    v_add_f32 v189, v189, v131
    v_cvt_pk_bf16_f32 v189, v189, v189
    v_and_b32 v189, 0xffff0000, v189
    v_cvt_pk_bf16_f32 v116, v180, v181
    v_cvt_pk_bf16_f32 v117, v182, v183
    v_cvt_pk_bf16_f32 v118, v184, v185
    v_cvt_pk_bf16_f32 v119, v186, v187
    v_cvt_pk_bf16_f32 v120, v188, v189
    buffer_store_dword v116, v2, s[16:19], s33 offen offset:0 sc0 sc1
    buffer_store_dword v117, v2, s[16:19], s33 offen offset:256 sc0 sc1
    buffer_store_dword v118, v2, s[16:19], s33 offen offset:512 sc0 sc1
    buffer_store_dword v119, v2, s[16:19], s33 offen offset:768 sc0 sc1
    buffer_store_dword v120, v2, s[16:19], s33 offen offset:1024 sc0 sc1
    v_add_f32 v5, v180, v181
    v_add_f32 v5, v5, v182
    v_add_f32 v5, v5, v183
    v_add_f32 v5, v5, v184
    v_add_f32 v5, v5, v185
    v_add_f32 v5, v5, v186
    v_add_f32 v5, v5, v187
    v_add_f32 v5, v5, v188
    v_add_f32 v5, v5, v189
    v_cvt_pk_bf16_f32 v138, v138, v138
    v_and_b32 v138, 0xffff0000, v138
    v_mul_f32 v138, v138, v60
    v_cvt_pk_bf16_f32 v138, v138, v138
    v_and_b32 v138, 0xffff0000, v138
    v_lshlrev_b32 v190, 16, v132
    v_add_f32 v190, v190, v138
    v_cvt_pk_bf16_f32 v190, v190, v190
    v_and_b32 v190, 0xffff0000, v190
    v_cvt_pk_bf16_f32 v139, v139, v139
    v_and_b32 v139, 0xffff0000, v139
    v_mul_f32 v139, v139, v61
    v_cvt_pk_bf16_f32 v139, v139, v139
    v_and_b32 v139, 0xffff0000, v139
    v_and_b32 v191, 0xffff0000, v132
    v_add_f32 v191, v191, v139
    v_cvt_pk_bf16_f32 v191, v191, v191
    v_and_b32 v191, 0xffff0000, v191
    v_cvt_pk_bf16_f32 v140, v140, v140
    v_and_b32 v140, 0xffff0000, v140
    v_mul_f32 v140, v140, v62
    v_cvt_pk_bf16_f32 v140, v140, v140
    v_and_b32 v140, 0xffff0000, v140
    v_lshlrev_b32 v192, 16, v133
    v_add_f32 v192, v192, v140
    v_cvt_pk_bf16_f32 v192, v192, v192
    v_and_b32 v192, 0xffff0000, v192
    v_cvt_pk_bf16_f32 v141, v141, v141
    v_and_b32 v141, 0xffff0000, v141
    v_mul_f32 v141, v141, v63
    v_cvt_pk_bf16_f32 v141, v141, v141
    v_and_b32 v141, 0xffff0000, v141
    v_and_b32 v193, 0xffff0000, v133
    v_add_f32 v193, v193, v141
    v_cvt_pk_bf16_f32 v193, v193, v193
    v_and_b32 v193, 0xffff0000, v193
    v_cvt_pk_bf16_f32 v142, v142, v142
    v_and_b32 v142, 0xffff0000, v142
    v_mul_f32 v142, v142, v64
    v_cvt_pk_bf16_f32 v142, v142, v142
    v_and_b32 v142, 0xffff0000, v142
    v_lshlrev_b32 v194, 16, v134
    v_add_f32 v194, v194, v142
    v_cvt_pk_bf16_f32 v194, v194, v194
    v_and_b32 v194, 0xffff0000, v194
    v_cvt_pk_bf16_f32 v143, v143, v143
    v_and_b32 v143, 0xffff0000, v143
    v_mul_f32 v143, v143, v65
    v_cvt_pk_bf16_f32 v143, v143, v143
    v_and_b32 v143, 0xffff0000, v143
    v_and_b32 v195, 0xffff0000, v134
    v_add_f32 v195, v195, v143
    v_cvt_pk_bf16_f32 v195, v195, v195
    v_and_b32 v195, 0xffff0000, v195
    v_cvt_pk_bf16_f32 v144, v144, v144
    v_and_b32 v144, 0xffff0000, v144
    v_mul_f32 v144, v144, v66
    v_cvt_pk_bf16_f32 v144, v144, v144
    v_and_b32 v144, 0xffff0000, v144
    v_lshlrev_b32 v196, 16, v135
    v_add_f32 v196, v196, v144
    v_cvt_pk_bf16_f32 v196, v196, v196
    v_and_b32 v196, 0xffff0000, v196
    v_cvt_pk_bf16_f32 v145, v145, v145
    v_and_b32 v145, 0xffff0000, v145
    v_mul_f32 v145, v145, v67
    v_cvt_pk_bf16_f32 v145, v145, v145
    v_and_b32 v145, 0xffff0000, v145
    v_and_b32 v197, 0xffff0000, v135
    v_add_f32 v197, v197, v145
    v_cvt_pk_bf16_f32 v197, v197, v197
    v_and_b32 v197, 0xffff0000, v197
    v_cvt_pk_bf16_f32 v146, v146, v146
    v_and_b32 v146, 0xffff0000, v146
    v_mul_f32 v146, v146, v68
    v_cvt_pk_bf16_f32 v146, v146, v146
    v_and_b32 v146, 0xffff0000, v146
    v_lshlrev_b32 v198, 16, v136
    v_add_f32 v198, v198, v146
    v_cvt_pk_bf16_f32 v198, v198, v198
    v_and_b32 v198, 0xffff0000, v198
    v_cvt_pk_bf16_f32 v147, v147, v147
    v_and_b32 v147, 0xffff0000, v147
    v_mul_f32 v147, v147, v69
    v_cvt_pk_bf16_f32 v147, v147, v147
    v_and_b32 v147, 0xffff0000, v147
    v_and_b32 v199, 0xffff0000, v136
    v_add_f32 v199, v199, v147
    v_cvt_pk_bf16_f32 v199, v199, v199
    v_and_b32 v199, 0xffff0000, v199
    v_cvt_pk_bf16_f32 v132, v190, v191
    v_cvt_pk_bf16_f32 v133, v192, v193
    v_cvt_pk_bf16_f32 v134, v194, v195
    v_cvt_pk_bf16_f32 v135, v196, v197
    v_cvt_pk_bf16_f32 v136, v198, v199
    buffer_store_dword v132, v2, s[16:19], s34 offen offset:0 sc0 sc1
    buffer_store_dword v133, v2, s[16:19], s34 offen offset:256 sc0 sc1
    buffer_store_dword v134, v2, s[16:19], s34 offen offset:512 sc0 sc1
    buffer_store_dword v135, v2, s[16:19], s34 offen offset:768 sc0 sc1
    buffer_store_dword v136, v2, s[16:19], s34 offen offset:1024 sc0 sc1
    v_add_f32 v6, v190, v191
    v_add_f32 v6, v6, v192
    v_add_f32 v6, v6, v193
    v_add_f32 v6, v6, v194
    v_add_f32 v6, v6, v195
    v_add_f32 v6, v6, v196
    v_add_f32 v6, v6, v197
    v_add_f32 v6, v6, v198
    v_add_f32 v6, v6, v199
    v_cvt_pk_bf16_f32 v154, v154, v154
    v_and_b32 v154, 0xffff0000, v154
    v_mul_f32 v154, v154, v60
    v_cvt_pk_bf16_f32 v154, v154, v154
    v_and_b32 v154, 0xffff0000, v154
    v_lshlrev_b32 v200, 16, v148
    v_add_f32 v200, v200, v154
    v_cvt_pk_bf16_f32 v200, v200, v200
    v_and_b32 v200, 0xffff0000, v200
    v_cvt_pk_bf16_f32 v155, v155, v155
    v_and_b32 v155, 0xffff0000, v155
    v_mul_f32 v155, v155, v61
    v_cvt_pk_bf16_f32 v155, v155, v155
    v_and_b32 v155, 0xffff0000, v155
    v_and_b32 v201, 0xffff0000, v148
    v_add_f32 v201, v201, v155
    v_cvt_pk_bf16_f32 v201, v201, v201
    v_and_b32 v201, 0xffff0000, v201
    v_cvt_pk_bf16_f32 v156, v156, v156
    v_and_b32 v156, 0xffff0000, v156
    v_mul_f32 v156, v156, v62
    v_cvt_pk_bf16_f32 v156, v156, v156
    v_and_b32 v156, 0xffff0000, v156
    v_lshlrev_b32 v202, 16, v149
    v_add_f32 v202, v202, v156
    v_cvt_pk_bf16_f32 v202, v202, v202
    v_and_b32 v202, 0xffff0000, v202
    v_cvt_pk_bf16_f32 v157, v157, v157
    v_and_b32 v157, 0xffff0000, v157
    v_mul_f32 v157, v157, v63
    v_cvt_pk_bf16_f32 v157, v157, v157
    v_and_b32 v157, 0xffff0000, v157
    v_and_b32 v203, 0xffff0000, v149
    v_add_f32 v203, v203, v157
    v_cvt_pk_bf16_f32 v203, v203, v203
    v_and_b32 v203, 0xffff0000, v203
    v_cvt_pk_bf16_f32 v158, v158, v158
    v_and_b32 v158, 0xffff0000, v158
    v_mul_f32 v158, v158, v64
    v_cvt_pk_bf16_f32 v158, v158, v158
    v_and_b32 v158, 0xffff0000, v158
    v_lshlrev_b32 v204, 16, v150
    v_add_f32 v204, v204, v158
    v_cvt_pk_bf16_f32 v204, v204, v204
    v_and_b32 v204, 0xffff0000, v204
    v_cvt_pk_bf16_f32 v159, v159, v159
    v_and_b32 v159, 0xffff0000, v159
    v_mul_f32 v159, v159, v65
    v_cvt_pk_bf16_f32 v159, v159, v159
    v_and_b32 v159, 0xffff0000, v159
    v_and_b32 v205, 0xffff0000, v150
    v_add_f32 v205, v205, v159
    v_cvt_pk_bf16_f32 v205, v205, v205
    v_and_b32 v205, 0xffff0000, v205
    v_cvt_pk_bf16_f32 v160, v160, v160
    v_and_b32 v160, 0xffff0000, v160
    v_mul_f32 v160, v160, v66
    v_cvt_pk_bf16_f32 v160, v160, v160
    v_and_b32 v160, 0xffff0000, v160
    v_lshlrev_b32 v206, 16, v151
    v_add_f32 v206, v206, v160
    v_cvt_pk_bf16_f32 v206, v206, v206
    v_and_b32 v206, 0xffff0000, v206
    v_cvt_pk_bf16_f32 v161, v161, v161
    v_and_b32 v161, 0xffff0000, v161
    v_mul_f32 v161, v161, v67
    v_cvt_pk_bf16_f32 v161, v161, v161
    v_and_b32 v161, 0xffff0000, v161
    v_and_b32 v207, 0xffff0000, v151
    v_add_f32 v207, v207, v161
    v_cvt_pk_bf16_f32 v207, v207, v207
    v_and_b32 v207, 0xffff0000, v207
    v_cvt_pk_bf16_f32 v162, v162, v162
    v_and_b32 v162, 0xffff0000, v162
    v_mul_f32 v162, v162, v68
    v_cvt_pk_bf16_f32 v162, v162, v162
    v_and_b32 v162, 0xffff0000, v162
    v_lshlrev_b32 v208, 16, v152
    v_add_f32 v208, v208, v162
    v_cvt_pk_bf16_f32 v208, v208, v208
    v_and_b32 v208, 0xffff0000, v208
    v_cvt_pk_bf16_f32 v163, v163, v163
    v_and_b32 v163, 0xffff0000, v163
    v_mul_f32 v163, v163, v69
    v_cvt_pk_bf16_f32 v163, v163, v163
    v_and_b32 v163, 0xffff0000, v163
    v_and_b32 v209, 0xffff0000, v152
    v_add_f32 v209, v209, v163
    v_cvt_pk_bf16_f32 v209, v209, v209
    v_and_b32 v209, 0xffff0000, v209
    v_cvt_pk_bf16_f32 v148, v200, v201
    v_cvt_pk_bf16_f32 v149, v202, v203
    v_cvt_pk_bf16_f32 v150, v204, v205
    v_cvt_pk_bf16_f32 v151, v206, v207
    v_cvt_pk_bf16_f32 v152, v208, v209
    buffer_store_dword v148, v2, s[16:19], s35 offen offset:0 sc0 sc1
    buffer_store_dword v149, v2, s[16:19], s35 offen offset:256 sc0 sc1
    buffer_store_dword v150, v2, s[16:19], s35 offen offset:512 sc0 sc1
    buffer_store_dword v151, v2, s[16:19], s35 offen offset:768 sc0 sc1
    buffer_store_dword v152, v2, s[16:19], s35 offen offset:1024 sc0 sc1
    v_add_f32 v7, v200, v201
    v_add_f32 v7, v7, v202
    v_add_f32 v7, v7, v203
    v_add_f32 v7, v7, v204
    v_add_f32 v7, v7, v205
    v_add_f32 v7, v7, v206
    v_add_f32 v7, v7, v207
    v_add_f32 v7, v7, v208
    v_add_f32 v7, v7, v209
    ds_swizzle_b32 v8, v4 offset:1055
    ds_swizzle_b32 v9, v5 offset:1055
    ds_swizzle_b32 v10, v6 offset:1055
    ds_swizzle_b32 v11, v7 offset:1055
    s_waitcnt lgkmcnt(0)
    v_add_f32 v4, v4, v8
    v_add_f32 v5, v5, v9
    v_add_f32 v6, v6, v10
    v_add_f32 v7, v7, v11
    ds_swizzle_b32 v8, v4 offset:2079
    ds_swizzle_b32 v9, v5 offset:2079
    ds_swizzle_b32 v10, v6 offset:2079
    ds_swizzle_b32 v11, v7 offset:2079
    s_waitcnt lgkmcnt(0)
    v_add_f32 v4, v4, v8
    v_add_f32 v5, v5, v9
    v_add_f32 v6, v6, v10
    v_add_f32 v7, v7, v11
    ds_swizzle_b32 v8, v4 offset:4127
    ds_swizzle_b32 v9, v5 offset:4127
    ds_swizzle_b32 v10, v6 offset:4127
    ds_swizzle_b32 v11, v7 offset:4127
    s_waitcnt lgkmcnt(0)
    v_add_f32 v4, v4, v8
    v_add_f32 v5, v5, v9
    v_add_f32 v6, v6, v10
    v_add_f32 v7, v7, v11
    ds_swizzle_b32 v8, v4 offset:8223
    ds_swizzle_b32 v9, v5 offset:8223
    ds_swizzle_b32 v10, v6 offset:8223
    ds_swizzle_b32 v11, v7 offset:8223
    s_waitcnt lgkmcnt(0)
    v_add_f32 v4, v4, v8
    v_add_f32 v5, v5, v9
    v_add_f32 v6, v6, v10
    v_add_f32 v7, v7, v11
    ds_swizzle_b32 v8, v4 offset:16415
    ds_swizzle_b32 v9, v5 offset:16415
    ds_swizzle_b32 v10, v6 offset:16415
    ds_swizzle_b32 v11, v7 offset:16415
    s_waitcnt lgkmcnt(0)
    v_add_f32 v4, v4, v8
    v_add_f32 v5, v5, v9
    v_add_f32 v6, v6, v10
    v_add_f32 v7, v7, v11
    v_mov_b32 v8, v4
    v_mov_b32 v9, v5
    v_mov_b32 v10, v6
    v_mov_b32 v11, v7
    s_nop 1
    v_permlane32_swap_b32 v8, v4
    v_permlane32_swap_b32 v9, v5
    v_permlane32_swap_b32 v10, v6
    v_permlane32_swap_b32 v11, v7
    s_nop 0
    v_add_f32 v4, v4, v8
    v_add_f32 v5, v5, v9
    v_add_f32 v6, v6, v10
    v_add_f32 v7, v7, v11
    v_mul_f32 v4, 0x3acccccd, v4
    v_mov_b32 v12, 0
    v_sub_f32 v16, v170, v4
    v_fmac_f32 v12, v16, v16
    v_sub_f32 v16, v171, v4
    v_fmac_f32 v12, v16, v16
    v_sub_f32 v16, v172, v4
    v_fmac_f32 v12, v16, v16
    v_sub_f32 v16, v173, v4
    v_fmac_f32 v12, v16, v16
    v_sub_f32 v16, v174, v4
    v_fmac_f32 v12, v16, v16
    v_sub_f32 v16, v175, v4
    v_fmac_f32 v12, v16, v16
    v_sub_f32 v16, v176, v4
    v_fmac_f32 v12, v16, v16
    v_sub_f32 v16, v177, v4
    v_fmac_f32 v12, v16, v16
    v_sub_f32 v16, v178, v4
    v_fmac_f32 v12, v16, v16
    v_sub_f32 v16, v179, v4
    v_fmac_f32 v12, v16, v16
    v_mul_f32 v5, 0x3acccccd, v5
    v_mov_b32 v13, 0
    v_sub_f32 v16, v180, v5
    v_fmac_f32 v13, v16, v16
    v_sub_f32 v16, v181, v5
    v_fmac_f32 v13, v16, v16
    v_sub_f32 v16, v182, v5
    v_fmac_f32 v13, v16, v16
    v_sub_f32 v16, v183, v5
    v_fmac_f32 v13, v16, v16
    v_sub_f32 v16, v184, v5
    v_fmac_f32 v13, v16, v16
    v_sub_f32 v16, v185, v5
    v_fmac_f32 v13, v16, v16
    v_sub_f32 v16, v186, v5
    v_fmac_f32 v13, v16, v16
    v_sub_f32 v16, v187, v5
    v_fmac_f32 v13, v16, v16
    v_sub_f32 v16, v188, v5
    v_fmac_f32 v13, v16, v16
    v_sub_f32 v16, v189, v5
    v_fmac_f32 v13, v16, v16
    v_mul_f32 v6, 0x3acccccd, v6
    v_mov_b32 v14, 0
    v_sub_f32 v16, v190, v6
    v_fmac_f32 v14, v16, v16
    v_sub_f32 v16, v191, v6
    v_fmac_f32 v14, v16, v16
    v_sub_f32 v16, v192, v6
    v_fmac_f32 v14, v16, v16
    v_sub_f32 v16, v193, v6
    v_fmac_f32 v14, v16, v16
    v_sub_f32 v16, v194, v6
    v_fmac_f32 v14, v16, v16
    v_sub_f32 v16, v195, v6
    v_fmac_f32 v14, v16, v16
    v_sub_f32 v16, v196, v6
    v_fmac_f32 v14, v16, v16
    v_sub_f32 v16, v197, v6
    v_fmac_f32 v14, v16, v16
    v_sub_f32 v16, v198, v6
    v_fmac_f32 v14, v16, v16
    v_sub_f32 v16, v199, v6
    v_fmac_f32 v14, v16, v16
    v_mul_f32 v7, 0x3acccccd, v7
    v_mov_b32 v15, 0
    v_sub_f32 v16, v200, v7
    v_fmac_f32 v15, v16, v16
    v_sub_f32 v16, v201, v7
    v_fmac_f32 v15, v16, v16
    v_sub_f32 v16, v202, v7
    v_fmac_f32 v15, v16, v16
    v_sub_f32 v16, v203, v7
    v_fmac_f32 v15, v16, v16
    v_sub_f32 v16, v204, v7
    v_fmac_f32 v15, v16, v16
    v_sub_f32 v16, v205, v7
    v_fmac_f32 v15, v16, v16
    v_sub_f32 v16, v206, v7
    v_fmac_f32 v15, v16, v16
    v_sub_f32 v16, v207, v7
    v_fmac_f32 v15, v16, v16
    v_sub_f32 v16, v208, v7
    v_fmac_f32 v15, v16, v16
    v_sub_f32 v16, v209, v7
    v_fmac_f32 v15, v16, v16
    ds_swizzle_b32 v8, v12 offset:1055
    ds_swizzle_b32 v9, v13 offset:1055
    ds_swizzle_b32 v10, v14 offset:1055
    ds_swizzle_b32 v11, v15 offset:1055
    s_waitcnt lgkmcnt(0)
    v_add_f32 v12, v12, v8
    v_add_f32 v13, v13, v9
    v_add_f32 v14, v14, v10
    v_add_f32 v15, v15, v11
    ds_swizzle_b32 v8, v12 offset:2079
    ds_swizzle_b32 v9, v13 offset:2079
    ds_swizzle_b32 v10, v14 offset:2079
    ds_swizzle_b32 v11, v15 offset:2079
    s_waitcnt lgkmcnt(0)
    v_add_f32 v12, v12, v8
    v_add_f32 v13, v13, v9
    v_add_f32 v14, v14, v10
    v_add_f32 v15, v15, v11
    ds_swizzle_b32 v8, v12 offset:4127
    ds_swizzle_b32 v9, v13 offset:4127
    ds_swizzle_b32 v10, v14 offset:4127
    ds_swizzle_b32 v11, v15 offset:4127
    s_waitcnt lgkmcnt(0)
    v_add_f32 v12, v12, v8
    v_add_f32 v13, v13, v9
    v_add_f32 v14, v14, v10
    v_add_f32 v15, v15, v11
    ds_swizzle_b32 v8, v12 offset:8223
    ds_swizzle_b32 v9, v13 offset:8223
    ds_swizzle_b32 v10, v14 offset:8223
    ds_swizzle_b32 v11, v15 offset:8223
    s_waitcnt lgkmcnt(0)
    v_add_f32 v12, v12, v8
    v_add_f32 v13, v13, v9
    v_add_f32 v14, v14, v10
    v_add_f32 v15, v15, v11
    ds_swizzle_b32 v8, v12 offset:16415
    ds_swizzle_b32 v9, v13 offset:16415
    ds_swizzle_b32 v10, v14 offset:16415
    ds_swizzle_b32 v11, v15 offset:16415
    s_waitcnt lgkmcnt(0)
    v_add_f32 v12, v12, v8
    v_add_f32 v13, v13, v9
    v_add_f32 v14, v14, v10
    v_add_f32 v15, v15, v11
    v_mov_b32 v8, v12
    v_mov_b32 v9, v13
    v_mov_b32 v10, v14
    v_mov_b32 v11, v15
    s_nop 1
    v_permlane32_swap_b32 v8, v12
    v_permlane32_swap_b32 v9, v13
    v_permlane32_swap_b32 v10, v14
    v_permlane32_swap_b32 v11, v15
    s_nop 0
    v_add_f32 v12, v12, v8
    v_add_f32 v13, v13, v9
    v_add_f32 v14, v14, v10
    v_add_f32 v15, v15, v11
    v_mul_f32 v12, 0x3acccccd, v12
    v_cvt_pk_bf16_f32 v4, v4, v4
    v_and_b32 v4, 0xffff0000, v4
    v_cvt_pk_bf16_f32 v12, v12, v12
    v_and_b32 v12, 0xffff0000, v12
    v_add_f32 v12, 0x3727c5ac, v12
    v_cvt_pk_bf16_f32 v12, v12, v12
    v_and_b32 v12, 0xffff0000, v12
    v_sqrt_f32 v12, v12
    s_nop 0
    v_cvt_pk_bf16_f32 v12, v12, v12
    v_and_b32 v12, 0xffff0000, v12
    v_rcp_f32 v12, v12
    s_nop 0
    v_sub_f32 v170, v170, v4
    v_cvt_pk_bf16_f32 v170, v170, v170
    v_and_b32 v170, 0xffff0000, v170
    v_mul_f32 v170, v170, v12
    v_cvt_pk_bf16_f32 v170, v170, v170
    v_and_b32 v170, 0xffff0000, v170
    v_mul_f32 v170, v170, v32
    v_cvt_pk_bf16_f32 v170, v170, v170
    v_and_b32 v170, 0xffff0000, v170
    v_add_f32 v170, v170, v44
    v_sub_f32 v171, v171, v4
    v_cvt_pk_bf16_f32 v171, v171, v171
    v_and_b32 v171, 0xffff0000, v171
    v_mul_f32 v171, v171, v12
    v_cvt_pk_bf16_f32 v171, v171, v171
    v_and_b32 v171, 0xffff0000, v171
    v_mul_f32 v171, v171, v33
    v_cvt_pk_bf16_f32 v171, v171, v171
    v_and_b32 v171, 0xffff0000, v171
    v_add_f32 v171, v171, v45
    v_sub_f32 v172, v172, v4
    v_cvt_pk_bf16_f32 v172, v172, v172
    v_and_b32 v172, 0xffff0000, v172
    v_mul_f32 v172, v172, v12
    v_cvt_pk_bf16_f32 v172, v172, v172
    v_and_b32 v172, 0xffff0000, v172
    v_mul_f32 v172, v172, v34
    v_cvt_pk_bf16_f32 v172, v172, v172
    v_and_b32 v172, 0xffff0000, v172
    v_add_f32 v172, v172, v46
    v_sub_f32 v173, v173, v4
    v_cvt_pk_bf16_f32 v173, v173, v173
    v_and_b32 v173, 0xffff0000, v173
    v_mul_f32 v173, v173, v12
    v_cvt_pk_bf16_f32 v173, v173, v173
    v_and_b32 v173, 0xffff0000, v173
    v_mul_f32 v173, v173, v35
    v_cvt_pk_bf16_f32 v173, v173, v173
    v_and_b32 v173, 0xffff0000, v173
    v_add_f32 v173, v173, v47
    v_sub_f32 v174, v174, v4
    v_cvt_pk_bf16_f32 v174, v174, v174
    v_and_b32 v174, 0xffff0000, v174
    v_mul_f32 v174, v174, v12
    v_cvt_pk_bf16_f32 v174, v174, v174
    v_and_b32 v174, 0xffff0000, v174
    v_mul_f32 v174, v174, v36
    v_cvt_pk_bf16_f32 v174, v174, v174
    v_and_b32 v174, 0xffff0000, v174
    v_add_f32 v174, v174, v48
    v_sub_f32 v175, v175, v4
    v_cvt_pk_bf16_f32 v175, v175, v175
    v_and_b32 v175, 0xffff0000, v175
    v_mul_f32 v175, v175, v12
    v_cvt_pk_bf16_f32 v175, v175, v175
    v_and_b32 v175, 0xffff0000, v175
    v_mul_f32 v175, v175, v37
    v_cvt_pk_bf16_f32 v175, v175, v175
    v_and_b32 v175, 0xffff0000, v175
    v_add_f32 v175, v175, v49
    v_sub_f32 v176, v176, v4
    v_cvt_pk_bf16_f32 v176, v176, v176
    v_and_b32 v176, 0xffff0000, v176
    v_mul_f32 v176, v176, v12
    v_cvt_pk_bf16_f32 v176, v176, v176
    v_and_b32 v176, 0xffff0000, v176
    v_mul_f32 v176, v176, v38
    v_cvt_pk_bf16_f32 v176, v176, v176
    v_and_b32 v176, 0xffff0000, v176
    v_add_f32 v176, v176, v50
    v_sub_f32 v177, v177, v4
    v_cvt_pk_bf16_f32 v177, v177, v177
    v_and_b32 v177, 0xffff0000, v177
    v_mul_f32 v177, v177, v12
    v_cvt_pk_bf16_f32 v177, v177, v177
    v_and_b32 v177, 0xffff0000, v177
    v_mul_f32 v177, v177, v39
    v_cvt_pk_bf16_f32 v177, v177, v177
    v_and_b32 v177, 0xffff0000, v177
    v_add_f32 v177, v177, v51
    v_sub_f32 v178, v178, v4
    v_cvt_pk_bf16_f32 v178, v178, v178
    v_and_b32 v178, 0xffff0000, v178
    v_mul_f32 v178, v178, v12
    v_cvt_pk_bf16_f32 v178, v178, v178
    v_and_b32 v178, 0xffff0000, v178
    v_mul_f32 v178, v178, v40
    v_cvt_pk_bf16_f32 v178, v178, v178
    v_and_b32 v178, 0xffff0000, v178
    v_add_f32 v178, v178, v52
    v_sub_f32 v179, v179, v4
    v_cvt_pk_bf16_f32 v179, v179, v179
    v_and_b32 v179, 0xffff0000, v179
    v_mul_f32 v179, v179, v12
    v_cvt_pk_bf16_f32 v179, v179, v179
    v_and_b32 v179, 0xffff0000, v179
    v_mul_f32 v179, v179, v41
    v_cvt_pk_bf16_f32 v179, v179, v179
    v_and_b32 v179, 0xffff0000, v179
    v_add_f32 v179, v179, v53
    v_cvt_pk_bf16_f32 v80, v170, v171
    v_cvt_pk_bf16_f32 v81, v172, v173
    v_cvt_pk_bf16_f32 v82, v174, v175
    v_cvt_pk_bf16_f32 v83, v176, v177
    v_cvt_pk_bf16_f32 v84, v178, v179
    buffer_store_dword v80, v2, s[20:23], s32 offen offset:0 sc0 sc1
    buffer_store_dword v81, v2, s[20:23], s32 offen offset:256 sc0 sc1
    buffer_store_dword v82, v2, s[20:23], s32 offen offset:512 sc0 sc1
    buffer_store_dword v83, v2, s[20:23], s32 offen offset:768 sc0 sc1
    buffer_store_dword v84, v2, s[20:23], s32 offen offset:1024 sc0 sc1
    v_mul_f32 v13, 0x3acccccd, v13
    v_cvt_pk_bf16_f32 v5, v5, v5
    v_and_b32 v5, 0xffff0000, v5
    v_cvt_pk_bf16_f32 v13, v13, v13
    v_and_b32 v13, 0xffff0000, v13
    v_add_f32 v13, 0x3727c5ac, v13
    v_cvt_pk_bf16_f32 v13, v13, v13
    v_and_b32 v13, 0xffff0000, v13
    v_sqrt_f32 v13, v13
    s_nop 0
    v_cvt_pk_bf16_f32 v13, v13, v13
    v_and_b32 v13, 0xffff0000, v13
    v_rcp_f32 v13, v13
    s_nop 0
    v_sub_f32 v180, v180, v5
    v_cvt_pk_bf16_f32 v180, v180, v180
    v_and_b32 v180, 0xffff0000, v180
    v_mul_f32 v180, v180, v13
    v_cvt_pk_bf16_f32 v180, v180, v180
    v_and_b32 v180, 0xffff0000, v180
    v_mul_f32 v180, v180, v32
    v_cvt_pk_bf16_f32 v180, v180, v180
    v_and_b32 v180, 0xffff0000, v180
    v_add_f32 v180, v180, v44
    v_sub_f32 v181, v181, v5
    v_cvt_pk_bf16_f32 v181, v181, v181
    v_and_b32 v181, 0xffff0000, v181
    v_mul_f32 v181, v181, v13
    v_cvt_pk_bf16_f32 v181, v181, v181
    v_and_b32 v181, 0xffff0000, v181
    v_mul_f32 v181, v181, v33
    v_cvt_pk_bf16_f32 v181, v181, v181
    v_and_b32 v181, 0xffff0000, v181
    v_add_f32 v181, v181, v45
    v_sub_f32 v182, v182, v5
    v_cvt_pk_bf16_f32 v182, v182, v182
    v_and_b32 v182, 0xffff0000, v182
    v_mul_f32 v182, v182, v13
    v_cvt_pk_bf16_f32 v182, v182, v182
    v_and_b32 v182, 0xffff0000, v182
    v_mul_f32 v182, v182, v34
    v_cvt_pk_bf16_f32 v182, v182, v182
    v_and_b32 v182, 0xffff0000, v182
    v_add_f32 v182, v182, v46
    v_sub_f32 v183, v183, v5
    v_cvt_pk_bf16_f32 v183, v183, v183
    v_and_b32 v183, 0xffff0000, v183
    v_mul_f32 v183, v183, v13
    v_cvt_pk_bf16_f32 v183, v183, v183
    v_and_b32 v183, 0xffff0000, v183
    v_mul_f32 v183, v183, v35
    v_cvt_pk_bf16_f32 v183, v183, v183
    v_and_b32 v183, 0xffff0000, v183
    v_add_f32 v183, v183, v47
    v_sub_f32 v184, v184, v5
    v_cvt_pk_bf16_f32 v184, v184, v184
    v_and_b32 v184, 0xffff0000, v184
    v_mul_f32 v184, v184, v13
    v_cvt_pk_bf16_f32 v184, v184, v184
    v_and_b32 v184, 0xffff0000, v184
    v_mul_f32 v184, v184, v36
    v_cvt_pk_bf16_f32 v184, v184, v184
    v_and_b32 v184, 0xffff0000, v184
    v_add_f32 v184, v184, v48
    v_sub_f32 v185, v185, v5
    v_cvt_pk_bf16_f32 v185, v185, v185
    v_and_b32 v185, 0xffff0000, v185
    v_mul_f32 v185, v185, v13
    v_cvt_pk_bf16_f32 v185, v185, v185
    v_and_b32 v185, 0xffff0000, v185
    v_mul_f32 v185, v185, v37
    v_cvt_pk_bf16_f32 v185, v185, v185
    v_and_b32 v185, 0xffff0000, v185
    v_add_f32 v185, v185, v49
    v_sub_f32 v186, v186, v5
    v_cvt_pk_bf16_f32 v186, v186, v186
    v_and_b32 v186, 0xffff0000, v186
    v_mul_f32 v186, v186, v13
    v_cvt_pk_bf16_f32 v186, v186, v186
    v_and_b32 v186, 0xffff0000, v186
    v_mul_f32 v186, v186, v38
    v_cvt_pk_bf16_f32 v186, v186, v186
    v_and_b32 v186, 0xffff0000, v186
    v_add_f32 v186, v186, v50
    v_sub_f32 v187, v187, v5
    v_cvt_pk_bf16_f32 v187, v187, v187
    v_and_b32 v187, 0xffff0000, v187
    v_mul_f32 v187, v187, v13
    v_cvt_pk_bf16_f32 v187, v187, v187
    v_and_b32 v187, 0xffff0000, v187
    v_mul_f32 v187, v187, v39
    v_cvt_pk_bf16_f32 v187, v187, v187
    v_and_b32 v187, 0xffff0000, v187
    v_add_f32 v187, v187, v51
    v_sub_f32 v188, v188, v5
    v_cvt_pk_bf16_f32 v188, v188, v188
    v_and_b32 v188, 0xffff0000, v188
    v_mul_f32 v188, v188, v13
    v_cvt_pk_bf16_f32 v188, v188, v188
    v_and_b32 v188, 0xffff0000, v188
    v_mul_f32 v188, v188, v40
    v_cvt_pk_bf16_f32 v188, v188, v188
    v_and_b32 v188, 0xffff0000, v188
    v_add_f32 v188, v188, v52
    v_sub_f32 v189, v189, v5
    v_cvt_pk_bf16_f32 v189, v189, v189
    v_and_b32 v189, 0xffff0000, v189
    v_mul_f32 v189, v189, v13
    v_cvt_pk_bf16_f32 v189, v189, v189
    v_and_b32 v189, 0xffff0000, v189
    v_mul_f32 v189, v189, v41
    v_cvt_pk_bf16_f32 v189, v189, v189
    v_and_b32 v189, 0xffff0000, v189
    v_add_f32 v189, v189, v53
    v_cvt_pk_bf16_f32 v85, v180, v181
    v_cvt_pk_bf16_f32 v86, v182, v183
    v_cvt_pk_bf16_f32 v87, v184, v185
    v_cvt_pk_bf16_f32 v88, v186, v187
    v_cvt_pk_bf16_f32 v89, v188, v189
    buffer_store_dword v85, v2, s[20:23], s33 offen offset:0 sc0 sc1
    buffer_store_dword v86, v2, s[20:23], s33 offen offset:256 sc0 sc1
    buffer_store_dword v87, v2, s[20:23], s33 offen offset:512 sc0 sc1
    buffer_store_dword v88, v2, s[20:23], s33 offen offset:768 sc0 sc1
    buffer_store_dword v89, v2, s[20:23], s33 offen offset:1024 sc0 sc1
    v_mul_f32 v14, 0x3acccccd, v14
    v_cvt_pk_bf16_f32 v6, v6, v6
    v_and_b32 v6, 0xffff0000, v6
    v_cvt_pk_bf16_f32 v14, v14, v14
    v_and_b32 v14, 0xffff0000, v14
    v_add_f32 v14, 0x3727c5ac, v14
    v_cvt_pk_bf16_f32 v14, v14, v14
    v_and_b32 v14, 0xffff0000, v14
    v_sqrt_f32 v14, v14
    s_nop 0
    v_cvt_pk_bf16_f32 v14, v14, v14
    v_and_b32 v14, 0xffff0000, v14
    v_rcp_f32 v14, v14
    s_nop 0
    v_sub_f32 v190, v190, v6
    v_cvt_pk_bf16_f32 v190, v190, v190
    v_and_b32 v190, 0xffff0000, v190
    v_mul_f32 v190, v190, v14
    v_cvt_pk_bf16_f32 v190, v190, v190
    v_and_b32 v190, 0xffff0000, v190
    v_mul_f32 v190, v190, v32
    v_cvt_pk_bf16_f32 v190, v190, v190
    v_and_b32 v190, 0xffff0000, v190
    v_add_f32 v190, v190, v44
    v_sub_f32 v191, v191, v6
    v_cvt_pk_bf16_f32 v191, v191, v191
    v_and_b32 v191, 0xffff0000, v191
    v_mul_f32 v191, v191, v14
    v_cvt_pk_bf16_f32 v191, v191, v191
    v_and_b32 v191, 0xffff0000, v191
    v_mul_f32 v191, v191, v33
    v_cvt_pk_bf16_f32 v191, v191, v191
    v_and_b32 v191, 0xffff0000, v191
    v_add_f32 v191, v191, v45
    v_sub_f32 v192, v192, v6
    v_cvt_pk_bf16_f32 v192, v192, v192
    v_and_b32 v192, 0xffff0000, v192
    v_mul_f32 v192, v192, v14
    v_cvt_pk_bf16_f32 v192, v192, v192
    v_and_b32 v192, 0xffff0000, v192
    v_mul_f32 v192, v192, v34
    v_cvt_pk_bf16_f32 v192, v192, v192
    v_and_b32 v192, 0xffff0000, v192
    v_add_f32 v192, v192, v46
    v_sub_f32 v193, v193, v6
    v_cvt_pk_bf16_f32 v193, v193, v193
    v_and_b32 v193, 0xffff0000, v193
    v_mul_f32 v193, v193, v14
    v_cvt_pk_bf16_f32 v193, v193, v193
    v_and_b32 v193, 0xffff0000, v193
    v_mul_f32 v193, v193, v35
    v_cvt_pk_bf16_f32 v193, v193, v193
    v_and_b32 v193, 0xffff0000, v193
    v_add_f32 v193, v193, v47
    v_sub_f32 v194, v194, v6
    v_cvt_pk_bf16_f32 v194, v194, v194
    v_and_b32 v194, 0xffff0000, v194
    v_mul_f32 v194, v194, v14
    v_cvt_pk_bf16_f32 v194, v194, v194
    v_and_b32 v194, 0xffff0000, v194
    v_mul_f32 v194, v194, v36
    v_cvt_pk_bf16_f32 v194, v194, v194
    v_and_b32 v194, 0xffff0000, v194
    v_add_f32 v194, v194, v48
    v_sub_f32 v195, v195, v6
    v_cvt_pk_bf16_f32 v195, v195, v195
    v_and_b32 v195, 0xffff0000, v195
    v_mul_f32 v195, v195, v14
    v_cvt_pk_bf16_f32 v195, v195, v195
    v_and_b32 v195, 0xffff0000, v195
    v_mul_f32 v195, v195, v37
    v_cvt_pk_bf16_f32 v195, v195, v195
    v_and_b32 v195, 0xffff0000, v195
    v_add_f32 v195, v195, v49
    v_sub_f32 v196, v196, v6
    v_cvt_pk_bf16_f32 v196, v196, v196
    v_and_b32 v196, 0xffff0000, v196
    v_mul_f32 v196, v196, v14
    v_cvt_pk_bf16_f32 v196, v196, v196
    v_and_b32 v196, 0xffff0000, v196
    v_mul_f32 v196, v196, v38
    v_cvt_pk_bf16_f32 v196, v196, v196
    v_and_b32 v196, 0xffff0000, v196
    v_add_f32 v196, v196, v50
    v_sub_f32 v197, v197, v6
    v_cvt_pk_bf16_f32 v197, v197, v197
    v_and_b32 v197, 0xffff0000, v197
    v_mul_f32 v197, v197, v14
    v_cvt_pk_bf16_f32 v197, v197, v197
    v_and_b32 v197, 0xffff0000, v197
    v_mul_f32 v197, v197, v39
    v_cvt_pk_bf16_f32 v197, v197, v197
    v_and_b32 v197, 0xffff0000, v197
    v_add_f32 v197, v197, v51
    v_sub_f32 v198, v198, v6
    v_cvt_pk_bf16_f32 v198, v198, v198
    v_and_b32 v198, 0xffff0000, v198
    v_mul_f32 v198, v198, v14
    v_cvt_pk_bf16_f32 v198, v198, v198
    v_and_b32 v198, 0xffff0000, v198
    v_mul_f32 v198, v198, v40
    v_cvt_pk_bf16_f32 v198, v198, v198
    v_and_b32 v198, 0xffff0000, v198
    v_add_f32 v198, v198, v52
    v_sub_f32 v199, v199, v6
    v_cvt_pk_bf16_f32 v199, v199, v199
    v_and_b32 v199, 0xffff0000, v199
    v_mul_f32 v199, v199, v14
    v_cvt_pk_bf16_f32 v199, v199, v199
    v_and_b32 v199, 0xffff0000, v199
    v_mul_f32 v199, v199, v41
    v_cvt_pk_bf16_f32 v199, v199, v199
    v_and_b32 v199, 0xffff0000, v199
    v_add_f32 v199, v199, v53
    v_cvt_pk_bf16_f32 v90, v190, v191
    v_cvt_pk_bf16_f32 v91, v192, v193
    v_cvt_pk_bf16_f32 v92, v194, v195
    v_cvt_pk_bf16_f32 v93, v196, v197
    v_cvt_pk_bf16_f32 v94, v198, v199
    buffer_store_dword v90, v2, s[20:23], s34 offen offset:0 sc0 sc1
    buffer_store_dword v91, v2, s[20:23], s34 offen offset:256 sc0 sc1
    buffer_store_dword v92, v2, s[20:23], s34 offen offset:512 sc0 sc1
    buffer_store_dword v93, v2, s[20:23], s34 offen offset:768 sc0 sc1
    buffer_store_dword v94, v2, s[20:23], s34 offen offset:1024 sc0 sc1
    v_mul_f32 v15, 0x3acccccd, v15
    v_cvt_pk_bf16_f32 v7, v7, v7
    v_and_b32 v7, 0xffff0000, v7
    v_cvt_pk_bf16_f32 v15, v15, v15
    v_and_b32 v15, 0xffff0000, v15
    v_add_f32 v15, 0x3727c5ac, v15
    v_cvt_pk_bf16_f32 v15, v15, v15
    v_and_b32 v15, 0xffff0000, v15
    v_sqrt_f32 v15, v15
    s_nop 0
    v_cvt_pk_bf16_f32 v15, v15, v15
    v_and_b32 v15, 0xffff0000, v15
    v_rcp_f32 v15, v15
    s_nop 0
    v_sub_f32 v200, v200, v7
    v_cvt_pk_bf16_f32 v200, v200, v200
    v_and_b32 v200, 0xffff0000, v200
    v_mul_f32 v200, v200, v15
    v_cvt_pk_bf16_f32 v200, v200, v200
    v_and_b32 v200, 0xffff0000, v200
    v_mul_f32 v200, v200, v32
    v_cvt_pk_bf16_f32 v200, v200, v200
    v_and_b32 v200, 0xffff0000, v200
    v_add_f32 v200, v200, v44
    v_sub_f32 v201, v201, v7
    v_cvt_pk_bf16_f32 v201, v201, v201
    v_and_b32 v201, 0xffff0000, v201
    v_mul_f32 v201, v201, v15
    v_cvt_pk_bf16_f32 v201, v201, v201
    v_and_b32 v201, 0xffff0000, v201
    v_mul_f32 v201, v201, v33
    v_cvt_pk_bf16_f32 v201, v201, v201
    v_and_b32 v201, 0xffff0000, v201
    v_add_f32 v201, v201, v45
    v_sub_f32 v202, v202, v7
    v_cvt_pk_bf16_f32 v202, v202, v202
    v_and_b32 v202, 0xffff0000, v202
    v_mul_f32 v202, v202, v15
    v_cvt_pk_bf16_f32 v202, v202, v202
    v_and_b32 v202, 0xffff0000, v202
    v_mul_f32 v202, v202, v34
    v_cvt_pk_bf16_f32 v202, v202, v202
    v_and_b32 v202, 0xffff0000, v202
    v_add_f32 v202, v202, v46
    v_sub_f32 v203, v203, v7
    v_cvt_pk_bf16_f32 v203, v203, v203
    v_and_b32 v203, 0xffff0000, v203
    v_mul_f32 v203, v203, v15
    v_cvt_pk_bf16_f32 v203, v203, v203
    v_and_b32 v203, 0xffff0000, v203
    v_mul_f32 v203, v203, v35
    v_cvt_pk_bf16_f32 v203, v203, v203
    v_and_b32 v203, 0xffff0000, v203
    v_add_f32 v203, v203, v47
    v_sub_f32 v204, v204, v7
    v_cvt_pk_bf16_f32 v204, v204, v204
    v_and_b32 v204, 0xffff0000, v204
    v_mul_f32 v204, v204, v15
    v_cvt_pk_bf16_f32 v204, v204, v204
    v_and_b32 v204, 0xffff0000, v204
    v_mul_f32 v204, v204, v36
    v_cvt_pk_bf16_f32 v204, v204, v204
    v_and_b32 v204, 0xffff0000, v204
    v_add_f32 v204, v204, v48
    v_sub_f32 v205, v205, v7
    v_cvt_pk_bf16_f32 v205, v205, v205
    v_and_b32 v205, 0xffff0000, v205
    v_mul_f32 v205, v205, v15
    v_cvt_pk_bf16_f32 v205, v205, v205
    v_and_b32 v205, 0xffff0000, v205
    v_mul_f32 v205, v205, v37
    v_cvt_pk_bf16_f32 v205, v205, v205
    v_and_b32 v205, 0xffff0000, v205
    v_add_f32 v205, v205, v49
    v_sub_f32 v206, v206, v7
    v_cvt_pk_bf16_f32 v206, v206, v206
    v_and_b32 v206, 0xffff0000, v206
    v_mul_f32 v206, v206, v15
    v_cvt_pk_bf16_f32 v206, v206, v206
    v_and_b32 v206, 0xffff0000, v206
    v_mul_f32 v206, v206, v38
    v_cvt_pk_bf16_f32 v206, v206, v206
    v_and_b32 v206, 0xffff0000, v206
    v_add_f32 v206, v206, v50
    v_sub_f32 v207, v207, v7
    v_cvt_pk_bf16_f32 v207, v207, v207
    v_and_b32 v207, 0xffff0000, v207
    v_mul_f32 v207, v207, v15
    v_cvt_pk_bf16_f32 v207, v207, v207
    v_and_b32 v207, 0xffff0000, v207
    v_mul_f32 v207, v207, v39
    v_cvt_pk_bf16_f32 v207, v207, v207
    v_and_b32 v207, 0xffff0000, v207
    v_add_f32 v207, v207, v51
    v_sub_f32 v208, v208, v7
    v_cvt_pk_bf16_f32 v208, v208, v208
    v_and_b32 v208, 0xffff0000, v208
    v_mul_f32 v208, v208, v15
    v_cvt_pk_bf16_f32 v208, v208, v208
    v_and_b32 v208, 0xffff0000, v208
    v_mul_f32 v208, v208, v40
    v_cvt_pk_bf16_f32 v208, v208, v208
    v_and_b32 v208, 0xffff0000, v208
    v_add_f32 v208, v208, v52
    v_sub_f32 v209, v209, v7
    v_cvt_pk_bf16_f32 v209, v209, v209
    v_and_b32 v209, 0xffff0000, v209
    v_mul_f32 v209, v209, v15
    v_cvt_pk_bf16_f32 v209, v209, v209
    v_and_b32 v209, 0xffff0000, v209
    v_mul_f32 v209, v209, v41
    v_cvt_pk_bf16_f32 v209, v209, v209
    v_and_b32 v209, 0xffff0000, v209
    v_add_f32 v209, v209, v53
    v_cvt_pk_bf16_f32 v95, v200, v201
    v_cvt_pk_bf16_f32 v96, v202, v203
    v_cvt_pk_bf16_f32 v97, v204, v205
    v_cvt_pk_bf16_f32 v98, v206, v207
    v_cvt_pk_bf16_f32 v99, v208, v209
    buffer_store_dword v95, v2, s[20:23], s35 offen offset:0 sc0 sc1
    buffer_store_dword v96, v2, s[20:23], s35 offen offset:256 sc0 sc1
    buffer_store_dword v97, v2, s[20:23], s35 offen offset:512 sc0 sc1
    buffer_store_dword v98, v2, s[20:23], s35 offen offset:768 sc0 sc1
    buffer_store_dword v99, v2, s[20:23], s35 offen offset:1024 sc0 sc1
    s_waitcnt vmcnt(0)
    s_barrier
    s_cmp_lg_u32 s94, 0
    s_cbranch_scc1 mega_kernel_sg76
    s_lshl_b32 s93, s91, 7
    s_add_u32 s93, s93, 24576
    v_mov_b32 v1, s93
    v_mov_b32 v2, 1
    s_mov_b64 exec, 1
    buffer_atomic_add v2, v1, s[80:83], 0 offen sc1
    s_mov_b64 exec, -1
mega_kernel_sg76:
    s_add_u32 s91, s91, 1
    s_cmp_lt_u32 s91, 16
    s_cbranch_scc1 mega_kernel_lln71
    s_branch mega_kernel_done1
mega_kernel_bf148:
    s_mov_b32 s91, 0
mega_kernel_lf177:
    s_cmp_lg_u32 s94, 0
    s_cbranch_scc1 mega_kernel_wd79
    s_lshl_b32 s93, s91, 7
    s_add_u32 s93, s93, 24576
    v_mov_b32 v1, s93
    s_mov_b32 s95, 0
mega_kernel_wl78:
    buffer_load_dword v2, v1, s[80:83], 0 offen sc1
    s_waitcnt vmcnt(0)
    v_cmp_gt_u32 vcc, 8, v2
    s_nop 0
    s_cbranch_vccz mega_kernel_wok80
    s_cmp_ge_u32 s91, 14
    s_cbranch_scc1 mega_kernel_wfast81
    s_sleep 48
mega_kernel_wfast81:
    s_sleep 4
    s_add_u32 s95, s95, 1
    s_cmp_lt_u32 s95, 1000000
    s_cbranch_scc1 mega_kernel_wl78
    s_branch mega_kernel_done1
mega_kernel_wok80:
mega_kernel_wd79:
    s_barrier
    s_mov_b32 s13, s91
    s_sub_u32 s14, s90, 80
    s_mov_b64 s[4:5], s[78:79]
    s_mul_i32 s12, s13, 163840
    s_add_u32 s4, s4, 134135808
    s_addc_u32 s5, s5, 0
    s_add_u32 s4, s4, s12
    s_addc_u32 s5, s5, 0
    s_mov_b64 s[6:7], s[64:65]
    s_mov_b64 s[8:9], s[66:67]
    s_lshl_b32 s12, s14, 7
    s_add_u32 s6, s6, s12
    s_addc_u32 s7, s7, 0
    s_add_u32 s8, s8, s12
    s_addc_u32 s9, s9, 0
    v_and_b32 v48, 63, v0
    v_lshrrev_b32 v49, 6, v0
    s_nop 1
    v_readfirstlane_b32 s10, v49
    s_nop 3
    s_lshl_b32 s11, s10, 11
    s_mul_i32 s10, s10, 4096
    v_lshrrev_b32 v50, 3, v48
    v_and_b32 v51, 7, v48
    v_lshrrev_b32 v52, 4, v48
    s_mov_b32 s12, 1280
    v_mul_u32_u24 v53, 32, v49
    v_add_u32 v53, 0, v53
    v_add_u32 v53, v53, v50
    v_lshrrev_b32 v54, 1, v53
    v_and_b32 v54, 7, v54
    v_xor_b32 v54, v54, v51
    v_lshlrev_b32 v54, 4, v54
    v_mul_lo_u32 v1, v53, s12
    v_add_u32 v1, v1, v54
    v_mul_u32_u24 v53, 32, v49
    v_add_u32 v53, 8, v53
    v_add_u32 v53, v53, v50
    v_lshrrev_b32 v54, 1, v53
    v_and_b32 v54, 7, v54
    v_xor_b32 v54, v54, v51
    v_lshlrev_b32 v54, 4, v54
    v_mul_lo_u32 v2, v53, s12
    v_add_u32 v2, v2, v54
    v_mul_u32_u24 v53, 32, v49
    v_add_u32 v53, 16, v53
    v_add_u32 v53, v53, v50
    v_lshrrev_b32 v54, 1, v53
    v_and_b32 v54, 7, v54
    v_xor_b32 v54, v54, v51
    v_lshlrev_b32 v54, 4, v54
    v_mul_lo_u32 v3, v53, s12
    v_add_u32 v3, v3, v54
    v_mul_u32_u24 v53, 32, v49
    v_add_u32 v53, 24, v53
    v_add_u32 v53, v53, v50
    v_lshrrev_b32 v54, 1, v53
    v_and_b32 v54, 7, v54
    v_xor_b32 v54, v54, v51
    v_lshlrev_b32 v54, 4, v54
    v_mul_lo_u32 v4, v53, s12
    v_add_u32 v4, v4, v54
    v_lshrrev_b32 v53, 2, v51
    v_and_b32 v54, 1, v52
    v_xor_b32 v53, v53, v54
    v_lshlrev_b32 v53, 2, v53
    v_and_b32 v54, 3, v51
    v_or_b32 v53, v53, v54
    v_lshlrev_b32 v53, 4, v53
    v_lshlrev_b32 v54, 4, v49
    v_add_u32 v54, v54, v50
    s_mov_b32 s12, 3072
    v_mul_lo_u32 v5, v54, s12
    v_add_u32 v5, v5, v53
    v_add_u32 v6, 24576, v5
    v_lshrrev_b32 v53, 1, v49
    v_and_b32 v54, 1, v49
    v_mul_u32_u24 v55, 64, v53
    v_and_b32 v56, 31, v48
    v_add_u32 v55, v55, v56
    v_lshrrev_b32 v56, 1, v55
    v_and_b32 v56, 7, v56
    v_lshrrev_b32 v57, 5, v48
    v_xor_b32 v56, v56, v57
    v_lshlrev_b32 v56, 4, v56
    v_lshlrev_b32 v55, 7, v55
    v_add_u32 v8, v55, v56
    v_xor_b32 v9, 32, v8
    v_xor_b32 v10, 64, v8
    v_xor_b32 v11, 96, v8
    v_and_b32 v55, 15, v48
    v_lshrrev_b32 v55, 2, v55
    v_lshrrev_b32 v56, 5, v48
    v_lshlrev_b32 v56, 3, v56
    v_add_u32 v56, v56, v55
    v_lshrrev_b32 v57, 1, v55
    v_and_b32 v57, 1, v57
    v_lshlrev_b32 v57, 6, v57
    v_lshlrev_b32 v56, 7, v56
    v_add_u32 v56, v56, v57
    v_and_b32 v57, 1, v52
    v_lshlrev_b32 v57, 5, v57
    v_add_u32 v56, v56, v57
    v_and_b32 v57, 3, v48
    v_lshlrev_b32 v57, 3, v57
    v_add_u32 v56, v56, v57
    v_add_u32 v56, 16384, v56
    v_lshlrev_b32 v57, 6, v54
    v_xor_b32 v12, v56, v57
    v_mov_b32 v13, v12
    v_add_u32 v128, 65536, v8
    v_add_u32 v129, 65536, v9
    v_add_u32 v130, 65536, v10
    v_add_u32 v131, 65536, v11
    v_add_u32 v132, 65536, v12
    v_add_u32 v133, 65536, v13
    v_mov_b32 v64, 0
    v_mov_b32 v65, 0
    v_mov_b32 v66, 0
    v_mov_b32 v67, 0
    v_mov_b32 v68, 0
    v_mov_b32 v69, 0
    v_mov_b32 v70, 0
    v_mov_b32 v71, 0
    v_mov_b32 v72, 0
    v_mov_b32 v73, 0
    v_mov_b32 v74, 0
    v_mov_b32 v75, 0
    v_mov_b32 v76, 0
    v_mov_b32 v77, 0
    v_mov_b32 v78, 0
    v_mov_b32 v79, 0
    v_mov_b32 v80, 0
    v_mov_b32 v81, 0
    v_mov_b32 v82, 0
    v_mov_b32 v83, 0
    v_mov_b32 v84, 0
    v_mov_b32 v85, 0
    v_mov_b32 v86, 0
    v_mov_b32 v87, 0
    v_mov_b32 v88, 0
    v_mov_b32 v89, 0
    v_mov_b32 v90, 0
    v_mov_b32 v91, 0
    v_mov_b32 v92, 0
    v_mov_b32 v93, 0
    v_mov_b32 v94, 0
    v_mov_b32 v95, 0
    v_mov_b32 v96, 0
    v_mov_b32 v97, 0
    v_mov_b32 v98, 0
    v_mov_b32 v99, 0
    v_mov_b32 v100, 0
    v_mov_b32 v101, 0
    v_mov_b32 v102, 0
    v_mov_b32 v103, 0
    v_mov_b32 v104, 0
    v_mov_b32 v105, 0
    v_mov_b32 v106, 0
    v_mov_b32 v107, 0
    v_mov_b32 v108, 0
    v_mov_b32 v109, 0
    v_mov_b32 v110, 0
    v_mov_b32 v111, 0
    v_mov_b32 v112, 0
    v_mov_b32 v113, 0
    v_mov_b32 v114, 0
    v_mov_b32 v115, 0
    v_mov_b32 v116, 0
    v_mov_b32 v117, 0
    v_mov_b32 v118, 0
    v_mov_b32 v119, 0
    v_mov_b32 v120, 0
    v_mov_b32 v121, 0
    v_mov_b32 v122, 0
    v_mov_b32 v123, 0
    v_mov_b32 v124, 0
    v_mov_b32 v125, 0
    v_mov_b32 v126, 0
    v_mov_b32 v127, 0
    s_add_u32 m0, s10, 0
    s_nop 0
    global_load_lds_dwordx4 v1, s[4:5]
    s_add_u32 m0, s10, 1024
    s_nop 0
    global_load_lds_dwordx4 v2, s[4:5]
    s_add_u32 m0, s10, 2048
    s_nop 0
    global_load_lds_dwordx4 v3, s[4:5]
    s_add_u32 m0, s10, 3072
    s_nop 0
    global_load_lds_dwordx4 v4, s[4:5]
    s_add_u32 m0, s11, 16384
    s_nop 0
    global_load_lds_dwordx4 v5, s[6:7]
    s_add_u32 m0, s11, 17408
    s_nop 0
    global_load_lds_dwordx4 v6, s[6:7]
    s_add_u32 m0, s11, 24576
    s_nop 0
    global_load_lds_dwordx4 v5, s[8:9]
    s_add_u32 m0, s11, 25600
    s_nop 0
    global_load_lds_dwordx4 v6, s[8:9]
    s_add_u32 s4, s4, 128
    s_addc_u32 s5, s5, 0
    s_add_u32 s6, s6, 196608
    s_addc_u32 s7, s7, 0
    s_add_u32 s8, s8, 196608
    s_addc_u32 s9, s9, 0
    s_add_u32 m0, s10, 32768
    s_nop 0
    global_load_lds_dwordx4 v1, s[4:5]
    s_add_u32 m0, s10, 33792
    s_nop 0
    global_load_lds_dwordx4 v2, s[4:5]
    s_add_u32 m0, s10, 34816
    s_nop 0
    global_load_lds_dwordx4 v3, s[4:5]
    s_add_u32 m0, s10, 35840
    s_nop 0
    global_load_lds_dwordx4 v4, s[4:5]
    s_add_u32 m0, s11, 49152
    s_nop 0
    global_load_lds_dwordx4 v5, s[6:7]
    s_add_u32 m0, s11, 50176
    s_nop 0
    global_load_lds_dwordx4 v6, s[6:7]
    s_add_u32 m0, s11, 57344
    s_nop 0
    global_load_lds_dwordx4 v5, s[8:9]
    s_add_u32 m0, s11, 58368
    s_nop 0
    global_load_lds_dwordx4 v6, s[8:9]
    s_add_u32 s4, s4, 128
    s_addc_u32 s5, s5, 0
    s_add_u32 s6, s6, 196608
    s_addc_u32 s7, s7, 0
    s_add_u32 s8, s8, 196608
    s_addc_u32 s9, s9, 0
    s_waitcnt vmcnt(8)
    s_barrier
    ds_read_b128 v[16:19], v8 offset:0
    ds_read_b128 v[20:23], v8 offset:4096
    ds_read_b64_tr_b16 v[24:25], v12 offset:0
    ds_read_b64_tr_b16 v[26:27], v12 offset:512
    ds_read_b64_tr_b16 v[28:29], v13 offset:8192
    ds_read_b64_tr_b16 v[30:31], v13 offset:8704
    ds_read_b128 v[32:35], v9 offset:0
    ds_read_b128 v[36:39], v9 offset:4096
    ds_read_b64_tr_b16 v[40:41], v12 offset:2048
    ds_read_b64_tr_b16 v[42:43], v12 offset:2560
    ds_read_b64_tr_b16 v[44:45], v13 offset:10240
    ds_read_b64_tr_b16 v[46:47], v13 offset:10752
    s_add_u32 m0, s10, 65536
    s_nop 0
    global_load_lds_dwordx4 v1, s[4:5]
    s_add_u32 m0, s10, 66560
    s_nop 0
    global_load_lds_dwordx4 v2, s[4:5]
    s_add_u32 m0, s10, 67584
    s_nop 0
    global_load_lds_dwordx4 v3, s[4:5]
    s_add_u32 m0, s10, 68608
    s_nop 0
    global_load_lds_dwordx4 v4, s[4:5]
    s_add_u32 m0, s11, 81920
    s_nop 0
    global_load_lds_dwordx4 v5, s[6:7]
    s_add_u32 m0, s11, 82944
    s_nop 0
    global_load_lds_dwordx4 v6, s[6:7]
    s_add_u32 m0, s11, 90112
    s_nop 0
    global_load_lds_dwordx4 v5, s[8:9]
    s_add_u32 m0, s11, 91136
    s_nop 0
    global_load_lds_dwordx4 v6, s[8:9]
    s_add_u32 s4, s4, 128
    s_addc_u32 s5, s5, 0
    s_add_u32 s6, s6, 196608
    s_addc_u32 s7, s7, 0
    s_add_u32 s8, s8, 196608
    s_addc_u32 s9, s9, 0
    s_waitcnt lgkmcnt(6)
    v_mfma_f32_32x32x16_bf16 v[64:79], v[24:27], v[16:19], v[64:79]
    v_mfma_f32_32x32x16_bf16 v[80:95], v[28:31], v[16:19], v[80:95]
    v_mfma_f32_32x32x16_bf16 v[96:111], v[24:27], v[20:23], v[96:111]
    v_mfma_f32_32x32x16_bf16 v[112:127], v[28:31], v[20:23], v[112:127]
    ds_read_b128 v[16:19], v10 offset:0
    ds_read_b128 v[20:23], v10 offset:4096
    ds_read_b64_tr_b16 v[24:25], v12 offset:4096
    ds_read_b64_tr_b16 v[26:27], v12 offset:4608
    ds_read_b64_tr_b16 v[28:29], v13 offset:12288
    ds_read_b64_tr_b16 v[30:31], v13 offset:12800
    s_waitcnt lgkmcnt(6)
    v_mfma_f32_32x32x16_bf16 v[64:79], v[40:43], v[32:35], v[64:79]
    v_mfma_f32_32x32x16_bf16 v[80:95], v[44:47], v[32:35], v[80:95]
    v_mfma_f32_32x32x16_bf16 v[96:111], v[40:43], v[36:39], v[96:111]
    v_mfma_f32_32x32x16_bf16 v[112:127], v[44:47], v[36:39], v[112:127]
    ds_read_b128 v[32:35], v11 offset:0
    ds_read_b128 v[36:39], v11 offset:4096
    ds_read_b64_tr_b16 v[40:41], v12 offset:6144
    ds_read_b64_tr_b16 v[42:43], v12 offset:6656
    ds_read_b64_tr_b16 v[44:45], v13 offset:14336
    ds_read_b64_tr_b16 v[46:47], v13 offset:14848
    s_waitcnt lgkmcnt(6)
    v_mfma_f32_32x32x16_bf16 v[64:79], v[24:27], v[16:19], v[64:79]
    v_mfma_f32_32x32x16_bf16 v[80:95], v[28:31], v[16:19], v[80:95]
    v_mfma_f32_32x32x16_bf16 v[96:111], v[24:27], v[20:23], v[96:111]
    v_mfma_f32_32x32x16_bf16 v[112:127], v[28:31], v[20:23], v[112:127]
    s_waitcnt lgkmcnt(0)
    v_mfma_f32_32x32x16_bf16 v[64:79], v[40:43], v[32:35], v[64:79]
    v_mfma_f32_32x32x16_bf16 v[80:95], v[44:47], v[32:35], v[80:95]
    v_mfma_f32_32x32x16_bf16 v[96:111], v[40:43], v[36:39], v[96:111]
    v_mfma_f32_32x32x16_bf16 v[112:127], v[44:47], v[36:39], v[112:127]
    s_waitcnt vmcnt(8)
    s_barrier
    ds_read_b128 v[16:19], v8 offset:32768
    ds_read_b128 v[20:23], v8 offset:36864
    ds_read_b64_tr_b16 v[24:25], v12 offset:32768
    ds_read_b64_tr_b16 v[26:27], v12 offset:33280
    ds_read_b64_tr_b16 v[28:29], v13 offset:40960
    ds_read_b64_tr_b16 v[30:31], v13 offset:41472
    ds_read_b128 v[32:35], v9 offset:32768
    ds_read_b128 v[36:39], v9 offset:36864
    ds_read_b64_tr_b16 v[40:41], v12 offset:34816
    ds_read_b64_tr_b16 v[42:43], v12 offset:35328
    ds_read_b64_tr_b16 v[44:45], v13 offset:43008
    ds_read_b64_tr_b16 v[46:47], v13 offset:43520
    s_add_u32 m0, s10, 0
    s_nop 0
    global_load_lds_dwordx4 v1, s[4:5]
    s_add_u32 m0, s10, 1024
    s_nop 0
    global_load_lds_dwordx4 v2, s[4:5]
    s_add_u32 m0, s10, 2048
    s_nop 0
    global_load_lds_dwordx4 v3, s[4:5]
    s_add_u32 m0, s10, 3072
    s_nop 0
    global_load_lds_dwordx4 v4, s[4:5]
    s_add_u32 m0, s11, 16384
    s_nop 0
    global_load_lds_dwordx4 v5, s[6:7]
    s_add_u32 m0, s11, 17408
    s_nop 0
    global_load_lds_dwordx4 v6, s[6:7]
    s_add_u32 m0, s11, 24576
    s_nop 0
    global_load_lds_dwordx4 v5, s[8:9]
    s_add_u32 m0, s11, 25600
    s_nop 0
    global_load_lds_dwordx4 v6, s[8:9]
    s_add_u32 s4, s4, 128
    s_addc_u32 s5, s5, 0
    s_add_u32 s6, s6, 196608
    s_addc_u32 s7, s7, 0
    s_add_u32 s8, s8, 196608
    s_addc_u32 s9, s9, 0
    s_waitcnt lgkmcnt(6)
    v_mfma_f32_32x32x16_bf16 v[64:79], v[24:27], v[16:19], v[64:79]
    v_mfma_f32_32x32x16_bf16 v[80:95], v[28:31], v[16:19], v[80:95]
    v_mfma_f32_32x32x16_bf16 v[96:111], v[24:27], v[20:23], v[96:111]
    v_mfma_f32_32x32x16_bf16 v[112:127], v[28:31], v[20:23], v[112:127]
    ds_read_b128 v[16:19], v10 offset:32768
    ds_read_b128 v[20:23], v10 offset:36864
    ds_read_b64_tr_b16 v[24:25], v12 offset:36864
    ds_read_b64_tr_b16 v[26:27], v12 offset:37376
    ds_read_b64_tr_b16 v[28:29], v13 offset:45056
    ds_read_b64_tr_b16 v[30:31], v13 offset:45568
    s_waitcnt lgkmcnt(6)
    v_mfma_f32_32x32x16_bf16 v[64:79], v[40:43], v[32:35], v[64:79]
    v_mfma_f32_32x32x16_bf16 v[80:95], v[44:47], v[32:35], v[80:95]
    v_mfma_f32_32x32x16_bf16 v[96:111], v[40:43], v[36:39], v[96:111]
    v_mfma_f32_32x32x16_bf16 v[112:127], v[44:47], v[36:39], v[112:127]
    ds_read_b128 v[32:35], v11 offset:32768
    ds_read_b128 v[36:39], v11 offset:36864
    ds_read_b64_tr_b16 v[40:41], v12 offset:38912
    ds_read_b64_tr_b16 v[42:43], v12 offset:39424
    ds_read_b64_tr_b16 v[44:45], v13 offset:47104
    ds_read_b64_tr_b16 v[46:47], v13 offset:47616
    s_waitcnt lgkmcnt(6)
    v_mfma_f32_32x32x16_bf16 v[64:79], v[24:27], v[16:19], v[64:79]
    v_mfma_f32_32x32x16_bf16 v[80:95], v[28:31], v[16:19], v[80:95]
    v_mfma_f32_32x32x16_bf16 v[96:111], v[24:27], v[20:23], v[96:111]
    v_mfma_f32_32x32x16_bf16 v[112:127], v[28:31], v[20:23], v[112:127]
    s_waitcnt lgkmcnt(0)
    v_mfma_f32_32x32x16_bf16 v[64:79], v[40:43], v[32:35], v[64:79]
    v_mfma_f32_32x32x16_bf16 v[80:95], v[44:47], v[32:35], v[80:95]
    v_mfma_f32_32x32x16_bf16 v[96:111], v[40:43], v[36:39], v[96:111]
    v_mfma_f32_32x32x16_bf16 v[112:127], v[44:47], v[36:39], v[112:127]
    s_waitcnt vmcnt(8)
    s_barrier
    ds_read_b128 v[16:19], v128 offset:0
    ds_read_b128 v[20:23], v128 offset:4096
    ds_read_b64_tr_b16 v[24:25], v132 offset:0
    ds_read_b64_tr_b16 v[26:27], v132 offset:512
    ds_read_b64_tr_b16 v[28:29], v133 offset:8192
    ds_read_b64_tr_b16 v[30:31], v133 offset:8704
    ds_read_b128 v[32:35], v129 offset:0
    ds_read_b128 v[36:39], v129 offset:4096
    ds_read_b64_tr_b16 v[40:41], v132 offset:2048
    ds_read_b64_tr_b16 v[42:43], v132 offset:2560
    ds_read_b64_tr_b16 v[44:45], v133 offset:10240
    ds_read_b64_tr_b16 v[46:47], v133 offset:10752
    s_add_u32 m0, s10, 32768
    s_nop 0
    global_load_lds_dwordx4 v1, s[4:5]
    s_add_u32 m0, s10, 33792
    s_nop 0
    global_load_lds_dwordx4 v2, s[4:5]
    s_add_u32 m0, s10, 34816
    s_nop 0
    global_load_lds_dwordx4 v3, s[4:5]
    s_add_u32 m0, s10, 35840
    s_nop 0
    global_load_lds_dwordx4 v4, s[4:5]
    s_add_u32 m0, s11, 49152
    s_nop 0
    global_load_lds_dwordx4 v5, s[6:7]
    s_add_u32 m0, s11, 50176
    s_nop 0
    global_load_lds_dwordx4 v6, s[6:7]
    s_add_u32 m0, s11, 57344
    s_nop 0
    global_load_lds_dwordx4 v5, s[8:9]
    s_add_u32 m0, s11, 58368
    s_nop 0
    global_load_lds_dwordx4 v6, s[8:9]
    s_add_u32 s4, s4, 128
    s_addc_u32 s5, s5, 0
    s_add_u32 s6, s6, 196608
    s_addc_u32 s7, s7, 0
    s_add_u32 s8, s8, 196608
    s_addc_u32 s9, s9, 0
    s_waitcnt lgkmcnt(6)
    v_mfma_f32_32x32x16_bf16 v[64:79], v[24:27], v[16:19], v[64:79]
    v_mfma_f32_32x32x16_bf16 v[80:95], v[28:31], v[16:19], v[80:95]
    v_mfma_f32_32x32x16_bf16 v[96:111], v[24:27], v[20:23], v[96:111]
    v_mfma_f32_32x32x16_bf16 v[112:127], v[28:31], v[20:23], v[112:127]
    ds_read_b128 v[16:19], v130 offset:0
    ds_read_b128 v[20:23], v130 offset:4096
    ds_read_b64_tr_b16 v[24:25], v132 offset:4096
    ds_read_b64_tr_b16 v[26:27], v132 offset:4608
    ds_read_b64_tr_b16 v[28:29], v133 offset:12288
    ds_read_b64_tr_b16 v[30:31], v133 offset:12800
    s_waitcnt lgkmcnt(6)
    v_mfma_f32_32x32x16_bf16 v[64:79], v[40:43], v[32:35], v[64:79]
    v_mfma_f32_32x32x16_bf16 v[80:95], v[44:47], v[32:35], v[80:95]
    v_mfma_f32_32x32x16_bf16 v[96:111], v[40:43], v[36:39], v[96:111]
    v_mfma_f32_32x32x16_bf16 v[112:127], v[44:47], v[36:39], v[112:127]
    ds_read_b128 v[32:35], v131 offset:0
    ds_read_b128 v[36:39], v131 offset:4096
    ds_read_b64_tr_b16 v[40:41], v132 offset:6144
    ds_read_b64_tr_b16 v[42:43], v132 offset:6656
    ds_read_b64_tr_b16 v[44:45], v133 offset:14336
    ds_read_b64_tr_b16 v[46:47], v133 offset:14848
    s_waitcnt lgkmcnt(6)
    v_mfma_f32_32x32x16_bf16 v[64:79], v[24:27], v[16:19], v[64:79]
    v_mfma_f32_32x32x16_bf16 v[80:95], v[28:31], v[16:19], v[80:95]
    v_mfma_f32_32x32x16_bf16 v[96:111], v[24:27], v[20:23], v[96:111]
    v_mfma_f32_32x32x16_bf16 v[112:127], v[28:31], v[20:23], v[112:127]
    s_waitcnt lgkmcnt(0)
    v_mfma_f32_32x32x16_bf16 v[64:79], v[40:43], v[32:35], v[64:79]
    v_mfma_f32_32x32x16_bf16 v[80:95], v[44:47], v[32:35], v[80:95]
    v_mfma_f32_32x32x16_bf16 v[96:111], v[40:43], v[36:39], v[96:111]
    v_mfma_f32_32x32x16_bf16 v[112:127], v[44:47], v[36:39], v[112:127]
    s_waitcnt vmcnt(8)
    s_barrier
    ds_read_b128 v[16:19], v8 offset:0
    ds_read_b128 v[20:23], v8 offset:4096
    ds_read_b64_tr_b16 v[24:25], v12 offset:0
    ds_read_b64_tr_b16 v[26:27], v12 offset:512
    ds_read_b64_tr_b16 v[28:29], v13 offset:8192
    ds_read_b64_tr_b16 v[30:31], v13 offset:8704
    ds_read_b128 v[32:35], v9 offset:0
    ds_read_b128 v[36:39], v9 offset:4096
    ds_read_b64_tr_b16 v[40:41], v12 offset:2048
    ds_read_b64_tr_b16 v[42:43], v12 offset:2560
    ds_read_b64_tr_b16 v[44:45], v13 offset:10240
    ds_read_b64_tr_b16 v[46:47], v13 offset:10752
    s_add_u32 m0, s10, 65536
    s_nop 0
    global_load_lds_dwordx4 v1, s[4:5]
    s_add_u32 m0, s10, 66560
    s_nop 0
    global_load_lds_dwordx4 v2, s[4:5]
    s_add_u32 m0, s10, 67584
    s_nop 0
    global_load_lds_dwordx4 v3, s[4:5]
    s_add_u32 m0, s10, 68608
    s_nop 0
    global_load_lds_dwordx4 v4, s[4:5]
    s_add_u32 m0, s11, 81920
    s_nop 0
    global_load_lds_dwordx4 v5, s[6:7]
    s_add_u32 m0, s11, 82944
    s_nop 0
    global_load_lds_dwordx4 v6, s[6:7]
    s_add_u32 m0, s11, 90112
    s_nop 0
    global_load_lds_dwordx4 v5, s[8:9]
    s_add_u32 m0, s11, 91136
    s_nop 0
    global_load_lds_dwordx4 v6, s[8:9]
    s_add_u32 s4, s4, 128
    s_addc_u32 s5, s5, 0
    s_add_u32 s6, s6, 196608
    s_addc_u32 s7, s7, 0
    s_add_u32 s8, s8, 196608
    s_addc_u32 s9, s9, 0
    s_waitcnt lgkmcnt(6)
    v_mfma_f32_32x32x16_bf16 v[64:79], v[24:27], v[16:19], v[64:79]
    v_mfma_f32_32x32x16_bf16 v[80:95], v[28:31], v[16:19], v[80:95]
    v_mfma_f32_32x32x16_bf16 v[96:111], v[24:27], v[20:23], v[96:111]
    v_mfma_f32_32x32x16_bf16 v[112:127], v[28:31], v[20:23], v[112:127]
    ds_read_b128 v[16:19], v10 offset:0
    ds_read_b128 v[20:23], v10 offset:4096
    ds_read_b64_tr_b16 v[24:25], v12 offset:4096
    ds_read_b64_tr_b16 v[26:27], v12 offset:4608
    ds_read_b64_tr_b16 v[28:29], v13 offset:12288
    ds_read_b64_tr_b16 v[30:31], v13 offset:12800
    s_waitcnt lgkmcnt(6)
    v_mfma_f32_32x32x16_bf16 v[64:79], v[40:43], v[32:35], v[64:79]
    v_mfma_f32_32x32x16_bf16 v[80:95], v[44:47], v[32:35], v[80:95]
    v_mfma_f32_32x32x16_bf16 v[96:111], v[40:43], v[36:39], v[96:111]
    v_mfma_f32_32x32x16_bf16 v[112:127], v[44:47], v[36:39], v[112:127]
    ds_read_b128 v[32:35], v11 offset:0
    ds_read_b128 v[36:39], v11 offset:4096
    ds_read_b64_tr_b16 v[40:41], v12 offset:6144
    ds_read_b64_tr_b16 v[42:43], v12 offset:6656
    ds_read_b64_tr_b16 v[44:45], v13 offset:14336
    ds_read_b64_tr_b16 v[46:47], v13 offset:14848
    s_waitcnt lgkmcnt(6)
    v_mfma_f32_32x32x16_bf16 v[64:79], v[24:27], v[16:19], v[64:79]
    v_mfma_f32_32x32x16_bf16 v[80:95], v[28:31], v[16:19], v[80:95]
    v_mfma_f32_32x32x16_bf16 v[96:111], v[24:27], v[20:23], v[96:111]
    v_mfma_f32_32x32x16_bf16 v[112:127], v[28:31], v[20:23], v[112:127]
    s_waitcnt lgkmcnt(0)
    v_mfma_f32_32x32x16_bf16 v[64:79], v[40:43], v[32:35], v[64:79]
    v_mfma_f32_32x32x16_bf16 v[80:95], v[44:47], v[32:35], v[80:95]
    v_mfma_f32_32x32x16_bf16 v[96:111], v[40:43], v[36:39], v[96:111]
    v_mfma_f32_32x32x16_bf16 v[112:127], v[44:47], v[36:39], v[112:127]
    s_waitcnt vmcnt(8)
    s_barrier
    ds_read_b128 v[16:19], v8 offset:32768
    ds_read_b128 v[20:23], v8 offset:36864
    ds_read_b64_tr_b16 v[24:25], v12 offset:32768
    ds_read_b64_tr_b16 v[26:27], v12 offset:33280
    ds_read_b64_tr_b16 v[28:29], v13 offset:40960
    ds_read_b64_tr_b16 v[30:31], v13 offset:41472
    ds_read_b128 v[32:35], v9 offset:32768
    ds_read_b128 v[36:39], v9 offset:36864
    ds_read_b64_tr_b16 v[40:41], v12 offset:34816
    ds_read_b64_tr_b16 v[42:43], v12 offset:35328
    ds_read_b64_tr_b16 v[44:45], v13 offset:43008
    ds_read_b64_tr_b16 v[46:47], v13 offset:43520
    s_add_u32 m0, s10, 0
    s_nop 0
    global_load_lds_dwordx4 v1, s[4:5]
    s_add_u32 m0, s10, 1024
    s_nop 0
    global_load_lds_dwordx4 v2, s[4:5]
    s_add_u32 m0, s10, 2048
    s_nop 0
    global_load_lds_dwordx4 v3, s[4:5]
    s_add_u32 m0, s10, 3072
    s_nop 0
    global_load_lds_dwordx4 v4, s[4:5]
    s_add_u32 m0, s11, 16384
    s_nop 0
    global_load_lds_dwordx4 v5, s[6:7]
    s_add_u32 m0, s11, 17408
    s_nop 0
    global_load_lds_dwordx4 v6, s[6:7]
    s_add_u32 m0, s11, 24576
    s_nop 0
    global_load_lds_dwordx4 v5, s[8:9]
    s_add_u32 m0, s11, 25600
    s_nop 0
    global_load_lds_dwordx4 v6, s[8:9]
    s_add_u32 s4, s4, 128
    s_addc_u32 s5, s5, 0
    s_add_u32 s6, s6, 196608
    s_addc_u32 s7, s7, 0
    s_add_u32 s8, s8, 196608
    s_addc_u32 s9, s9, 0
    s_waitcnt lgkmcnt(6)
    v_mfma_f32_32x32x16_bf16 v[64:79], v[24:27], v[16:19], v[64:79]
    v_mfma_f32_32x32x16_bf16 v[80:95], v[28:31], v[16:19], v[80:95]
    v_mfma_f32_32x32x16_bf16 v[96:111], v[24:27], v[20:23], v[96:111]
    v_mfma_f32_32x32x16_bf16 v[112:127], v[28:31], v[20:23], v[112:127]
    ds_read_b128 v[16:19], v10 offset:32768
    ds_read_b128 v[20:23], v10 offset:36864
    ds_read_b64_tr_b16 v[24:25], v12 offset:36864
    ds_read_b64_tr_b16 v[26:27], v12 offset:37376
    ds_read_b64_tr_b16 v[28:29], v13 offset:45056
    ds_read_b64_tr_b16 v[30:31], v13 offset:45568
    s_waitcnt lgkmcnt(6)
    v_mfma_f32_32x32x16_bf16 v[64:79], v[40:43], v[32:35], v[64:79]
    v_mfma_f32_32x32x16_bf16 v[80:95], v[44:47], v[32:35], v[80:95]
    v_mfma_f32_32x32x16_bf16 v[96:111], v[40:43], v[36:39], v[96:111]
    v_mfma_f32_32x32x16_bf16 v[112:127], v[44:47], v[36:39], v[112:127]
    ds_read_b128 v[32:35], v11 offset:32768
    ds_read_b128 v[36:39], v11 offset:36864
    ds_read_b64_tr_b16 v[40:41], v12 offset:38912
    ds_read_b64_tr_b16 v[42:43], v12 offset:39424
    ds_read_b64_tr_b16 v[44:45], v13 offset:47104
    ds_read_b64_tr_b16 v[46:47], v13 offset:47616
    s_waitcnt lgkmcnt(6)
    v_mfma_f32_32x32x16_bf16 v[64:79], v[24:27], v[16:19], v[64:79]
    v_mfma_f32_32x32x16_bf16 v[80:95], v[28:31], v[16:19], v[80:95]
    v_mfma_f32_32x32x16_bf16 v[96:111], v[24:27], v[20:23], v[96:111]
    v_mfma_f32_32x32x16_bf16 v[112:127], v[28:31], v[20:23], v[112:127]
    s_waitcnt lgkmcnt(0)
    v_mfma_f32_32x32x16_bf16 v[64:79], v[40:43], v[32:35], v[64:79]
    v_mfma_f32_32x32x16_bf16 v[80:95], v[44:47], v[32:35], v[80:95]
    v_mfma_f32_32x32x16_bf16 v[96:111], v[40:43], v[36:39], v[96:111]
    v_mfma_f32_32x32x16_bf16 v[112:127], v[44:47], v[36:39], v[112:127]
    s_waitcnt vmcnt(8)
    s_barrier
    ds_read_b128 v[16:19], v128 offset:0
    ds_read_b128 v[20:23], v128 offset:4096
    ds_read_b64_tr_b16 v[24:25], v132 offset:0
    ds_read_b64_tr_b16 v[26:27], v132 offset:512
    ds_read_b64_tr_b16 v[28:29], v133 offset:8192
    ds_read_b64_tr_b16 v[30:31], v133 offset:8704
    ds_read_b128 v[32:35], v129 offset:0
    ds_read_b128 v[36:39], v129 offset:4096
    ds_read_b64_tr_b16 v[40:41], v132 offset:2048
    ds_read_b64_tr_b16 v[42:43], v132 offset:2560
    ds_read_b64_tr_b16 v[44:45], v133 offset:10240
    ds_read_b64_tr_b16 v[46:47], v133 offset:10752
    s_add_u32 m0, s10, 32768
    s_nop 0
    global_load_lds_dwordx4 v1, s[4:5]
    s_add_u32 m0, s10, 33792
    s_nop 0
    global_load_lds_dwordx4 v2, s[4:5]
    s_add_u32 m0, s10, 34816
    s_nop 0
    global_load_lds_dwordx4 v3, s[4:5]
    s_add_u32 m0, s10, 35840
    s_nop 0
    global_load_lds_dwordx4 v4, s[4:5]
    s_add_u32 m0, s11, 49152
    s_nop 0
    global_load_lds_dwordx4 v5, s[6:7]
    s_add_u32 m0, s11, 50176
    s_nop 0
    global_load_lds_dwordx4 v6, s[6:7]
    s_add_u32 m0, s11, 57344
    s_nop 0
    global_load_lds_dwordx4 v5, s[8:9]
    s_add_u32 m0, s11, 58368
    s_nop 0
    global_load_lds_dwordx4 v6, s[8:9]
    s_add_u32 s4, s4, 128
    s_addc_u32 s5, s5, 0
    s_add_u32 s6, s6, 196608
    s_addc_u32 s7, s7, 0
    s_add_u32 s8, s8, 196608
    s_addc_u32 s9, s9, 0
    s_waitcnt lgkmcnt(6)
    v_mfma_f32_32x32x16_bf16 v[64:79], v[24:27], v[16:19], v[64:79]
    v_mfma_f32_32x32x16_bf16 v[80:95], v[28:31], v[16:19], v[80:95]
    v_mfma_f32_32x32x16_bf16 v[96:111], v[24:27], v[20:23], v[96:111]
    v_mfma_f32_32x32x16_bf16 v[112:127], v[28:31], v[20:23], v[112:127]
    ds_read_b128 v[16:19], v130 offset:0
    ds_read_b128 v[20:23], v130 offset:4096
    ds_read_b64_tr_b16 v[24:25], v132 offset:4096
    ds_read_b64_tr_b16 v[26:27], v132 offset:4608
    ds_read_b64_tr_b16 v[28:29], v133 offset:12288
    ds_read_b64_tr_b16 v[30:31], v133 offset:12800
    s_waitcnt lgkmcnt(6)
    v_mfma_f32_32x32x16_bf16 v[64:79], v[40:43], v[32:35], v[64:79]
    v_mfma_f32_32x32x16_bf16 v[80:95], v[44:47], v[32:35], v[80:95]
    v_mfma_f32_32x32x16_bf16 v[96:111], v[40:43], v[36:39], v[96:111]
    v_mfma_f32_32x32x16_bf16 v[112:127], v[44:47], v[36:39], v[112:127]
    ds_read_b128 v[32:35], v131 offset:0
    ds_read_b128 v[36:39], v131 offset:4096
    ds_read_b64_tr_b16 v[40:41], v132 offset:6144
    ds_read_b64_tr_b16 v[42:43], v132 offset:6656
    ds_read_b64_tr_b16 v[44:45], v133 offset:14336
    ds_read_b64_tr_b16 v[46:47], v133 offset:14848
    s_waitcnt lgkmcnt(6)
    v_mfma_f32_32x32x16_bf16 v[64:79], v[24:27], v[16:19], v[64:79]
    v_mfma_f32_32x32x16_bf16 v[80:95], v[28:31], v[16:19], v[80:95]
    v_mfma_f32_32x32x16_bf16 v[96:111], v[24:27], v[20:23], v[96:111]
    v_mfma_f32_32x32x16_bf16 v[112:127], v[28:31], v[20:23], v[112:127]
    s_waitcnt lgkmcnt(0)
    v_mfma_f32_32x32x16_bf16 v[64:79], v[40:43], v[32:35], v[64:79]
    v_mfma_f32_32x32x16_bf16 v[80:95], v[44:47], v[32:35], v[80:95]
    v_mfma_f32_32x32x16_bf16 v[96:111], v[40:43], v[36:39], v[96:111]
    v_mfma_f32_32x32x16_bf16 v[112:127], v[44:47], v[36:39], v[112:127]
    s_waitcnt vmcnt(8)
    s_barrier
    ds_read_b128 v[16:19], v8 offset:0
    ds_read_b128 v[20:23], v8 offset:4096
    ds_read_b64_tr_b16 v[24:25], v12 offset:0
    ds_read_b64_tr_b16 v[26:27], v12 offset:512
    ds_read_b64_tr_b16 v[28:29], v13 offset:8192
    ds_read_b64_tr_b16 v[30:31], v13 offset:8704
    ds_read_b128 v[32:35], v9 offset:0
    ds_read_b128 v[36:39], v9 offset:4096
    ds_read_b64_tr_b16 v[40:41], v12 offset:2048
    ds_read_b64_tr_b16 v[42:43], v12 offset:2560
    ds_read_b64_tr_b16 v[44:45], v13 offset:10240
    ds_read_b64_tr_b16 v[46:47], v13 offset:10752
    s_add_u32 m0, s10, 65536
    s_nop 0
    global_load_lds_dwordx4 v1, s[4:5]
    s_add_u32 m0, s10, 66560
    s_nop 0
    global_load_lds_dwordx4 v2, s[4:5]
    s_add_u32 m0, s10, 67584
    s_nop 0
    global_load_lds_dwordx4 v3, s[4:5]
    s_add_u32 m0, s10, 68608
    s_nop 0
    global_load_lds_dwordx4 v4, s[4:5]
    s_add_u32 m0, s11, 81920
    s_nop 0
    global_load_lds_dwordx4 v5, s[6:7]
    s_add_u32 m0, s11, 82944
    s_nop 0
    global_load_lds_dwordx4 v6, s[6:7]
    s_add_u32 m0, s11, 90112
    s_nop 0
    global_load_lds_dwordx4 v5, s[8:9]
    s_add_u32 m0, s11, 91136
    s_nop 0
    global_load_lds_dwordx4 v6, s[8:9]
    s_add_u32 s4, s4, 128
    s_addc_u32 s5, s5, 0
    s_add_u32 s6, s6, 196608
    s_addc_u32 s7, s7, 0
    s_add_u32 s8, s8, 196608
    s_addc_u32 s9, s9, 0
    s_waitcnt lgkmcnt(6)
    v_mfma_f32_32x32x16_bf16 v[64:79], v[24:27], v[16:19], v[64:79]
    v_mfma_f32_32x32x16_bf16 v[80:95], v[28:31], v[16:19], v[80:95]
    v_mfma_f32_32x32x16_bf16 v[96:111], v[24:27], v[20:23], v[96:111]
    v_mfma_f32_32x32x16_bf16 v[112:127], v[28:31], v[20:23], v[112:127]
    ds_read_b128 v[16:19], v10 offset:0
    ds_read_b128 v[20:23], v10 offset:4096
    ds_read_b64_tr_b16 v[24:25], v12 offset:4096
    ds_read_b64_tr_b16 v[26:27], v12 offset:4608
    ds_read_b64_tr_b16 v[28:29], v13 offset:12288
    ds_read_b64_tr_b16 v[30:31], v13 offset:12800
    s_waitcnt lgkmcnt(6)
    v_mfma_f32_32x32x16_bf16 v[64:79], v[40:43], v[32:35], v[64:79]
    v_mfma_f32_32x32x16_bf16 v[80:95], v[44:47], v[32:35], v[80:95]
    v_mfma_f32_32x32x16_bf16 v[96:111], v[40:43], v[36:39], v[96:111]
    v_mfma_f32_32x32x16_bf16 v[112:127], v[44:47], v[36:39], v[112:127]
    ds_read_b128 v[32:35], v11 offset:0
    ds_read_b128 v[36:39], v11 offset:4096
    ds_read_b64_tr_b16 v[40:41], v12 offset:6144
    ds_read_b64_tr_b16 v[42:43], v12 offset:6656
    ds_read_b64_tr_b16 v[44:45], v13 offset:14336
    ds_read_b64_tr_b16 v[46:47], v13 offset:14848
    s_waitcnt lgkmcnt(6)
    v_mfma_f32_32x32x16_bf16 v[64:79], v[24:27], v[16:19], v[64:79]
    v_mfma_f32_32x32x16_bf16 v[80:95], v[28:31], v[16:19], v[80:95]
    v_mfma_f32_32x32x16_bf16 v[96:111], v[24:27], v[20:23], v[96:111]
    v_mfma_f32_32x32x16_bf16 v[112:127], v[28:31], v[20:23], v[112:127]
    s_waitcnt lgkmcnt(0)
    v_mfma_f32_32x32x16_bf16 v[64:79], v[40:43], v[32:35], v[64:79]
    v_mfma_f32_32x32x16_bf16 v[80:95], v[44:47], v[32:35], v[80:95]
    v_mfma_f32_32x32x16_bf16 v[96:111], v[40:43], v[36:39], v[96:111]
    v_mfma_f32_32x32x16_bf16 v[112:127], v[44:47], v[36:39], v[112:127]
    s_waitcnt vmcnt(8)
    s_barrier
    ds_read_b128 v[16:19], v8 offset:32768
    ds_read_b128 v[20:23], v8 offset:36864
    ds_read_b64_tr_b16 v[24:25], v12 offset:32768
    ds_read_b64_tr_b16 v[26:27], v12 offset:33280
    ds_read_b64_tr_b16 v[28:29], v13 offset:40960
    ds_read_b64_tr_b16 v[30:31], v13 offset:41472
    ds_read_b128 v[32:35], v9 offset:32768
    ds_read_b128 v[36:39], v9 offset:36864
    ds_read_b64_tr_b16 v[40:41], v12 offset:34816
    ds_read_b64_tr_b16 v[42:43], v12 offset:35328
    ds_read_b64_tr_b16 v[44:45], v13 offset:43008
    ds_read_b64_tr_b16 v[46:47], v13 offset:43520
    s_add_u32 m0, s10, 0
    s_nop 0
    global_load_lds_dwordx4 v1, s[4:5]
    s_add_u32 m0, s10, 1024
    s_nop 0
    global_load_lds_dwordx4 v2, s[4:5]
    s_add_u32 m0, s10, 2048
    s_nop 0
    global_load_lds_dwordx4 v3, s[4:5]
    s_add_u32 m0, s10, 3072
    s_nop 0
    global_load_lds_dwordx4 v4, s[4:5]
    s_add_u32 m0, s11, 16384
    s_nop 0
    global_load_lds_dwordx4 v5, s[6:7]
    s_add_u32 m0, s11, 17408
    s_nop 0
    global_load_lds_dwordx4 v6, s[6:7]
    s_add_u32 m0, s11, 24576
    s_nop 0
    global_load_lds_dwordx4 v5, s[8:9]
    s_add_u32 m0, s11, 25600
    s_nop 0
    global_load_lds_dwordx4 v6, s[8:9]
    s_add_u32 s4, s4, 128
    s_addc_u32 s5, s5, 0
    s_add_u32 s6, s6, 196608
    s_addc_u32 s7, s7, 0
    s_add_u32 s8, s8, 196608
    s_addc_u32 s9, s9, 0
    s_waitcnt lgkmcnt(6)
    v_mfma_f32_32x32x16_bf16 v[64:79], v[24:27], v[16:19], v[64:79]
    v_mfma_f32_32x32x16_bf16 v[80:95], v[28:31], v[16:19], v[80:95]
    v_mfma_f32_32x32x16_bf16 v[96:111], v[24:27], v[20:23], v[96:111]
    v_mfma_f32_32x32x16_bf16 v[112:127], v[28:31], v[20:23], v[112:127]
    ds_read_b128 v[16:19], v10 offset:32768
    ds_read_b128 v[20:23], v10 offset:36864
    ds_read_b64_tr_b16 v[24:25], v12 offset:36864
    ds_read_b64_tr_b16 v[26:27], v12 offset:37376
    ds_read_b64_tr_b16 v[28:29], v13 offset:45056
    ds_read_b64_tr_b16 v[30:31], v13 offset:45568
    s_waitcnt lgkmcnt(6)
    v_mfma_f32_32x32x16_bf16 v[64:79], v[40:43], v[32:35], v[64:79]
    v_mfma_f32_32x32x16_bf16 v[80:95], v[44:47], v[32:35], v[80:95]
    v_mfma_f32_32x32x16_bf16 v[96:111], v[40:43], v[36:39], v[96:111]
    v_mfma_f32_32x32x16_bf16 v[112:127], v[44:47], v[36:39], v[112:127]
    ds_read_b128 v[32:35], v11 offset:32768
    ds_read_b128 v[36:39], v11 offset:36864
    ds_read_b64_tr_b16 v[40:41], v12 offset:38912
    ds_read_b64_tr_b16 v[42:43], v12 offset:39424
    ds_read_b64_tr_b16 v[44:45], v13 offset:47104
    ds_read_b64_tr_b16 v[46:47], v13 offset:47616
    s_waitcnt lgkmcnt(6)
    v_mfma_f32_32x32x16_bf16 v[64:79], v[24:27], v[16:19], v[64:79]
    v_mfma_f32_32x32x16_bf16 v[80:95], v[28:31], v[16:19], v[80:95]
    v_mfma_f32_32x32x16_bf16 v[96:111], v[24:27], v[20:23], v[96:111]
    v_mfma_f32_32x32x16_bf16 v[112:127], v[28:31], v[20:23], v[112:127]
    s_waitcnt lgkmcnt(0)
    v_mfma_f32_32x32x16_bf16 v[64:79], v[40:43], v[32:35], v[64:79]
    v_mfma_f32_32x32x16_bf16 v[80:95], v[44:47], v[32:35], v[80:95]
    v_mfma_f32_32x32x16_bf16 v[96:111], v[40:43], v[36:39], v[96:111]
    v_mfma_f32_32x32x16_bf16 v[112:127], v[44:47], v[36:39], v[112:127]
    s_waitcnt vmcnt(8)
    s_barrier
    ds_read_b128 v[16:19], v128 offset:0
    ds_read_b128 v[20:23], v128 offset:4096
    ds_read_b64_tr_b16 v[24:25], v132 offset:0
    ds_read_b64_tr_b16 v[26:27], v132 offset:512
    ds_read_b64_tr_b16 v[28:29], v133 offset:8192
    ds_read_b64_tr_b16 v[30:31], v133 offset:8704
    ds_read_b128 v[32:35], v129 offset:0
    ds_read_b128 v[36:39], v129 offset:4096
    ds_read_b64_tr_b16 v[40:41], v132 offset:2048
    ds_read_b64_tr_b16 v[42:43], v132 offset:2560
    ds_read_b64_tr_b16 v[44:45], v133 offset:10240
    ds_read_b64_tr_b16 v[46:47], v133 offset:10752
    s_waitcnt lgkmcnt(6)
    v_mfma_f32_32x32x16_bf16 v[64:79], v[24:27], v[16:19], v[64:79]
    v_mfma_f32_32x32x16_bf16 v[80:95], v[28:31], v[16:19], v[80:95]
    v_mfma_f32_32x32x16_bf16 v[96:111], v[24:27], v[20:23], v[96:111]
    v_mfma_f32_32x32x16_bf16 v[112:127], v[28:31], v[20:23], v[112:127]
    ds_read_b128 v[16:19], v130 offset:0
    ds_read_b128 v[20:23], v130 offset:4096
    ds_read_b64_tr_b16 v[24:25], v132 offset:4096
    ds_read_b64_tr_b16 v[26:27], v132 offset:4608
    ds_read_b64_tr_b16 v[28:29], v133 offset:12288
    ds_read_b64_tr_b16 v[30:31], v133 offset:12800
    s_waitcnt lgkmcnt(6)
    v_mfma_f32_32x32x16_bf16 v[64:79], v[40:43], v[32:35], v[64:79]
    v_mfma_f32_32x32x16_bf16 v[80:95], v[44:47], v[32:35], v[80:95]
    v_mfma_f32_32x32x16_bf16 v[96:111], v[40:43], v[36:39], v[96:111]
    v_mfma_f32_32x32x16_bf16 v[112:127], v[44:47], v[36:39], v[112:127]
    ds_read_b128 v[32:35], v131 offset:0
    ds_read_b128 v[36:39], v131 offset:4096
    ds_read_b64_tr_b16 v[40:41], v132 offset:6144
    ds_read_b64_tr_b16 v[42:43], v132 offset:6656
    ds_read_b64_tr_b16 v[44:45], v133 offset:14336
    ds_read_b64_tr_b16 v[46:47], v133 offset:14848
    s_waitcnt lgkmcnt(6)
    v_mfma_f32_32x32x16_bf16 v[64:79], v[24:27], v[16:19], v[64:79]
    v_mfma_f32_32x32x16_bf16 v[80:95], v[28:31], v[16:19], v[80:95]
    v_mfma_f32_32x32x16_bf16 v[96:111], v[24:27], v[20:23], v[96:111]
    v_mfma_f32_32x32x16_bf16 v[112:127], v[28:31], v[20:23], v[112:127]
    s_waitcnt lgkmcnt(0)
    v_mfma_f32_32x32x16_bf16 v[64:79], v[40:43], v[32:35], v[64:79]
    v_mfma_f32_32x32x16_bf16 v[80:95], v[44:47], v[32:35], v[80:95]
    v_mfma_f32_32x32x16_bf16 v[96:111], v[40:43], v[36:39], v[96:111]
    v_mfma_f32_32x32x16_bf16 v[112:127], v[44:47], v[36:39], v[112:127]
    s_waitcnt vmcnt(0)
    s_barrier
    ds_read_b128 v[16:19], v8 offset:0
    ds_read_b128 v[20:23], v8 offset:4096
    ds_read_b64_tr_b16 v[24:25], v12 offset:0
    ds_read_b64_tr_b16 v[26:27], v12 offset:512
    ds_read_b64_tr_b16 v[28:29], v13 offset:8192
    ds_read_b64_tr_b16 v[30:31], v13 offset:8704
    ds_read_b128 v[32:35], v9 offset:0
    ds_read_b128 v[36:39], v9 offset:4096
    ds_read_b64_tr_b16 v[40:41], v12 offset:2048
    ds_read_b64_tr_b16 v[42:43], v12 offset:2560
    ds_read_b64_tr_b16 v[44:45], v13 offset:10240
    ds_read_b64_tr_b16 v[46:47], v13 offset:10752
    s_waitcnt lgkmcnt(6)
    v_mfma_f32_32x32x16_bf16 v[64:79], v[24:27], v[16:19], v[64:79]
    v_mfma_f32_32x32x16_bf16 v[80:95], v[28:31], v[16:19], v[80:95]
    v_mfma_f32_32x32x16_bf16 v[96:111], v[24:27], v[20:23], v[96:111]
    v_mfma_f32_32x32x16_bf16 v[112:127], v[28:31], v[20:23], v[112:127]
    ds_read_b128 v[16:19], v10 offset:0
    ds_read_b128 v[20:23], v10 offset:4096
    ds_read_b64_tr_b16 v[24:25], v12 offset:4096
    ds_read_b64_tr_b16 v[26:27], v12 offset:4608
    ds_read_b64_tr_b16 v[28:29], v13 offset:12288
    ds_read_b64_tr_b16 v[30:31], v13 offset:12800
    s_waitcnt lgkmcnt(6)
    v_mfma_f32_32x32x16_bf16 v[64:79], v[40:43], v[32:35], v[64:79]
    v_mfma_f32_32x32x16_bf16 v[80:95], v[44:47], v[32:35], v[80:95]
    v_mfma_f32_32x32x16_bf16 v[96:111], v[40:43], v[36:39], v[96:111]
    v_mfma_f32_32x32x16_bf16 v[112:127], v[44:47], v[36:39], v[112:127]
    ds_read_b128 v[32:35], v11 offset:0
    ds_read_b128 v[36:39], v11 offset:4096
    ds_read_b64_tr_b16 v[40:41], v12 offset:6144
    ds_read_b64_tr_b16 v[42:43], v12 offset:6656
    ds_read_b64_tr_b16 v[44:45], v13 offset:14336
    ds_read_b64_tr_b16 v[46:47], v13 offset:14848
    s_waitcnt lgkmcnt(6)
    v_mfma_f32_32x32x16_bf16 v[64:79], v[24:27], v[16:19], v[64:79]
    v_mfma_f32_32x32x16_bf16 v[80:95], v[28:31], v[16:19], v[80:95]
    v_mfma_f32_32x32x16_bf16 v[96:111], v[24:27], v[20:23], v[96:111]
    v_mfma_f32_32x32x16_bf16 v[112:127], v[28:31], v[20:23], v[112:127]
    s_waitcnt lgkmcnt(0)
    v_mfma_f32_32x32x16_bf16 v[64:79], v[40:43], v[32:35], v[64:79]
    v_mfma_f32_32x32x16_bf16 v[80:95], v[44:47], v[32:35], v[80:95]
    v_mfma_f32_32x32x16_bf16 v[96:111], v[40:43], v[36:39], v[96:111]
    v_mfma_f32_32x32x16_bf16 v[112:127], v[44:47], v[36:39], v[112:127]
    s_nop 15
    v_and_b32 v48, 63, v0
    v_lshrrev_b32 v49, 6, v0
    v_lshrrev_b32 v53, 1, v49
    v_and_b32 v54, 1, v49
    v_and_b32 v55, 31, v48
    v_lshrrev_b32 v56, 5, v48
    s_mov_b64 s[16:17], s[78:79]
    s_add_u32 s16, s16, 136757248
    s_addc_u32 s17, s17, 0
    s_and_b32 s17, s17, 0xffff
    s_mov_b32 s18, 6291456
    s_mov_b32 s19, 0x00020000
    s_mul_i32 s12, s13, 128
    v_mul_u32_u24 v57, 64, v53
    v_add_u32 v57, v57, v55
    v_add_u32 v57, s12, v57
    s_mov_b32 s12, 3072
    v_mul_lo_u32 v57, v57, s12
    v_lshlrev_b32 v58, 5, v54
    v_lshlrev_b32 v59, 2, v56
    v_add_u32 v58, v58, v59
    s_lshl_b32 s12, s14, 6
    v_add_u32 v58, s12, v58
    v_lshlrev_b32 v59, 1, v58
    v_add_u32 v57, v57, v59
    s_mov_b32 s12, 0
    v_cvt_pk_bf16_f32 v64, v64, v64
    v_and_b32 v64, 0xffff0000, v64
    v_cvt_pk_bf16_f32 v80, v80, v80
    v_and_b32 v80, 0xffff0000, v80
    v_mul_f32 v62, 0xbfb8aa3b, v64
    v_exp_f32 v62, v62
    s_nop 0
    v_add_f32 v62, 1.0, v62
    v_rcp_f32 v62, v62
    s_nop 0
    v_mul_f32 v64, v64, v62
    v_cvt_pk_bf16_f32 v64, v64, v64
    v_and_b32 v64, 0xffff0000, v64
    v_mul_f32 v64, v64, v80
    v_cvt_pk_bf16_f32 v65, v65, v65
    v_and_b32 v65, 0xffff0000, v65
    v_cvt_pk_bf16_f32 v81, v81, v81
    v_and_b32 v81, 0xffff0000, v81
    v_mul_f32 v62, 0xbfb8aa3b, v65
    v_exp_f32 v62, v62
    s_nop 0
    v_add_f32 v62, 1.0, v62
    v_rcp_f32 v62, v62
    s_nop 0
    v_mul_f32 v65, v65, v62
    v_cvt_pk_bf16_f32 v65, v65, v65
    v_and_b32 v65, 0xffff0000, v65
    v_mul_f32 v65, v65, v81
    v_cvt_pk_bf16_f32 v66, v66, v66
    v_and_b32 v66, 0xffff0000, v66
    v_cvt_pk_bf16_f32 v82, v82, v82
    v_and_b32 v82, 0xffff0000, v82
    v_mul_f32 v62, 0xbfb8aa3b, v66
    v_exp_f32 v62, v62
    s_nop 0
    v_add_f32 v62, 1.0, v62
    v_rcp_f32 v62, v62
    s_nop 0
    v_mul_f32 v66, v66, v62
    v_cvt_pk_bf16_f32 v66, v66, v66
    v_and_b32 v66, 0xffff0000, v66
    v_mul_f32 v66, v66, v82
    v_cvt_pk_bf16_f32 v67, v67, v67
    v_and_b32 v67, 0xffff0000, v67
    v_cvt_pk_bf16_f32 v83, v83, v83
    v_and_b32 v83, 0xffff0000, v83
    v_mul_f32 v62, 0xbfb8aa3b, v67
    v_exp_f32 v62, v62
    s_nop 0
    v_add_f32 v62, 1.0, v62
    v_rcp_f32 v62, v62
    s_nop 0
    v_mul_f32 v67, v67, v62
    v_cvt_pk_bf16_f32 v67, v67, v67
    v_and_b32 v67, 0xffff0000, v67
    v_mul_f32 v67, v67, v83
    v_cvt_pk_bf16_f32 v60, v64, v65
    v_cvt_pk_bf16_f32 v61, v66, v67
    buffer_store_dwordx2 v[60:61], v57, s[16:19], s12 offen offset:0 sc0 sc1
    s_nop 0
    v_cvt_pk_bf16_f32 v68, v68, v68
    v_and_b32 v68, 0xffff0000, v68
    v_cvt_pk_bf16_f32 v84, v84, v84
    v_and_b32 v84, 0xffff0000, v84
    v_mul_f32 v62, 0xbfb8aa3b, v68
    v_exp_f32 v62, v62
    s_nop 0
    v_add_f32 v62, 1.0, v62
    v_rcp_f32 v62, v62
    s_nop 0
    v_mul_f32 v68, v68, v62
    v_cvt_pk_bf16_f32 v68, v68, v68
    v_and_b32 v68, 0xffff0000, v68
    v_mul_f32 v68, v68, v84
    v_cvt_pk_bf16_f32 v69, v69, v69
    v_and_b32 v69, 0xffff0000, v69
    v_cvt_pk_bf16_f32 v85, v85, v85
    v_and_b32 v85, 0xffff0000, v85
    v_mul_f32 v62, 0xbfb8aa3b, v69
    v_exp_f32 v62, v62
    s_nop 0
    v_add_f32 v62, 1.0, v62
    v_rcp_f32 v62, v62
    s_nop 0
    v_mul_f32 v69, v69, v62
    v_cvt_pk_bf16_f32 v69, v69, v69
    v_and_b32 v69, 0xffff0000, v69
    v_mul_f32 v69, v69, v85
    v_cvt_pk_bf16_f32 v70, v70, v70
    v_and_b32 v70, 0xffff0000, v70
    v_cvt_pk_bf16_f32 v86, v86, v86
    v_and_b32 v86, 0xffff0000, v86
    v_mul_f32 v62, 0xbfb8aa3b, v70
    v_exp_f32 v62, v62
    s_nop 0
    v_add_f32 v62, 1.0, v62
    v_rcp_f32 v62, v62
    s_nop 0
    v_mul_f32 v70, v70, v62
    v_cvt_pk_bf16_f32 v70, v70, v70
    v_and_b32 v70, 0xffff0000, v70
    v_mul_f32 v70, v70, v86
    v_cvt_pk_bf16_f32 v71, v71, v71
    v_and_b32 v71, 0xffff0000, v71
    v_cvt_pk_bf16_f32 v87, v87, v87
    v_and_b32 v87, 0xffff0000, v87
    v_mul_f32 v62, 0xbfb8aa3b, v71
    v_exp_f32 v62, v62
    s_nop 0
    v_add_f32 v62, 1.0, v62
    v_rcp_f32 v62, v62
    s_nop 0
    v_mul_f32 v71, v71, v62
    v_cvt_pk_bf16_f32 v71, v71, v71
    v_and_b32 v71, 0xffff0000, v71
    v_mul_f32 v71, v71, v87
    v_cvt_pk_bf16_f32 v60, v68, v69
    v_cvt_pk_bf16_f32 v61, v70, v71
    buffer_store_dwordx2 v[60:61], v57, s[16:19], s12 offen offset:16 sc0 sc1
    s_nop 0
    v_cvt_pk_bf16_f32 v72, v72, v72
    v_and_b32 v72, 0xffff0000, v72
    v_cvt_pk_bf16_f32 v88, v88, v88
    v_and_b32 v88, 0xffff0000, v88
    v_mul_f32 v62, 0xbfb8aa3b, v72
    v_exp_f32 v62, v62
    s_nop 0
    v_add_f32 v62, 1.0, v62
    v_rcp_f32 v62, v62
    s_nop 0
    v_mul_f32 v72, v72, v62
    v_cvt_pk_bf16_f32 v72, v72, v72
    v_and_b32 v72, 0xffff0000, v72
    v_mul_f32 v72, v72, v88
    v_cvt_pk_bf16_f32 v73, v73, v73
    v_and_b32 v73, 0xffff0000, v73
    v_cvt_pk_bf16_f32 v89, v89, v89
    v_and_b32 v89, 0xffff0000, v89
    v_mul_f32 v62, 0xbfb8aa3b, v73
    v_exp_f32 v62, v62
    s_nop 0
    v_add_f32 v62, 1.0, v62
    v_rcp_f32 v62, v62
    s_nop 0
    v_mul_f32 v73, v73, v62
    v_cvt_pk_bf16_f32 v73, v73, v73
    v_and_b32 v73, 0xffff0000, v73
    v_mul_f32 v73, v73, v89
    v_cvt_pk_bf16_f32 v74, v74, v74
    v_and_b32 v74, 0xffff0000, v74
    v_cvt_pk_bf16_f32 v90, v90, v90
    v_and_b32 v90, 0xffff0000, v90
    v_mul_f32 v62, 0xbfb8aa3b, v74
    v_exp_f32 v62, v62
    s_nop 0
    v_add_f32 v62, 1.0, v62
    v_rcp_f32 v62, v62
    s_nop 0
    v_mul_f32 v74, v74, v62
    v_cvt_pk_bf16_f32 v74, v74, v74
    v_and_b32 v74, 0xffff0000, v74
    v_mul_f32 v74, v74, v90
    v_cvt_pk_bf16_f32 v75, v75, v75
    v_and_b32 v75, 0xffff0000, v75
    v_cvt_pk_bf16_f32 v91, v91, v91
    v_and_b32 v91, 0xffff0000, v91
    v_mul_f32 v62, 0xbfb8aa3b, v75
    v_exp_f32 v62, v62
    s_nop 0
    v_add_f32 v62, 1.0, v62
    v_rcp_f32 v62, v62
    s_nop 0
    v_mul_f32 v75, v75, v62
    v_cvt_pk_bf16_f32 v75, v75, v75
    v_and_b32 v75, 0xffff0000, v75
    v_mul_f32 v75, v75, v91
    v_cvt_pk_bf16_f32 v60, v72, v73
    v_cvt_pk_bf16_f32 v61, v74, v75
    buffer_store_dwordx2 v[60:61], v57, s[16:19], s12 offen offset:32 sc0 sc1
    s_nop 0
    v_cvt_pk_bf16_f32 v76, v76, v76
    v_and_b32 v76, 0xffff0000, v76
    v_cvt_pk_bf16_f32 v92, v92, v92
    v_and_b32 v92, 0xffff0000, v92
    v_mul_f32 v62, 0xbfb8aa3b, v76
    v_exp_f32 v62, v62
    s_nop 0
    v_add_f32 v62, 1.0, v62
    v_rcp_f32 v62, v62
    s_nop 0
    v_mul_f32 v76, v76, v62
    v_cvt_pk_bf16_f32 v76, v76, v76
    v_and_b32 v76, 0xffff0000, v76
    v_mul_f32 v76, v76, v92
    v_cvt_pk_bf16_f32 v77, v77, v77
    v_and_b32 v77, 0xffff0000, v77
    v_cvt_pk_bf16_f32 v93, v93, v93
    v_and_b32 v93, 0xffff0000, v93
    v_mul_f32 v62, 0xbfb8aa3b, v77
    v_exp_f32 v62, v62
    s_nop 0
    v_add_f32 v62, 1.0, v62
    v_rcp_f32 v62, v62
    s_nop 0
    v_mul_f32 v77, v77, v62
    v_cvt_pk_bf16_f32 v77, v77, v77
    v_and_b32 v77, 0xffff0000, v77
    v_mul_f32 v77, v77, v93
    v_cvt_pk_bf16_f32 v78, v78, v78
    v_and_b32 v78, 0xffff0000, v78
    v_cvt_pk_bf16_f32 v94, v94, v94
    v_and_b32 v94, 0xffff0000, v94
    v_mul_f32 v62, 0xbfb8aa3b, v78
    v_exp_f32 v62, v62
    s_nop 0
    v_add_f32 v62, 1.0, v62
    v_rcp_f32 v62, v62
    s_nop 0
    v_mul_f32 v78, v78, v62
    v_cvt_pk_bf16_f32 v78, v78, v78
    v_and_b32 v78, 0xffff0000, v78
    v_mul_f32 v78, v78, v94
    v_cvt_pk_bf16_f32 v79, v79, v79
    v_and_b32 v79, 0xffff0000, v79
    v_cvt_pk_bf16_f32 v95, v95, v95
    v_and_b32 v95, 0xffff0000, v95
    v_mul_f32 v62, 0xbfb8aa3b, v79
    v_exp_f32 v62, v62
    s_nop 0
    v_add_f32 v62, 1.0, v62
    v_rcp_f32 v62, v62
    s_nop 0
    v_mul_f32 v79, v79, v62
    v_cvt_pk_bf16_f32 v79, v79, v79
    v_and_b32 v79, 0xffff0000, v79
    v_mul_f32 v79, v79, v95
    v_cvt_pk_bf16_f32 v60, v76, v77
    v_cvt_pk_bf16_f32 v61, v78, v79
    buffer_store_dwordx2 v[60:61], v57, s[16:19], s12 offen offset:48 sc0 sc1
    s_nop 0
    s_mov_b32 s12, 98304
    v_cvt_pk_bf16_f32 v96, v96, v96
    v_and_b32 v96, 0xffff0000, v96
    v_cvt_pk_bf16_f32 v112, v112, v112
    v_and_b32 v112, 0xffff0000, v112
    v_mul_f32 v62, 0xbfb8aa3b, v96
    v_exp_f32 v62, v62
    s_nop 0
    v_add_f32 v62, 1.0, v62
    v_rcp_f32 v62, v62
    s_nop 0
    v_mul_f32 v96, v96, v62
    v_cvt_pk_bf16_f32 v96, v96, v96
    v_and_b32 v96, 0xffff0000, v96
    v_mul_f32 v96, v96, v112
    v_cvt_pk_bf16_f32 v97, v97, v97
    v_and_b32 v97, 0xffff0000, v97
    v_cvt_pk_bf16_f32 v113, v113, v113
    v_and_b32 v113, 0xffff0000, v113
    v_mul_f32 v62, 0xbfb8aa3b, v97
    v_exp_f32 v62, v62
    s_nop 0
    v_add_f32 v62, 1.0, v62
    v_rcp_f32 v62, v62
    s_nop 0
    v_mul_f32 v97, v97, v62
    v_cvt_pk_bf16_f32 v97, v97, v97
    v_and_b32 v97, 0xffff0000, v97
    v_mul_f32 v97, v97, v113
    v_cvt_pk_bf16_f32 v98, v98, v98
    v_and_b32 v98, 0xffff0000, v98
    v_cvt_pk_bf16_f32 v114, v114, v114
    v_and_b32 v114, 0xffff0000, v114
    v_mul_f32 v62, 0xbfb8aa3b, v98
    v_exp_f32 v62, v62
    s_nop 0
    v_add_f32 v62, 1.0, v62
    v_rcp_f32 v62, v62
    s_nop 0
    v_mul_f32 v98, v98, v62
    v_cvt_pk_bf16_f32 v98, v98, v98
    v_and_b32 v98, 0xffff0000, v98
    v_mul_f32 v98, v98, v114
    v_cvt_pk_bf16_f32 v99, v99, v99
    v_and_b32 v99, 0xffff0000, v99
    v_cvt_pk_bf16_f32 v115, v115, v115
    v_and_b32 v115, 0xffff0000, v115
    v_mul_f32 v62, 0xbfb8aa3b, v99
    v_exp_f32 v62, v62
    s_nop 0
    v_add_f32 v62, 1.0, v62
    v_rcp_f32 v62, v62
    s_nop 0
    v_mul_f32 v99, v99, v62
    v_cvt_pk_bf16_f32 v99, v99, v99
    v_and_b32 v99, 0xffff0000, v99
    v_mul_f32 v99, v99, v115
    v_cvt_pk_bf16_f32 v60, v96, v97
    v_cvt_pk_bf16_f32 v61, v98, v99
    buffer_store_dwordx2 v[60:61], v57, s[16:19], s12 offen offset:0 sc0 sc1
    s_nop 0
    v_cvt_pk_bf16_f32 v100, v100, v100
    v_and_b32 v100, 0xffff0000, v100
    v_cvt_pk_bf16_f32 v116, v116, v116
    v_and_b32 v116, 0xffff0000, v116
    v_mul_f32 v62, 0xbfb8aa3b, v100
    v_exp_f32 v62, v62
    s_nop 0
    v_add_f32 v62, 1.0, v62
    v_rcp_f32 v62, v62
    s_nop 0
    v_mul_f32 v100, v100, v62
    v_cvt_pk_bf16_f32 v100, v100, v100
    v_and_b32 v100, 0xffff0000, v100
    v_mul_f32 v100, v100, v116
    v_cvt_pk_bf16_f32 v101, v101, v101
    v_and_b32 v101, 0xffff0000, v101
    v_cvt_pk_bf16_f32 v117, v117, v117
    v_and_b32 v117, 0xffff0000, v117
    v_mul_f32 v62, 0xbfb8aa3b, v101
    v_exp_f32 v62, v62
    s_nop 0
    v_add_f32 v62, 1.0, v62
    v_rcp_f32 v62, v62
    s_nop 0
    v_mul_f32 v101, v101, v62
    v_cvt_pk_bf16_f32 v101, v101, v101
    v_and_b32 v101, 0xffff0000, v101
    v_mul_f32 v101, v101, v117
    v_cvt_pk_bf16_f32 v102, v102, v102
    v_and_b32 v102, 0xffff0000, v102
    v_cvt_pk_bf16_f32 v118, v118, v118
    v_and_b32 v118, 0xffff0000, v118
    v_mul_f32 v62, 0xbfb8aa3b, v102
    v_exp_f32 v62, v62
    s_nop 0
    v_add_f32 v62, 1.0, v62
    v_rcp_f32 v62, v62
    s_nop 0
    v_mul_f32 v102, v102, v62
    v_cvt_pk_bf16_f32 v102, v102, v102
    v_and_b32 v102, 0xffff0000, v102
    v_mul_f32 v102, v102, v118
    v_cvt_pk_bf16_f32 v103, v103, v103
    v_and_b32 v103, 0xffff0000, v103
    v_cvt_pk_bf16_f32 v119, v119, v119
    v_and_b32 v119, 0xffff0000, v119
    v_mul_f32 v62, 0xbfb8aa3b, v103
    v_exp_f32 v62, v62
    s_nop 0
    v_add_f32 v62, 1.0, v62
    v_rcp_f32 v62, v62
    s_nop 0
    v_mul_f32 v103, v103, v62
    v_cvt_pk_bf16_f32 v103, v103, v103
    v_and_b32 v103, 0xffff0000, v103
    v_mul_f32 v103, v103, v119
    v_cvt_pk_bf16_f32 v60, v100, v101
    v_cvt_pk_bf16_f32 v61, v102, v103
    buffer_store_dwordx2 v[60:61], v57, s[16:19], s12 offen offset:16 sc0 sc1
    s_nop 0
    v_cvt_pk_bf16_f32 v104, v104, v104
    v_and_b32 v104, 0xffff0000, v104
    v_cvt_pk_bf16_f32 v120, v120, v120
    v_and_b32 v120, 0xffff0000, v120
    v_mul_f32 v62, 0xbfb8aa3b, v104
    v_exp_f32 v62, v62
    s_nop 0
    v_add_f32 v62, 1.0, v62
    v_rcp_f32 v62, v62
    s_nop 0
    v_mul_f32 v104, v104, v62
    v_cvt_pk_bf16_f32 v104, v104, v104
    v_and_b32 v104, 0xffff0000, v104
    v_mul_f32 v104, v104, v120
    v_cvt_pk_bf16_f32 v105, v105, v105
    v_and_b32 v105, 0xffff0000, v105
    v_cvt_pk_bf16_f32 v121, v121, v121
    v_and_b32 v121, 0xffff0000, v121
    v_mul_f32 v62, 0xbfb8aa3b, v105
    v_exp_f32 v62, v62
    s_nop 0
    v_add_f32 v62, 1.0, v62
    v_rcp_f32 v62, v62
    s_nop 0
    v_mul_f32 v105, v105, v62
    v_cvt_pk_bf16_f32 v105, v105, v105
    v_and_b32 v105, 0xffff0000, v105
    v_mul_f32 v105, v105, v121
    v_cvt_pk_bf16_f32 v106, v106, v106
    v_and_b32 v106, 0xffff0000, v106
    v_cvt_pk_bf16_f32 v122, v122, v122
    v_and_b32 v122, 0xffff0000, v122
    v_mul_f32 v62, 0xbfb8aa3b, v106
    v_exp_f32 v62, v62
    s_nop 0
    v_add_f32 v62, 1.0, v62
    v_rcp_f32 v62, v62
    s_nop 0
    v_mul_f32 v106, v106, v62
    v_cvt_pk_bf16_f32 v106, v106, v106
    v_and_b32 v106, 0xffff0000, v106
    v_mul_f32 v106, v106, v122
    v_cvt_pk_bf16_f32 v107, v107, v107
    v_and_b32 v107, 0xffff0000, v107
    v_cvt_pk_bf16_f32 v123, v123, v123
    v_and_b32 v123, 0xffff0000, v123
    v_mul_f32 v62, 0xbfb8aa3b, v107
    v_exp_f32 v62, v62
    s_nop 0
    v_add_f32 v62, 1.0, v62
    v_rcp_f32 v62, v62
    s_nop 0
    v_mul_f32 v107, v107, v62
    v_cvt_pk_bf16_f32 v107, v107, v107
    v_and_b32 v107, 0xffff0000, v107
    v_mul_f32 v107, v107, v123
    v_cvt_pk_bf16_f32 v60, v104, v105
    v_cvt_pk_bf16_f32 v61, v106, v107
    buffer_store_dwordx2 v[60:61], v57, s[16:19], s12 offen offset:32 sc0 sc1
    s_nop 0
    v_cvt_pk_bf16_f32 v108, v108, v108
    v_and_b32 v108, 0xffff0000, v108
    v_cvt_pk_bf16_f32 v124, v124, v124
    v_and_b32 v124, 0xffff0000, v124
    v_mul_f32 v62, 0xbfb8aa3b, v108
    v_exp_f32 v62, v62
    s_nop 0
    v_add_f32 v62, 1.0, v62
    v_rcp_f32 v62, v62
    s_nop 0
    v_mul_f32 v108, v108, v62
    v_cvt_pk_bf16_f32 v108, v108, v108
    v_and_b32 v108, 0xffff0000, v108
    v_mul_f32 v108, v108, v124
    v_cvt_pk_bf16_f32 v109, v109, v109
    v_and_b32 v109, 0xffff0000, v109
    v_cvt_pk_bf16_f32 v125, v125, v125
    v_and_b32 v125, 0xffff0000, v125
    v_mul_f32 v62, 0xbfb8aa3b, v109
    v_exp_f32 v62, v62
    s_nop 0
    v_add_f32 v62, 1.0, v62
    v_rcp_f32 v62, v62
    s_nop 0
    v_mul_f32 v109, v109, v62
    v_cvt_pk_bf16_f32 v109, v109, v109
    v_and_b32 v109, 0xffff0000, v109
    v_mul_f32 v109, v109, v125
    v_cvt_pk_bf16_f32 v110, v110, v110
    v_and_b32 v110, 0xffff0000, v110
    v_cvt_pk_bf16_f32 v126, v126, v126
    v_and_b32 v126, 0xffff0000, v126
    v_mul_f32 v62, 0xbfb8aa3b, v110
    v_exp_f32 v62, v62
    s_nop 0
    v_add_f32 v62, 1.0, v62
    v_rcp_f32 v62, v62
    s_nop 0
    v_mul_f32 v110, v110, v62
    v_cvt_pk_bf16_f32 v110, v110, v110
    v_and_b32 v110, 0xffff0000, v110
    v_mul_f32 v110, v110, v126
    v_cvt_pk_bf16_f32 v111, v111, v111
    v_and_b32 v111, 0xffff0000, v111
    v_cvt_pk_bf16_f32 v127, v127, v127
    v_and_b32 v127, 0xffff0000, v127
    v_mul_f32 v62, 0xbfb8aa3b, v111
    v_exp_f32 v62, v62
    s_nop 0
    v_add_f32 v62, 1.0, v62
    v_rcp_f32 v62, v62
    s_nop 0
    v_mul_f32 v111, v111, v62
    v_cvt_pk_bf16_f32 v111, v111, v111
    v_and_b32 v111, 0xffff0000, v111
    v_mul_f32 v111, v111, v127
    v_cvt_pk_bf16_f32 v60, v108, v109
    v_cvt_pk_bf16_f32 v61, v110, v111
    buffer_store_dwordx2 v[60:61], v57, s[16:19], s12 offen offset:48 sc0 sc1
    s_nop 0
    s_waitcnt vmcnt(0)
    s_barrier
    s_cmp_lg_u32 s94, 0
    s_cbranch_scc1 mega_kernel_sg82
    s_lshl_b32 s93, s91, 7
    s_add_u32 s93, s93, 26624
    v_mov_b32 v1, s93
    v_mov_b32 v2, 1
    s_mov_b64 exec, 1
    buffer_atomic_add v2, v1, s[80:83], 0 offen sc1
    s_mov_b64 exec, -1
mega_kernel_sg82:
    s_add_u32 s91, s91, 1
    s_cmp_lt_u32 s91, 16
    s_cbranch_scc1 mega_kernel_lf177
    s_branch mega_kernel_done1
mega_kernel_bf249:
    s_sub_u32 s96, s90, 104
    s_mov_b32 s91, 0
mega_kernel_lf283:
    s_cmp_lg_u32 s94, 0
    s_cbranch_scc1 mega_kernel_wd85
    s_lshl_b32 s93, s91, 7
    s_add_u32 s93, s93, 26624
    v_mov_b32 v1, s93
    s_mov_b32 s95, 0
mega_kernel_wl84:
    buffer_load_dword v2, v1, s[80:83], 0 offen sc1
    s_waitcnt vmcnt(0)
    v_cmp_gt_u32 vcc, 24, v2
    s_nop 0
    s_cbranch_vccz mega_kernel_wok86
    s_cmp_ge_u32 s91, 14
    s_cbranch_scc1 mega_kernel_wfast87
    s_sleep 48
mega_kernel_wfast87:
    s_sleep 4
    s_add_u32 s95, s95, 1
    s_cmp_lt_u32 s95, 1000000
    s_cbranch_scc1 mega_kernel_wl84
    s_branch mega_kernel_done1
mega_kernel_wok86:
mega_kernel_wd85:
    s_barrier
    s_lshl_b32 s13, s91, 1
    s_mov_b32 s14, s96
    s_cmp_lt_u32 s96, 5
    s_cbranch_scc1 mega_kernel_f2t88
    s_add_u32 s13, s13, 1
    s_sub_u32 s14, s96, 5
mega_kernel_f2t88:
    s_mov_b64 s[4:5], s[78:79]
    s_mul_i32 s12, s13, 196608
    s_add_u32 s4, s4, 136757248
    s_addc_u32 s5, s5, 0
    s_add_u32 s4, s4, s12
    s_addc_u32 s5, s5, 0
    s_mov_b64 s[6:7], s[68:69]
    s_lshl_b32 s12, s14, 8
    s_add_u32 s6, s6, s12
    s_addc_u32 s7, s7, 0
    s_add_u32 s8, s6, 128
    s_addc_u32 s9, s7, 0
    v_and_b32 v48, 63, v0
    v_lshrrev_b32 v49, 6, v0
    s_nop 1
    v_readfirstlane_b32 s10, v49
    s_nop 3
    s_lshl_b32 s11, s10, 11
    s_mul_i32 s10, s10, 2048
    v_lshrrev_b32 v50, 3, v48
    v_and_b32 v51, 7, v48
    v_lshrrev_b32 v52, 4, v48
    s_mov_b32 s12, 3072
    v_mul_u32_u24 v53, 16, v49
    v_add_u32 v53, 0, v53
    v_add_u32 v53, v53, v50
    v_lshrrev_b32 v54, 1, v53
    v_and_b32 v54, 7, v54
    v_xor_b32 v54, v54, v51
    v_lshlrev_b32 v54, 4, v54
    v_mul_lo_u32 v1, v53, s12
    v_add_u32 v1, v1, v54
    v_mul_u32_u24 v53, 16, v49
    v_add_u32 v53, 8, v53
    v_add_u32 v53, v53, v50
    v_lshrrev_b32 v54, 1, v53
    v_and_b32 v54, 7, v54
    v_xor_b32 v54, v54, v51
    v_lshlrev_b32 v54, 4, v54
    v_mul_lo_u32 v2, v53, s12
    v_add_u32 v2, v2, v54
    v_lshrrev_b32 v53, 2, v51
    v_and_b32 v54, 1, v52
    v_xor_b32 v53, v53, v54
    v_lshlrev_b32 v53, 2, v53
    v_and_b32 v54, 3, v51
    v_or_b32 v53, v53, v54
    v_lshlrev_b32 v53, 4, v53
    v_lshlrev_b32 v54, 4, v49
    v_add_u32 v54, v54, v50
    s_mov_b32 s12, 1280
    v_mul_lo_u32 v5, v54, s12
    v_add_u32 v5, v5, v53
    v_add_u32 v6, 10240, v5
    v_lshrrev_b32 v53, 1, v49
    v_and_b32 v54, 1, v49
    v_mul_u32_u24 v55, 32, v53
    v_and_b32 v56, 31, v48
    v_add_u32 v55, v55, v56
    v_lshrrev_b32 v56, 1, v55
    v_and_b32 v56, 7, v56
    v_lshrrev_b32 v57, 5, v48
    v_xor_b32 v56, v56, v57
    v_lshlrev_b32 v56, 4, v56
    v_lshlrev_b32 v55, 7, v55
    v_add_u32 v8, v55, v56
    v_xor_b32 v9, 32, v8
    v_xor_b32 v10, 64, v8
    v_xor_b32 v11, 96, v8
    v_and_b32 v55, 15, v48
    v_lshrrev_b32 v55, 2, v55
    v_lshrrev_b32 v56, 5, v48
    v_lshlrev_b32 v56, 3, v56
    v_add_u32 v56, v56, v55
    v_lshrrev_b32 v57, 1, v55
    v_and_b32 v57, 1, v57
    v_lshlrev_b32 v57, 6, v57
    v_lshlrev_b32 v56, 7, v56
    v_add_u32 v56, v56, v57
    v_and_b32 v57, 1, v52
    v_lshlrev_b32 v57, 5, v57
    v_add_u32 v56, v56, v57
    v_and_b32 v57, 3, v48
    v_lshlrev_b32 v57, 3, v57
    v_add_u32 v56, v56, v57
    v_add_u32 v56, 8192, v56
    v_lshlrev_b32 v57, 13, v54
    v_add_u32 v12, v56, v57
    v_xor_b32 v13, 64, v12
    v_add_u32 v128, 49152, v8
    v_add_u32 v129, 49152, v9
    v_add_u32 v130, 49152, v10
    v_add_u32 v131, 49152, v11
    v_add_u32 v132, 49152, v12
    v_add_u32 v133, 49152, v13
    v_mov_b32 v64, 0
    v_mov_b32 v65, 0
    v_mov_b32 v66, 0
    v_mov_b32 v67, 0
    v_mov_b32 v68, 0
    v_mov_b32 v69, 0
    v_mov_b32 v70, 0
    v_mov_b32 v71, 0
    v_mov_b32 v72, 0
    v_mov_b32 v73, 0
    v_mov_b32 v74, 0
    v_mov_b32 v75, 0
    v_mov_b32 v76, 0
    v_mov_b32 v77, 0
    v_mov_b32 v78, 0
    v_mov_b32 v79, 0
    v_mov_b32 v80, 0
    v_mov_b32 v81, 0
    v_mov_b32 v82, 0
    v_mov_b32 v83, 0
    v_mov_b32 v84, 0
    v_mov_b32 v85, 0
    v_mov_b32 v86, 0
    v_mov_b32 v87, 0
    v_mov_b32 v88, 0
    v_mov_b32 v89, 0
    v_mov_b32 v90, 0
    v_mov_b32 v91, 0
    v_mov_b32 v92, 0
    v_mov_b32 v93, 0
    v_mov_b32 v94, 0
    v_mov_b32 v95, 0
    s_add_u32 m0, s10, 0
    s_nop 0
    global_load_lds_dwordx4 v1, s[4:5]
    s_add_u32 m0, s10, 1024
    s_nop 0
    global_load_lds_dwordx4 v2, s[4:5]
    s_add_u32 m0, s11, 8192
    s_nop 0
    global_load_lds_dwordx4 v5, s[6:7]
    s_add_u32 m0, s11, 9216
    s_nop 0
    global_load_lds_dwordx4 v6, s[6:7]
    s_add_u32 m0, s11, 16384
    s_nop 0
    global_load_lds_dwordx4 v5, s[8:9]
    s_add_u32 m0, s11, 17408
    s_nop 0
    global_load_lds_dwordx4 v6, s[8:9]
    s_add_u32 s4, s4, 128
    s_addc_u32 s5, s5, 0
    s_add_u32 s6, s6, 81920
    s_addc_u32 s7, s7, 0
    s_add_u32 s8, s8, 81920
    s_addc_u32 s9, s9, 0
    s_add_u32 m0, s10, 24576
    s_nop 0
    global_load_lds_dwordx4 v1, s[4:5]
    s_add_u32 m0, s10, 25600
    s_nop 0
    global_load_lds_dwordx4 v2, s[4:5]
    s_add_u32 m0, s11, 32768
    s_nop 0
    global_load_lds_dwordx4 v5, s[6:7]
    s_add_u32 m0, s11, 33792
    s_nop 0
    global_load_lds_dwordx4 v6, s[6:7]
    s_add_u32 m0, s11, 40960
    s_nop 0
    global_load_lds_dwordx4 v5, s[8:9]
    s_add_u32 m0, s11, 41984
    s_nop 0
    global_load_lds_dwordx4 v6, s[8:9]
    s_add_u32 s4, s4, 128
    s_addc_u32 s5, s5, 0
    s_add_u32 s6, s6, 81920
    s_addc_u32 s7, s7, 0
    s_add_u32 s8, s8, 81920
    s_addc_u32 s9, s9, 0
    s_add_u32 m0, s10, 49152
    s_nop 0
    global_load_lds_dwordx4 v1, s[4:5]
    s_add_u32 m0, s10, 50176
    s_nop 0
    global_load_lds_dwordx4 v2, s[4:5]
    s_add_u32 m0, s11, 57344
    s_nop 0
    global_load_lds_dwordx4 v5, s[6:7]
    s_add_u32 m0, s11, 58368
    s_nop 0
    global_load_lds_dwordx4 v6, s[6:7]
    s_add_u32 m0, s11, 65536
    s_nop 0
    global_load_lds_dwordx4 v5, s[8:9]
    s_add_u32 m0, s11, 66560
    s_nop 0
    global_load_lds_dwordx4 v6, s[8:9]
    s_add_u32 s4, s4, 128
    s_addc_u32 s5, s5, 0
    s_add_u32 s6, s6, 81920
    s_addc_u32 s7, s7, 0
    s_add_u32 s8, s8, 81920
    s_addc_u32 s9, s9, 0
    s_waitcnt vmcnt(12)
    s_barrier
    ds_read_b128 v[16:19], v8 offset:0
    ds_read_b64_tr_b16 v[24:25], v12 offset:0
    ds_read_b64_tr_b16 v[26:27], v12 offset:512
    ds_read_b64_tr_b16 v[28:29], v13 offset:0
    ds_read_b64_tr_b16 v[30:31], v13 offset:512
    ds_read_b128 v[32:35], v9 offset:0
    ds_read_b64_tr_b16 v[40:41], v12 offset:2048
    ds_read_b64_tr_b16 v[42:43], v12 offset:2560
    ds_read_b64_tr_b16 v[44:45], v13 offset:2048
    ds_read_b64_tr_b16 v[46:47], v13 offset:2560
    s_add_u32 m0, s10, 73728
    s_nop 0
    global_load_lds_dwordx4 v1, s[4:5]
    s_add_u32 m0, s10, 74752
    s_nop 0
    global_load_lds_dwordx4 v2, s[4:5]
    s_add_u32 m0, s11, 81920
    s_nop 0
    global_load_lds_dwordx4 v5, s[6:7]
    s_add_u32 m0, s11, 82944
    s_nop 0
    global_load_lds_dwordx4 v6, s[6:7]
    s_add_u32 m0, s11, 90112
    s_nop 0
    global_load_lds_dwordx4 v5, s[8:9]
    s_add_u32 m0, s11, 91136
    s_nop 0
    global_load_lds_dwordx4 v6, s[8:9]
    s_add_u32 s4, s4, 128
    s_addc_u32 s5, s5, 0
    s_add_u32 s6, s6, 81920
    s_addc_u32 s7, s7, 0
    s_add_u32 s8, s8, 81920
    s_addc_u32 s9, s9, 0
    s_waitcnt lgkmcnt(5)
    v_mfma_f32_32x32x16_bf16 v[64:79], v[24:27], v[16:19], v[64:79]
    v_mfma_f32_32x32x16_bf16 v[80:95], v[28:31], v[16:19], v[80:95]
    ds_read_b128 v[16:19], v10 offset:0
    ds_read_b64_tr_b16 v[24:25], v12 offset:4096
    ds_read_b64_tr_b16 v[26:27], v12 offset:4608
    ds_read_b64_tr_b16 v[28:29], v13 offset:4096
    ds_read_b64_tr_b16 v[30:31], v13 offset:4608
    s_waitcnt lgkmcnt(5)
    v_mfma_f32_32x32x16_bf16 v[64:79], v[40:43], v[32:35], v[64:79]
    v_mfma_f32_32x32x16_bf16 v[80:95], v[44:47], v[32:35], v[80:95]
    ds_read_b128 v[32:35], v11 offset:0
    ds_read_b64_tr_b16 v[40:41], v12 offset:6144
    ds_read_b64_tr_b16 v[42:43], v12 offset:6656
    ds_read_b64_tr_b16 v[44:45], v13 offset:6144
    ds_read_b64_tr_b16 v[46:47], v13 offset:6656
    s_waitcnt lgkmcnt(5)
    v_mfma_f32_32x32x16_bf16 v[64:79], v[24:27], v[16:19], v[64:79]
    v_mfma_f32_32x32x16_bf16 v[80:95], v[28:31], v[16:19], v[80:95]
    s_waitcnt lgkmcnt(0)
    v_mfma_f32_32x32x16_bf16 v[64:79], v[40:43], v[32:35], v[64:79]
    v_mfma_f32_32x32x16_bf16 v[80:95], v[44:47], v[32:35], v[80:95]
    s_mov_b32 s12, 5
mega_kernel_loop89:
    s_waitcnt vmcnt(12)
    s_barrier
    ds_read_b128 v[16:19], v8 offset:24576
    ds_read_b64_tr_b16 v[24:25], v12 offset:24576
    ds_read_b64_tr_b16 v[26:27], v12 offset:25088
    ds_read_b64_tr_b16 v[28:29], v13 offset:24576
    ds_read_b64_tr_b16 v[30:31], v13 offset:25088
    ds_read_b128 v[32:35], v9 offset:24576
    ds_read_b64_tr_b16 v[40:41], v12 offset:26624
    ds_read_b64_tr_b16 v[42:43], v12 offset:27136
    ds_read_b64_tr_b16 v[44:45], v13 offset:26624
    ds_read_b64_tr_b16 v[46:47], v13 offset:27136
    s_add_u32 m0, s10, 0
    s_nop 0
    global_load_lds_dwordx4 v1, s[4:5]
    s_add_u32 m0, s10, 1024
    s_nop 0
    global_load_lds_dwordx4 v2, s[4:5]
    s_add_u32 m0, s11, 8192
    s_nop 0
    global_load_lds_dwordx4 v5, s[6:7]
    s_add_u32 m0, s11, 9216
    s_nop 0
    global_load_lds_dwordx4 v6, s[6:7]
    s_add_u32 m0, s11, 16384
    s_nop 0
    global_load_lds_dwordx4 v5, s[8:9]
    s_add_u32 m0, s11, 17408
    s_nop 0
    global_load_lds_dwordx4 v6, s[8:9]
    s_add_u32 s4, s4, 128
    s_addc_u32 s5, s5, 0
    s_add_u32 s6, s6, 81920
    s_addc_u32 s7, s7, 0
    s_add_u32 s8, s8, 81920
    s_addc_u32 s9, s9, 0
    s_waitcnt lgkmcnt(5)
    v_mfma_f32_32x32x16_bf16 v[64:79], v[24:27], v[16:19], v[64:79]
    v_mfma_f32_32x32x16_bf16 v[80:95], v[28:31], v[16:19], v[80:95]
    ds_read_b128 v[16:19], v10 offset:24576
    ds_read_b64_tr_b16 v[24:25], v12 offset:28672
    ds_read_b64_tr_b16 v[26:27], v12 offset:29184
    ds_read_b64_tr_b16 v[28:29], v13 offset:28672
    ds_read_b64_tr_b16 v[30:31], v13 offset:29184
    s_waitcnt lgkmcnt(5)
    v_mfma_f32_32x32x16_bf16 v[64:79], v[40:43], v[32:35], v[64:79]
    v_mfma_f32_32x32x16_bf16 v[80:95], v[44:47], v[32:35], v[80:95]
    ds_read_b128 v[32:35], v11 offset:24576
    ds_read_b64_tr_b16 v[40:41], v12 offset:30720
    ds_read_b64_tr_b16 v[42:43], v12 offset:31232
    ds_read_b64_tr_b16 v[44:45], v13 offset:30720
    ds_read_b64_tr_b16 v[46:47], v13 offset:31232
    s_waitcnt lgkmcnt(5)
    v_mfma_f32_32x32x16_bf16 v[64:79], v[24:27], v[16:19], v[64:79]
    v_mfma_f32_32x32x16_bf16 v[80:95], v[28:31], v[16:19], v[80:95]
    s_waitcnt lgkmcnt(0)
    v_mfma_f32_32x32x16_bf16 v[64:79], v[40:43], v[32:35], v[64:79]
    v_mfma_f32_32x32x16_bf16 v[80:95], v[44:47], v[32:35], v[80:95]
    s_waitcnt vmcnt(12)
    s_barrier
    ds_read_b128 v[16:19], v128 offset:0
    ds_read_b64_tr_b16 v[24:25], v132 offset:0
    ds_read_b64_tr_b16 v[26:27], v132 offset:512
    ds_read_b64_tr_b16 v[28:29], v133 offset:0
    ds_read_b64_tr_b16 v[30:31], v133 offset:512
    ds_read_b128 v[32:35], v129 offset:0
    ds_read_b64_tr_b16 v[40:41], v132 offset:2048
    ds_read_b64_tr_b16 v[42:43], v132 offset:2560
    ds_read_b64_tr_b16 v[44:45], v133 offset:2048
    ds_read_b64_tr_b16 v[46:47], v133 offset:2560
    s_add_u32 m0, s10, 24576
    s_nop 0
    global_load_lds_dwordx4 v1, s[4:5]
    s_add_u32 m0, s10, 25600
    s_nop 0
    global_load_lds_dwordx4 v2, s[4:5]
    s_add_u32 m0, s11, 32768
    s_nop 0
    global_load_lds_dwordx4 v5, s[6:7]
    s_add_u32 m0, s11, 33792
    s_nop 0
    global_load_lds_dwordx4 v6, s[6:7]
    s_add_u32 m0, s11, 40960
    s_nop 0
    global_load_lds_dwordx4 v5, s[8:9]
    s_add_u32 m0, s11, 41984
    s_nop 0
    global_load_lds_dwordx4 v6, s[8:9]
    s_add_u32 s4, s4, 128
    s_addc_u32 s5, s5, 0
    s_add_u32 s6, s6, 81920
    s_addc_u32 s7, s7, 0
    s_add_u32 s8, s8, 81920
    s_addc_u32 s9, s9, 0
    s_waitcnt lgkmcnt(5)
    v_mfma_f32_32x32x16_bf16 v[64:79], v[24:27], v[16:19], v[64:79]
    v_mfma_f32_32x32x16_bf16 v[80:95], v[28:31], v[16:19], v[80:95]
    ds_read_b128 v[16:19], v130 offset:0
    ds_read_b64_tr_b16 v[24:25], v132 offset:4096
    ds_read_b64_tr_b16 v[26:27], v132 offset:4608
    ds_read_b64_tr_b16 v[28:29], v133 offset:4096
    ds_read_b64_tr_b16 v[30:31], v133 offset:4608
    s_waitcnt lgkmcnt(5)
    v_mfma_f32_32x32x16_bf16 v[64:79], v[40:43], v[32:35], v[64:79]
    v_mfma_f32_32x32x16_bf16 v[80:95], v[44:47], v[32:35], v[80:95]
    ds_read_b128 v[32:35], v131 offset:0
    ds_read_b64_tr_b16 v[40:41], v132 offset:6144
    ds_read_b64_tr_b16 v[42:43], v132 offset:6656
    ds_read_b64_tr_b16 v[44:45], v133 offset:6144
    ds_read_b64_tr_b16 v[46:47], v133 offset:6656
    s_waitcnt lgkmcnt(5)
    v_mfma_f32_32x32x16_bf16 v[64:79], v[24:27], v[16:19], v[64:79]
    v_mfma_f32_32x32x16_bf16 v[80:95], v[28:31], v[16:19], v[80:95]
    s_waitcnt lgkmcnt(0)
    v_mfma_f32_32x32x16_bf16 v[64:79], v[40:43], v[32:35], v[64:79]
    v_mfma_f32_32x32x16_bf16 v[80:95], v[44:47], v[32:35], v[80:95]
    s_waitcnt vmcnt(12)
    s_barrier
    ds_read_b128 v[16:19], v128 offset:24576
    ds_read_b64_tr_b16 v[24:25], v132 offset:24576
    ds_read_b64_tr_b16 v[26:27], v132 offset:25088
    ds_read_b64_tr_b16 v[28:29], v133 offset:24576
    ds_read_b64_tr_b16 v[30:31], v133 offset:25088
    ds_read_b128 v[32:35], v129 offset:24576
    ds_read_b64_tr_b16 v[40:41], v132 offset:26624
    ds_read_b64_tr_b16 v[42:43], v132 offset:27136
    ds_read_b64_tr_b16 v[44:45], v133 offset:26624
    ds_read_b64_tr_b16 v[46:47], v133 offset:27136
    s_add_u32 m0, s10, 49152
    s_nop 0
    global_load_lds_dwordx4 v1, s[4:5]
    s_add_u32 m0, s10, 50176
    s_nop 0
    global_load_lds_dwordx4 v2, s[4:5]
    s_add_u32 m0, s11, 57344
    s_nop 0
    global_load_lds_dwordx4 v5, s[6:7]
    s_add_u32 m0, s11, 58368
    s_nop 0
    global_load_lds_dwordx4 v6, s[6:7]
    s_add_u32 m0, s11, 65536
    s_nop 0
    global_load_lds_dwordx4 v5, s[8:9]
    s_add_u32 m0, s11, 66560
    s_nop 0
    global_load_lds_dwordx4 v6, s[8:9]
    s_add_u32 s4, s4, 128
    s_addc_u32 s5, s5, 0
    s_add_u32 s6, s6, 81920
    s_addc_u32 s7, s7, 0
    s_add_u32 s8, s8, 81920
    s_addc_u32 s9, s9, 0
    s_waitcnt lgkmcnt(5)
    v_mfma_f32_32x32x16_bf16 v[64:79], v[24:27], v[16:19], v[64:79]
    v_mfma_f32_32x32x16_bf16 v[80:95], v[28:31], v[16:19], v[80:95]
    ds_read_b128 v[16:19], v130 offset:24576
    ds_read_b64_tr_b16 v[24:25], v132 offset:28672
    ds_read_b64_tr_b16 v[26:27], v132 offset:29184
    ds_read_b64_tr_b16 v[28:29], v133 offset:28672
    ds_read_b64_tr_b16 v[30:31], v133 offset:29184
    s_waitcnt lgkmcnt(5)
    v_mfma_f32_32x32x16_bf16 v[64:79], v[40:43], v[32:35], v[64:79]
    v_mfma_f32_32x32x16_bf16 v[80:95], v[44:47], v[32:35], v[80:95]
    ds_read_b128 v[32:35], v131 offset:24576
    ds_read_b64_tr_b16 v[40:41], v132 offset:30720
    ds_read_b64_tr_b16 v[42:43], v132 offset:31232
    ds_read_b64_tr_b16 v[44:45], v133 offset:30720
    ds_read_b64_tr_b16 v[46:47], v133 offset:31232
    s_waitcnt lgkmcnt(5)
    v_mfma_f32_32x32x16_bf16 v[64:79], v[24:27], v[16:19], v[64:79]
    v_mfma_f32_32x32x16_bf16 v[80:95], v[28:31], v[16:19], v[80:95]
    s_waitcnt lgkmcnt(0)
    v_mfma_f32_32x32x16_bf16 v[64:79], v[40:43], v[32:35], v[64:79]
    v_mfma_f32_32x32x16_bf16 v[80:95], v[44:47], v[32:35], v[80:95]
    s_waitcnt vmcnt(12)
    s_barrier
    ds_read_b128 v[16:19], v8 offset:0
    ds_read_b64_tr_b16 v[24:25], v12 offset:0
    ds_read_b64_tr_b16 v[26:27], v12 offset:512
    ds_read_b64_tr_b16 v[28:29], v13 offset:0
    ds_read_b64_tr_b16 v[30:31], v13 offset:512
    ds_read_b128 v[32:35], v9 offset:0
    ds_read_b64_tr_b16 v[40:41], v12 offset:2048
    ds_read_b64_tr_b16 v[42:43], v12 offset:2560
    ds_read_b64_tr_b16 v[44:45], v13 offset:2048
    ds_read_b64_tr_b16 v[46:47], v13 offset:2560
    s_add_u32 m0, s10, 73728
    s_nop 0
    global_load_lds_dwordx4 v1, s[4:5]
    s_add_u32 m0, s10, 74752
    s_nop 0
    global_load_lds_dwordx4 v2, s[4:5]
    s_add_u32 m0, s11, 81920
    s_nop 0
    global_load_lds_dwordx4 v5, s[6:7]
    s_add_u32 m0, s11, 82944
    s_nop 0
    global_load_lds_dwordx4 v6, s[6:7]
    s_add_u32 m0, s11, 90112
    s_nop 0
    global_load_lds_dwordx4 v5, s[8:9]
    s_add_u32 m0, s11, 91136
    s_nop 0
    global_load_lds_dwordx4 v6, s[8:9]
    s_add_u32 s4, s4, 128
    s_addc_u32 s5, s5, 0
    s_add_u32 s6, s6, 81920
    s_addc_u32 s7, s7, 0
    s_add_u32 s8, s8, 81920
    s_addc_u32 s9, s9, 0
    s_waitcnt lgkmcnt(5)
    v_mfma_f32_32x32x16_bf16 v[64:79], v[24:27], v[16:19], v[64:79]
    v_mfma_f32_32x32x16_bf16 v[80:95], v[28:31], v[16:19], v[80:95]
    ds_read_b128 v[16:19], v10 offset:0
    ds_read_b64_tr_b16 v[24:25], v12 offset:4096
    ds_read_b64_tr_b16 v[26:27], v12 offset:4608
    ds_read_b64_tr_b16 v[28:29], v13 offset:4096
    ds_read_b64_tr_b16 v[30:31], v13 offset:4608
    s_waitcnt lgkmcnt(5)
    v_mfma_f32_32x32x16_bf16 v[64:79], v[40:43], v[32:35], v[64:79]
    v_mfma_f32_32x32x16_bf16 v[80:95], v[44:47], v[32:35], v[80:95]
    ds_read_b128 v[32:35], v11 offset:0
    ds_read_b64_tr_b16 v[40:41], v12 offset:6144
    ds_read_b64_tr_b16 v[42:43], v12 offset:6656
    ds_read_b64_tr_b16 v[44:45], v13 offset:6144
    ds_read_b64_tr_b16 v[46:47], v13 offset:6656
    s_waitcnt lgkmcnt(5)
    v_mfma_f32_32x32x16_bf16 v[64:79], v[24:27], v[16:19], v[64:79]
    v_mfma_f32_32x32x16_bf16 v[80:95], v[28:31], v[16:19], v[80:95]
    s_waitcnt lgkmcnt(0)
    v_mfma_f32_32x32x16_bf16 v[64:79], v[40:43], v[32:35], v[64:79]
    v_mfma_f32_32x32x16_bf16 v[80:95], v[44:47], v[32:35], v[80:95]
    s_sub_u32 s12, s12, 1
    s_cmp_lg_u32 s12, 0
    s_cbranch_scc1 mega_kernel_loop89
    s_waitcnt vmcnt(12)
    s_barrier
    ds_read_b128 v[16:19], v8 offset:24576
    ds_read_b64_tr_b16 v[24:25], v12 offset:24576
    ds_read_b64_tr_b16 v[26:27], v12 offset:25088
    ds_read_b64_tr_b16 v[28:29], v13 offset:24576
    ds_read_b64_tr_b16 v[30:31], v13 offset:25088
    ds_read_b128 v[32:35], v9 offset:24576
    ds_read_b64_tr_b16 v[40:41], v12 offset:26624
    ds_read_b64_tr_b16 v[42:43], v12 offset:27136
    ds_read_b64_tr_b16 v[44:45], v13 offset:26624
    ds_read_b64_tr_b16 v[46:47], v13 offset:27136
    s_waitcnt lgkmcnt(5)
    v_mfma_f32_32x32x16_bf16 v[64:79], v[24:27], v[16:19], v[64:79]
    v_mfma_f32_32x32x16_bf16 v[80:95], v[28:31], v[16:19], v[80:95]
    ds_read_b128 v[16:19], v10 offset:24576
    ds_read_b64_tr_b16 v[24:25], v12 offset:28672
    ds_read_b64_tr_b16 v[26:27], v12 offset:29184
    ds_read_b64_tr_b16 v[28:29], v13 offset:28672
    ds_read_b64_tr_b16 v[30:31], v13 offset:29184
    s_waitcnt lgkmcnt(5)
    v_mfma_f32_32x32x16_bf16 v[64:79], v[40:43], v[32:35], v[64:79]
    v_mfma_f32_32x32x16_bf16 v[80:95], v[44:47], v[32:35], v[80:95]
    ds_read_b128 v[32:35], v11 offset:24576
    ds_read_b64_tr_b16 v[40:41], v12 offset:30720
    ds_read_b64_tr_b16 v[42:43], v12 offset:31232
    ds_read_b64_tr_b16 v[44:45], v13 offset:30720
    ds_read_b64_tr_b16 v[46:47], v13 offset:31232
    s_waitcnt lgkmcnt(5)
    v_mfma_f32_32x32x16_bf16 v[64:79], v[24:27], v[16:19], v[64:79]
    v_mfma_f32_32x32x16_bf16 v[80:95], v[28:31], v[16:19], v[80:95]
    s_waitcnt lgkmcnt(0)
    v_mfma_f32_32x32x16_bf16 v[64:79], v[40:43], v[32:35], v[64:79]
    v_mfma_f32_32x32x16_bf16 v[80:95], v[44:47], v[32:35], v[80:95]
    s_waitcnt vmcnt(6)
    s_barrier
    ds_read_b128 v[16:19], v128 offset:0
    ds_read_b64_tr_b16 v[24:25], v132 offset:0
    ds_read_b64_tr_b16 v[26:27], v132 offset:512
    ds_read_b64_tr_b16 v[28:29], v133 offset:0
    ds_read_b64_tr_b16 v[30:31], v133 offset:512
    ds_read_b128 v[32:35], v129 offset:0
    ds_read_b64_tr_b16 v[40:41], v132 offset:2048
    ds_read_b64_tr_b16 v[42:43], v132 offset:2560
    ds_read_b64_tr_b16 v[44:45], v133 offset:2048
    ds_read_b64_tr_b16 v[46:47], v133 offset:2560
    s_waitcnt lgkmcnt(5)
    v_mfma_f32_32x32x16_bf16 v[64:79], v[24:27], v[16:19], v[64:79]
    v_mfma_f32_32x32x16_bf16 v[80:95], v[28:31], v[16:19], v[80:95]
    ds_read_b128 v[16:19], v130 offset:0
    ds_read_b64_tr_b16 v[24:25], v132 offset:4096
    ds_read_b64_tr_b16 v[26:27], v132 offset:4608
    ds_read_b64_tr_b16 v[28:29], v133 offset:4096
    ds_read_b64_tr_b16 v[30:31], v133 offset:4608
    s_waitcnt lgkmcnt(5)
    v_mfma_f32_32x32x16_bf16 v[64:79], v[40:43], v[32:35], v[64:79]
    v_mfma_f32_32x32x16_bf16 v[80:95], v[44:47], v[32:35], v[80:95]
    ds_read_b128 v[32:35], v131 offset:0
    ds_read_b64_tr_b16 v[40:41], v132 offset:6144
    ds_read_b64_tr_b16 v[42:43], v132 offset:6656
    ds_read_b64_tr_b16 v[44:45], v133 offset:6144
    ds_read_b64_tr_b16 v[46:47], v133 offset:6656
    s_waitcnt lgkmcnt(5)
    v_mfma_f32_32x32x16_bf16 v[64:79], v[24:27], v[16:19], v[64:79]
    v_mfma_f32_32x32x16_bf16 v[80:95], v[28:31], v[16:19], v[80:95]
    s_waitcnt lgkmcnt(0)
    v_mfma_f32_32x32x16_bf16 v[64:79], v[40:43], v[32:35], v[64:79]
    v_mfma_f32_32x32x16_bf16 v[80:95], v[44:47], v[32:35], v[80:95]
    s_waitcnt vmcnt(0)
    s_barrier
    ds_read_b128 v[16:19], v128 offset:24576
    ds_read_b64_tr_b16 v[24:25], v132 offset:24576
    ds_read_b64_tr_b16 v[26:27], v132 offset:25088
    ds_read_b64_tr_b16 v[28:29], v133 offset:24576
    ds_read_b64_tr_b16 v[30:31], v133 offset:25088
    ds_read_b128 v[32:35], v129 offset:24576
    ds_read_b64_tr_b16 v[40:41], v132 offset:26624
    ds_read_b64_tr_b16 v[42:43], v132 offset:27136
    ds_read_b64_tr_b16 v[44:45], v133 offset:26624
    ds_read_b64_tr_b16 v[46:47], v133 offset:27136
    s_waitcnt lgkmcnt(5)
    v_mfma_f32_32x32x16_bf16 v[64:79], v[24:27], v[16:19], v[64:79]
    v_mfma_f32_32x32x16_bf16 v[80:95], v[28:31], v[16:19], v[80:95]
    ds_read_b128 v[16:19], v130 offset:24576
    ds_read_b64_tr_b16 v[24:25], v132 offset:28672
    ds_read_b64_tr_b16 v[26:27], v132 offset:29184
    ds_read_b64_tr_b16 v[28:29], v133 offset:28672
    ds_read_b64_tr_b16 v[30:31], v133 offset:29184
    s_waitcnt lgkmcnt(5)
    v_mfma_f32_32x32x16_bf16 v[64:79], v[40:43], v[32:35], v[64:79]
    v_mfma_f32_32x32x16_bf16 v[80:95], v[44:47], v[32:35], v[80:95]
    ds_read_b128 v[32:35], v131 offset:24576
    ds_read_b64_tr_b16 v[40:41], v132 offset:30720
    ds_read_b64_tr_b16 v[42:43], v132 offset:31232
    ds_read_b64_tr_b16 v[44:45], v133 offset:30720
    ds_read_b64_tr_b16 v[46:47], v133 offset:31232
    s_waitcnt lgkmcnt(5)
    v_mfma_f32_32x32x16_bf16 v[64:79], v[24:27], v[16:19], v[64:79]
    v_mfma_f32_32x32x16_bf16 v[80:95], v[28:31], v[16:19], v[80:95]
    s_waitcnt lgkmcnt(0)
    v_mfma_f32_32x32x16_bf16 v[64:79], v[40:43], v[32:35], v[64:79]
    v_mfma_f32_32x32x16_bf16 v[80:95], v[44:47], v[32:35], v[80:95]
    s_nop 15
    v_and_b32 v48, 63, v0
    v_lshrrev_b32 v49, 6, v0
    v_lshrrev_b32 v53, 1, v49
    v_and_b32 v54, 1, v49
    v_and_b32 v55, 31, v48
    v_lshrrev_b32 v56, 5, v48
    s_mov_b64 s[16:17], s[74:75]
    s_and_b32 s17, s17, 0xffff
    s_mov_b32 s18, 2621440
    s_mov_b32 s19, 0x00020000
    s_mul_i32 s12, s13, 64
    v_mul_u32_u24 v57, 32, v53
    v_add_u32 v57, v57, v55
    v_add_u32 v57, s12, v57
    s_mov_b32 s12, 1280
    v_mul_lo_u32 v57, v57, s12
    v_lshlrev_b32 v58, 6, v54
    v_lshlrev_b32 v59, 2, v56
    v_add_u32 v58, v58, v59
    s_lshl_b32 s12, s14, 7
    v_add_u32 v58, s12, v58
    v_lshlrev_b32 v59, 1, v58
    v_add_u32 v57, v57, v59
    s_mov_b64 s[20:21], s[78:79]
    s_add_u32 s20, s20, 131514368
    s_addc_u32 s21, s21, 0
    s_and_b32 s21, s21, 0xffff
    s_mov_b32 s22, 2621440
    s_mov_b32 s23, 0x00020000
    s_mov_b64 s[24:25], s[78:79]
    s_add_u32 s24, s24, 12800
    s_addc_u32 s25, s25, 0
    s_and_b32 s25, s25, 0xffff
    s_mov_b32 s26, 2560
    s_mov_b32 s27, 0x00020000
    v_lshlrev_b32 v59, 2, v58
    buffer_load_dwordx4 v[16:19], v59, s[24:27], 0 offen offset:0
    buffer_load_dwordx4 v[20:23], v59, s[24:27], 0 offen offset:32
    buffer_load_dwordx4 v[24:27], v59, s[24:27], 0 offen offset:64
    buffer_load_dwordx4 v[28:31], v59, s[24:27], 0 offen offset:96
    buffer_load_dwordx4 v[32:35], v59, s[24:27], 0 offen offset:128
    buffer_load_dwordx4 v[36:39], v59, s[24:27], 0 offen offset:160
    buffer_load_dwordx4 v[40:43], v59, s[24:27], 0 offen offset:192
    buffer_load_dwordx4 v[44:47], v59, s[24:27], 0 offen offset:224
    s_mov_b32 s12, 0
    buffer_load_dwordx2 v[4:5], v57, s[20:23], s12 offen offset:0
    buffer_load_dwordx2 v[6:7], v57, s[20:23], s12 offen offset:16
    buffer_load_dwordx2 v[8:9], v57, s[20:23], s12 offen offset:32
    buffer_load_dwordx2 v[10:11], v57, s[20:23], s12 offen offset:48
    s_waitcnt vmcnt(0)
    v_cvt_pk_bf16_f32 v64, v64, v64
    v_and_b32 v64, 0xffff0000, v64
    v_mul_f32 v64, v64, v16
    v_cvt_pk_bf16_f32 v64, v64, v64
    v_and_b32 v64, 0xffff0000, v64
    v_lshlrev_b32 v62, 16, v4
    v_add_f32 v64, v64, v62
    v_cvt_pk_bf16_f32 v65, v65, v65
    v_and_b32 v65, 0xffff0000, v65
    v_mul_f32 v65, v65, v17
    v_cvt_pk_bf16_f32 v65, v65, v65
    v_and_b32 v65, 0xffff0000, v65
    v_and_b32 v62, 0xffff0000, v4
    v_add_f32 v65, v65, v62
    v_cvt_pk_bf16_f32 v66, v66, v66
    v_and_b32 v66, 0xffff0000, v66
    v_mul_f32 v66, v66, v18
    v_cvt_pk_bf16_f32 v66, v66, v66
    v_and_b32 v66, 0xffff0000, v66
    v_lshlrev_b32 v62, 16, v5
    v_add_f32 v66, v66, v62
    v_cvt_pk_bf16_f32 v67, v67, v67
    v_and_b32 v67, 0xffff0000, v67
    v_mul_f32 v67, v67, v19
    v_cvt_pk_bf16_f32 v67, v67, v67
    v_and_b32 v67, 0xffff0000, v67
    v_and_b32 v62, 0xffff0000, v5
    v_add_f32 v67, v67, v62
    v_cvt_pk_bf16_f32 v60, v64, v65
    v_cvt_pk_bf16_f32 v61, v66, v67
    buffer_store_dwordx2 v[60:61], v57, s[16:19], s12 offen offset:0
    s_nop 0
    v_cvt_pk_bf16_f32 v68, v68, v68
    v_and_b32 v68, 0xffff0000, v68
    v_mul_f32 v68, v68, v20
    v_cvt_pk_bf16_f32 v68, v68, v68
    v_and_b32 v68, 0xffff0000, v68
    v_lshlrev_b32 v62, 16, v6
    v_add_f32 v68, v68, v62
    v_cvt_pk_bf16_f32 v69, v69, v69
    v_and_b32 v69, 0xffff0000, v69
    v_mul_f32 v69, v69, v21
    v_cvt_pk_bf16_f32 v69, v69, v69
    v_and_b32 v69, 0xffff0000, v69
    v_and_b32 v62, 0xffff0000, v6
    v_add_f32 v69, v69, v62
    v_cvt_pk_bf16_f32 v70, v70, v70
    v_and_b32 v70, 0xffff0000, v70
    v_mul_f32 v70, v70, v22
    v_cvt_pk_bf16_f32 v70, v70, v70
    v_and_b32 v70, 0xffff0000, v70
    v_lshlrev_b32 v62, 16, v7
    v_add_f32 v70, v70, v62
    v_cvt_pk_bf16_f32 v71, v71, v71
    v_and_b32 v71, 0xffff0000, v71
    v_mul_f32 v71, v71, v23
    v_cvt_pk_bf16_f32 v71, v71, v71
    v_and_b32 v71, 0xffff0000, v71
    v_and_b32 v62, 0xffff0000, v7
    v_add_f32 v71, v71, v62
    v_cvt_pk_bf16_f32 v60, v68, v69
    v_cvt_pk_bf16_f32 v61, v70, v71
    buffer_store_dwordx2 v[60:61], v57, s[16:19], s12 offen offset:16
    s_nop 0
    v_cvt_pk_bf16_f32 v72, v72, v72
    v_and_b32 v72, 0xffff0000, v72
    v_mul_f32 v72, v72, v24
    v_cvt_pk_bf16_f32 v72, v72, v72
    v_and_b32 v72, 0xffff0000, v72
    v_lshlrev_b32 v62, 16, v8
    v_add_f32 v72, v72, v62
    v_cvt_pk_bf16_f32 v73, v73, v73
    v_and_b32 v73, 0xffff0000, v73
    v_mul_f32 v73, v73, v25
    v_cvt_pk_bf16_f32 v73, v73, v73
    v_and_b32 v73, 0xffff0000, v73
    v_and_b32 v62, 0xffff0000, v8
    v_add_f32 v73, v73, v62
    v_cvt_pk_bf16_f32 v74, v74, v74
    v_and_b32 v74, 0xffff0000, v74
    v_mul_f32 v74, v74, v26
    v_cvt_pk_bf16_f32 v74, v74, v74
    v_and_b32 v74, 0xffff0000, v74
    v_lshlrev_b32 v62, 16, v9
    v_add_f32 v74, v74, v62
    v_cvt_pk_bf16_f32 v75, v75, v75
    v_and_b32 v75, 0xffff0000, v75
    v_mul_f32 v75, v75, v27
    v_cvt_pk_bf16_f32 v75, v75, v75
    v_and_b32 v75, 0xffff0000, v75
    v_and_b32 v62, 0xffff0000, v9
    v_add_f32 v75, v75, v62
    v_cvt_pk_bf16_f32 v60, v72, v73
    v_cvt_pk_bf16_f32 v61, v74, v75
    buffer_store_dwordx2 v[60:61], v57, s[16:19], s12 offen offset:32
    s_nop 0
    v_cvt_pk_bf16_f32 v76, v76, v76
    v_and_b32 v76, 0xffff0000, v76
    v_mul_f32 v76, v76, v28
    v_cvt_pk_bf16_f32 v76, v76, v76
    v_and_b32 v76, 0xffff0000, v76
    v_lshlrev_b32 v62, 16, v10
    v_add_f32 v76, v76, v62
    v_cvt_pk_bf16_f32 v77, v77, v77
    v_and_b32 v77, 0xffff0000, v77
    v_mul_f32 v77, v77, v29
    v_cvt_pk_bf16_f32 v77, v77, v77
    v_and_b32 v77, 0xffff0000, v77
    v_and_b32 v62, 0xffff0000, v10
    v_add_f32 v77, v77, v62
    v_cvt_pk_bf16_f32 v78, v78, v78
    v_and_b32 v78, 0xffff0000, v78
    v_mul_f32 v78, v78, v30
    v_cvt_pk_bf16_f32 v78, v78, v78
    v_and_b32 v78, 0xffff0000, v78
    v_lshlrev_b32 v62, 16, v11
    v_add_f32 v78, v78, v62
    v_cvt_pk_bf16_f32 v79, v79, v79
    v_and_b32 v79, 0xffff0000, v79
    v_mul_f32 v79, v79, v31
    v_cvt_pk_bf16_f32 v79, v79, v79
    v_and_b32 v79, 0xffff0000, v79
    v_and_b32 v62, 0xffff0000, v11
    v_add_f32 v79, v79, v62
    v_cvt_pk_bf16_f32 v60, v76, v77
    v_cvt_pk_bf16_f32 v61, v78, v79
    buffer_store_dwordx2 v[60:61], v57, s[16:19], s12 offen offset:48
    s_nop 0
    s_mov_b32 s12, 64
    buffer_load_dwordx2 v[4:5], v57, s[20:23], s12 offen offset:0
    buffer_load_dwordx2 v[6:7], v57, s[20:23], s12 offen offset:16
    buffer_load_dwordx2 v[8:9], v57, s[20:23], s12 offen offset:32
    buffer_load_dwordx2 v[10:11], v57, s[20:23], s12 offen offset:48
    s_waitcnt vmcnt(0)
    v_cvt_pk_bf16_f32 v80, v80, v80
    v_and_b32 v80, 0xffff0000, v80
    v_mul_f32 v80, v80, v32
    v_cvt_pk_bf16_f32 v80, v80, v80
    v_and_b32 v80, 0xffff0000, v80
    v_lshlrev_b32 v62, 16, v4
    v_add_f32 v80, v80, v62
    v_cvt_pk_bf16_f32 v81, v81, v81
    v_and_b32 v81, 0xffff0000, v81
    v_mul_f32 v81, v81, v33
    v_cvt_pk_bf16_f32 v81, v81, v81
    v_and_b32 v81, 0xffff0000, v81
    v_and_b32 v62, 0xffff0000, v4
    v_add_f32 v81, v81, v62
    v_cvt_pk_bf16_f32 v82, v82, v82
    v_and_b32 v82, 0xffff0000, v82
    v_mul_f32 v82, v82, v34
    v_cvt_pk_bf16_f32 v82, v82, v82
    v_and_b32 v82, 0xffff0000, v82
    v_lshlrev_b32 v62, 16, v5
    v_add_f32 v82, v82, v62
    v_cvt_pk_bf16_f32 v83, v83, v83
    v_and_b32 v83, 0xffff0000, v83
    v_mul_f32 v83, v83, v35
    v_cvt_pk_bf16_f32 v83, v83, v83
    v_and_b32 v83, 0xffff0000, v83
    v_and_b32 v62, 0xffff0000, v5
    v_add_f32 v83, v83, v62
    v_cvt_pk_bf16_f32 v60, v80, v81
    v_cvt_pk_bf16_f32 v61, v82, v83
    buffer_store_dwordx2 v[60:61], v57, s[16:19], s12 offen offset:0
    s_nop 0
    v_cvt_pk_bf16_f32 v84, v84, v84
    v_and_b32 v84, 0xffff0000, v84
    v_mul_f32 v84, v84, v36
    v_cvt_pk_bf16_f32 v84, v84, v84
    v_and_b32 v84, 0xffff0000, v84
    v_lshlrev_b32 v62, 16, v6
    v_add_f32 v84, v84, v62
    v_cvt_pk_bf16_f32 v85, v85, v85
    v_and_b32 v85, 0xffff0000, v85
    v_mul_f32 v85, v85, v37
    v_cvt_pk_bf16_f32 v85, v85, v85
    v_and_b32 v85, 0xffff0000, v85
    v_and_b32 v62, 0xffff0000, v6
    v_add_f32 v85, v85, v62
    v_cvt_pk_bf16_f32 v86, v86, v86
    v_and_b32 v86, 0xffff0000, v86
    v_mul_f32 v86, v86, v38
    v_cvt_pk_bf16_f32 v86, v86, v86
    v_and_b32 v86, 0xffff0000, v86
    v_lshlrev_b32 v62, 16, v7
    v_add_f32 v86, v86, v62
    v_cvt_pk_bf16_f32 v87, v87, v87
    v_and_b32 v87, 0xffff0000, v87
    v_mul_f32 v87, v87, v39
    v_cvt_pk_bf16_f32 v87, v87, v87
    v_and_b32 v87, 0xffff0000, v87
    v_and_b32 v62, 0xffff0000, v7
    v_add_f32 v87, v87, v62
    v_cvt_pk_bf16_f32 v60, v84, v85
    v_cvt_pk_bf16_f32 v61, v86, v87
    buffer_store_dwordx2 v[60:61], v57, s[16:19], s12 offen offset:16
    s_nop 0
    v_cvt_pk_bf16_f32 v88, v88, v88
    v_and_b32 v88, 0xffff0000, v88
    v_mul_f32 v88, v88, v40
    v_cvt_pk_bf16_f32 v88, v88, v88
    v_and_b32 v88, 0xffff0000, v88
    v_lshlrev_b32 v62, 16, v8
    v_add_f32 v88, v88, v62
    v_cvt_pk_bf16_f32 v89, v89, v89
    v_and_b32 v89, 0xffff0000, v89
    v_mul_f32 v89, v89, v41
    v_cvt_pk_bf16_f32 v89, v89, v89
    v_and_b32 v89, 0xffff0000, v89
    v_and_b32 v62, 0xffff0000, v8
    v_add_f32 v89, v89, v62
    v_cvt_pk_bf16_f32 v90, v90, v90
    v_and_b32 v90, 0xffff0000, v90
    v_mul_f32 v90, v90, v42
    v_cvt_pk_bf16_f32 v90, v90, v90
    v_and_b32 v90, 0xffff0000, v90
    v_lshlrev_b32 v62, 16, v9
    v_add_f32 v90, v90, v62
    v_cvt_pk_bf16_f32 v91, v91, v91
    v_and_b32 v91, 0xffff0000, v91
    v_mul_f32 v91, v91, v43
    v_cvt_pk_bf16_f32 v91, v91, v91
    v_and_b32 v91, 0xffff0000, v91
    v_and_b32 v62, 0xffff0000, v9
    v_add_f32 v91, v91, v62
    v_cvt_pk_bf16_f32 v60, v88, v89
    v_cvt_pk_bf16_f32 v61, v90, v91
    buffer_store_dwordx2 v[60:61], v57, s[16:19], s12 offen offset:32
    s_nop 0
    v_cvt_pk_bf16_f32 v92, v92, v92
    v_and_b32 v92, 0xffff0000, v92
    v_mul_f32 v92, v92, v44
    v_cvt_pk_bf16_f32 v92, v92, v92
    v_and_b32 v92, 0xffff0000, v92
    v_lshlrev_b32 v62, 16, v10
    v_add_f32 v92, v92, v62
    v_cvt_pk_bf16_f32 v93, v93, v93
    v_and_b32 v93, 0xffff0000, v93
    v_mul_f32 v93, v93, v45
    v_cvt_pk_bf16_f32 v93, v93, v93
    v_and_b32 v93, 0xffff0000, v93
    v_and_b32 v62, 0xffff0000, v10
    v_add_f32 v93, v93, v62
    v_cvt_pk_bf16_f32 v94, v94, v94
    v_and_b32 v94, 0xffff0000, v94
    v_mul_f32 v94, v94, v46
    v_cvt_pk_bf16_f32 v94, v94, v94
    v_and_b32 v94, 0xffff0000, v94
    v_lshlrev_b32 v62, 16, v11
    v_add_f32 v94, v94, v62
    v_cvt_pk_bf16_f32 v95, v95, v95
    v_and_b32 v95, 0xffff0000, v95
    v_mul_f32 v95, v95, v47
    v_cvt_pk_bf16_f32 v95, v95, v95
    v_and_b32 v95, 0xffff0000, v95
    v_and_b32 v62, 0xffff0000, v11
    v_add_f32 v95, v95, v62
    v_cvt_pk_bf16_f32 v60, v92, v93
    v_cvt_pk_bf16_f32 v61, v94, v95
    buffer_store_dwordx2 v[60:61], v57, s[16:19], s12 offen offset:48
    s_nop 0
    s_waitcnt vmcnt(0)
    s_barrier
    s_add_u32 s91, s91, 1
    s_cmp_lt_u32 s91, 16
    s_cbranch_scc1 mega_kernel_lf283
mega_kernel_done1:
    s_endpgm

.section .rodata,"a"
.p2align 6
.amdhsa_kernel mod_kernel
  .amdhsa_next_free_vgpr 240
  .amdhsa_next_free_sgpr 64
  .amdhsa_accum_offset 240
  .amdhsa_group_segment_fixed_size 0
  .amdhsa_kernarg_size 128
  .amdhsa_user_sgpr_count 2
  .amdhsa_user_sgpr_kernarg_segment_ptr 1
  .amdhsa_system_sgpr_workgroup_id_x 1
  .amdhsa_float_denorm_mode_32 3
.end_amdhsa_kernel

.p2align 6
.amdhsa_kernel mega_kernel
  .amdhsa_next_free_vgpr 512
  .amdhsa_next_free_sgpr 102
  .amdhsa_accum_offset 256
  .amdhsa_group_segment_fixed_size 0
  .amdhsa_kernarg_size 128
  .amdhsa_user_sgpr_count 2
  .amdhsa_user_sgpr_kernarg_segment_ptr 1
  .amdhsa_system_sgpr_workgroup_id_x 1
  .amdhsa_float_denorm_mode_32 3
.end_amdhsa_kernel
```
